```python
import torch

def _softmax(x, axis=-1):
    return torch.softmax(x, dim=axis)

def _gelu(x):
    return torch.nn.functional.gelu(x, approximate='tanh')

def _silu(x):
    return torch.nn.functional.silu(x)

def _sigmoid(x):
    return torch.sigmoid(x)

def _layernorm(x, axis=-1, eps=1e-05):
    m = x.mean(dim=axis, keepdim=True)
    v = x.var(dim=axis, keepdim=True, unbiased=False)
    return (x - m) / torch.sqrt(v + eps)

def _scatter_add(tgt, idx, src, axis=0):
    return tgt.clone().index_add_(axis, idx, src)

def _segment_sum(src, seg, n):
    out = torch.zeros((n,) + src.shape[1:], dtype=src.dtype)
    return out.index_add_(0, seg, src)

def _pad(x, pw):
    flat = tuple((v for pair in reversed(pw) for v in pair))
    return torch.nn.functional.pad(x, flat)
kernel_name = 'recurrent_scan__memory_aug_recurrent_mem_tr__glu_gated_reglu__prompt'

def setup_inputs():

    _w = lambda a: (lambda t: t.to(torch.bfloat16) if t.is_floating_point() else t)(torch.as_tensor(a))

    def _A_setup():
        B, S, Dm = (1, 2048, 1024)
        H, Dh = (32, 128)
        M, seg = (8, 32)
        seg = min(seg, S)
        S = S // seg * seg
        return {'x': _w((lambda *s: torch.randn(*s, dtype=torch.bfloat16) * 0.1)(B, S, Dm)), 'mem0': _w((lambda *s: torch.randn(*s, dtype=torch.bfloat16) * 1.6)(B, M, Dm)), 'Wq': _w((lambda *s: torch.randn(*s, dtype=torch.bfloat16) * 0.8)(Dm, H, Dh) * Dm ** (-0.5)), 'Wk': _w((lambda *s: torch.randn(*s, dtype=torch.bfloat16) * 0.8)(Dm, H, Dh) * Dm ** (-0.5)), 'Wv': _w((lambda *s: torch.randn(*s, dtype=torch.bfloat16) * 1.6)(Dm, H, Dh) * Dm ** (-0.5)), 'Wo': _w((lambda *s: torch.randn(*s, dtype=torch.bfloat16) * 1.6)(H, Dh, Dm) * (H * Dh) ** (-0.5)), 'seg_len': seg}
    _A_in = _A_setup()

    def _B_setup():
        B, S, D, F = (1, 2048, 1024, 3584)
        return {'x': _w((lambda *s: torch.randn(*s, dtype=torch.bfloat16) * 0.1)(B, S, D)), 'W_gate': _w((lambda *s: torch.randn(*s, dtype=torch.bfloat16) * 0.4)(D, F) * (2.0 / D) ** 0.5), 'W_up': _w((lambda *s: torch.randn(*s, dtype=torch.bfloat16) * 0.4)(D, F) * (2.0 / D) ** 0.5), 'W_down': _w((lambda *s: torch.randn(*s, dtype=torch.bfloat16) * 0.4)(F, D) * (1.0 / F) ** 0.5)}
    _B_in = _B_setup()
    return {'A_x': _A_in['x'], 'A_mem0': _A_in['mem0'], 'A_Wq': _A_in['Wq'], 'A_Wk': _A_in['Wk'], 'A_Wv': _A_in['Wv'], 'A_Wo': _A_in['Wo'], 'A_seg_len': _A_in['seg_len'], 'B_x': _B_in['x'], 'B_W_gate': _B_in['W_gate'], 'B_W_up': _B_in['W_up'], 'B_W_down': _B_in['W_down']}

def reference(A_x, A_mem0, A_Wq, A_Wk, A_Wv, A_Wo, A_seg_len, B_x, B_W_gate, B_W_up, B_W_down):

    def _A_ref(x, mem0, Wq, Wk, Wv, Wo, seg_len):
        B, S, Dm = x.shape
        H, Dh = (Wq.shape[1], Wq.shape[2])
        M = mem0.shape[1]
        scale = Dh ** (-0.5)
        n_seg = S // seg_len
        L = M + seg_len
        idx = torch.arange(L)
        mask = (idx[:, None] < M) | (idx[:, None] >= idx[None, :])
        mem = mem0
        outs = []
        for s in range(n_seg):
            xs = x[:, s * seg_len:(s + 1) * seg_len, :].clone()
            h = torch.concatenate([mem, xs], axis=1)
            q = torch.einsum('btd,dhe->bhte', h, Wq)
            k = torch.einsum('btd,dhe->bhte', h, Wk)
            v = torch.einsum('btd,dhe->bhte', h, Wv)
            scores = torch.einsum('bhqe,bhke->bhqk', q, k) * scale
            scores = torch.where(mask[None, None], scores, -1000000000.0)
            p = _softmax(scores, axis=-1)
            o = torch.einsum('bhqk,bhke->bhqe', p, v)
            o = torch.einsum('bhte,hed->btd', o, Wo)
            mem = o[:, :M, :].clone()
            outs.append(o[:, M:, :])
        return torch.concatenate(outs, axis=1)

    def _B_ref(x, W_gate, W_up, W_down):
        gate = torch.einsum('bsd,df->bsf', x, W_gate)
        up = torch.einsum('bsd,df->bsf', x, W_up)
        gate = gate * (lambda x, dt: x.to(dt))(gate > 0, gate.dtype)
        h = gate * up
        return torch.einsum('bsf,fd->bsd', h, W_down)
    x = A_x
    xn = _layernorm(x, axis=-1)
    s = _A_ref(xn, A_mem0, A_Wq, A_Wk, A_Wv, A_Wo, A_seg_len)
    g = _silu(_B_ref(xn, B_W_gate, B_W_up, B_W_down))
    return x + s * g
```

```asm
; @launch grid=(256,1,1) block=(256,1,1) lds=163840
.amdgcn_target "amdgcn-amd-amdhsa--gfx950"
.text
.globl recurrent_scan__memory_aug_recurrent_mem_tr__glu_gated_reglu__prompt_kernel
.p2align 8
.type recurrent_scan__memory_aug_recurrent_mem_tr__glu_gated_reglu__prompt_kernel,@function
recurrent_scan__memory_aug_recurrent_mem_tr__glu_gated_reglu__prompt_kernel:
    s_cmp_ge_u32 s2, 256
    s_cbranch_scc1 L_exit
    s_load_dwordx2 s[8:9], s[0:1], 104
    s_load_dwordx2 s[64:65], s[0:1], 96
    s_mov_b32 s10, 268435456
    s_mov_b32 s11, 0x20000
    s_mov_b32 s66, 256
    s_mov_b32 s67, 0x20000
    v_lshrrev_b32 v1, 6, v0
    v_and_b32 v0, 63, v0
    s_getreg_b32 s4, hwreg(HW_REG_XCC_ID, 0, 4)
    v_readfirstlane_b32 s3, v1
    s_and_b32 s4, s4, 7
    s_and_b32 s5, s4, 3
    s_lshr_b32 s6, s4, 2
    s_lshl_b32 s6, s6, 5
    s_add_u32 s5, s5, s6
    s_lshl_b32 s5, s5, 2
    v_mov_b32 v1, s5
    v_mov_b32 v2, 1
    v_mov_b32 v3, 131080
    s_cmp_lg_u32 s3, 0
    s_waitcnt lgkmcnt(0)
    s_cbranch_scc1 L_notk
    v_cmp_eq_u32 vcc, 0, v0
    s_and_saveexec_b64 s[6:7], vcc
    buffer_atomic_add v2, v1, s[64:67], 0 offen sc0 sc1
    s_waitcnt vmcnt(0)
    ds_write_b32 v3, v2
    s_mov_b64 exec, s[6:7]
L_notk:
    s_waitcnt lgkmcnt(0)
    s_barrier
    ds_read_b32 v2, v3
    s_lshl_b32 s6, 1, s4
    s_sub_u32 s6, s6, 1
    s_lshr_b32 s7, 85, s4
    s_and_b32 s7, s7, 1
    s_mov_b32 s5, 85
    s_cmp_eq_u32 s7, 1
    s_cselect_b32 s5, s5, 170
    s_and_b32 s6, s6, s5
    s_bcnt1_i32_b32 s90, s6
    s_and_b32 s90, s90, 3
    s_waitcnt lgkmcnt(0)
    v_readfirstlane_b32 s5, v2
    s_cmp_ge_u32 s5, 32
    s_cbranch_scc1 L_exit
    s_lshl_b32 s91, s90, 5
    s_add_u32 s91, s91, s5
    s_lshl_b32 s6, s7, 7
    s_add_u32 s92, s91, s6
    s_mov_b32 s93, 0
    s_cmp_eq_u32 s7, 0
    s_cbranch_scc1 L_G
    s_mov_b32 s20, 400000
    s_lshr_b32 s16, s91, 4
    s_and_b32 s17, s91, 15
    s_lshr_b32 s4, s17, 2
    s_lshl_b32 s18, s16, 2
    s_add_u32 s18, s18, s4
    s_and_b32 s36, s17, 3
    s_and_b32 s75, s16, 1
    v_and_b32 v1, 15, v0
    v_lshrrev_b32 v2, 4, v0
    v_lshlrev_b32 v9, 4, v0
    s_lshl_b32 s4, s3, 12
    v_add_u32 v8, s4, v9
    s_lshl_b32 s4, s3, 11
    v_add_u32 v13, s4, v9
    s_lshl_b32 s4, s3, 10
    v_add_u32 v16, s4, v9
    v_lshlrev_b32 v3, 2, v2
    v_and_b32 v4, 1, v1
    v_lshlrev_b32 v4, 1, v4
    v_add_u32 v3, v3, v4
    v_lshrrev_b32 v4, 3, v1
    v_add_u32 v6, v3, v4
    v_lshlrev_b32 v4, 4, v6
    v_bfe_u32 v5, v1, 1, 2
    v_lshlrev_b32 v5, 2, v5
    v_add_u32 v4, v4, v5
    s_lshl_b32 s4, s17, 10
    s_lshl_b32 s5, s75, 9
    s_add_u32 s4, s4, s5
    s_lshl_b32 s5, s3, 7
    s_add_u32 s4, s4, s5
    v_add_u32 v4, s4, v4
    v_mov_b32 v5, 0x80000000
    v_cmp_gt_u32 vcc, 32, v0
    s_nop 1
    v_cndmask_b32 v10, v5, v4, vcc
    v_and_b32 v3, 1, v2
    v_lshlrev_b32 v3, 2, v3
    v_lshrrev_b32 v4, 1, v2
    v_lshlrev_b32 v4, 1, v4
    v_add_u32 v3, v3, v4
    v_and_b32 v4, 1, v1
    v_add_u32 v3, v3, v4
    v_lshrrev_b32 v4, 2, v1
    v_lshlrev_b32 v4, 8, v4
    v_lshlrev_b32 v5, 4, v3
    v_add_u32 v4, v4, v5
    v_bfe_u32 v5, v1, 1, 1
    v_lshlrev_b32 v5, 2, v5
    v_add_u32 v4, v4, v5
    s_lshl_b32 s4, s36, 10
    s_lshr_b32 s5, s3, 1
    s_xor_b32 s5, s5, 1
    s_lshl_b32 s5, s5, 7
    s_add_u32 s4, s4, s5
    s_and_b32 s5, s3, 1
    s_lshl_b32 s5, s5, 3
    s_add_u32 s4, s4, s5
    v_add_u32 v11, s4, v4
    v_lshrrev_b32 v4, 2, v1
    v_lshlrev_b32 v4, 7, v4
    v_lshlrev_b32 v5, 4, v3
    v_add_u32 v4, v4, v5
    v_bfe_u32 v5, v1, 1, 1
    v_lshlrev_b32 v5, 2, v5
    v_add_u32 v4, v4, v5
    s_and_b32 s5, s3, 1
    s_lshl_b32 s4, s5, 3
    v_add_u32 v4, s4, v4
    v_lshlrev_b32 v5, 2, v0
    s_lshl_b32 s4, s5, 8
    v_add_u32 v5, s4, v5
    v_add_u32 v33, 25600, v4
    v_add_u32 v34, 26112, v5
    s_lshl_b32 s4, s18, 12
    s_lshl_b32 s5, s36, 10
    s_add_u32 s4, s4, s5
    s_add_u32 s4, s4, 88080384
    v_add_u32 v35, s4, v9
    v_mov_b32 v24, -1
    v_mov_b32 v25, -1
    v_mov_b32 v26, -1
    v_mov_b32 v27, -1
    s_lshl_b32 s4, s17, 10
    s_lshl_b32 s5, s75, 9
    s_add_u32 s4, s4, s5
    v_add_u32 v4, s4, v9
    v_mov_b32 v5, 0x80000000
    v_cmp_gt_u32 vcc, 32, v0
    s_nop 1
    v_cndmask_b32 v7, v5, v4, vcc
    v_lshrrev_b32 v4, 3, v0
    v_lshlrev_b32 v4, 10, v4
    v_and_b32 v5, 7, v0
    v_lshlrev_b32 v5, 4, v5
    v_add_u32 v4, v4, v5
    s_lshl_b32 s4, s17, 13
    s_lshl_b32 s5, s16, 7
    s_add_u32 s4, s4, s5
    v_add_u32 v4, s4, v4
    s_cmp_eq_u32 s3, 0
    s_cselect_b64 vcc, -1, 0
    v_cndmask_b32 v30, v4, v7, vcc
    s_lshl_b32 s4, s36, 10
    v_add_u32 v31, s4, v9
    s_lshr_b32 s4, s17, 2
    s_lshl_b32 s4, s4, 1
    s_lshr_b32 s5, s36, 1
    s_add_u32 s4, s4, s5
    s_lshl_b32 s4, s4, 10
    s_and_b32 s5, s36, 1
    s_lshl_b32 s5, s5, 7
    s_add_u32 s4, s4, s5
    v_lshrrev_b32 v4, 3, v0
    v_lshlrev_b32 v4, 8, v4
    v_and_b32 v5, 7, v0
    v_lshlrev_b32 v5, 4, v5
    v_add_u32 v4, v4, v5
    v_add_u32 v4, s4, v4
    v_mov_b32 v5, 0x80000000
    v_cmp_gt_u32 vcc, 32, v0
    s_nop 1
    v_cndmask_b32 v32, v5, v4, vcc
    s_lshr_b32 s4, s17, 2
    s_lshl_b32 s4, s4, 1
    s_lshr_b32 s5, s36, 1
    s_add_u32 s4, s4, s5
    s_lshl_b32 s4, s4, 10
    s_and_b32 s5, s36, 1
    s_lshl_b32 s5, s5, 7
    s_add_u32 s4, s4, s5
    s_and_b32 s5, s3, 1
    s_lshl_b32 s5, s5, 3
    s_add_u32 s4, s4, s5
    v_lshlrev_b32 v4, 8, v2
    v_lshlrev_b32 v5, 4, v1
    v_add_u32 v4, v4, v5
    v_add_u32 v4, s4, v4
    v_mov_b32 v5, 0x80000000
    v_cmp_gt_u32 vcc, 8, v1
    s_nop 1
    v_cndmask_b32 v12, v5, v4, vcc
    v_lshrrev_b32 v4, 3, v1
    v_lshlrev_b32 v4, 10, v4
    v_and_b32 v5, 7, v1
    v_lshlrev_b32 v5, 4, v5
    v_add_u32 v4, v4, v5
    v_lshlrev_b32 v5, 3, v2
    v_add_u32 v4, v4, v5
    s_lshl_b32 s4, s17, 13
    s_lshl_b32 s5, s3, 11
    s_add_u32 s4, s4, s5
    s_lshl_b32 s5, s16, 7
    s_add_u32 s4, s4, s5
    v_add_u32 v4, s4, v4
    v_mov_b32 v5, 0x80000000
    v_cmp_gt_u32 vcc, 16, v0
    s_nop 1
    v_cndmask_b32 v14, v5, v4, vcc
    s_lshl_b32 s4, s17, 13
    s_lshl_b32 s5, s75, 12
    s_add_u32 s4, s4, s5
    s_lshl_b32 s5, s3, 10
    s_add_u32 s4, s4, s5
    v_add_u32 v15, s4, v9
    v_lshlrev_b32 v4, 12, v2
    v_lshlrev_b32 v5, 4, v1
    v_add_u32 v17, v4, v5
    v_lshlrev_b32 v4, 16, v2
    v_add_u32 v18, v4, v5
    v_mov_b32 v4, 0x44444444
    v_mov_b32 v5, 0xeeeeeeee
    v_cmp_gt_u32 vcc, 8, v1
    s_nop 1
    v_cndmask_b32 v19, v5, v4, vcc
    v_and_b32 v4, 1, v1
    v_cmp_eq_u32 vcc, 0, v4
    v_mov_b32 v4, 0x01000504
    v_mov_b32 v5, 0x07060302
    v_cndmask_b32 v20, v5, v4, vcc
    v_mov_b32 v4, 0x01000504
    v_mov_b32 v5, 0x05040100
    v_cndmask_b32 v4, v5, v4, vcc
    v_lshrrev_b32 v5, 3, v1
    v_mul_u32_u24 v5, 0x020202, v5
    v_lshrrev_b32 v7, 3, v1
    v_lshlrev_b32 v7, 25, v7
    v_add_u32 v5, v5, v7
    v_add_u32 v21, v4, v5
    s_mov_b32 s26, 0xaaaaaaaa
    s_mov_b32 s27, 0xaaaaaaaa
    v_mov_b32 v4, 0
    v_mov_b32 v5, 0x3f80
    v_cmp_eq_u32 vcc, 0, v1
    s_nop 1
    v_cndmask_b32 v4, v4, v5, vcc
    v_mov_b32 v5, 0x3f800000
    v_cmp_eq_u32 vcc, 1, v1
    s_nop 1
    v_cndmask_b32 v36, v4, v5, vcc
    v_mov_b32 v4, 0
    v_mov_b32 v5, 0x3f80
    v_cmp_eq_u32 vcc, 2, v1
    s_nop 1
    v_cndmask_b32 v4, v4, v5, vcc
    v_mov_b32 v5, 0x3f800000
    v_cmp_eq_u32 vcc, 3, v1
    s_nop 1
    v_cndmask_b32 v37, v4, v5, vcc
    v_mov_b32 v4, 0
    v_mov_b32 v5, 0x3f80
    v_cmp_eq_u32 vcc, 4, v1
    s_nop 1
    v_cndmask_b32 v4, v4, v5, vcc
    v_mov_b32 v5, 0x3f800000
    v_cmp_eq_u32 vcc, 5, v1
    s_nop 1
    v_cndmask_b32 v38, v4, v5, vcc
    v_mov_b32 v4, 0
    v_mov_b32 v5, 0x3f80
    v_cmp_eq_u32 vcc, 6, v1
    s_nop 1
    v_cndmask_b32 v4, v4, v5, vcc
    v_mov_b32 v5, 0x3f800000
    v_cmp_eq_u32 vcc, 7, v1
    s_nop 1
    v_cndmask_b32 v39, v4, v5, vcc
    v_lshlrev_b32 v4, 3, v0
    s_and_b32 s5, s3, 1
    s_lshl_b32 s5, s5, 9
    s_add_u32 s5, s5, 24576
    v_add_u32 v22, s5, v4
    s_mov_b32 s35, 1040356334
    s_lshr_b32 s4, s16, 1
    s_lshl_b32 s4, s4, 16
    s_add_u32 s72, s4, 96468992
    s_lshl_b32 s4, s18, 14
    s_add_u32 s73, s4, 96993280
    s_lshl_b32 s4, s16, 15
    s_add_u32 s74, s4, 97517568
    s_lshl_b32 s4, s18, 16
    s_lshl_b32 s5, s3, 14
    s_add_u32 s4, s4, s5
    s_add_u32 s76, s4, 4194304
    s_lshl_b32 s4, s18, 11
    s_lshl_b32 s5, s36, 9
    s_add_u32 s4, s4, s5
    s_lshl_b32 s5, s3, 8
    s_add_u32 s4, s4, s5
    s_add_u32 s77, s4, 20971520
    s_load_dwordx2 s[12:13], s[0:1], 8
    s_mov_b32 s14, 16384
    s_mov_b32 s15, 0x20000
    v_lshlrev_b32 v4, 11, v6
    v_and_b32 v5, 6, v1
    v_lshlrev_b32 v5, 1, v5
    v_add_u32 v4, v4, v5
    v_mov_b32 v5, 0x80000000
    v_cmp_gt_u32 vcc, 32, v0
    s_nop 1
    v_cndmask_b32 v4, v5, v4, vcc
    s_lshl_b32 s4, s17, 7
    s_lshl_b32 s5, s75, 6
    s_add_u32 s4, s4, s5
    s_lshl_b32 s5, s3, 4
    s_add_u32 s4, s4, s5
    s_waitcnt lgkmcnt(0)
    buffer_load_dword v6, v4, s[12:15], s4 offen
    s_mov_b32 s4, s72
    s_waitcnt vmcnt(0)
    buffer_store_dword v6, v10, s[8:11], s4 offen
    s_add_u32 s4, s4, 16384
    buffer_store_dword v24, v10, s[8:11], s4 offen
    s_add_u32 s4, s4, 16384
    buffer_store_dword v24, v10, s[8:11], s4 offen
    s_add_u32 s4, s4, 16384
    buffer_store_dword v24, v10, s[8:11], s4 offen
    s_mov_b32 s4, s73
    s_mov_b32 s5, s74
    s_mov_b32 s6, 98566144
    buffer_store_dword v24, v11, s[8:11], s4 offen
    buffer_store_dwordx4 v[24:27], v14, s[8:11], s6 offen sc1
    s_add_u32 s4, s4, 4096
    s_add_u32 s6, s6, 131072
    buffer_store_dword v24, v11, s[8:11], s4 offen
    buffer_store_dwordx4 v[24:27], v14, s[8:11], s6 offen sc1
    s_add_u32 s4, s4, 4096
    s_add_u32 s6, s6, 131072
    buffer_store_dword v24, v11, s[8:11], s4 offen
    buffer_store_dwordx4 v[24:27], v14, s[8:11], s6 offen sc1
    s_add_u32 s4, s4, 4096
    s_add_u32 s6, s6, 131072
    buffer_store_dword v24, v11, s[8:11], s4 offen
    buffer_store_dwordx4 v[24:27], v14, s[8:11], s6 offen sc1
    s_add_u32 s4, s4, 4096
    s_add_u32 s6, s6, 131072
    s_lshl_b32 s4, s3, 21
    buffer_store_dwordx4 v[24:27], v35, s[8:11], s4 offen sc1
    s_add_u32 s4, s4, 131072
    buffer_store_dwordx4 v[24:27], v35, s[8:11], s4 offen sc1
    s_add_u32 s4, s4, 131072
    buffer_store_dwordx4 v[24:27], v35, s[8:11], s4 offen sc1
    s_add_u32 s4, s4, 131072
    buffer_store_dwordx4 v[24:27], v35, s[8:11], s4 offen sc1
    s_add_u32 s4, s4, 131072
    buffer_store_dwordx4 v[24:27], v35, s[8:11], s4 offen sc1
    s_add_u32 s4, s4, 131072
    buffer_store_dwordx4 v[24:27], v35, s[8:11], s4 offen sc1
    s_add_u32 s4, s4, 131072
    buffer_store_dwordx4 v[24:27], v35, s[8:11], s4 offen sc1
    s_add_u32 s4, s4, 131072
    buffer_store_dwordx4 v[24:27], v35, s[8:11], s4 offen sc1
    s_add_u32 s4, s4, 131072
    buffer_store_dwordx4 v[24:27], v35, s[8:11], s4 offen sc1
    s_add_u32 s4, s4, 131072
    buffer_store_dwordx4 v[24:27], v35, s[8:11], s4 offen sc1
    s_add_u32 s4, s4, 131072
    buffer_store_dwordx4 v[24:27], v35, s[8:11], s4 offen sc1
    s_add_u32 s4, s4, 131072
    buffer_store_dwordx4 v[24:27], v35, s[8:11], s4 offen sc1
    s_add_u32 s4, s4, 131072
    buffer_store_dwordx4 v[24:27], v35, s[8:11], s4 offen sc1
    s_add_u32 s4, s4, 131072
    buffer_store_dwordx4 v[24:27], v35, s[8:11], s4 offen sc1
    s_add_u32 s4, s4, 131072
    buffer_store_dwordx4 v[24:27], v35, s[8:11], s4 offen sc1
    s_add_u32 s4, s4, 131072
    buffer_store_dwordx4 v[24:27], v35, s[8:11], s4 offen sc1
    s_add_u32 s4, s4, 131072
    s_cmp_lt_u32 s3, 2
    s_cbranch_scc1 Lnoo_1
    buffer_store_dwordx2 v[24:25], v12, s[8:11], s5 offen
    s_add_u32 s5, s5, 8192
    buffer_store_dwordx2 v[24:25], v12, s[8:11], s5 offen
    s_add_u32 s5, s5, 8192
    buffer_store_dwordx2 v[24:25], v12, s[8:11], s5 offen
    s_add_u32 s5, s5, 8192
    buffer_store_dwordx2 v[24:25], v12, s[8:11], s5 offen
    s_add_u32 s5, s5, 8192
Lnoo_1:
    s_waitcnt vmcnt(0)
    s_barrier
    s_cmp_lg_u32 s3, 0
    s_cbranch_scc1 Lsbo_2
    v_mov_b32 v4, 160
    v_mov_b32 v5, 1
    v_cmp_eq_u32 vcc, 0, v0
    s_and_saveexec_b64 s[6:7], vcc
    buffer_atomic_add v5, v4, s[64:67], 0 offen sc1
    s_mov_b64 exec, s[6:7]
Lsbo_2:
    v_lshrrev_b32 v4, 2, v0
    v_lshlrev_b32 v4, 13, v4
    v_and_b32 v5, 3, v0
    v_lshlrev_b32 v5, 4, v5
    v_add_u32 v76, v4, v5
    v_lshrrev_b32 v4, 3, v0
    v_lshlrev_b32 v4, 11, v4
    v_and_b32 v5, 7, v0
    v_lshlrev_b32 v5, 4, v5
    v_add_u32 v77, v4, v5
    s_lshl_b32 s4, s18, 8
    s_lshl_b32 s5, s36, 6
    s_add_u32 s37, s4, s5
    s_lshl_b32 s4, s3, 21
    s_add_u32 s37, s37, s4
    v_lshrrev_b32 v4, 5, v0
    v_lshlrev_b32 v4, 4, v4
    v_bfe_u32 v5, v0, 4, 1
    v_lshlrev_b32 v6, 2, v5
    v_add_u32 v4, v4, v6
    v_bfe_u32 v6, v0, 3, 1
    v_lshlrev_b32 v7, 3, v6
    v_add_u32 v4, v4, v7
    v_bfe_u32 v7, v0, 2, 1
    v_add_u32 v4, v4, v7
    v_lshlrev_b32 v4, 6, v4
    v_and_b32 v7, 3, v0
    v_lshlrev_b32 v7, 3, v7
    v_add_u32 v4, v4, v7
    s_lshl_b32 s4, s3, 14
    v_add_u32 v78, s4, v4
    s_add_u32 s4, s4, 65536
    v_add_u32 v79, s4, v4
    v_lshlrev_b32 v4, 5, v6
    v_lshlrev_b32 v5, 4, v5
    v_add_u32 v4, v4, v5
    v_lshrrev_b32 v5, 5, v0
    v_lshlrev_b32 v5, 2, v5
    v_add_u32 v4, v4, v5
    v_bfe_u32 v5, v0, 2, 1
    v_add_u32 v4, v4, v5
    v_lshlrev_b32 v4, 7, v4
    v_add_u32 v4, v4, v7
    s_lshl_b32 s4, s3, 5
    s_add_u32 s4, s4, 65536
    v_add_u32 v80, s4, v4
    s_load_dwordx2 s[12:13], s[0:1], 16
    s_mov_b32 s14, 8388608
    s_mov_b32 s15, 0x20000
    s_waitcnt lgkmcnt(0)
    s_mov_b32 s4, s37
    s_lshl_b32 s5, s3, 14
    s_add_u32 s5, s5, 0
    s_mov_b32 m0, s5
    s_add_u32 s5, s5, 1024
    buffer_load_dwordx4 v76, s[12:15], s4 offen lds
    s_add_u32 s4, s4, 131072
    s_mov_b32 m0, s5
    s_add_u32 s5, s5, 1024
    buffer_load_dwordx4 v76, s[12:15], s4 offen lds
    s_add_u32 s4, s4, 131072
    s_mov_b32 m0, s5
    s_add_u32 s5, s5, 1024
    buffer_load_dwordx4 v76, s[12:15], s4 offen lds
    s_add_u32 s4, s4, 131072
    s_mov_b32 m0, s5
    s_add_u32 s5, s5, 1024
    buffer_load_dwordx4 v76, s[12:15], s4 offen lds
    s_add_u32 s4, s4, 131072
    s_mov_b32 m0, s5
    s_add_u32 s5, s5, 1024
    buffer_load_dwordx4 v76, s[12:15], s4 offen lds
    s_add_u32 s4, s4, 131072
    s_mov_b32 m0, s5
    s_add_u32 s5, s5, 1024
    buffer_load_dwordx4 v76, s[12:15], s4 offen lds
    s_add_u32 s4, s4, 131072
    s_mov_b32 m0, s5
    s_add_u32 s5, s5, 1024
    buffer_load_dwordx4 v76, s[12:15], s4 offen lds
    s_add_u32 s4, s4, 131072
    s_mov_b32 m0, s5
    s_add_u32 s5, s5, 1024
    buffer_load_dwordx4 v76, s[12:15], s4 offen lds
    s_add_u32 s4, s4, 131072
    s_mov_b32 m0, s5
    s_add_u32 s5, s5, 1024
    buffer_load_dwordx4 v76, s[12:15], s4 offen lds
    s_add_u32 s4, s4, 131072
    s_mov_b32 m0, s5
    s_add_u32 s5, s5, 1024
    buffer_load_dwordx4 v76, s[12:15], s4 offen lds
    s_add_u32 s4, s4, 131072
    s_mov_b32 m0, s5
    s_add_u32 s5, s5, 1024
    buffer_load_dwordx4 v76, s[12:15], s4 offen lds
    s_add_u32 s4, s4, 131072
    s_mov_b32 m0, s5
    s_add_u32 s5, s5, 1024
    buffer_load_dwordx4 v76, s[12:15], s4 offen lds
    s_add_u32 s4, s4, 131072
    s_mov_b32 m0, s5
    s_add_u32 s5, s5, 1024
    buffer_load_dwordx4 v76, s[12:15], s4 offen lds
    s_add_u32 s4, s4, 131072
    s_mov_b32 m0, s5
    s_add_u32 s5, s5, 1024
    buffer_load_dwordx4 v76, s[12:15], s4 offen lds
    s_add_u32 s4, s4, 131072
    s_mov_b32 m0, s5
    s_add_u32 s5, s5, 1024
    buffer_load_dwordx4 v76, s[12:15], s4 offen lds
    s_add_u32 s4, s4, 131072
    s_mov_b32 m0, s5
    s_add_u32 s5, s5, 1024
    buffer_load_dwordx4 v76, s[12:15], s4 offen lds
    s_add_u32 s4, s4, 131072
    s_load_dwordx2 s[12:13], s[0:1], 24
    s_mov_b32 s14, 8388608
    s_mov_b32 s15, 0x20000
    s_waitcnt lgkmcnt(0)
    s_mov_b32 s4, s37
    s_lshl_b32 s5, s3, 14
    s_add_u32 s5, s5, 65536
    s_mov_b32 m0, s5
    s_add_u32 s5, s5, 1024
    buffer_load_dwordx4 v76, s[12:15], s4 offen lds
    s_add_u32 s4, s4, 131072
    s_mov_b32 m0, s5
    s_add_u32 s5, s5, 1024
    buffer_load_dwordx4 v76, s[12:15], s4 offen lds
    s_add_u32 s4, s4, 131072
    s_mov_b32 m0, s5
    s_add_u32 s5, s5, 1024
    buffer_load_dwordx4 v76, s[12:15], s4 offen lds
    s_add_u32 s4, s4, 131072
    s_mov_b32 m0, s5
    s_add_u32 s5, s5, 1024
    buffer_load_dwordx4 v76, s[12:15], s4 offen lds
    s_add_u32 s4, s4, 131072
    s_mov_b32 m0, s5
    s_add_u32 s5, s5, 1024
    buffer_load_dwordx4 v76, s[12:15], s4 offen lds
    s_add_u32 s4, s4, 131072
    s_mov_b32 m0, s5
    s_add_u32 s5, s5, 1024
    buffer_load_dwordx4 v76, s[12:15], s4 offen lds
    s_add_u32 s4, s4, 131072
    s_mov_b32 m0, s5
    s_add_u32 s5, s5, 1024
    buffer_load_dwordx4 v76, s[12:15], s4 offen lds
    s_add_u32 s4, s4, 131072
    s_mov_b32 m0, s5
    s_add_u32 s5, s5, 1024
    buffer_load_dwordx4 v76, s[12:15], s4 offen lds
    s_add_u32 s4, s4, 131072
    s_mov_b32 m0, s5
    s_add_u32 s5, s5, 1024
    buffer_load_dwordx4 v76, s[12:15], s4 offen lds
    s_add_u32 s4, s4, 131072
    s_mov_b32 m0, s5
    s_add_u32 s5, s5, 1024
    buffer_load_dwordx4 v76, s[12:15], s4 offen lds
    s_add_u32 s4, s4, 131072
    s_mov_b32 m0, s5
    s_add_u32 s5, s5, 1024
    buffer_load_dwordx4 v76, s[12:15], s4 offen lds
    s_add_u32 s4, s4, 131072
    s_mov_b32 m0, s5
    s_add_u32 s5, s5, 1024
    buffer_load_dwordx4 v76, s[12:15], s4 offen lds
    s_add_u32 s4, s4, 131072
    s_mov_b32 m0, s5
    s_add_u32 s5, s5, 1024
    buffer_load_dwordx4 v76, s[12:15], s4 offen lds
    s_add_u32 s4, s4, 131072
    s_mov_b32 m0, s5
    s_add_u32 s5, s5, 1024
    buffer_load_dwordx4 v76, s[12:15], s4 offen lds
    s_add_u32 s4, s4, 131072
    s_mov_b32 m0, s5
    s_add_u32 s5, s5, 1024
    buffer_load_dwordx4 v76, s[12:15], s4 offen lds
    s_add_u32 s4, s4, 131072
    s_mov_b32 m0, s5
    s_add_u32 s5, s5, 1024
    buffer_load_dwordx4 v76, s[12:15], s4 offen lds
    s_add_u32 s4, s4, 131072
    s_waitcnt vmcnt(16)
    ds_read_b64_tr_b16 a[64:65], v78 offset:0
    ds_read_b64_tr_b16 a[66:67], v78 offset:128
    ds_read_b64_tr_b16 a[68:69], v78 offset:2048
    ds_read_b64_tr_b16 a[70:71], v78 offset:2176
    ds_read_b64_tr_b16 a[72:73], v78 offset:4096
    ds_read_b64_tr_b16 a[74:75], v78 offset:4224
    ds_read_b64_tr_b16 a[76:77], v78 offset:6144
    ds_read_b64_tr_b16 a[78:79], v78 offset:6272
    s_waitcnt lgkmcnt(4)
    ds_read_b64_tr_b16 a[80:81], v78 offset:8192
    ds_read_b64_tr_b16 a[82:83], v78 offset:8320
    ds_read_b64_tr_b16 a[84:85], v78 offset:10240
    ds_read_b64_tr_b16 a[86:87], v78 offset:10368
    ds_read_b64_tr_b16 a[88:89], v78 offset:12288
    ds_read_b64_tr_b16 a[90:91], v78 offset:12416
    ds_read_b64_tr_b16 a[92:93], v78 offset:14336
    ds_read_b64_tr_b16 a[94:95], v78 offset:14464
    s_waitcnt lgkmcnt(4)
    ds_read_b64_tr_b16 a[96:97], v78 offset:32
    ds_read_b64_tr_b16 a[98:99], v78 offset:160
    ds_read_b64_tr_b16 a[100:101], v78 offset:2080
    ds_read_b64_tr_b16 a[102:103], v78 offset:2208
    ds_read_b64_tr_b16 a[104:105], v78 offset:4128
    ds_read_b64_tr_b16 a[106:107], v78 offset:4256
    ds_read_b64_tr_b16 a[108:109], v78 offset:6176
    ds_read_b64_tr_b16 a[110:111], v78 offset:6304
    s_waitcnt lgkmcnt(4)
    ds_read_b64_tr_b16 a[112:113], v78 offset:8224
    ds_read_b64_tr_b16 a[114:115], v78 offset:8352
    ds_read_b64_tr_b16 a[116:117], v78 offset:10272
    ds_read_b64_tr_b16 a[118:119], v78 offset:10400
    ds_read_b64_tr_b16 a[120:121], v78 offset:12320
    ds_read_b64_tr_b16 a[122:123], v78 offset:12448
    ds_read_b64_tr_b16 a[124:125], v78 offset:14368
    ds_read_b64_tr_b16 a[126:127], v78 offset:14496
    s_waitcnt lgkmcnt(4)
    s_waitcnt lgkmcnt(0)
    s_load_dwordx2 s[12:13], s[0:1], 32
    s_mov_b32 s14, 8388608
    s_mov_b32 s15, 0x20000
    s_waitcnt lgkmcnt(0)
    s_mov_b32 s4, s37
    s_lshl_b32 s5, s3, 14
    s_add_u32 s5, s5, 0
    s_mov_b32 m0, s5
    s_add_u32 s5, s5, 1024
    buffer_load_dwordx4 v76, s[12:15], s4 offen lds
    s_add_u32 s4, s4, 131072
    s_mov_b32 m0, s5
    s_add_u32 s5, s5, 1024
    buffer_load_dwordx4 v76, s[12:15], s4 offen lds
    s_add_u32 s4, s4, 131072
    s_mov_b32 m0, s5
    s_add_u32 s5, s5, 1024
    buffer_load_dwordx4 v76, s[12:15], s4 offen lds
    s_add_u32 s4, s4, 131072
    s_mov_b32 m0, s5
    s_add_u32 s5, s5, 1024
    buffer_load_dwordx4 v76, s[12:15], s4 offen lds
    s_add_u32 s4, s4, 131072
    s_mov_b32 m0, s5
    s_add_u32 s5, s5, 1024
    buffer_load_dwordx4 v76, s[12:15], s4 offen lds
    s_add_u32 s4, s4, 131072
    s_mov_b32 m0, s5
    s_add_u32 s5, s5, 1024
    buffer_load_dwordx4 v76, s[12:15], s4 offen lds
    s_add_u32 s4, s4, 131072
    s_mov_b32 m0, s5
    s_add_u32 s5, s5, 1024
    buffer_load_dwordx4 v76, s[12:15], s4 offen lds
    s_add_u32 s4, s4, 131072
    s_mov_b32 m0, s5
    s_add_u32 s5, s5, 1024
    buffer_load_dwordx4 v76, s[12:15], s4 offen lds
    s_add_u32 s4, s4, 131072
    s_mov_b32 m0, s5
    s_add_u32 s5, s5, 1024
    buffer_load_dwordx4 v76, s[12:15], s4 offen lds
    s_add_u32 s4, s4, 131072
    s_mov_b32 m0, s5
    s_add_u32 s5, s5, 1024
    buffer_load_dwordx4 v76, s[12:15], s4 offen lds
    s_add_u32 s4, s4, 131072
    s_mov_b32 m0, s5
    s_add_u32 s5, s5, 1024
    buffer_load_dwordx4 v76, s[12:15], s4 offen lds
    s_add_u32 s4, s4, 131072
    s_mov_b32 m0, s5
    s_add_u32 s5, s5, 1024
    buffer_load_dwordx4 v76, s[12:15], s4 offen lds
    s_add_u32 s4, s4, 131072
    s_mov_b32 m0, s5
    s_add_u32 s5, s5, 1024
    buffer_load_dwordx4 v76, s[12:15], s4 offen lds
    s_add_u32 s4, s4, 131072
    s_mov_b32 m0, s5
    s_add_u32 s5, s5, 1024
    buffer_load_dwordx4 v76, s[12:15], s4 offen lds
    s_add_u32 s4, s4, 131072
    s_mov_b32 m0, s5
    s_add_u32 s5, s5, 1024
    buffer_load_dwordx4 v76, s[12:15], s4 offen lds
    s_add_u32 s4, s4, 131072
    s_mov_b32 m0, s5
    s_add_u32 s5, s5, 1024
    buffer_load_dwordx4 v76, s[12:15], s4 offen lds
    s_add_u32 s4, s4, 131072
    s_waitcnt vmcnt(16)
    ds_read_b64_tr_b16 a[0:1], v79 offset:0
    ds_read_b64_tr_b16 a[2:3], v79 offset:128
    ds_read_b64_tr_b16 a[4:5], v79 offset:2048
    ds_read_b64_tr_b16 a[6:7], v79 offset:2176
    ds_read_b64_tr_b16 a[8:9], v79 offset:4096
    ds_read_b64_tr_b16 a[10:11], v79 offset:4224
    ds_read_b64_tr_b16 a[12:13], v79 offset:6144
    ds_read_b64_tr_b16 a[14:15], v79 offset:6272
    s_waitcnt lgkmcnt(4)
    ds_read_b64_tr_b16 a[16:17], v79 offset:8192
    ds_read_b64_tr_b16 a[18:19], v79 offset:8320
    ds_read_b64_tr_b16 a[20:21], v79 offset:10240
    ds_read_b64_tr_b16 a[22:23], v79 offset:10368
    ds_read_b64_tr_b16 a[24:25], v79 offset:12288
    ds_read_b64_tr_b16 a[26:27], v79 offset:12416
    ds_read_b64_tr_b16 a[28:29], v79 offset:14336
    ds_read_b64_tr_b16 a[30:31], v79 offset:14464
    s_waitcnt lgkmcnt(4)
    ds_read_b64_tr_b16 a[32:33], v79 offset:32
    ds_read_b64_tr_b16 a[34:35], v79 offset:160
    ds_read_b64_tr_b16 a[36:37], v79 offset:2080
    ds_read_b64_tr_b16 a[38:39], v79 offset:2208
    ds_read_b64_tr_b16 a[40:41], v79 offset:4128
    ds_read_b64_tr_b16 a[42:43], v79 offset:4256
    ds_read_b64_tr_b16 a[44:45], v79 offset:6176
    ds_read_b64_tr_b16 a[46:47], v79 offset:6304
    s_waitcnt lgkmcnt(4)
    ds_read_b64_tr_b16 a[48:49], v79 offset:8224
    ds_read_b64_tr_b16 a[50:51], v79 offset:8352
    ds_read_b64_tr_b16 a[52:53], v79 offset:10272
    ds_read_b64_tr_b16 a[54:55], v79 offset:10400
    ds_read_b64_tr_b16 a[56:57], v79 offset:12320
    ds_read_b64_tr_b16 a[58:59], v79 offset:12448
    ds_read_b64_tr_b16 a[60:61], v79 offset:14368
    ds_read_b64_tr_b16 a[62:63], v79 offset:14496
    s_waitcnt lgkmcnt(4)
    s_waitcnt lgkmcnt(0)
    s_load_dwordx2 s[12:13], s[0:1], 40
    s_mov_b32 s14, 8388608
    s_mov_b32 s15, 0x20000
    s_waitcnt lgkmcnt(0)
    s_lshl_b32 s4, s16, 9
    s_lshl_b32 s5, s3, 7
    s_add_u32 s4, s4, s5
    s_lshl_b32 s4, s4, 11
    s_lshl_b32 s5, s17, 7
    s_add_u32 s4, s4, s5
    s_lshl_b32 s5, s3, 14
    s_add_u32 s5, s5, 65536
    s_mov_b32 m0, s5
    s_add_u32 s5, s5, 1024
    buffer_load_dwordx4 v77, s[12:15], s4 offen lds
    s_add_u32 s4, s4, 16384
    s_mov_b32 m0, s5
    s_add_u32 s5, s5, 1024
    buffer_load_dwordx4 v77, s[12:15], s4 offen lds
    s_add_u32 s4, s4, 16384
    s_mov_b32 m0, s5
    s_add_u32 s5, s5, 1024
    buffer_load_dwordx4 v77, s[12:15], s4 offen lds
    s_add_u32 s4, s4, 16384
    s_mov_b32 m0, s5
    s_add_u32 s5, s5, 1024
    buffer_load_dwordx4 v77, s[12:15], s4 offen lds
    s_add_u32 s4, s4, 16384
    s_mov_b32 m0, s5
    s_add_u32 s5, s5, 1024
    buffer_load_dwordx4 v77, s[12:15], s4 offen lds
    s_add_u32 s4, s4, 16384
    s_mov_b32 m0, s5
    s_add_u32 s5, s5, 1024
    buffer_load_dwordx4 v77, s[12:15], s4 offen lds
    s_add_u32 s4, s4, 16384
    s_mov_b32 m0, s5
    s_add_u32 s5, s5, 1024
    buffer_load_dwordx4 v77, s[12:15], s4 offen lds
    s_add_u32 s4, s4, 16384
    s_mov_b32 m0, s5
    s_add_u32 s5, s5, 1024
    buffer_load_dwordx4 v77, s[12:15], s4 offen lds
    s_add_u32 s4, s4, 16384
    s_mov_b32 m0, s5
    s_add_u32 s5, s5, 1024
    buffer_load_dwordx4 v77, s[12:15], s4 offen lds
    s_add_u32 s4, s4, 16384
    s_mov_b32 m0, s5
    s_add_u32 s5, s5, 1024
    buffer_load_dwordx4 v77, s[12:15], s4 offen lds
    s_add_u32 s4, s4, 16384
    s_mov_b32 m0, s5
    s_add_u32 s5, s5, 1024
    buffer_load_dwordx4 v77, s[12:15], s4 offen lds
    s_add_u32 s4, s4, 16384
    s_mov_b32 m0, s5
    s_add_u32 s5, s5, 1024
    buffer_load_dwordx4 v77, s[12:15], s4 offen lds
    s_add_u32 s4, s4, 16384
    s_mov_b32 m0, s5
    s_add_u32 s5, s5, 1024
    buffer_load_dwordx4 v77, s[12:15], s4 offen lds
    s_add_u32 s4, s4, 16384
    s_mov_b32 m0, s5
    s_add_u32 s5, s5, 1024
    buffer_load_dwordx4 v77, s[12:15], s4 offen lds
    s_add_u32 s4, s4, 16384
    s_mov_b32 m0, s5
    s_add_u32 s5, s5, 1024
    buffer_load_dwordx4 v77, s[12:15], s4 offen lds
    s_add_u32 s4, s4, 16384
    s_mov_b32 m0, s5
    s_add_u32 s5, s5, 1024
    buffer_load_dwordx4 v77, s[12:15], s4 offen lds
    s_add_u32 s4, s4, 16384
    s_waitcnt vmcnt(16)
    ds_read_b64_tr_b16 a[128:129], v78 offset:0
    ds_read_b64_tr_b16 a[130:131], v78 offset:128
    ds_read_b64_tr_b16 a[132:133], v78 offset:2048
    ds_read_b64_tr_b16 a[134:135], v78 offset:2176
    ds_read_b64_tr_b16 a[136:137], v78 offset:4096
    ds_read_b64_tr_b16 a[138:139], v78 offset:4224
    ds_read_b64_tr_b16 a[140:141], v78 offset:6144
    ds_read_b64_tr_b16 a[142:143], v78 offset:6272
    s_waitcnt lgkmcnt(4)
    ds_read_b64_tr_b16 a[144:145], v78 offset:8192
    ds_read_b64_tr_b16 a[146:147], v78 offset:8320
    ds_read_b64_tr_b16 a[148:149], v78 offset:10240
    ds_read_b64_tr_b16 a[150:151], v78 offset:10368
    ds_read_b64_tr_b16 a[152:153], v78 offset:12288
    ds_read_b64_tr_b16 a[154:155], v78 offset:12416
    ds_read_b64_tr_b16 a[156:157], v78 offset:14336
    ds_read_b64_tr_b16 a[158:159], v78 offset:14464
    s_waitcnt lgkmcnt(4)
    ds_read_b64_tr_b16 a[160:161], v78 offset:32
    ds_read_b64_tr_b16 a[162:163], v78 offset:160
    ds_read_b64_tr_b16 a[164:165], v78 offset:2080
    ds_read_b64_tr_b16 a[166:167], v78 offset:2208
    ds_read_b64_tr_b16 a[168:169], v78 offset:4128
    ds_read_b64_tr_b16 a[170:171], v78 offset:4256
    ds_read_b64_tr_b16 a[172:173], v78 offset:6176
    ds_read_b64_tr_b16 a[174:175], v78 offset:6304
    s_waitcnt lgkmcnt(4)
    ds_read_b64_tr_b16 a[176:177], v78 offset:8224
    ds_read_b64_tr_b16 a[178:179], v78 offset:8352
    ds_read_b64_tr_b16 a[180:181], v78 offset:10272
    ds_read_b64_tr_b16 a[182:183], v78 offset:10400
    ds_read_b64_tr_b16 a[184:185], v78 offset:12320
    ds_read_b64_tr_b16 a[186:187], v78 offset:12448
    ds_read_b64_tr_b16 a[188:189], v78 offset:14368
    ds_read_b64_tr_b16 a[190:191], v78 offset:14496
    s_waitcnt lgkmcnt(4)
    s_waitcnt lgkmcnt(0)
    s_waitcnt vmcnt(0)
    s_barrier
    ds_read_b64_tr_b16 a[192:193], v80 offset:0
    ds_read_b64_tr_b16 a[194:195], v80 offset:256
    ds_read_b64_tr_b16 a[196:197], v80 offset:1024
    ds_read_b64_tr_b16 a[198:199], v80 offset:1280
    ds_read_b64_tr_b16 a[200:201], v80 offset:8192
    ds_read_b64_tr_b16 a[202:203], v80 offset:8448
    ds_read_b64_tr_b16 a[204:205], v80 offset:9216
    ds_read_b64_tr_b16 a[206:207], v80 offset:9472
    s_waitcnt lgkmcnt(4)
    ds_read_b64_tr_b16 a[208:209], v80 offset:16384
    ds_read_b64_tr_b16 a[210:211], v80 offset:16640
    ds_read_b64_tr_b16 a[212:213], v80 offset:17408
    ds_read_b64_tr_b16 a[214:215], v80 offset:17664
    ds_read_b64_tr_b16 a[216:217], v80 offset:24576
    ds_read_b64_tr_b16 a[218:219], v80 offset:24832
    ds_read_b64_tr_b16 a[220:221], v80 offset:25600
    ds_read_b64_tr_b16 a[222:223], v80 offset:25856
    s_waitcnt lgkmcnt(4)
    ds_read_b64_tr_b16 a[224:225], v80 offset:32768
    ds_read_b64_tr_b16 a[226:227], v80 offset:33024
    ds_read_b64_tr_b16 a[228:229], v80 offset:33792
    ds_read_b64_tr_b16 a[230:231], v80 offset:34048
    ds_read_b64_tr_b16 a[232:233], v80 offset:40960
    ds_read_b64_tr_b16 a[234:235], v80 offset:41216
    ds_read_b64_tr_b16 a[236:237], v80 offset:41984
    ds_read_b64_tr_b16 a[238:239], v80 offset:42240
    s_waitcnt lgkmcnt(4)
    ds_read_b64_tr_b16 a[240:241], v80 offset:49152
    ds_read_b64_tr_b16 a[242:243], v80 offset:49408
    ds_read_b64_tr_b16 a[244:245], v80 offset:50176
    ds_read_b64_tr_b16 a[246:247], v80 offset:50432
    ds_read_b64_tr_b16 a[248:249], v80 offset:57344
    ds_read_b64_tr_b16 a[250:251], v80 offset:57600
    ds_read_b64_tr_b16 a[252:253], v80 offset:58368
    ds_read_b64_tr_b16 a[254:255], v80 offset:58624
    s_waitcnt lgkmcnt(4)
    s_waitcnt lgkmcnt(0)
    s_barrier
    s_cmp_lg_u32 s3, 0
    s_cbranch_scc1 Lwb_3_ok
    v_mov_b32 v4, 160
Lwb_3:
    buffer_load_dword v5, v4, s[64:67], 0 offen sc1
    s_waitcnt vmcnt(0)
    v_cmp_le_u32 vcc, 128, v5
    s_cbranch_vccnz Lwb_3_ok
    s_sleep 8
    s_sub_u32 s20, s20, 1
    s_cbranch_scc0 Lwb_3
    s_branch L_R_abort
Lwb_3_ok:
    s_barrier
    s_cmp_lg_u32 s3, 0
    s_cbranch_scc1 Lwb_4_ok
    v_mov_b32 v4, 192
Lwb_4:
    buffer_load_dword v5, v4, s[64:67], 0 offen sc1
    s_waitcnt vmcnt(0)
    v_cmp_le_u32 vcc, 8, v5
    s_cbranch_vccnz Lwb_4_ok
    s_sleep 2
    s_sub_u32 s20, s20, 1
    s_cbranch_scc0 Lwb_4
    s_branch L_R_abort
Lwb_4_ok:
    s_barrier
    s_mov_b32 s19, -1
    s_add_u32 s19, s19, 1
    s_and_b32 s4, s19, 3
    s_lshl_b32 s5, s4, 14
    s_add_u32 s21, s5, s72
    s_lshl_b32 s5, s4, 12
    s_add_u32 s22, s5, s73
    s_lshl_b32 s5, s4, 13
    s_add_u32 s23, s5, s74
    s_and_b32 s4, s19, 1
    s_mul_i32 s4, s4, 10240
    s_add_u32 s33, s4, 26624
    s_add_u32 s37, s19, 1
    s_min_u32 s37, s37, 63
    s_lshr_b32 s4, s37, 3
    s_lshl_b32 s4, s4, 21
    s_and_b32 s5, s37, 7
    s_lshl_b32 s5, s5, 9
    s_add_u32 s4, s4, s5
    s_add_u32 s31, s4, s76
    s_lshl_b32 s4, s37, 18
    s_add_u32 s32, s4, s77
    s_and_b32 s4, s37, 1
    s_mul_i32 s4, s4, 10240
    s_add_u32 s34, s4, 26624
    s_waitcnt vmcnt(0)
    s_barrier
    s_cmp_eq_u32 s3, 1
    s_cbranch_scc1 Lwave_6
    s_cmp_eq_u32 s3, 2
    s_cbranch_scc1 Lwave_7
    s_cmp_eq_u32 s3, 3
    s_cbranch_scc1 Lwave_8
Lwave_5:
Lstep_9:
    s_cmp_eq_u32 s19, 63
    s_cbranch_scc1 Llast_10
    s_sleep 3
    buffer_load_dwordx4 v[96:99], v8, s[8:11], s21 offen offset:0 sc1
    buffer_load_dwordx4 v[100:103], v8, s[8:11], s21 offen offset:1024 sc1
    buffer_load_dwordx4 v[104:107], v8, s[8:11], s21 offen offset:2048 sc1
    buffer_load_dwordx4 v[108:111], v8, s[8:11], s21 offen offset:3072 sc1
    v_mov_b32 v40, 0
    v_mov_b32 v41, 0
    v_mov_b32 v42, 0
    v_mov_b32 v43, 0
    v_mov_b32 v44, 0
    v_mov_b32 v45, 0
    v_mov_b32 v46, 0
    v_mov_b32 v47, 0
    v_mov_b32 v48, 0
    v_mov_b32 v49, 0
    v_mov_b32 v50, 0
    v_mov_b32 v51, 0
    v_mov_b32 v52, 0
    v_mov_b32 v53, 0
    v_mov_b32 v54, 0
    v_mov_b32 v55, 0
    v_mov_b32 v56, 0
    v_mov_b32 v57, 0
    v_mov_b32 v58, 0
    v_mov_b32 v59, 0
    v_mov_b32 v60, 0
    v_mov_b32 v61, 0
    v_mov_b32 v62, 0
    v_mov_b32 v63, 0
    s_and_b32 s4, s19, 3
    s_lshl_b32 s5, s4, 17
    s_add_u32 s24, s5, 98566144
    s_add_u32 s5, s4, 2
    s_and_b32 s5, s5, 3
    s_lshl_b32 s5, s5, 17
    s_add_u32 s28, s5, 98566144
    s_add_u32 s4, s4, 3
    s_and_b32 s4, s4, 3
    s_lshl_b32 s5, s4, 14
    s_add_u32 s78, s5, s72
    s_lshl_b32 s5, s4, 12
    s_add_u32 s79, s5, s73
    s_lshl_b32 s5, s4, 13
    s_add_u32 s29, s5, s74
    s_lshl_b32 s30, s19, 17
    s_waitcnt vmcnt(3)
LpA_11:
    v_max3_u32 v28, v96, v97, v98
    v_max_u32 v28, v28, v99
    v_cmp_eq_u32 vcc, -1, v28
    s_cbranch_vccnz LrA_12
    v_smfmac_f32_16x16x64_bf16 v[40:43], v[96:99], a[0:7], v19
    v_smfmac_f32_16x16x64_bf16 v[44:47], v[96:99], a[32:39], v19
    v_smfmac_f32_16x16x64_bf16 v[48:51], v[96:99], a[64:71], v19
    v_smfmac_f32_16x16x64_bf16 v[52:55], v[96:99], a[96:103], v19
    s_waitcnt vmcnt(2)
LpA_14:
    v_max3_u32 v28, v100, v101, v102
    v_max_u32 v28, v28, v103
    v_cmp_eq_u32 vcc, -1, v28
    s_cbranch_vccnz LrA_15
    v_smfmac_f32_16x16x64_bf16 v[40:43], v[100:103], a[8:15], v19
    v_smfmac_f32_16x16x64_bf16 v[44:47], v[100:103], a[40:47], v19
    v_smfmac_f32_16x16x64_bf16 v[48:51], v[100:103], a[72:79], v19
    v_smfmac_f32_16x16x64_bf16 v[52:55], v[100:103], a[104:111], v19
    s_waitcnt vmcnt(1)
LpA_17:
    v_max3_u32 v28, v104, v105, v106
    v_max_u32 v28, v28, v107
    v_cmp_eq_u32 vcc, -1, v28
    s_cbranch_vccnz LrA_18
    v_smfmac_f32_16x16x64_bf16 v[40:43], v[104:107], a[16:23], v19
    v_smfmac_f32_16x16x64_bf16 v[44:47], v[104:107], a[48:55], v19
    v_smfmac_f32_16x16x64_bf16 v[48:51], v[104:107], a[80:87], v19
    v_smfmac_f32_16x16x64_bf16 v[52:55], v[104:107], a[112:119], v19
    s_waitcnt vmcnt(0)
LpA_20:
    v_max3_u32 v28, v108, v109, v110
    v_max_u32 v28, v28, v111
    v_cmp_eq_u32 vcc, -1, v28
    s_cbranch_vccnz LrA_21
    v_smfmac_f32_16x16x64_bf16 v[40:43], v[108:111], a[24:31], v19
    v_smfmac_f32_16x16x64_bf16 v[44:47], v[108:111], a[56:63], v19
    v_smfmac_f32_16x16x64_bf16 v[48:51], v[108:111], a[88:95], v19
    v_smfmac_f32_16x16x64_bf16 v[52:55], v[108:111], a[120:127], v19
    v_smfmac_f32_16x16x64_bf16 v[56:59], v[96:99], a[128:135], v19
    v_smfmac_f32_16x16x64_bf16 v[60:63], v[96:99], a[160:167], v19
    ds_write_b128 v16, v[40:43] offset:0
    v_smfmac_f32_16x16x64_bf16 v[56:59], v[100:103], a[136:143], v19
    ds_write_b128 v16, v[44:47] offset:4096
    v_smfmac_f32_16x16x64_bf16 v[60:63], v[100:103], a[168:175], v19
    ds_write_b128 v16, v[48:51] offset:8192
    v_smfmac_f32_16x16x64_bf16 v[56:59], v[104:107], a[144:151], v19
    ds_write_b128 v16, v[52:55] offset:12288
    v_smfmac_f32_16x16x64_bf16 v[60:63], v[104:107], a[176:183], v19
    v_smfmac_f32_16x16x64_bf16 v[56:59], v[108:111], a[152:159], v19
    v_smfmac_f32_16x16x64_bf16 v[60:63], v[108:111], a[184:191], v19
    s_waitcnt lgkmcnt(0)
    s_barrier
    ds_read_b128 v[112:115], v8 offset:0
    ds_read_b128 v[116:119], v8 offset:1024
    ds_read_b128 v[120:123], v8 offset:2048
    ds_read_b128 v[124:127], v8 offset:3072
    ds_write_b128 v16, v[56:59] offset:47104
    ds_write_b128 v16, v[60:63] offset:51200
    s_waitcnt lgkmcnt(2)
    v_pk_add_f32 v[112:113], v[112:113], v[116:117]
    v_pk_add_f32 v[114:115], v[114:115], v[118:119]
    v_pk_add_f32 v[120:121], v[120:121], v[124:125]
    v_pk_add_f32 v[122:123], v[122:123], v[126:127]
    v_pk_add_f32 v[112:113], v[112:113], v[120:121]
    v_pk_add_f32 v[114:115], v[114:115], v[122:123]
    s_nop 1
    v_permlane32_swap_b32 v112, v114
    v_permlane32_swap_b32 v113, v115
    v_add_f32 v76, v112, v114
    v_add_f32 v77, v113, v115
    v_cvt_pk_bf16_f32 v78, v76, v77
    s_nop 1
    v_mov_b32_dpp v79, v78 quad_perm:[1,0,3,2] row_mask:0xf bank_mask:0xf
    v_perm_b32 v78, v78, v79, v20
    buffer_store_dword v78, v11, s[8:11], s22 offen
    s_cmp_eq_u32 s19, 0
    s_cbranch_scc1 Lk0h_23
Lk0b_24:
    s_waitcnt lgkmcnt(0)
    s_barrier
    ds_read_b128 v[112:115], v8 offset:47104
    ds_read_b128 v[116:119], v8 offset:48128
    ds_read_b128 v[120:123], v8 offset:49152
    ds_read_b128 v[124:127], v8 offset:50176
    ds_write_b32 v33, v78
    s_waitcnt lgkmcnt(1)
    v_pk_add_f32 v[112:113], v[112:113], v[116:117]
    v_pk_add_f32 v[114:115], v[114:115], v[118:119]
    v_pk_add_f32 v[120:121], v[120:121], v[124:125]
    v_pk_add_f32 v[122:123], v[122:123], v[126:127]
    v_pk_add_f32 v[112:113], v[112:113], v[120:121]
    v_pk_add_f32 v[114:115], v[114:115], v[122:123]
    s_nop 1
    v_permlane32_swap_b32 v112, v114
    v_permlane32_swap_b32 v113, v115
    v_add_f32 v80, v112, v114
    v_add_f32 v81, v113, v115
    v_cvt_pk_bf16_f32 v82, v80, 0
    v_cvt_pk_bf16_f32 v83, v81, 0
    v_cvt_pk_bf16_f32 v23, v80, v81
    ds_write_b64 v22, v[82:83]
    ds_write_b32 v34, v23
    s_waitcnt lgkmcnt(0)
    s_barrier
    buffer_store_dwordx4 v[24:27], v30, s[8:11], s78 offen
    buffer_store_dwordx4 v[24:27], v31, s[8:11], s79 offen
    buffer_store_dwordx4 v[24:27], v32, s[8:11], s29 offen
    ds_read_b128 v[72:75], v9 offset:25600
    s_add_u32 s4, s19, 1
    s_mov_b32 s6, 128
    s_cmp_eq_u32 s4, 4
    s_cselect_b32 s4, 64, s4
    s_cselect_b32 s7, 0, 1
    s_and_b32 s5, s4, 7
    s_cmp_lg_u32 s5, 0
    s_cbranch_scc1 Lkv_27_ok
    s_lshr_b32 s4, s4, 3
    s_mul_i32 s4, s4, s7
    s_cmp_eq_u32 s7, 1
    s_cselect_b32 s6, 32, s6
    s_cmp_ge_u32 s4, 8
    s_cbranch_scc1 Lkv_27_ok
    s_add_u32 s4, s4, 0
    s_lshl_b32 s4, s4, 8
    s_add_u32 s4, s4, 102760448
    s_branch Lkv_27_cold
Lkv_27_ok:
    s_barrier
    s_sleep 4
    buffer_load_dwordx4 v[128:131], v13, s[8:11], s23 offen offset:0 sc1
    buffer_load_dwordx4 v[132:135], v13, s[8:11], s23 offen offset:1024 sc1
    v_mov_b32 v64, 0
    v_mov_b32 v65, 0
    v_mov_b32 v66, 0
    v_mov_b32 v67, 0
LpO_28:
    s_waitcnt vmcnt(0)
    v_max3_u32 v28, v128, v129, v130
    v_max3_u32 v28, v28, v131, v132
    v_max3_u32 v28, v28, v133, v134
    v_max_u32 v28, v28, v135
    v_cmp_eq_u32 vcc, -1, v28
    s_cbranch_vccnz LrO_29
    ds_write_b128 v13, v[128:131] offset:16384
    ds_write_b128 v13, v[132:135] offset:17408
    v_smfmac_f32_16x16x64_bf16 v[64:67], v[128:131], a[192:199], v19
    s_waitcnt lgkmcnt(0)
    s_barrier
    ds_read_b128 v[136:139], v9 offset:18432
    ds_read_b128 v[140:143], v9 offset:19456
    ds_read_b128 v[144:147], v9 offset:20480
    ds_read_b128 v[148:151], v9 offset:21504
    ds_read_b128 v[152:155], v9 offset:22528
    ds_read_b128 v[156:159], v9 offset:23552
    v_smfmac_f32_16x16x64_bf16 v[64:67], v[132:135], a[200:207], v19
    s_waitcnt lgkmcnt(5)
    v_smfmac_f32_16x16x64_bf16 v[64:67], v[136:139], a[208:215], v19
    s_waitcnt lgkmcnt(4)
    v_smfmac_f32_16x16x64_bf16 v[64:67], v[140:143], a[216:223], v19
    s_waitcnt lgkmcnt(3)
    v_smfmac_f32_16x16x64_bf16 v[64:67], v[144:147], a[224:231], v19
    s_waitcnt lgkmcnt(2)
    v_smfmac_f32_16x16x64_bf16 v[64:67], v[148:151], a[232:239], v19
    s_waitcnt lgkmcnt(1)
    v_smfmac_f32_16x16x64_bf16 v[64:67], v[152:155], a[240:247], v19
    s_waitcnt lgkmcnt(0)
    v_smfmac_f32_16x16x64_bf16 v[64:67], v[156:159], a[248:255], v19
    s_nop 7
    v_permlane32_swap_b32 v64, v76
    v_permlane32_swap_b32 v65, v77
    v_permlane32_swap_b32 v66, v78
    v_permlane32_swap_b32 v67, v79
    v_pk_add_f32 v[64:65], v[64:65], v[76:77]
    v_pk_add_f32 v[66:67], v[66:67], v[78:79]
    v_cvt_pk_bf16_f32 v80, v64, v65
    v_cvt_pk_bf16_f32 v81, v66, v67
    s_nop 0
    v_permlane16_swap_b32 v80, v82
    v_permlane16_swap_b32 v81, v83
    buffer_store_dwordx4 v[80:83], v14, s[8:11], s24 offen sc1
    s_lshl_b32 s6, s3, 10
    s_add_u32 s6, s6, s34
    s_mov_b32 m0, s6
    s_add_u32 s6, s6, 3840
    buffer_load_dwordx4 v17, s[8:11], s31 offen sc1 lds
    s_mov_b32 m0, s6
    s_add_u32 s6, s6, 4352
    buffer_load_dwordx4 v17, s[8:11], s31 offen offset:256 sc1 lds
    s_mov_b32 m0, s6
    s_nop 0
    buffer_load_dwordx4 v18, s[8:11], s32 offen sc1 lds
    s_add_u32 s4, s19, 2
    s_and_b32 s5, s4, 3
    s_cbranch_scc1 Lpb_30
    s_lshr_b32 s4, s4, 3
    s_min_u32 s4, s4, 7
    s_lshl_b32 s4, s4, 8
    s_add_u32 s4, s4, 102760448
    buffer_load_dword v224, off, s[8:11], s4 sc1
Lpb_30:
    buffer_store_dwordx4 v[72:75], v35, s[8:11], s30 offen sc1
    s_sleep 12
    buffer_load_dwordx4 v[68:71], v15, s[8:11], s24 offen sc1
    s_add_u32 s19, s19, 1
    s_and_b32 s4, s19, 3
    s_lshl_b32 s5, s4, 14
    s_add_u32 s21, s5, s72
    s_lshl_b32 s5, s4, 12
    s_add_u32 s22, s5, s73
    s_lshl_b32 s5, s4, 13
    s_add_u32 s23, s5, s74
    s_and_b32 s4, s19, 1
    s_mul_i32 s4, s4, 10240
    s_add_u32 s33, s4, 26624
    s_add_u32 s37, s19, 1
    s_min_u32 s37, s37, 63
    s_lshr_b32 s4, s37, 3
    s_lshl_b32 s4, s4, 21
    s_and_b32 s5, s37, 7
    s_lshl_b32 s5, s5, 9
    s_add_u32 s4, s4, s5
    s_add_u32 s31, s4, s76
    s_lshl_b32 s4, s37, 18
    s_add_u32 s32, s4, s77
    s_and_b32 s4, s37, 1
    s_mul_i32 s4, s4, 10240
    s_add_u32 s34, s4, 26624
LpC_31:
    s_waitcnt vmcnt(0)
    v_max3_u32 v28, v68, v69, v70
    v_max_u32 v28, v28, v71
    v_cmp_eq_u32 vcc, -1, v28
    s_cbranch_vccnz LrC_32
    v_mfma_f32_16x16x32_bf16 v[76:79], v[36:39], v[68:71], 0
    s_nop 7
    v_add_f32_dpp v76, v76, v76 row_ror:8 row_mask:0xf bank_mask:0xf
    v_add_f32_dpp v77, v77, v77 row_ror:8 row_mask:0xf bank_mask:0xf
    v_add_f32_dpp v78, v78, v78 row_ror:8 row_mask:0xf bank_mask:0xf
    v_add_f32_dpp v79, v79, v79 row_ror:8 row_mask:0xf bank_mask:0xf
    v_cvt_pk_bf16_f32 v80, v76, v77
    v_cvt_pk_bf16_f32 v81, v78, v79
    v_cndmask_b32 v82, v81, v80, s[26:27]
    v_cndmask_b32 v83, v80, v81, s[26:27]
    s_nop 0
    v_mov_b32_dpp v84, v82 quad_perm:[1,0,3,2] row_mask:0xf bank_mask:0xf
    v_perm_b32 v85, v83, v84, v21
    buffer_store_dword v85, v10, s[8:11], s21 offen
    s_branch Lstep_9
Llast_10:
    s_sleep 3
    buffer_load_dwordx4 v[96:99], v8, s[8:11], s21 offen offset:0 sc1
    buffer_load_dwordx4 v[100:103], v8, s[8:11], s21 offen offset:1024 sc1
    buffer_load_dwordx4 v[104:107], v8, s[8:11], s21 offen offset:2048 sc1
    buffer_load_dwordx4 v[108:111], v8, s[8:11], s21 offen offset:3072 sc1
    v_mov_b32 v40, 0
    v_mov_b32 v41, 0
    v_mov_b32 v42, 0
    v_mov_b32 v43, 0
    v_mov_b32 v44, 0
    v_mov_b32 v45, 0
    v_mov_b32 v46, 0
    v_mov_b32 v47, 0
    v_mov_b32 v48, 0
    v_mov_b32 v49, 0
    v_mov_b32 v50, 0
    v_mov_b32 v51, 0
    v_mov_b32 v52, 0
    v_mov_b32 v53, 0
    v_mov_b32 v54, 0
    v_mov_b32 v55, 0
    v_mov_b32 v56, 0
    v_mov_b32 v57, 0
    v_mov_b32 v58, 0
    v_mov_b32 v59, 0
    v_mov_b32 v60, 0
    v_mov_b32 v61, 0
    v_mov_b32 v62, 0
    v_mov_b32 v63, 0
    s_and_b32 s4, s19, 3
    s_lshl_b32 s5, s4, 17
    s_add_u32 s24, s5, 98566144
    s_add_u32 s5, s4, 2
    s_and_b32 s5, s5, 3
    s_lshl_b32 s5, s5, 17
    s_add_u32 s28, s5, 98566144
    s_add_u32 s4, s4, 3
    s_and_b32 s4, s4, 3
    s_lshl_b32 s5, s4, 14
    s_add_u32 s78, s5, s72
    s_lshl_b32 s5, s4, 12
    s_add_u32 s79, s5, s73
    s_lshl_b32 s5, s4, 13
    s_add_u32 s29, s5, s74
    s_lshl_b32 s30, s19, 17
    s_waitcnt vmcnt(3)
LpA_33:
    v_max3_u32 v28, v96, v97, v98
    v_max_u32 v28, v28, v99
    v_cmp_eq_u32 vcc, -1, v28
    s_cbranch_vccnz LrA_34
    v_smfmac_f32_16x16x64_bf16 v[40:43], v[96:99], a[0:7], v19
    v_smfmac_f32_16x16x64_bf16 v[44:47], v[96:99], a[32:39], v19
    v_smfmac_f32_16x16x64_bf16 v[48:51], v[96:99], a[64:71], v19
    v_smfmac_f32_16x16x64_bf16 v[52:55], v[96:99], a[96:103], v19
    s_waitcnt vmcnt(2)
LpA_36:
    v_max3_u32 v28, v100, v101, v102
    v_max_u32 v28, v28, v103
    v_cmp_eq_u32 vcc, -1, v28
    s_cbranch_vccnz LrA_37
    v_smfmac_f32_16x16x64_bf16 v[40:43], v[100:103], a[8:15], v19
    v_smfmac_f32_16x16x64_bf16 v[44:47], v[100:103], a[40:47], v19
    v_smfmac_f32_16x16x64_bf16 v[48:51], v[100:103], a[72:79], v19
    v_smfmac_f32_16x16x64_bf16 v[52:55], v[100:103], a[104:111], v19
    s_waitcnt vmcnt(1)
LpA_39:
    v_max3_u32 v28, v104, v105, v106
    v_max_u32 v28, v28, v107
    v_cmp_eq_u32 vcc, -1, v28
    s_cbranch_vccnz LrA_40
    v_smfmac_f32_16x16x64_bf16 v[40:43], v[104:107], a[16:23], v19
    v_smfmac_f32_16x16x64_bf16 v[44:47], v[104:107], a[48:55], v19
    v_smfmac_f32_16x16x64_bf16 v[48:51], v[104:107], a[80:87], v19
    v_smfmac_f32_16x16x64_bf16 v[52:55], v[104:107], a[112:119], v19
    s_waitcnt vmcnt(0)
LpA_42:
    v_max3_u32 v28, v108, v109, v110
    v_max_u32 v28, v28, v111
    v_cmp_eq_u32 vcc, -1, v28
    s_cbranch_vccnz LrA_43
    v_smfmac_f32_16x16x64_bf16 v[40:43], v[108:111], a[24:31], v19
    v_smfmac_f32_16x16x64_bf16 v[44:47], v[108:111], a[56:63], v19
    v_smfmac_f32_16x16x64_bf16 v[48:51], v[108:111], a[88:95], v19
    v_smfmac_f32_16x16x64_bf16 v[52:55], v[108:111], a[120:127], v19
    v_smfmac_f32_16x16x64_bf16 v[56:59], v[96:99], a[128:135], v19
    v_smfmac_f32_16x16x64_bf16 v[60:63], v[96:99], a[160:167], v19
    ds_write_b128 v16, v[40:43] offset:0
    v_smfmac_f32_16x16x64_bf16 v[56:59], v[100:103], a[136:143], v19
    ds_write_b128 v16, v[44:47] offset:4096
    v_smfmac_f32_16x16x64_bf16 v[60:63], v[100:103], a[168:175], v19
    ds_write_b128 v16, v[48:51] offset:8192
    v_smfmac_f32_16x16x64_bf16 v[56:59], v[104:107], a[144:151], v19
    ds_write_b128 v16, v[52:55] offset:12288
    v_smfmac_f32_16x16x64_bf16 v[60:63], v[104:107], a[176:183], v19
    v_smfmac_f32_16x16x64_bf16 v[56:59], v[108:111], a[152:159], v19
    v_smfmac_f32_16x16x64_bf16 v[60:63], v[108:111], a[184:191], v19
    s_waitcnt lgkmcnt(0)
    s_barrier
    ds_read_b128 v[112:115], v8 offset:0
    ds_read_b128 v[116:119], v8 offset:1024
    ds_read_b128 v[120:123], v8 offset:2048
    ds_read_b128 v[124:127], v8 offset:3072
    ds_write_b128 v16, v[56:59] offset:47104
    ds_write_b128 v16, v[60:63] offset:51200
    s_waitcnt lgkmcnt(2)
    v_pk_add_f32 v[112:113], v[112:113], v[116:117]
    v_pk_add_f32 v[114:115], v[114:115], v[118:119]
    v_pk_add_f32 v[120:121], v[120:121], v[124:125]
    v_pk_add_f32 v[122:123], v[122:123], v[126:127]
    v_pk_add_f32 v[112:113], v[112:113], v[120:121]
    v_pk_add_f32 v[114:115], v[114:115], v[122:123]
    s_nop 1
    v_permlane32_swap_b32 v112, v114
    v_permlane32_swap_b32 v113, v115
    v_add_f32 v76, v112, v114
    v_add_f32 v77, v113, v115
    v_cvt_pk_bf16_f32 v78, v76, v77
    s_nop 1
    v_mov_b32_dpp v79, v78 quad_perm:[1,0,3,2] row_mask:0xf bank_mask:0xf
    v_perm_b32 v78, v78, v79, v20
    s_waitcnt lgkmcnt(0)
    s_barrier
    ds_read_b128 v[112:115], v8 offset:47104
    ds_read_b128 v[116:119], v8 offset:48128
    ds_read_b128 v[120:123], v8 offset:49152
    ds_read_b128 v[124:127], v8 offset:50176
    ds_write_b32 v33, v78
    s_waitcnt lgkmcnt(1)
    v_pk_add_f32 v[112:113], v[112:113], v[116:117]
    v_pk_add_f32 v[114:115], v[114:115], v[118:119]
    v_pk_add_f32 v[120:121], v[120:121], v[124:125]
    v_pk_add_f32 v[122:123], v[122:123], v[126:127]
    v_pk_add_f32 v[112:113], v[112:113], v[120:121]
    v_pk_add_f32 v[114:115], v[114:115], v[122:123]
    s_nop 1
    v_permlane32_swap_b32 v112, v114
    v_permlane32_swap_b32 v113, v115
    v_add_f32 v80, v112, v114
    v_add_f32 v81, v113, v115
    v_cvt_pk_bf16_f32 v82, v80, 0
    v_cvt_pk_bf16_f32 v83, v81, 0
    v_cvt_pk_bf16_f32 v23, v80, v81
    ds_write_b64 v22, v[82:83]
    ds_write_b32 v34, v23
    s_waitcnt lgkmcnt(0)
    s_barrier
    ds_read_b128 v[72:75], v9 offset:25600
    s_waitcnt lgkmcnt(0)
    buffer_store_dwordx4 v[72:75], v35, s[8:11], s30 offen sc1
    s_waitcnt vmcnt(0)
    s_branch L_R_done
Lwave_6:
Lstep_45:
    s_cmp_eq_u32 s19, 63
    s_cbranch_scc1 Llast_46
    s_sleep 3
    buffer_load_dwordx4 v[96:99], v8, s[8:11], s21 offen offset:0 sc1
    buffer_load_dwordx4 v[100:103], v8, s[8:11], s21 offen offset:1024 sc1
    buffer_load_dwordx4 v[104:107], v8, s[8:11], s21 offen offset:2048 sc1
    buffer_load_dwordx4 v[108:111], v8, s[8:11], s21 offen offset:3072 sc1
    v_mov_b32 v40, 0
    v_mov_b32 v41, 0
    v_mov_b32 v42, 0
    v_mov_b32 v43, 0
    v_mov_b32 v44, 0
    v_mov_b32 v45, 0
    v_mov_b32 v46, 0
    v_mov_b32 v47, 0
    v_mov_b32 v48, 0
    v_mov_b32 v49, 0
    v_mov_b32 v50, 0
    v_mov_b32 v51, 0
    v_mov_b32 v52, 0
    v_mov_b32 v53, 0
    v_mov_b32 v54, 0
    v_mov_b32 v55, 0
    v_mov_b32 v56, 0
    v_mov_b32 v57, 0
    v_mov_b32 v58, 0
    v_mov_b32 v59, 0
    v_mov_b32 v60, 0
    v_mov_b32 v61, 0
    v_mov_b32 v62, 0
    v_mov_b32 v63, 0
    s_and_b32 s4, s19, 3
    s_lshl_b32 s5, s4, 17
    s_add_u32 s24, s5, 98566144
    s_add_u32 s5, s4, 2
    s_and_b32 s5, s5, 3
    s_lshl_b32 s5, s5, 17
    s_add_u32 s28, s5, 98566144
    s_add_u32 s4, s4, 3
    s_and_b32 s4, s4, 3
    s_lshl_b32 s5, s4, 14
    s_add_u32 s78, s5, s72
    s_lshl_b32 s5, s4, 12
    s_add_u32 s79, s5, s73
    s_lshl_b32 s5, s4, 13
    s_add_u32 s29, s5, s74
    s_lshl_b32 s30, s19, 17
    s_waitcnt vmcnt(3)
LpA_47:
    v_max3_u32 v28, v96, v97, v98
    v_max_u32 v28, v28, v99
    v_cmp_eq_u32 vcc, -1, v28
    s_cbranch_vccnz LrA_48
    v_smfmac_f32_16x16x64_bf16 v[40:43], v[96:99], a[0:7], v19
    v_smfmac_f32_16x16x64_bf16 v[44:47], v[96:99], a[32:39], v19
    v_smfmac_f32_16x16x64_bf16 v[48:51], v[96:99], a[64:71], v19
    v_smfmac_f32_16x16x64_bf16 v[52:55], v[96:99], a[96:103], v19
    s_waitcnt vmcnt(2)
LpA_50:
    v_max3_u32 v28, v100, v101, v102
    v_max_u32 v28, v28, v103
    v_cmp_eq_u32 vcc, -1, v28
    s_cbranch_vccnz LrA_51
    v_smfmac_f32_16x16x64_bf16 v[40:43], v[100:103], a[8:15], v19
    v_smfmac_f32_16x16x64_bf16 v[44:47], v[100:103], a[40:47], v19
    v_smfmac_f32_16x16x64_bf16 v[48:51], v[100:103], a[72:79], v19
    v_smfmac_f32_16x16x64_bf16 v[52:55], v[100:103], a[104:111], v19
    s_waitcnt vmcnt(1)
LpA_53:
    v_max3_u32 v28, v104, v105, v106
    v_max_u32 v28, v28, v107
    v_cmp_eq_u32 vcc, -1, v28
    s_cbranch_vccnz LrA_54
    v_smfmac_f32_16x16x64_bf16 v[40:43], v[104:107], a[16:23], v19
    v_smfmac_f32_16x16x64_bf16 v[44:47], v[104:107], a[48:55], v19
    v_smfmac_f32_16x16x64_bf16 v[48:51], v[104:107], a[80:87], v19
    v_smfmac_f32_16x16x64_bf16 v[52:55], v[104:107], a[112:119], v19
    s_waitcnt vmcnt(0)
LpA_56:
    v_max3_u32 v28, v108, v109, v110
    v_max_u32 v28, v28, v111
    v_cmp_eq_u32 vcc, -1, v28
    s_cbranch_vccnz LrA_57
    v_smfmac_f32_16x16x64_bf16 v[40:43], v[108:111], a[24:31], v19
    v_smfmac_f32_16x16x64_bf16 v[44:47], v[108:111], a[56:63], v19
    v_smfmac_f32_16x16x64_bf16 v[48:51], v[108:111], a[88:95], v19
    v_smfmac_f32_16x16x64_bf16 v[52:55], v[108:111], a[120:127], v19
    v_smfmac_f32_16x16x64_bf16 v[56:59], v[96:99], a[128:135], v19
    v_smfmac_f32_16x16x64_bf16 v[60:63], v[96:99], a[160:167], v19
    ds_write_b128 v16, v[40:43] offset:0
    v_smfmac_f32_16x16x64_bf16 v[56:59], v[100:103], a[136:143], v19
    ds_write_b128 v16, v[44:47] offset:4096
    v_smfmac_f32_16x16x64_bf16 v[60:63], v[100:103], a[168:175], v19
    ds_write_b128 v16, v[48:51] offset:8192
    v_smfmac_f32_16x16x64_bf16 v[56:59], v[104:107], a[144:151], v19
    ds_write_b128 v16, v[52:55] offset:12288
    v_smfmac_f32_16x16x64_bf16 v[60:63], v[104:107], a[176:183], v19
    v_smfmac_f32_16x16x64_bf16 v[56:59], v[108:111], a[152:159], v19
    v_smfmac_f32_16x16x64_bf16 v[60:63], v[108:111], a[184:191], v19
    s_waitcnt lgkmcnt(0)
    s_barrier
    ds_read_b128 v[112:115], v8 offset:0
    ds_read_b128 v[116:119], v8 offset:1024
    ds_read_b128 v[120:123], v8 offset:2048
    ds_read_b128 v[124:127], v8 offset:3072
    ds_write_b128 v16, v[56:59] offset:47104
    ds_write_b128 v16, v[60:63] offset:51200
    s_waitcnt lgkmcnt(2)
    v_pk_add_f32 v[112:113], v[112:113], v[116:117]
    v_pk_add_f32 v[114:115], v[114:115], v[118:119]
    v_pk_add_f32 v[120:121], v[120:121], v[124:125]
    v_pk_add_f32 v[122:123], v[122:123], v[126:127]
    v_pk_add_f32 v[112:113], v[112:113], v[120:121]
    v_pk_add_f32 v[114:115], v[114:115], v[122:123]
    s_nop 1
    v_permlane32_swap_b32 v112, v114
    v_permlane32_swap_b32 v113, v115
    v_add_f32 v76, v112, v114
    v_add_f32 v77, v113, v115
    v_cvt_pk_bf16_f32 v78, v76, v77
    s_nop 1
    v_mov_b32_dpp v79, v78 quad_perm:[1,0,3,2] row_mask:0xf bank_mask:0xf
    v_perm_b32 v78, v78, v79, v20
    buffer_store_dword v78, v11, s[8:11], s22 offen
    s_cmp_eq_u32 s19, 0
    s_cbranch_scc1 Lk0h_59
Lk0b_60:
    s_waitcnt lgkmcnt(0)
    s_barrier
    ds_read_b128 v[112:115], v8 offset:47104
    ds_read_b128 v[116:119], v8 offset:48128
    ds_read_b128 v[120:123], v8 offset:49152
    ds_read_b128 v[124:127], v8 offset:50176
    ds_write_b32 v33, v78
    s_waitcnt lgkmcnt(1)
    v_pk_add_f32 v[112:113], v[112:113], v[116:117]
    v_pk_add_f32 v[114:115], v[114:115], v[118:119]
    v_pk_add_f32 v[120:121], v[120:121], v[124:125]
    v_pk_add_f32 v[122:123], v[122:123], v[126:127]
    v_pk_add_f32 v[112:113], v[112:113], v[120:121]
    v_pk_add_f32 v[114:115], v[114:115], v[122:123]
    s_nop 1
    v_permlane32_swap_b32 v112, v114
    v_permlane32_swap_b32 v113, v115
    v_add_f32 v80, v112, v114
    v_add_f32 v81, v113, v115
    v_cvt_pk_bf16_f32 v82, v80, 0
    v_cvt_pk_bf16_f32 v83, v81, 0
    v_cvt_pk_bf16_f32 v23, v80, v81
    ds_write_b64 v22, v[82:83]
    ds_write_b32 v34, v23
    s_waitcnt lgkmcnt(0)
    s_barrier
    s_or_b32 s4, s16, s17
    s_cmp_lg_u32 s4, 0
    s_cbranch_scc1 Lprg_63
    s_add_u32 s4, s19, 1
    v_mov_b32 v28, 102772736
    v_mov_b32 v29, s4
    s_mov_b64 exec, 1
    buffer_store_dword v29, v28, s[8:11], 0 offen sc1
    s_mov_b64 exec, -1
Lprg_63:
    s_barrier
    s_sleep 4
    buffer_load_dwordx4 v[136:139], v13, s[8:11], s23 offen offset:0 sc1
    buffer_load_dwordx4 v[140:143], v13, s[8:11], s23 offen offset:1024 sc1
    v_mov_b32 v64, 0
    v_mov_b32 v65, 0
    v_mov_b32 v66, 0
    v_mov_b32 v67, 0
LpO_64:
    s_waitcnt vmcnt(0)
    v_max3_u32 v28, v136, v137, v138
    v_max3_u32 v28, v28, v139, v140
    v_max3_u32 v28, v28, v141, v142
    v_max_u32 v28, v28, v143
    v_cmp_eq_u32 vcc, -1, v28
    s_cbranch_vccnz LrO_65
    ds_write_b128 v13, v[136:139] offset:16384
    ds_write_b128 v13, v[140:143] offset:17408
    v_smfmac_f32_16x16x64_bf16 v[64:67], v[136:139], a[208:215], v19
    s_waitcnt lgkmcnt(0)
    s_barrier
    ds_read_b128 v[128:131], v9 offset:16384
    ds_read_b128 v[132:135], v9 offset:17408
    ds_read_b128 v[144:147], v9 offset:20480
    ds_read_b128 v[148:151], v9 offset:21504
    ds_read_b128 v[152:155], v9 offset:22528
    ds_read_b128 v[156:159], v9 offset:23552
    v_smfmac_f32_16x16x64_bf16 v[64:67], v[140:143], a[216:223], v19
    s_waitcnt lgkmcnt(5)
    v_smfmac_f32_16x16x64_bf16 v[64:67], v[128:131], a[192:199], v19
    s_waitcnt lgkmcnt(4)
    v_smfmac_f32_16x16x64_bf16 v[64:67], v[132:135], a[200:207], v19
    s_waitcnt lgkmcnt(3)
    v_smfmac_f32_16x16x64_bf16 v[64:67], v[144:147], a[224:231], v19
    s_waitcnt lgkmcnt(2)
    v_smfmac_f32_16x16x64_bf16 v[64:67], v[148:151], a[232:239], v19
    s_waitcnt lgkmcnt(1)
    v_smfmac_f32_16x16x64_bf16 v[64:67], v[152:155], a[240:247], v19
    s_waitcnt lgkmcnt(0)
    v_smfmac_f32_16x16x64_bf16 v[64:67], v[156:159], a[248:255], v19
    s_nop 7
    v_permlane32_swap_b32 v64, v76
    v_permlane32_swap_b32 v65, v77
    v_permlane32_swap_b32 v66, v78
    v_permlane32_swap_b32 v67, v79
    v_pk_add_f32 v[64:65], v[64:65], v[76:77]
    v_pk_add_f32 v[66:67], v[66:67], v[78:79]
    v_cvt_pk_bf16_f32 v80, v64, v65
    v_cvt_pk_bf16_f32 v81, v66, v67
    s_nop 0
    v_permlane16_swap_b32 v80, v82
    v_permlane16_swap_b32 v81, v83
    buffer_store_dwordx4 v[80:83], v14, s[8:11], s24 offen sc1
    s_lshl_b32 s6, s3, 10
    s_add_u32 s6, s6, s34
    s_mov_b32 m0, s6
    s_add_u32 s6, s6, 3840
    buffer_load_dwordx4 v17, s[8:11], s31 offen sc1 lds
    s_mov_b32 m0, s6
    s_add_u32 s6, s6, 4352
    buffer_load_dwordx4 v17, s[8:11], s31 offen offset:256 sc1 lds
    s_mov_b32 m0, s6
    s_nop 0
    buffer_load_dwordx4 v18, s[8:11], s32 offen sc1 lds
    buffer_store_dwordx4 v[24:27], v30, s[8:11], s28 offen sc1
    s_sleep 12
    buffer_load_dwordx4 v[68:71], v15, s[8:11], s24 offen sc1
    s_add_u32 s19, s19, 1
    s_and_b32 s4, s19, 3
    s_lshl_b32 s5, s4, 14
    s_add_u32 s21, s5, s72
    s_lshl_b32 s5, s4, 12
    s_add_u32 s22, s5, s73
    s_lshl_b32 s5, s4, 13
    s_add_u32 s23, s5, s74
    s_and_b32 s4, s19, 1
    s_mul_i32 s4, s4, 10240
    s_add_u32 s33, s4, 26624
    s_add_u32 s37, s19, 1
    s_min_u32 s37, s37, 63
    s_lshr_b32 s4, s37, 3
    s_lshl_b32 s4, s4, 21
    s_and_b32 s5, s37, 7
    s_lshl_b32 s5, s5, 9
    s_add_u32 s4, s4, s5
    s_add_u32 s31, s4, s76
    s_lshl_b32 s4, s37, 18
    s_add_u32 s32, s4, s77
    s_and_b32 s4, s37, 1
    s_mul_i32 s4, s4, 10240
    s_add_u32 s34, s4, 26624
LpC_66:
    s_waitcnt vmcnt(0)
    v_max3_u32 v28, v68, v69, v70
    v_max_u32 v28, v28, v71
    v_cmp_eq_u32 vcc, -1, v28
    s_cbranch_vccnz LrC_67
    v_mfma_f32_16x16x32_bf16 v[76:79], v[36:39], v[68:71], 0
    s_nop 7
    v_add_f32_dpp v76, v76, v76 row_ror:8 row_mask:0xf bank_mask:0xf
    v_add_f32_dpp v77, v77, v77 row_ror:8 row_mask:0xf bank_mask:0xf
    v_add_f32_dpp v78, v78, v78 row_ror:8 row_mask:0xf bank_mask:0xf
    v_add_f32_dpp v79, v79, v79 row_ror:8 row_mask:0xf bank_mask:0xf
    v_cvt_pk_bf16_f32 v80, v76, v77
    v_cvt_pk_bf16_f32 v81, v78, v79
    v_cndmask_b32 v82, v81, v80, s[26:27]
    v_cndmask_b32 v83, v80, v81, s[26:27]
    s_nop 0
    v_mov_b32_dpp v84, v82 quad_perm:[1,0,3,2] row_mask:0xf bank_mask:0xf
    v_perm_b32 v85, v83, v84, v21
    buffer_store_dword v85, v10, s[8:11], s21 offen
    s_branch Lstep_45
Llast_46:
    s_sleep 3
    buffer_load_dwordx4 v[96:99], v8, s[8:11], s21 offen offset:0 sc1
    buffer_load_dwordx4 v[100:103], v8, s[8:11], s21 offen offset:1024 sc1
    buffer_load_dwordx4 v[104:107], v8, s[8:11], s21 offen offset:2048 sc1
    buffer_load_dwordx4 v[108:111], v8, s[8:11], s21 offen offset:3072 sc1
    v_mov_b32 v40, 0
    v_mov_b32 v41, 0
    v_mov_b32 v42, 0
    v_mov_b32 v43, 0
    v_mov_b32 v44, 0
    v_mov_b32 v45, 0
    v_mov_b32 v46, 0
    v_mov_b32 v47, 0
    v_mov_b32 v48, 0
    v_mov_b32 v49, 0
    v_mov_b32 v50, 0
    v_mov_b32 v51, 0
    v_mov_b32 v52, 0
    v_mov_b32 v53, 0
    v_mov_b32 v54, 0
    v_mov_b32 v55, 0
    v_mov_b32 v56, 0
    v_mov_b32 v57, 0
    v_mov_b32 v58, 0
    v_mov_b32 v59, 0
    v_mov_b32 v60, 0
    v_mov_b32 v61, 0
    v_mov_b32 v62, 0
    v_mov_b32 v63, 0
    s_and_b32 s4, s19, 3
    s_lshl_b32 s5, s4, 17
    s_add_u32 s24, s5, 98566144
    s_add_u32 s5, s4, 2
    s_and_b32 s5, s5, 3
    s_lshl_b32 s5, s5, 17
    s_add_u32 s28, s5, 98566144
    s_add_u32 s4, s4, 3
    s_and_b32 s4, s4, 3
    s_lshl_b32 s5, s4, 14
    s_add_u32 s78, s5, s72
    s_lshl_b32 s5, s4, 12
    s_add_u32 s79, s5, s73
    s_lshl_b32 s5, s4, 13
    s_add_u32 s29, s5, s74
    s_lshl_b32 s30, s19, 17
    s_waitcnt vmcnt(3)
LpA_68:
    v_max3_u32 v28, v96, v97, v98
    v_max_u32 v28, v28, v99
    v_cmp_eq_u32 vcc, -1, v28
    s_cbranch_vccnz LrA_69
    v_smfmac_f32_16x16x64_bf16 v[40:43], v[96:99], a[0:7], v19
    v_smfmac_f32_16x16x64_bf16 v[44:47], v[96:99], a[32:39], v19
    v_smfmac_f32_16x16x64_bf16 v[48:51], v[96:99], a[64:71], v19
    v_smfmac_f32_16x16x64_bf16 v[52:55], v[96:99], a[96:103], v19
    s_waitcnt vmcnt(2)
LpA_71:
    v_max3_u32 v28, v100, v101, v102
    v_max_u32 v28, v28, v103
    v_cmp_eq_u32 vcc, -1, v28
    s_cbranch_vccnz LrA_72
    v_smfmac_f32_16x16x64_bf16 v[40:43], v[100:103], a[8:15], v19
    v_smfmac_f32_16x16x64_bf16 v[44:47], v[100:103], a[40:47], v19
    v_smfmac_f32_16x16x64_bf16 v[48:51], v[100:103], a[72:79], v19
    v_smfmac_f32_16x16x64_bf16 v[52:55], v[100:103], a[104:111], v19
    s_waitcnt vmcnt(1)
LpA_74:
    v_max3_u32 v28, v104, v105, v106
    v_max_u32 v28, v28, v107
    v_cmp_eq_u32 vcc, -1, v28
    s_cbranch_vccnz LrA_75
    v_smfmac_f32_16x16x64_bf16 v[40:43], v[104:107], a[16:23], v19
    v_smfmac_f32_16x16x64_bf16 v[44:47], v[104:107], a[48:55], v19
    v_smfmac_f32_16x16x64_bf16 v[48:51], v[104:107], a[80:87], v19
    v_smfmac_f32_16x16x64_bf16 v[52:55], v[104:107], a[112:119], v19
    s_waitcnt vmcnt(0)
LpA_77:
    v_max3_u32 v28, v108, v109, v110
    v_max_u32 v28, v28, v111
    v_cmp_eq_u32 vcc, -1, v28
    s_cbranch_vccnz LrA_78
    v_smfmac_f32_16x16x64_bf16 v[40:43], v[108:111], a[24:31], v19
    v_smfmac_f32_16x16x64_bf16 v[44:47], v[108:111], a[56:63], v19
    v_smfmac_f32_16x16x64_bf16 v[48:51], v[108:111], a[88:95], v19
    v_smfmac_f32_16x16x64_bf16 v[52:55], v[108:111], a[120:127], v19
    v_smfmac_f32_16x16x64_bf16 v[56:59], v[96:99], a[128:135], v19
    v_smfmac_f32_16x16x64_bf16 v[60:63], v[96:99], a[160:167], v19
    ds_write_b128 v16, v[40:43] offset:0
    v_smfmac_f32_16x16x64_bf16 v[56:59], v[100:103], a[136:143], v19
    ds_write_b128 v16, v[44:47] offset:4096
    v_smfmac_f32_16x16x64_bf16 v[60:63], v[100:103], a[168:175], v19
    ds_write_b128 v16, v[48:51] offset:8192
    v_smfmac_f32_16x16x64_bf16 v[56:59], v[104:107], a[144:151], v19
    ds_write_b128 v16, v[52:55] offset:12288
    v_smfmac_f32_16x16x64_bf16 v[60:63], v[104:107], a[176:183], v19
    v_smfmac_f32_16x16x64_bf16 v[56:59], v[108:111], a[152:159], v19
    v_smfmac_f32_16x16x64_bf16 v[60:63], v[108:111], a[184:191], v19
    s_waitcnt lgkmcnt(0)
    s_barrier
    ds_read_b128 v[112:115], v8 offset:0
    ds_read_b128 v[116:119], v8 offset:1024
    ds_read_b128 v[120:123], v8 offset:2048
    ds_read_b128 v[124:127], v8 offset:3072
    ds_write_b128 v16, v[56:59] offset:47104
    ds_write_b128 v16, v[60:63] offset:51200
    s_waitcnt lgkmcnt(2)
    v_pk_add_f32 v[112:113], v[112:113], v[116:117]
    v_pk_add_f32 v[114:115], v[114:115], v[118:119]
    v_pk_add_f32 v[120:121], v[120:121], v[124:125]
    v_pk_add_f32 v[122:123], v[122:123], v[126:127]
    v_pk_add_f32 v[112:113], v[112:113], v[120:121]
    v_pk_add_f32 v[114:115], v[114:115], v[122:123]
    s_nop 1
    v_permlane32_swap_b32 v112, v114
    v_permlane32_swap_b32 v113, v115
    v_add_f32 v76, v112, v114
    v_add_f32 v77, v113, v115
    v_cvt_pk_bf16_f32 v78, v76, v77
    s_nop 1
    v_mov_b32_dpp v79, v78 quad_perm:[1,0,3,2] row_mask:0xf bank_mask:0xf
    v_perm_b32 v78, v78, v79, v20
    s_waitcnt lgkmcnt(0)
    s_barrier
    ds_read_b128 v[112:115], v8 offset:47104
    ds_read_b128 v[116:119], v8 offset:48128
    ds_read_b128 v[120:123], v8 offset:49152
    ds_read_b128 v[124:127], v8 offset:50176
    ds_write_b32 v33, v78
    s_waitcnt lgkmcnt(1)
    v_pk_add_f32 v[112:113], v[112:113], v[116:117]
    v_pk_add_f32 v[114:115], v[114:115], v[118:119]
    v_pk_add_f32 v[120:121], v[120:121], v[124:125]
    v_pk_add_f32 v[122:123], v[122:123], v[126:127]
    v_pk_add_f32 v[112:113], v[112:113], v[120:121]
    v_pk_add_f32 v[114:115], v[114:115], v[122:123]
    s_nop 1
    v_permlane32_swap_b32 v112, v114
    v_permlane32_swap_b32 v113, v115
    v_add_f32 v80, v112, v114
    v_add_f32 v81, v113, v115
    v_cvt_pk_bf16_f32 v82, v80, 0
    v_cvt_pk_bf16_f32 v83, v81, 0
    v_cvt_pk_bf16_f32 v23, v80, v81
    ds_write_b64 v22, v[82:83]
    ds_write_b32 v34, v23
    s_waitcnt lgkmcnt(0)
    s_barrier
    s_waitcnt vmcnt(0)
    s_branch L_R_done
Lwave_7:
    v_mov_b32 v216, 0x3f803f80
    v_mov_b32 v217, 0x3f803f80
    v_mov_b32 v218, 0x3f803f80
    v_mov_b32 v219, 0x3f803f80
    v_mov_b32 v211, 0
    v_mov_b32 v215, 0
    v_mov_b32 v223, 0
Lstep_80:
    s_cmp_eq_u32 s19, 63
    s_cbranch_scc1 Llast_81
    s_sleep 3
    buffer_load_dwordx4 v[96:99], v8, s[8:11], s21 offen offset:0 sc1
    buffer_load_dwordx4 v[100:103], v8, s[8:11], s21 offen offset:1024 sc1
    buffer_load_dwordx4 v[104:107], v8, s[8:11], s21 offen offset:2048 sc1
    buffer_load_dwordx4 v[108:111], v8, s[8:11], s21 offen offset:3072 sc1
    v_mov_b32 v40, 0
    v_mov_b32 v41, 0
    v_mov_b32 v42, 0
    v_mov_b32 v43, 0
    v_mov_b32 v44, 0
    v_mov_b32 v45, 0
    v_mov_b32 v46, 0
    v_mov_b32 v47, 0
    v_mov_b32 v48, 0
    v_mov_b32 v49, 0
    v_mov_b32 v50, 0
    v_mov_b32 v51, 0
    v_mov_b32 v52, 0
    v_mov_b32 v53, 0
    v_mov_b32 v54, 0
    v_mov_b32 v55, 0
    v_mov_b32 v56, 0
    v_mov_b32 v57, 0
    v_mov_b32 v58, 0
    v_mov_b32 v59, 0
    v_mov_b32 v60, 0
    v_mov_b32 v61, 0
    v_mov_b32 v62, 0
    v_mov_b32 v63, 0
    s_and_b32 s4, s19, 3
    s_lshl_b32 s5, s4, 17
    s_add_u32 s24, s5, 98566144
    s_add_u32 s5, s4, 2
    s_and_b32 s5, s5, 3
    s_lshl_b32 s5, s5, 17
    s_add_u32 s28, s5, 98566144
    s_add_u32 s4, s4, 3
    s_and_b32 s4, s4, 3
    s_lshl_b32 s5, s4, 14
    s_add_u32 s78, s5, s72
    s_lshl_b32 s5, s4, 12
    s_add_u32 s79, s5, s73
    s_lshl_b32 s5, s4, 13
    s_add_u32 s29, s5, s74
    s_lshl_b32 s30, s19, 17
    s_waitcnt vmcnt(3)
LpA_82:
    v_max3_u32 v28, v96, v97, v98
    v_max_u32 v28, v28, v99
    v_cmp_eq_u32 vcc, -1, v28
    s_cbranch_vccnz LrA_83
    v_smfmac_f32_16x16x64_bf16 v[40:43], v[96:99], a[0:7], v19
    v_smfmac_f32_16x16x64_bf16 v[44:47], v[96:99], a[32:39], v19
    v_smfmac_f32_16x16x64_bf16 v[48:51], v[96:99], a[64:71], v19
    v_smfmac_f32_16x16x64_bf16 v[52:55], v[96:99], a[96:103], v19
    s_waitcnt vmcnt(2)
LpA_85:
    v_max3_u32 v28, v100, v101, v102
    v_max_u32 v28, v28, v103
    v_cmp_eq_u32 vcc, -1, v28
    s_cbranch_vccnz LrA_86
    v_smfmac_f32_16x16x64_bf16 v[40:43], v[100:103], a[8:15], v19
    v_smfmac_f32_16x16x64_bf16 v[44:47], v[100:103], a[40:47], v19
    v_smfmac_f32_16x16x64_bf16 v[48:51], v[100:103], a[72:79], v19
    v_smfmac_f32_16x16x64_bf16 v[52:55], v[100:103], a[104:111], v19
    s_waitcnt vmcnt(1)
LpA_88:
    v_max3_u32 v28, v104, v105, v106
    v_max_u32 v28, v28, v107
    v_cmp_eq_u32 vcc, -1, v28
    s_cbranch_vccnz LrA_89
    v_smfmac_f32_16x16x64_bf16 v[40:43], v[104:107], a[16:23], v19
    v_smfmac_f32_16x16x64_bf16 v[44:47], v[104:107], a[48:55], v19
    v_smfmac_f32_16x16x64_bf16 v[48:51], v[104:107], a[80:87], v19
    v_smfmac_f32_16x16x64_bf16 v[52:55], v[104:107], a[112:119], v19
    s_waitcnt vmcnt(0)
LpA_91:
    v_max3_u32 v28, v108, v109, v110
    v_max_u32 v28, v28, v111
    v_cmp_eq_u32 vcc, -1, v28
    s_cbranch_vccnz LrA_92
    v_smfmac_f32_16x16x64_bf16 v[40:43], v[108:111], a[24:31], v19
    v_smfmac_f32_16x16x64_bf16 v[44:47], v[108:111], a[56:63], v19
    v_smfmac_f32_16x16x64_bf16 v[48:51], v[108:111], a[88:95], v19
    v_smfmac_f32_16x16x64_bf16 v[52:55], v[108:111], a[120:127], v19
    v_smfmac_f32_16x16x64_bf16 v[56:59], v[96:99], a[128:135], v19
    v_smfmac_f32_16x16x64_bf16 v[60:63], v[96:99], a[160:167], v19
    ds_write_b128 v16, v[40:43] offset:0
    v_smfmac_f32_16x16x64_bf16 v[56:59], v[100:103], a[136:143], v19
    ds_write_b128 v16, v[44:47] offset:4096
    v_smfmac_f32_16x16x64_bf16 v[60:63], v[100:103], a[168:175], v19
    ds_write_b128 v16, v[48:51] offset:8192
    v_smfmac_f32_16x16x64_bf16 v[56:59], v[104:107], a[144:151], v19
    ds_write_b128 v16, v[52:55] offset:12288
    v_smfmac_f32_16x16x64_bf16 v[60:63], v[104:107], a[176:183], v19
    v_smfmac_f32_16x16x64_bf16 v[56:59], v[108:111], a[152:159], v19
    v_smfmac_f32_16x16x64_bf16 v[60:63], v[108:111], a[184:191], v19
    s_waitcnt lgkmcnt(0)
    s_barrier
    ds_read_b128 v[112:115], v8 offset:0
    ds_read_b128 v[116:119], v8 offset:1024
    ds_read_b128 v[120:123], v8 offset:2048
    ds_read_b128 v[124:127], v8 offset:3072
    ds_write_b128 v16, v[56:59] offset:47104
    ds_write_b128 v16, v[60:63] offset:51200
    s_waitcnt lgkmcnt(2)
    v_pk_add_f32 v[112:113], v[112:113], v[116:117]
    v_pk_add_f32 v[114:115], v[114:115], v[118:119]
    v_pk_add_f32 v[120:121], v[120:121], v[124:125]
    v_pk_add_f32 v[122:123], v[122:123], v[126:127]
    v_pk_add_f32 v[112:113], v[112:113], v[120:121]
    v_pk_add_f32 v[114:115], v[114:115], v[122:123]
    s_nop 1
    v_permlane32_swap_b32 v112, v114
    v_permlane32_swap_b32 v113, v115
    v_add_f32 v76, v112, v114
    v_add_f32 v77, v113, v115
    v_cvt_pk_bf16_f32 v78, v76, v77
    s_nop 1
    v_mov_b32_dpp v79, v78 quad_perm:[1,0,3,2] row_mask:0xf bank_mask:0xf
    v_perm_b32 v78, v78, v79, v20
    buffer_store_dword v78, v11, s[8:11], s22 offen
    s_cmp_eq_u32 s19, 0
    s_cbranch_scc1 Lk0h_94
Lk0b_95:
    s_waitcnt lgkmcnt(0)
    s_barrier
    v_add_u32 v29, s33, v9
    ds_read_b128 v[160:163], v29 offset:0
    ds_read_b128 v[164:167], v29 offset:1024
    ds_read_b128 v[168:171], v29 offset:2048
    ds_read_b128 v[172:175], v29 offset:3072
    ds_read_b128 v[176:179], v29 offset:4096
    ds_read_b128 v[180:183], v29 offset:5120
    ds_read_b128 v[184:187], v29 offset:6144
    ds_read_b128 v[188:191], v29 offset:7168
    ds_read_b64 v[208:209], v29 offset:8192
    ds_read_b64 v[212:213], v29 offset:8200
    s_sleep 4
    buffer_load_dwordx4 v[192:195], v9, s[8:11], s22 offen offset:0 sc1
    buffer_load_dwordx4 v[196:199], v9, s[8:11], s22 offen offset:1024 sc1
    buffer_load_dwordx4 v[200:203], v9, s[8:11], s22 offen offset:2048 sc1
    buffer_load_dwordx4 v[204:207], v9, s[8:11], s22 offen offset:3072 sc1
    s_sleep 3
    buffer_load_dwordx4 v[192:195], v9, s[8:11], s22 offen offset:0 sc1
    buffer_load_dwordx4 v[196:199], v9, s[8:11], s22 offen offset:1024 sc1
    buffer_load_dwordx4 v[200:203], v9, s[8:11], s22 offen offset:2048 sc1
    buffer_load_dwordx4 v[204:207], v9, s[8:11], s22 offen offset:3072 sc1
    s_barrier
    ds_read_b32 v210, v22
    ds_read_b32 v214, v22 offset:4
LpB_98:
    s_waitcnt vmcnt(4)
    v_max3_u32 v28, v192, v193, v194
    v_max3_u32 v28, v28, v195, v196
    v_max3_u32 v28, v28, v197, v198
    v_max3_u32 v28, v28, v199, v200
    v_max3_u32 v28, v28, v201, v202
    v_max3_u32 v28, v28, v203, v204
    v_max3_u32 v28, v28, v205, v206
    v_max_u32 v28, v28, v207
    v_cmp_eq_u32 vcc, -1, v28
    s_cbranch_vccnz LrB_99
    s_waitcnt lgkmcnt(0)
    v_mfma_f32_16x16x32_bf16 v[76:79], v[192:195], v[192:195], 0
    v_mfma_f32_16x16x32_bf16 v[80:83], v[160:163], v[192:195], 0
    v_mfma_f32_16x16x32_bf16 v[84:87], v[176:179], v[192:195], 0
    v_mfma_f32_16x16x32_bf16 v[76:79], v[196:199], v[196:199], v[76:79]
    v_mfma_f32_16x16x32_bf16 v[80:83], v[164:167], v[196:199], v[80:83]
    v_mfma_f32_16x16x32_bf16 v[84:87], v[180:183], v[196:199], v[84:87]
    v_mfma_f32_16x16x32_bf16 v[76:79], v[200:203], v[200:203], v[76:79]
    v_mfma_f32_16x16x32_bf16 v[80:83], v[168:171], v[200:203], v[80:83]
    v_mfma_f32_16x16x32_bf16 v[84:87], v[184:187], v[200:203], v[84:87]
    v_mfma_f32_16x16x32_bf16 v[76:79], v[204:207], v[204:207], v[76:79]
    v_mfma_f32_16x16x32_bf16 v[80:83], v[172:175], v[204:207], v[80:83]
    v_mfma_f32_16x16x32_bf16 v[84:87], v[188:191], v[204:207], v[84:87]
    s_nop 0
    v_mov_b32_dpp v76, v77 row_shr:8 row_mask:0xf bank_mask:0xc
    v_mov_b32_dpp v78, v79 row_shr:8 row_mask:0xf bank_mask:0xc
    s_nop 4
    v_mov_b32_dpp v80, v84 row_shr:8 row_mask:0xf bank_mask:0xc
    v_mov_b32_dpp v81, v85 row_shr:8 row_mask:0xf bank_mask:0xc
    v_mov_b32_dpp v82, v86 row_shr:8 row_mask:0xf bank_mask:0xc
    v_mov_b32_dpp v83, v87 row_shr:8 row_mask:0xf bank_mask:0xc
    v_permlane32_swap_b32 v76, v78
    v_max3_f32 v88, v80, v81, v82
    v_max3_f32 v88, v88, v83, v78
    s_nop 1
    v_max_f32_dpp v89, v88, v88 row_ror:8 row_mask:0xf bank_mask:0xf
    v_max_f32_dpp v88, v88, v88 row_ror:8 row_mask:0xf bank_mask:0xf
    s_nop 1
    v_permlane16_swap_b32 v88, v89
    v_max_f32 v88, v88, v89
    v_max_f32 v89, v88, v88
    s_nop 1
    v_permlane32_swap_b32 v88, v89
    v_max_f32 v88, v88, v89
    v_mul_f32 v88, s35, v88
    v_fma_f32 v80, v80, s35, -v88
    v_fma_f32 v81, v81, s35, -v88
    v_fma_f32 v82, v82, s35, -v88
    v_fma_f32 v83, v83, s35, -v88
    v_fma_f32 v78, v78, s35, -v88
    v_exp_f32 v80, v80
    v_exp_f32 v81, v81
    v_exp_f32 v82, v82
    v_exp_f32 v83, v83
    v_exp_f32 v78, v78
    v_cvt_pk_bf16_f32 v220, v80, v81
    v_cvt_pk_bf16_f32 v221, v82, v83
    v_cvt_pk_bf16_f32 v222, v78, 0
    s_nop 1
    v_mfma_f32_16x16x32_bf16 v[84:87], v[216:219], v[220:223], 0
    v_mfma_f32_16x16x32_bf16 v[76:79], v[208:211], v[220:223], 0
    v_mfma_f32_16x16x32_bf16 v[80:83], v[212:215], v[220:223], 0
    s_nop 3
    v_add_f32_dpp v88, v84, v84 row_ror:8 row_mask:0xf bank_mask:0xf
    v_rcp_f32 v88, v88
    s_nop 2
    v_add_f32_dpp v76, v80, v76 row_ror:8 row_mask:0xf bank_mask:0xf
    v_add_f32_dpp v77, v81, v77 row_ror:8 row_mask:0xf bank_mask:0xf
    v_add_f32_dpp v78, v82, v78 row_ror:8 row_mask:0xf bank_mask:0xf
    v_add_f32_dpp v79, v83, v79 row_ror:8 row_mask:0xf bank_mask:0xf
    v_mul_f32 v76, v76, v88
    v_mul_f32 v77, v77, v88
    v_mul_f32 v78, v78, v88
    v_mul_f32 v79, v79, v88
    v_cvt_pk_bf16_f32 v80, v76, v77
    v_cvt_pk_bf16_f32 v81, v78, v79
    buffer_store_dwordx2 v[80:81], v12, s[8:11], s23 offen
    s_barrier
    s_sleep 4
    buffer_load_dwordx4 v[144:147], v13, s[8:11], s23 offen offset:0 sc1
    buffer_load_dwordx4 v[148:151], v13, s[8:11], s23 offen offset:1024 sc1
    v_mov_b32 v64, 0
    v_mov_b32 v65, 0
    v_mov_b32 v66, 0
    v_mov_b32 v67, 0
LpO_100:
    s_waitcnt vmcnt(0)
    v_max3_u32 v28, v144, v145, v146
    v_max3_u32 v28, v28, v147, v148
    v_max3_u32 v28, v28, v149, v150
    v_max_u32 v28, v28, v151
    v_cmp_eq_u32 vcc, -1, v28
    s_cbranch_vccnz LrO_101
    ds_write_b128 v13, v[144:147] offset:16384
    ds_write_b128 v13, v[148:151] offset:17408
    v_smfmac_f32_16x16x64_bf16 v[64:67], v[144:147], a[224:231], v19
    s_waitcnt lgkmcnt(0)
    s_barrier
    ds_read_b128 v[128:131], v9 offset:16384
    ds_read_b128 v[132:135], v9 offset:17408
    ds_read_b128 v[136:139], v9 offset:18432
    ds_read_b128 v[140:143], v9 offset:19456
    ds_read_b128 v[152:155], v9 offset:22528
    ds_read_b128 v[156:159], v9 offset:23552
    v_smfmac_f32_16x16x64_bf16 v[64:67], v[148:151], a[232:239], v19
    s_waitcnt lgkmcnt(5)
    v_smfmac_f32_16x16x64_bf16 v[64:67], v[128:131], a[192:199], v19
    s_waitcnt lgkmcnt(4)
    v_smfmac_f32_16x16x64_bf16 v[64:67], v[132:135], a[200:207], v19
    s_waitcnt lgkmcnt(3)
    v_smfmac_f32_16x16x64_bf16 v[64:67], v[136:139], a[208:215], v19
    s_waitcnt lgkmcnt(2)
    v_smfmac_f32_16x16x64_bf16 v[64:67], v[140:143], a[216:223], v19
    s_waitcnt lgkmcnt(1)
    v_smfmac_f32_16x16x64_bf16 v[64:67], v[152:155], a[240:247], v19
    s_waitcnt lgkmcnt(0)
    v_smfmac_f32_16x16x64_bf16 v[64:67], v[156:159], a[248:255], v19
    s_nop 7
    v_permlane32_swap_b32 v64, v76
    v_permlane32_swap_b32 v65, v77
    v_permlane32_swap_b32 v66, v78
    v_permlane32_swap_b32 v67, v79
    v_pk_add_f32 v[64:65], v[64:65], v[76:77]
    v_pk_add_f32 v[66:67], v[66:67], v[78:79]
    v_cvt_pk_bf16_f32 v80, v64, v65
    v_cvt_pk_bf16_f32 v81, v66, v67
    s_nop 0
    v_permlane16_swap_b32 v80, v82
    v_permlane16_swap_b32 v81, v83
    buffer_store_dwordx4 v[80:83], v14, s[8:11], s24 offen sc1
    s_lshl_b32 s6, s3, 10
    s_add_u32 s6, s6, s34
    s_mov_b32 m0, s6
    s_add_u32 s6, s6, 3840
    buffer_load_dwordx4 v17, s[8:11], s31 offen sc1 lds
    s_mov_b32 m0, s6
    s_add_u32 s6, s6, 4352
    buffer_load_dwordx4 v17, s[8:11], s31 offen offset:256 sc1 lds
    s_sleep 12
    buffer_load_dwordx4 v[68:71], v15, s[8:11], s24 offen sc1
    s_add_u32 s19, s19, 1
    s_and_b32 s4, s19, 3
    s_lshl_b32 s5, s4, 14
    s_add_u32 s21, s5, s72
    s_lshl_b32 s5, s4, 12
    s_add_u32 s22, s5, s73
    s_lshl_b32 s5, s4, 13
    s_add_u32 s23, s5, s74
    s_and_b32 s4, s19, 1
    s_mul_i32 s4, s4, 10240
    s_add_u32 s33, s4, 26624
    s_add_u32 s37, s19, 1
    s_min_u32 s37, s37, 63
    s_lshr_b32 s4, s37, 3
    s_lshl_b32 s4, s4, 21
    s_and_b32 s5, s37, 7
    s_lshl_b32 s5, s5, 9
    s_add_u32 s4, s4, s5
    s_add_u32 s31, s4, s76
    s_lshl_b32 s4, s37, 18
    s_add_u32 s32, s4, s77
    s_and_b32 s4, s37, 1
    s_mul_i32 s4, s4, 10240
    s_add_u32 s34, s4, 26624
LpC_102:
    s_waitcnt vmcnt(0)
    v_max3_u32 v28, v68, v69, v70
    v_max_u32 v28, v28, v71
    v_cmp_eq_u32 vcc, -1, v28
    s_cbranch_vccnz LrC_103
    v_mfma_f32_16x16x32_bf16 v[76:79], v[36:39], v[68:71], 0
    s_nop 7
    v_add_f32_dpp v76, v76, v76 row_ror:8 row_mask:0xf bank_mask:0xf
    v_add_f32_dpp v77, v77, v77 row_ror:8 row_mask:0xf bank_mask:0xf
    v_add_f32_dpp v78, v78, v78 row_ror:8 row_mask:0xf bank_mask:0xf
    v_add_f32_dpp v79, v79, v79 row_ror:8 row_mask:0xf bank_mask:0xf
    v_cvt_pk_bf16_f32 v80, v76, v77
    v_cvt_pk_bf16_f32 v81, v78, v79
    v_cndmask_b32 v82, v81, v80, s[26:27]
    v_cndmask_b32 v83, v80, v81, s[26:27]
    s_nop 0
    v_mov_b32_dpp v84, v82 quad_perm:[1,0,3,2] row_mask:0xf bank_mask:0xf
    v_perm_b32 v85, v83, v84, v21
    buffer_store_dword v85, v10, s[8:11], s21 offen
    s_branch Lstep_80
Llast_81:
    s_sleep 3
    buffer_load_dwordx4 v[96:99], v8, s[8:11], s21 offen offset:0 sc1
    buffer_load_dwordx4 v[100:103], v8, s[8:11], s21 offen offset:1024 sc1
    buffer_load_dwordx4 v[104:107], v8, s[8:11], s21 offen offset:2048 sc1
    buffer_load_dwordx4 v[108:111], v8, s[8:11], s21 offen offset:3072 sc1
    v_mov_b32 v40, 0
    v_mov_b32 v41, 0
    v_mov_b32 v42, 0
    v_mov_b32 v43, 0
    v_mov_b32 v44, 0
    v_mov_b32 v45, 0
    v_mov_b32 v46, 0
    v_mov_b32 v47, 0
    v_mov_b32 v48, 0
    v_mov_b32 v49, 0
    v_mov_b32 v50, 0
    v_mov_b32 v51, 0
    v_mov_b32 v52, 0
    v_mov_b32 v53, 0
    v_mov_b32 v54, 0
    v_mov_b32 v55, 0
    v_mov_b32 v56, 0
    v_mov_b32 v57, 0
    v_mov_b32 v58, 0
    v_mov_b32 v59, 0
    v_mov_b32 v60, 0
    v_mov_b32 v61, 0
    v_mov_b32 v62, 0
    v_mov_b32 v63, 0
    s_and_b32 s4, s19, 3
    s_lshl_b32 s5, s4, 17
    s_add_u32 s24, s5, 98566144
    s_add_u32 s5, s4, 2
    s_and_b32 s5, s5, 3
    s_lshl_b32 s5, s5, 17
    s_add_u32 s28, s5, 98566144
    s_add_u32 s4, s4, 3
    s_and_b32 s4, s4, 3
    s_lshl_b32 s5, s4, 14
    s_add_u32 s78, s5, s72
    s_lshl_b32 s5, s4, 12
    s_add_u32 s79, s5, s73
    s_lshl_b32 s5, s4, 13
    s_add_u32 s29, s5, s74
    s_lshl_b32 s30, s19, 17
    s_waitcnt vmcnt(3)
LpA_104:
    v_max3_u32 v28, v96, v97, v98
    v_max_u32 v28, v28, v99
    v_cmp_eq_u32 vcc, -1, v28
    s_cbranch_vccnz LrA_105
    v_smfmac_f32_16x16x64_bf16 v[40:43], v[96:99], a[0:7], v19
    v_smfmac_f32_16x16x64_bf16 v[44:47], v[96:99], a[32:39], v19
    v_smfmac_f32_16x16x64_bf16 v[48:51], v[96:99], a[64:71], v19
    v_smfmac_f32_16x16x64_bf16 v[52:55], v[96:99], a[96:103], v19
    s_waitcnt vmcnt(2)
LpA_107:
    v_max3_u32 v28, v100, v101, v102
    v_max_u32 v28, v28, v103
    v_cmp_eq_u32 vcc, -1, v28
    s_cbranch_vccnz LrA_108
    v_smfmac_f32_16x16x64_bf16 v[40:43], v[100:103], a[8:15], v19
    v_smfmac_f32_16x16x64_bf16 v[44:47], v[100:103], a[40:47], v19
    v_smfmac_f32_16x16x64_bf16 v[48:51], v[100:103], a[72:79], v19
    v_smfmac_f32_16x16x64_bf16 v[52:55], v[100:103], a[104:111], v19
    s_waitcnt vmcnt(1)
LpA_110:
    v_max3_u32 v28, v104, v105, v106
    v_max_u32 v28, v28, v107
    v_cmp_eq_u32 vcc, -1, v28
    s_cbranch_vccnz LrA_111
    v_smfmac_f32_16x16x64_bf16 v[40:43], v[104:107], a[16:23], v19
    v_smfmac_f32_16x16x64_bf16 v[44:47], v[104:107], a[48:55], v19
    v_smfmac_f32_16x16x64_bf16 v[48:51], v[104:107], a[80:87], v19
    v_smfmac_f32_16x16x64_bf16 v[52:55], v[104:107], a[112:119], v19
    s_waitcnt vmcnt(0)
LpA_113:
    v_max3_u32 v28, v108, v109, v110
    v_max_u32 v28, v28, v111
    v_cmp_eq_u32 vcc, -1, v28
    s_cbranch_vccnz LrA_114
    v_smfmac_f32_16x16x64_bf16 v[40:43], v[108:111], a[24:31], v19
    v_smfmac_f32_16x16x64_bf16 v[44:47], v[108:111], a[56:63], v19
    v_smfmac_f32_16x16x64_bf16 v[48:51], v[108:111], a[88:95], v19
    v_smfmac_f32_16x16x64_bf16 v[52:55], v[108:111], a[120:127], v19
    v_smfmac_f32_16x16x64_bf16 v[56:59], v[96:99], a[128:135], v19
    v_smfmac_f32_16x16x64_bf16 v[60:63], v[96:99], a[160:167], v19
    ds_write_b128 v16, v[40:43] offset:0
    v_smfmac_f32_16x16x64_bf16 v[56:59], v[100:103], a[136:143], v19
    ds_write_b128 v16, v[44:47] offset:4096
    v_smfmac_f32_16x16x64_bf16 v[60:63], v[100:103], a[168:175], v19
    ds_write_b128 v16, v[48:51] offset:8192
    v_smfmac_f32_16x16x64_bf16 v[56:59], v[104:107], a[144:151], v19
    ds_write_b128 v16, v[52:55] offset:12288
    v_smfmac_f32_16x16x64_bf16 v[60:63], v[104:107], a[176:183], v19
    v_smfmac_f32_16x16x64_bf16 v[56:59], v[108:111], a[152:159], v19
    v_smfmac_f32_16x16x64_bf16 v[60:63], v[108:111], a[184:191], v19
    s_waitcnt lgkmcnt(0)
    s_barrier
    ds_read_b128 v[112:115], v8 offset:0
    ds_read_b128 v[116:119], v8 offset:1024
    ds_read_b128 v[120:123], v8 offset:2048
    ds_read_b128 v[124:127], v8 offset:3072
    ds_write_b128 v16, v[56:59] offset:47104
    ds_write_b128 v16, v[60:63] offset:51200
    s_waitcnt lgkmcnt(2)
    v_pk_add_f32 v[112:113], v[112:113], v[116:117]
    v_pk_add_f32 v[114:115], v[114:115], v[118:119]
    v_pk_add_f32 v[120:121], v[120:121], v[124:125]
    v_pk_add_f32 v[122:123], v[122:123], v[126:127]
    v_pk_add_f32 v[112:113], v[112:113], v[120:121]
    v_pk_add_f32 v[114:115], v[114:115], v[122:123]
    s_nop 1
    v_permlane32_swap_b32 v112, v114
    v_permlane32_swap_b32 v113, v115
    v_add_f32 v76, v112, v114
    v_add_f32 v77, v113, v115
    v_cvt_pk_bf16_f32 v78, v76, v77
    s_nop 1
    v_mov_b32_dpp v79, v78 quad_perm:[1,0,3,2] row_mask:0xf bank_mask:0xf
    v_perm_b32 v78, v78, v79, v20
    s_waitcnt lgkmcnt(0)
    s_barrier
    s_waitcnt lgkmcnt(0)
    s_barrier
    s_waitcnt vmcnt(0)
    s_branch L_R_done
Lwave_8:
    v_mov_b32 v216, 0x3f803f80
    v_mov_b32 v217, 0x3f803f80
    v_mov_b32 v218, 0x3f803f80
    v_mov_b32 v219, 0x3f803f80
    v_mov_b32 v211, 0
    v_mov_b32 v215, 0
    v_mov_b32 v223, 0
Lstep_116:
    s_cmp_eq_u32 s19, 63
    s_cbranch_scc1 Llast_117
    s_sleep 3
    buffer_load_dwordx4 v[96:99], v8, s[8:11], s21 offen offset:0 sc1
    buffer_load_dwordx4 v[100:103], v8, s[8:11], s21 offen offset:1024 sc1
    buffer_load_dwordx4 v[104:107], v8, s[8:11], s21 offen offset:2048 sc1
    buffer_load_dwordx4 v[108:111], v8, s[8:11], s21 offen offset:3072 sc1
    v_mov_b32 v40, 0
    v_mov_b32 v41, 0
    v_mov_b32 v42, 0
    v_mov_b32 v43, 0
    v_mov_b32 v44, 0
    v_mov_b32 v45, 0
    v_mov_b32 v46, 0
    v_mov_b32 v47, 0
    v_mov_b32 v48, 0
    v_mov_b32 v49, 0
    v_mov_b32 v50, 0
    v_mov_b32 v51, 0
    v_mov_b32 v52, 0
    v_mov_b32 v53, 0
    v_mov_b32 v54, 0
    v_mov_b32 v55, 0
    v_mov_b32 v56, 0
    v_mov_b32 v57, 0
    v_mov_b32 v58, 0
    v_mov_b32 v59, 0
    v_mov_b32 v60, 0
    v_mov_b32 v61, 0
    v_mov_b32 v62, 0
    v_mov_b32 v63, 0
    s_and_b32 s4, s19, 3
    s_lshl_b32 s5, s4, 17
    s_add_u32 s24, s5, 98566144
    s_add_u32 s5, s4, 2
    s_and_b32 s5, s5, 3
    s_lshl_b32 s5, s5, 17
    s_add_u32 s28, s5, 98566144
    s_add_u32 s4, s4, 3
    s_and_b32 s4, s4, 3
    s_lshl_b32 s5, s4, 14
    s_add_u32 s78, s5, s72
    s_lshl_b32 s5, s4, 12
    s_add_u32 s79, s5, s73
    s_lshl_b32 s5, s4, 13
    s_add_u32 s29, s5, s74
    s_lshl_b32 s30, s19, 17
    s_waitcnt vmcnt(3)
LpA_118:
    v_max3_u32 v28, v96, v97, v98
    v_max_u32 v28, v28, v99
    v_cmp_eq_u32 vcc, -1, v28
    s_cbranch_vccnz LrA_119
    v_smfmac_f32_16x16x64_bf16 v[40:43], v[96:99], a[0:7], v19
    v_smfmac_f32_16x16x64_bf16 v[44:47], v[96:99], a[32:39], v19
    v_smfmac_f32_16x16x64_bf16 v[48:51], v[96:99], a[64:71], v19
    v_smfmac_f32_16x16x64_bf16 v[52:55], v[96:99], a[96:103], v19
    s_waitcnt vmcnt(2)
LpA_121:
    v_max3_u32 v28, v100, v101, v102
    v_max_u32 v28, v28, v103
    v_cmp_eq_u32 vcc, -1, v28
    s_cbranch_vccnz LrA_122
    v_smfmac_f32_16x16x64_bf16 v[40:43], v[100:103], a[8:15], v19
    v_smfmac_f32_16x16x64_bf16 v[44:47], v[100:103], a[40:47], v19
    v_smfmac_f32_16x16x64_bf16 v[48:51], v[100:103], a[72:79], v19
    v_smfmac_f32_16x16x64_bf16 v[52:55], v[100:103], a[104:111], v19
    s_waitcnt vmcnt(1)
LpA_124:
    v_max3_u32 v28, v104, v105, v106
    v_max_u32 v28, v28, v107
    v_cmp_eq_u32 vcc, -1, v28
    s_cbranch_vccnz LrA_125
    v_smfmac_f32_16x16x64_bf16 v[40:43], v[104:107], a[16:23], v19
    v_smfmac_f32_16x16x64_bf16 v[44:47], v[104:107], a[48:55], v19
    v_smfmac_f32_16x16x64_bf16 v[48:51], v[104:107], a[80:87], v19
    v_smfmac_f32_16x16x64_bf16 v[52:55], v[104:107], a[112:119], v19
    s_waitcnt vmcnt(0)
LpA_127:
    v_max3_u32 v28, v108, v109, v110
    v_max_u32 v28, v28, v111
    v_cmp_eq_u32 vcc, -1, v28
    s_cbranch_vccnz LrA_128
    v_smfmac_f32_16x16x64_bf16 v[40:43], v[108:111], a[24:31], v19
    v_smfmac_f32_16x16x64_bf16 v[44:47], v[108:111], a[56:63], v19
    v_smfmac_f32_16x16x64_bf16 v[48:51], v[108:111], a[88:95], v19
    v_smfmac_f32_16x16x64_bf16 v[52:55], v[108:111], a[120:127], v19
    v_smfmac_f32_16x16x64_bf16 v[56:59], v[96:99], a[128:135], v19
    v_smfmac_f32_16x16x64_bf16 v[60:63], v[96:99], a[160:167], v19
    ds_write_b128 v16, v[40:43] offset:0
    v_smfmac_f32_16x16x64_bf16 v[56:59], v[100:103], a[136:143], v19
    ds_write_b128 v16, v[44:47] offset:4096
    v_smfmac_f32_16x16x64_bf16 v[60:63], v[100:103], a[168:175], v19
    ds_write_b128 v16, v[48:51] offset:8192
    v_smfmac_f32_16x16x64_bf16 v[56:59], v[104:107], a[144:151], v19
    ds_write_b128 v16, v[52:55] offset:12288
    v_smfmac_f32_16x16x64_bf16 v[60:63], v[104:107], a[176:183], v19
    v_smfmac_f32_16x16x64_bf16 v[56:59], v[108:111], a[152:159], v19
    v_smfmac_f32_16x16x64_bf16 v[60:63], v[108:111], a[184:191], v19
    s_waitcnt lgkmcnt(0)
    s_barrier
    ds_read_b128 v[112:115], v8 offset:0
    ds_read_b128 v[116:119], v8 offset:1024
    ds_read_b128 v[120:123], v8 offset:2048
    ds_read_b128 v[124:127], v8 offset:3072
    ds_write_b128 v16, v[56:59] offset:47104
    ds_write_b128 v16, v[60:63] offset:51200
    s_waitcnt lgkmcnt(2)
    v_pk_add_f32 v[112:113], v[112:113], v[116:117]
    v_pk_add_f32 v[114:115], v[114:115], v[118:119]
    v_pk_add_f32 v[120:121], v[120:121], v[124:125]
    v_pk_add_f32 v[122:123], v[122:123], v[126:127]
    v_pk_add_f32 v[112:113], v[112:113], v[120:121]
    v_pk_add_f32 v[114:115], v[114:115], v[122:123]
    s_nop 1
    v_permlane32_swap_b32 v112, v114
    v_permlane32_swap_b32 v113, v115
    v_add_f32 v76, v112, v114
    v_add_f32 v77, v113, v115
    v_cvt_pk_bf16_f32 v78, v76, v77
    s_nop 1
    v_mov_b32_dpp v79, v78 quad_perm:[1,0,3,2] row_mask:0xf bank_mask:0xf
    v_perm_b32 v78, v78, v79, v20
    buffer_store_dword v78, v11, s[8:11], s22 offen
    s_cmp_eq_u32 s19, 0
    s_cbranch_scc1 Lk0h_130
Lk0b_131:
    s_waitcnt lgkmcnt(0)
    s_barrier
    v_add_u32 v29, s33, v9
    ds_read_b128 v[160:163], v29 offset:0
    ds_read_b128 v[164:167], v29 offset:1024
    ds_read_b128 v[168:171], v29 offset:2048
    ds_read_b128 v[172:175], v29 offset:3072
    ds_read_b128 v[176:179], v29 offset:4096
    ds_read_b128 v[180:183], v29 offset:5120
    ds_read_b128 v[184:187], v29 offset:6144
    ds_read_b128 v[188:191], v29 offset:7168
    ds_read_b64 v[208:209], v29 offset:9216
    ds_read_b64 v[212:213], v29 offset:9224
    s_sleep 4
    buffer_load_dwordx4 v[192:195], v9, s[8:11], s22 offen offset:0 sc1
    buffer_load_dwordx4 v[196:199], v9, s[8:11], s22 offen offset:1024 sc1
    buffer_load_dwordx4 v[200:203], v9, s[8:11], s22 offen offset:2048 sc1
    buffer_load_dwordx4 v[204:207], v9, s[8:11], s22 offen offset:3072 sc1
    s_sleep 3
    buffer_load_dwordx4 v[192:195], v9, s[8:11], s22 offen offset:0 sc1
    buffer_load_dwordx4 v[196:199], v9, s[8:11], s22 offen offset:1024 sc1
    buffer_load_dwordx4 v[200:203], v9, s[8:11], s22 offen offset:2048 sc1
    buffer_load_dwordx4 v[204:207], v9, s[8:11], s22 offen offset:3072 sc1
    s_barrier
    ds_read_b32 v210, v22
    ds_read_b32 v214, v22 offset:4
LpB_134:
    s_waitcnt vmcnt(4)
    v_max3_u32 v28, v192, v193, v194
    v_max3_u32 v28, v28, v195, v196
    v_max3_u32 v28, v28, v197, v198
    v_max3_u32 v28, v28, v199, v200
    v_max3_u32 v28, v28, v201, v202
    v_max3_u32 v28, v28, v203, v204
    v_max3_u32 v28, v28, v205, v206
    v_max_u32 v28, v28, v207
    v_cmp_eq_u32 vcc, -1, v28
    s_cbranch_vccnz LrB_135
    s_waitcnt lgkmcnt(0)
    v_mfma_f32_16x16x32_bf16 v[76:79], v[192:195], v[192:195], 0
    v_mfma_f32_16x16x32_bf16 v[80:83], v[160:163], v[192:195], 0
    v_mfma_f32_16x16x32_bf16 v[84:87], v[176:179], v[192:195], 0
    v_mfma_f32_16x16x32_bf16 v[76:79], v[196:199], v[196:199], v[76:79]
    v_mfma_f32_16x16x32_bf16 v[80:83], v[164:167], v[196:199], v[80:83]
    v_mfma_f32_16x16x32_bf16 v[84:87], v[180:183], v[196:199], v[84:87]
    v_mfma_f32_16x16x32_bf16 v[76:79], v[200:203], v[200:203], v[76:79]
    v_mfma_f32_16x16x32_bf16 v[80:83], v[168:171], v[200:203], v[80:83]
    v_mfma_f32_16x16x32_bf16 v[84:87], v[184:187], v[200:203], v[84:87]
    v_mfma_f32_16x16x32_bf16 v[76:79], v[204:207], v[204:207], v[76:79]
    v_mfma_f32_16x16x32_bf16 v[80:83], v[172:175], v[204:207], v[80:83]
    v_mfma_f32_16x16x32_bf16 v[84:87], v[188:191], v[204:207], v[84:87]
    s_nop 0
    v_mov_b32_dpp v76, v77 row_shr:8 row_mask:0xf bank_mask:0xc
    v_mov_b32_dpp v78, v79 row_shr:8 row_mask:0xf bank_mask:0xc
    s_nop 4
    v_mov_b32_dpp v80, v84 row_shr:8 row_mask:0xf bank_mask:0xc
    v_mov_b32_dpp v81, v85 row_shr:8 row_mask:0xf bank_mask:0xc
    v_mov_b32_dpp v82, v86 row_shr:8 row_mask:0xf bank_mask:0xc
    v_mov_b32_dpp v83, v87 row_shr:8 row_mask:0xf bank_mask:0xc
    v_permlane32_swap_b32 v76, v78
    v_max3_f32 v88, v80, v81, v82
    v_max3_f32 v88, v88, v83, v78
    s_nop 1
    v_max_f32_dpp v89, v88, v88 row_ror:8 row_mask:0xf bank_mask:0xf
    v_max_f32_dpp v88, v88, v88 row_ror:8 row_mask:0xf bank_mask:0xf
    s_nop 1
    v_permlane16_swap_b32 v88, v89
    v_max_f32 v88, v88, v89
    v_max_f32 v89, v88, v88
    s_nop 1
    v_permlane32_swap_b32 v88, v89
    v_max_f32 v88, v88, v89
    v_mul_f32 v88, s35, v88
    v_fma_f32 v80, v80, s35, -v88
    v_fma_f32 v81, v81, s35, -v88
    v_fma_f32 v82, v82, s35, -v88
    v_fma_f32 v83, v83, s35, -v88
    v_fma_f32 v78, v78, s35, -v88
    v_exp_f32 v80, v80
    v_exp_f32 v81, v81
    v_exp_f32 v82, v82
    v_exp_f32 v83, v83
    v_exp_f32 v78, v78
    v_cvt_pk_bf16_f32 v220, v80, v81
    v_cvt_pk_bf16_f32 v221, v82, v83
    v_cvt_pk_bf16_f32 v222, v78, 0
    s_nop 1
    v_mfma_f32_16x16x32_bf16 v[84:87], v[216:219], v[220:223], 0
    v_mfma_f32_16x16x32_bf16 v[76:79], v[208:211], v[220:223], 0
    v_mfma_f32_16x16x32_bf16 v[80:83], v[212:215], v[220:223], 0
    s_nop 3
    v_add_f32_dpp v88, v84, v84 row_ror:8 row_mask:0xf bank_mask:0xf
    v_rcp_f32 v88, v88
    s_nop 2
    v_add_f32_dpp v76, v80, v76 row_ror:8 row_mask:0xf bank_mask:0xf
    v_add_f32_dpp v77, v81, v77 row_ror:8 row_mask:0xf bank_mask:0xf
    v_add_f32_dpp v78, v82, v78 row_ror:8 row_mask:0xf bank_mask:0xf
    v_add_f32_dpp v79, v83, v79 row_ror:8 row_mask:0xf bank_mask:0xf
    v_mul_f32 v76, v76, v88
    v_mul_f32 v77, v77, v88
    v_mul_f32 v78, v78, v88
    v_mul_f32 v79, v79, v88
    v_cvt_pk_bf16_f32 v80, v76, v77
    v_cvt_pk_bf16_f32 v81, v78, v79
    buffer_store_dwordx2 v[80:81], v12, s[8:11], s23 offen
    s_barrier
    s_sleep 4
    buffer_load_dwordx4 v[152:155], v13, s[8:11], s23 offen offset:0 sc1
    buffer_load_dwordx4 v[156:159], v13, s[8:11], s23 offen offset:1024 sc1
    v_mov_b32 v64, 0
    v_mov_b32 v65, 0
    v_mov_b32 v66, 0
    v_mov_b32 v67, 0
LpO_136:
    s_waitcnt vmcnt(0)
    v_max3_u32 v28, v152, v153, v154
    v_max3_u32 v28, v28, v155, v156
    v_max3_u32 v28, v28, v157, v158
    v_max_u32 v28, v28, v159
    v_cmp_eq_u32 vcc, -1, v28
    s_cbranch_vccnz LrO_137
    ds_write_b128 v13, v[152:155] offset:16384
    ds_write_b128 v13, v[156:159] offset:17408
    v_smfmac_f32_16x16x64_bf16 v[64:67], v[152:155], a[240:247], v19
    s_waitcnt lgkmcnt(0)
    s_barrier
    ds_read_b128 v[128:131], v9 offset:16384
    ds_read_b128 v[132:135], v9 offset:17408
    ds_read_b128 v[136:139], v9 offset:18432
    ds_read_b128 v[140:143], v9 offset:19456
    ds_read_b128 v[144:147], v9 offset:20480
    ds_read_b128 v[148:151], v9 offset:21504
    v_smfmac_f32_16x16x64_bf16 v[64:67], v[156:159], a[248:255], v19
    s_waitcnt lgkmcnt(5)
    v_smfmac_f32_16x16x64_bf16 v[64:67], v[128:131], a[192:199], v19
    s_waitcnt lgkmcnt(4)
    v_smfmac_f32_16x16x64_bf16 v[64:67], v[132:135], a[200:207], v19
    s_waitcnt lgkmcnt(3)
    v_smfmac_f32_16x16x64_bf16 v[64:67], v[136:139], a[208:215], v19
    s_waitcnt lgkmcnt(2)
    v_smfmac_f32_16x16x64_bf16 v[64:67], v[140:143], a[216:223], v19
    s_waitcnt lgkmcnt(1)
    v_smfmac_f32_16x16x64_bf16 v[64:67], v[144:147], a[224:231], v19
    s_waitcnt lgkmcnt(0)
    v_smfmac_f32_16x16x64_bf16 v[64:67], v[148:151], a[232:239], v19
    s_nop 7
    v_permlane32_swap_b32 v64, v76
    v_permlane32_swap_b32 v65, v77
    v_permlane32_swap_b32 v66, v78
    v_permlane32_swap_b32 v67, v79
    v_pk_add_f32 v[64:65], v[64:65], v[76:77]
    v_pk_add_f32 v[66:67], v[66:67], v[78:79]
    v_cvt_pk_bf16_f32 v80, v64, v65
    v_cvt_pk_bf16_f32 v81, v66, v67
    s_nop 0
    v_permlane16_swap_b32 v80, v82
    v_permlane16_swap_b32 v81, v83
    buffer_store_dwordx4 v[80:83], v14, s[8:11], s24 offen sc1
    s_lshl_b32 s6, s3, 10
    s_add_u32 s6, s6, s34
    s_mov_b32 m0, s6
    s_add_u32 s6, s6, 3840
    buffer_load_dwordx4 v17, s[8:11], s31 offen sc1 lds
    s_mov_b32 m0, s6
    s_add_u32 s6, s6, 4352
    buffer_load_dwordx4 v17, s[8:11], s31 offen offset:256 sc1 lds
    s_sleep 12
    buffer_load_dwordx4 v[68:71], v15, s[8:11], s24 offen sc1
    s_add_u32 s19, s19, 1
    s_and_b32 s4, s19, 3
    s_lshl_b32 s5, s4, 14
    s_add_u32 s21, s5, s72
    s_lshl_b32 s5, s4, 12
    s_add_u32 s22, s5, s73
    s_lshl_b32 s5, s4, 13
    s_add_u32 s23, s5, s74
    s_and_b32 s4, s19, 1
    s_mul_i32 s4, s4, 10240
    s_add_u32 s33, s4, 26624
    s_add_u32 s37, s19, 1
    s_min_u32 s37, s37, 63
    s_lshr_b32 s4, s37, 3
    s_lshl_b32 s4, s4, 21
    s_and_b32 s5, s37, 7
    s_lshl_b32 s5, s5, 9
    s_add_u32 s4, s4, s5
    s_add_u32 s31, s4, s76
    s_lshl_b32 s4, s37, 18
    s_add_u32 s32, s4, s77
    s_and_b32 s4, s37, 1
    s_mul_i32 s4, s4, 10240
    s_add_u32 s34, s4, 26624
LpC_138:
    s_waitcnt vmcnt(0)
    v_max3_u32 v28, v68, v69, v70
    v_max_u32 v28, v28, v71
    v_cmp_eq_u32 vcc, -1, v28
    s_cbranch_vccnz LrC_139
    v_mfma_f32_16x16x32_bf16 v[76:79], v[36:39], v[68:71], 0
    s_nop 7
    v_add_f32_dpp v76, v76, v76 row_ror:8 row_mask:0xf bank_mask:0xf
    v_add_f32_dpp v77, v77, v77 row_ror:8 row_mask:0xf bank_mask:0xf
    v_add_f32_dpp v78, v78, v78 row_ror:8 row_mask:0xf bank_mask:0xf
    v_add_f32_dpp v79, v79, v79 row_ror:8 row_mask:0xf bank_mask:0xf
    v_cvt_pk_bf16_f32 v80, v76, v77
    v_cvt_pk_bf16_f32 v81, v78, v79
    v_cndmask_b32 v82, v81, v80, s[26:27]
    v_cndmask_b32 v83, v80, v81, s[26:27]
    s_nop 0
    v_mov_b32_dpp v84, v82 quad_perm:[1,0,3,2] row_mask:0xf bank_mask:0xf
    v_perm_b32 v85, v83, v84, v21
    buffer_store_dword v85, v10, s[8:11], s21 offen
    s_branch Lstep_116
Llast_117:
    s_sleep 3
    buffer_load_dwordx4 v[96:99], v8, s[8:11], s21 offen offset:0 sc1
    buffer_load_dwordx4 v[100:103], v8, s[8:11], s21 offen offset:1024 sc1
    buffer_load_dwordx4 v[104:107], v8, s[8:11], s21 offen offset:2048 sc1
    buffer_load_dwordx4 v[108:111], v8, s[8:11], s21 offen offset:3072 sc1
    v_mov_b32 v40, 0
    v_mov_b32 v41, 0
    v_mov_b32 v42, 0
    v_mov_b32 v43, 0
    v_mov_b32 v44, 0
    v_mov_b32 v45, 0
    v_mov_b32 v46, 0
    v_mov_b32 v47, 0
    v_mov_b32 v48, 0
    v_mov_b32 v49, 0
    v_mov_b32 v50, 0
    v_mov_b32 v51, 0
    v_mov_b32 v52, 0
    v_mov_b32 v53, 0
    v_mov_b32 v54, 0
    v_mov_b32 v55, 0
    v_mov_b32 v56, 0
    v_mov_b32 v57, 0
    v_mov_b32 v58, 0
    v_mov_b32 v59, 0
    v_mov_b32 v60, 0
    v_mov_b32 v61, 0
    v_mov_b32 v62, 0
    v_mov_b32 v63, 0
    s_and_b32 s4, s19, 3
    s_lshl_b32 s5, s4, 17
    s_add_u32 s24, s5, 98566144
    s_add_u32 s5, s4, 2
    s_and_b32 s5, s5, 3
    s_lshl_b32 s5, s5, 17
    s_add_u32 s28, s5, 98566144
    s_add_u32 s4, s4, 3
    s_and_b32 s4, s4, 3
    s_lshl_b32 s5, s4, 14
    s_add_u32 s78, s5, s72
    s_lshl_b32 s5, s4, 12
    s_add_u32 s79, s5, s73
    s_lshl_b32 s5, s4, 13
    s_add_u32 s29, s5, s74
    s_lshl_b32 s30, s19, 17
    s_waitcnt vmcnt(3)
LpA_140:
    v_max3_u32 v28, v96, v97, v98
    v_max_u32 v28, v28, v99
    v_cmp_eq_u32 vcc, -1, v28
    s_cbranch_vccnz LrA_141
    v_smfmac_f32_16x16x64_bf16 v[40:43], v[96:99], a[0:7], v19
    v_smfmac_f32_16x16x64_bf16 v[44:47], v[96:99], a[32:39], v19
    v_smfmac_f32_16x16x64_bf16 v[48:51], v[96:99], a[64:71], v19
    v_smfmac_f32_16x16x64_bf16 v[52:55], v[96:99], a[96:103], v19
    s_waitcnt vmcnt(2)
LpA_143:
    v_max3_u32 v28, v100, v101, v102
    v_max_u32 v28, v28, v103
    v_cmp_eq_u32 vcc, -1, v28
    s_cbranch_vccnz LrA_144
    v_smfmac_f32_16x16x64_bf16 v[40:43], v[100:103], a[8:15], v19
    v_smfmac_f32_16x16x64_bf16 v[44:47], v[100:103], a[40:47], v19
    v_smfmac_f32_16x16x64_bf16 v[48:51], v[100:103], a[72:79], v19
    v_smfmac_f32_16x16x64_bf16 v[52:55], v[100:103], a[104:111], v19
    s_waitcnt vmcnt(1)
LpA_146:
    v_max3_u32 v28, v104, v105, v106
    v_max_u32 v28, v28, v107
    v_cmp_eq_u32 vcc, -1, v28
    s_cbranch_vccnz LrA_147
    v_smfmac_f32_16x16x64_bf16 v[40:43], v[104:107], a[16:23], v19
    v_smfmac_f32_16x16x64_bf16 v[44:47], v[104:107], a[48:55], v19
    v_smfmac_f32_16x16x64_bf16 v[48:51], v[104:107], a[80:87], v19
    v_smfmac_f32_16x16x64_bf16 v[52:55], v[104:107], a[112:119], v19
    s_waitcnt vmcnt(0)
LpA_149:
    v_max3_u32 v28, v108, v109, v110
    v_max_u32 v28, v28, v111
    v_cmp_eq_u32 vcc, -1, v28
    s_cbranch_vccnz LrA_150
    v_smfmac_f32_16x16x64_bf16 v[40:43], v[108:111], a[24:31], v19
    v_smfmac_f32_16x16x64_bf16 v[44:47], v[108:111], a[56:63], v19
    v_smfmac_f32_16x16x64_bf16 v[48:51], v[108:111], a[88:95], v19
    v_smfmac_f32_16x16x64_bf16 v[52:55], v[108:111], a[120:127], v19
    v_smfmac_f32_16x16x64_bf16 v[56:59], v[96:99], a[128:135], v19
    v_smfmac_f32_16x16x64_bf16 v[60:63], v[96:99], a[160:167], v19
    ds_write_b128 v16, v[40:43] offset:0
    v_smfmac_f32_16x16x64_bf16 v[56:59], v[100:103], a[136:143], v19
    ds_write_b128 v16, v[44:47] offset:4096
    v_smfmac_f32_16x16x64_bf16 v[60:63], v[100:103], a[168:175], v19
    ds_write_b128 v16, v[48:51] offset:8192
    v_smfmac_f32_16x16x64_bf16 v[56:59], v[104:107], a[144:151], v19
    ds_write_b128 v16, v[52:55] offset:12288
    v_smfmac_f32_16x16x64_bf16 v[60:63], v[104:107], a[176:183], v19
    v_smfmac_f32_16x16x64_bf16 v[56:59], v[108:111], a[152:159], v19
    v_smfmac_f32_16x16x64_bf16 v[60:63], v[108:111], a[184:191], v19
    s_waitcnt lgkmcnt(0)
    s_barrier
    ds_read_b128 v[112:115], v8 offset:0
    ds_read_b128 v[116:119], v8 offset:1024
    ds_read_b128 v[120:123], v8 offset:2048
    ds_read_b128 v[124:127], v8 offset:3072
    ds_write_b128 v16, v[56:59] offset:47104
    ds_write_b128 v16, v[60:63] offset:51200
    s_waitcnt lgkmcnt(2)
    v_pk_add_f32 v[112:113], v[112:113], v[116:117]
    v_pk_add_f32 v[114:115], v[114:115], v[118:119]
    v_pk_add_f32 v[120:121], v[120:121], v[124:125]
    v_pk_add_f32 v[122:123], v[122:123], v[126:127]
    v_pk_add_f32 v[112:113], v[112:113], v[120:121]
    v_pk_add_f32 v[114:115], v[114:115], v[122:123]
    s_nop 1
    v_permlane32_swap_b32 v112, v114
    v_permlane32_swap_b32 v113, v115
    v_add_f32 v76, v112, v114
    v_add_f32 v77, v113, v115
    v_cvt_pk_bf16_f32 v78, v76, v77
    s_nop 1
    v_mov_b32_dpp v79, v78 quad_perm:[1,0,3,2] row_mask:0xf bank_mask:0xf
    v_perm_b32 v78, v78, v79, v20
    s_waitcnt lgkmcnt(0)
    s_barrier
    s_waitcnt lgkmcnt(0)
    s_barrier
    s_waitcnt vmcnt(0)
    s_branch L_R_done
LrA_12:
    s_sub_u32 s20, s20, 1
    s_cbranch_scc1 L_R_abort
    buffer_load_dwordx4 v[96:99], v8, s[8:11], s21 offen offset:0 sc1
    buffer_load_dwordx4 v[100:103], v8, s[8:11], s21 offen offset:1024 sc1
    buffer_load_dwordx4 v[104:107], v8, s[8:11], s21 offen offset:2048 sc1
    buffer_load_dwordx4 v[108:111], v8, s[8:11], s21 offen offset:3072 sc1
    s_waitcnt vmcnt(3)
    s_branch LpA_11
LrA_15:
    s_sub_u32 s20, s20, 1
    s_cbranch_scc1 L_R_abort
    buffer_load_dwordx4 v[100:103], v8, s[8:11], s21 offen offset:1024 sc1
    buffer_load_dwordx4 v[104:107], v8, s[8:11], s21 offen offset:2048 sc1
    buffer_load_dwordx4 v[108:111], v8, s[8:11], s21 offen offset:3072 sc1
    s_waitcnt vmcnt(2)
    s_branch LpA_14
LrA_18:
    s_sub_u32 s20, s20, 1
    s_cbranch_scc1 L_R_abort
    buffer_load_dwordx4 v[104:107], v8, s[8:11], s21 offen offset:2048 sc1
    buffer_load_dwordx4 v[108:111], v8, s[8:11], s21 offen offset:3072 sc1
    s_waitcnt vmcnt(1)
    s_branch LpA_17
LrA_21:
    s_sub_u32 s20, s20, 1
    s_cbranch_scc1 L_R_abort
    buffer_load_dwordx4 v[108:111], v8, s[8:11], s21 offen offset:3072 sc1
    s_waitcnt vmcnt(0)
    s_branch LpA_20
Lk0h_23:
    s_cmp_lg_u32 s3, 0
    s_cbranch_scc1 Lwb_26_ok
    v_mov_b32 v4, 102773248
Lwb_26:
    buffer_load_dword v5, v4, s[8:11], 0 offen sc1
    s_waitcnt vmcnt(0)
    v_cmp_le_u32 vcc, 128, v5
    s_cbranch_vccnz Lwb_26_ok
    s_sleep 2
    s_sub_u32 s20, s20, 1
    s_cbranch_scc0 Lwb_26
    s_branch L_R_abort
Lwb_26_ok:
    s_barrier
    s_lshr_b32 s4, s19, 3
    s_lshl_b32 s4, s4, 21
    s_and_b32 s5, s19, 7
    s_lshl_b32 s5, s5, 9
    s_add_u32 s4, s4, s5
    s_add_u32 s31, s4, s76
    s_lshl_b32 s4, s19, 18
    s_add_u32 s32, s4, s77
    s_and_b32 s4, s19, 1
    s_mul_i32 s4, s4, 10240
    s_add_u32 s34, s4, 26624
    s_lshl_b32 s6, s3, 10
    s_add_u32 s6, s6, s34
    s_mov_b32 m0, s6
    s_add_u32 s6, s6, 3840
    buffer_load_dwordx4 v17, s[8:11], s31 offen sc1 lds
    s_mov_b32 m0, s6
    s_add_u32 s6, s6, 4352
    buffer_load_dwordx4 v17, s[8:11], s31 offen offset:256 sc1 lds
    s_mov_b32 m0, s6
    s_nop 0
    buffer_load_dwordx4 v18, s[8:11], s32 offen sc1 lds
    s_mov_b32 s37, 1
    s_lshr_b32 s4, s37, 3
    s_lshl_b32 s4, s4, 21
    s_and_b32 s5, s37, 7
    s_lshl_b32 s5, s5, 9
    s_add_u32 s4, s4, s5
    s_add_u32 s31, s4, s76
    s_lshl_b32 s4, s37, 18
    s_add_u32 s32, s4, s77
    s_and_b32 s4, s37, 1
    s_mul_i32 s4, s4, 10240
    s_add_u32 s34, s4, 26624
    s_waitcnt vmcnt(0)
    s_barrier
    s_branch Lk0b_24
Lkv_27_cold:
    v_readfirstlane_b32 s5, v224
    s_cmp_ge_u32 s5, s6
    s_cbranch_scc1 Lkv_27_ok
    v_mov_b32 v4, s4
Lkv_27_l:
    buffer_load_dword v5, v4, s[8:11], 0 offen sc1
    s_waitcnt vmcnt(0)
    v_cmp_le_u32 vcc, s6, v5
    s_cbranch_vccnz Lkv_27_ok
    s_sleep 4
    s_sub_u32 s20, s20, 1
    s_cbranch_scc0 Lkv_27_l
    s_branch L_R_abort
LrO_29:
    s_sub_u32 s20, s20, 1
    s_cbranch_scc1 L_R_abort
    buffer_load_dwordx4 v[128:131], v13, s[8:11], s23 offen offset:0 sc1
    buffer_load_dwordx4 v[132:135], v13, s[8:11], s23 offen offset:1024 sc1
    s_branch LpO_28
LrC_32:
    s_sub_u32 s20, s20, 1
    s_cbranch_scc1 L_R_abort
    buffer_load_dwordx4 v[68:71], v15, s[8:11], s24 offen sc1
    s_branch LpC_31
LrA_34:
    s_sub_u32 s20, s20, 1
    s_cbranch_scc1 L_R_abort
    buffer_load_dwordx4 v[96:99], v8, s[8:11], s21 offen offset:0 sc1
    buffer_load_dwordx4 v[100:103], v8, s[8:11], s21 offen offset:1024 sc1
    buffer_load_dwordx4 v[104:107], v8, s[8:11], s21 offen offset:2048 sc1
    buffer_load_dwordx4 v[108:111], v8, s[8:11], s21 offen offset:3072 sc1
    s_waitcnt vmcnt(3)
    s_branch LpA_33
LrA_37:
    s_sub_u32 s20, s20, 1
    s_cbranch_scc1 L_R_abort
    buffer_load_dwordx4 v[100:103], v8, s[8:11], s21 offen offset:1024 sc1
    buffer_load_dwordx4 v[104:107], v8, s[8:11], s21 offen offset:2048 sc1
    buffer_load_dwordx4 v[108:111], v8, s[8:11], s21 offen offset:3072 sc1
    s_waitcnt vmcnt(2)
    s_branch LpA_36
LrA_40:
    s_sub_u32 s20, s20, 1
    s_cbranch_scc1 L_R_abort
    buffer_load_dwordx4 v[104:107], v8, s[8:11], s21 offen offset:2048 sc1
    buffer_load_dwordx4 v[108:111], v8, s[8:11], s21 offen offset:3072 sc1
    s_waitcnt vmcnt(1)
    s_branch LpA_39
LrA_43:
    s_sub_u32 s20, s20, 1
    s_cbranch_scc1 L_R_abort
    buffer_load_dwordx4 v[108:111], v8, s[8:11], s21 offen offset:3072 sc1
    s_waitcnt vmcnt(0)
    s_branch LpA_42
LrA_48:
    s_sub_u32 s20, s20, 1
    s_cbranch_scc1 L_R_abort
    buffer_load_dwordx4 v[96:99], v8, s[8:11], s21 offen offset:0 sc1
    buffer_load_dwordx4 v[100:103], v8, s[8:11], s21 offen offset:1024 sc1
    buffer_load_dwordx4 v[104:107], v8, s[8:11], s21 offen offset:2048 sc1
    buffer_load_dwordx4 v[108:111], v8, s[8:11], s21 offen offset:3072 sc1
    s_waitcnt vmcnt(3)
    s_branch LpA_47
LrA_51:
    s_sub_u32 s20, s20, 1
    s_cbranch_scc1 L_R_abort
    buffer_load_dwordx4 v[100:103], v8, s[8:11], s21 offen offset:1024 sc1
    buffer_load_dwordx4 v[104:107], v8, s[8:11], s21 offen offset:2048 sc1
    buffer_load_dwordx4 v[108:111], v8, s[8:11], s21 offen offset:3072 sc1
    s_waitcnt vmcnt(2)
    s_branch LpA_50
LrA_54:
    s_sub_u32 s20, s20, 1
    s_cbranch_scc1 L_R_abort
    buffer_load_dwordx4 v[104:107], v8, s[8:11], s21 offen offset:2048 sc1
    buffer_load_dwordx4 v[108:111], v8, s[8:11], s21 offen offset:3072 sc1
    s_waitcnt vmcnt(1)
    s_branch LpA_53
LrA_57:
    s_sub_u32 s20, s20, 1
    s_cbranch_scc1 L_R_abort
    buffer_load_dwordx4 v[108:111], v8, s[8:11], s21 offen offset:3072 sc1
    s_waitcnt vmcnt(0)
    s_branch LpA_56
Lk0h_59:
    s_cmp_lg_u32 s3, 0
    s_cbranch_scc1 Lwb_62_ok
    v_mov_b32 v4, 102773248
Lwb_62:
    buffer_load_dword v5, v4, s[8:11], 0 offen sc1
    s_waitcnt vmcnt(0)
    v_cmp_le_u32 vcc, 128, v5
    s_cbranch_vccnz Lwb_62_ok
    s_sleep 2
    s_sub_u32 s20, s20, 1
    s_cbranch_scc0 Lwb_62
    s_branch L_R_abort
Lwb_62_ok:
    s_barrier
    s_lshr_b32 s4, s19, 3
    s_lshl_b32 s4, s4, 21
    s_and_b32 s5, s19, 7
    s_lshl_b32 s5, s5, 9
    s_add_u32 s4, s4, s5
    s_add_u32 s31, s4, s76
    s_lshl_b32 s4, s19, 18
    s_add_u32 s32, s4, s77
    s_and_b32 s4, s19, 1
    s_mul_i32 s4, s4, 10240
    s_add_u32 s34, s4, 26624
    s_lshl_b32 s6, s3, 10
    s_add_u32 s6, s6, s34
    s_mov_b32 m0, s6
    s_add_u32 s6, s6, 3840
    buffer_load_dwordx4 v17, s[8:11], s31 offen sc1 lds
    s_mov_b32 m0, s6
    s_add_u32 s6, s6, 4352
    buffer_load_dwordx4 v17, s[8:11], s31 offen offset:256 sc1 lds
    s_mov_b32 m0, s6
    s_nop 0
    buffer_load_dwordx4 v18, s[8:11], s32 offen sc1 lds
    s_mov_b32 s37, 1
    s_lshr_b32 s4, s37, 3
    s_lshl_b32 s4, s4, 21
    s_and_b32 s5, s37, 7
    s_lshl_b32 s5, s5, 9
    s_add_u32 s4, s4, s5
    s_add_u32 s31, s4, s76
    s_lshl_b32 s4, s37, 18
    s_add_u32 s32, s4, s77
    s_and_b32 s4, s37, 1
    s_mul_i32 s4, s4, 10240
    s_add_u32 s34, s4, 26624
    s_waitcnt vmcnt(0)
    s_barrier
    s_branch Lk0b_60
LrO_65:
    s_sub_u32 s20, s20, 1
    s_cbranch_scc1 L_R_abort
    buffer_load_dwordx4 v[136:139], v13, s[8:11], s23 offen offset:0 sc1
    buffer_load_dwordx4 v[140:143], v13, s[8:11], s23 offen offset:1024 sc1
    s_branch LpO_64
LrC_67:
    s_sub_u32 s20, s20, 1
    s_cbranch_scc1 L_R_abort
    buffer_load_dwordx4 v[68:71], v15, s[8:11], s24 offen sc1
    s_branch LpC_66
LrA_69:
    s_sub_u32 s20, s20, 1
    s_cbranch_scc1 L_R_abort
    buffer_load_dwordx4 v[96:99], v8, s[8:11], s21 offen offset:0 sc1
    buffer_load_dwordx4 v[100:103], v8, s[8:11], s21 offen offset:1024 sc1
    buffer_load_dwordx4 v[104:107], v8, s[8:11], s21 offen offset:2048 sc1
    buffer_load_dwordx4 v[108:111], v8, s[8:11], s21 offen offset:3072 sc1
    s_waitcnt vmcnt(3)
    s_branch LpA_68
LrA_72:
    s_sub_u32 s20, s20, 1
    s_cbranch_scc1 L_R_abort
    buffer_load_dwordx4 v[100:103], v8, s[8:11], s21 offen offset:1024 sc1
    buffer_load_dwordx4 v[104:107], v8, s[8:11], s21 offen offset:2048 sc1
    buffer_load_dwordx4 v[108:111], v8, s[8:11], s21 offen offset:3072 sc1
    s_waitcnt vmcnt(2)
    s_branch LpA_71
LrA_75:
    s_sub_u32 s20, s20, 1
    s_cbranch_scc1 L_R_abort
    buffer_load_dwordx4 v[104:107], v8, s[8:11], s21 offen offset:2048 sc1
    buffer_load_dwordx4 v[108:111], v8, s[8:11], s21 offen offset:3072 sc1
    s_waitcnt vmcnt(1)
    s_branch LpA_74
LrA_78:
    s_sub_u32 s20, s20, 1
    s_cbranch_scc1 L_R_abort
    buffer_load_dwordx4 v[108:111], v8, s[8:11], s21 offen offset:3072 sc1
    s_waitcnt vmcnt(0)
    s_branch LpA_77
LrA_83:
    s_sub_u32 s20, s20, 1
    s_cbranch_scc1 L_R_abort
    buffer_load_dwordx4 v[96:99], v8, s[8:11], s21 offen offset:0 sc1
    buffer_load_dwordx4 v[100:103], v8, s[8:11], s21 offen offset:1024 sc1
    buffer_load_dwordx4 v[104:107], v8, s[8:11], s21 offen offset:2048 sc1
    buffer_load_dwordx4 v[108:111], v8, s[8:11], s21 offen offset:3072 sc1
    s_waitcnt vmcnt(3)
    s_branch LpA_82
LrA_86:
    s_sub_u32 s20, s20, 1
    s_cbranch_scc1 L_R_abort
    buffer_load_dwordx4 v[100:103], v8, s[8:11], s21 offen offset:1024 sc1
    buffer_load_dwordx4 v[104:107], v8, s[8:11], s21 offen offset:2048 sc1
    buffer_load_dwordx4 v[108:111], v8, s[8:11], s21 offen offset:3072 sc1
    s_waitcnt vmcnt(2)
    s_branch LpA_85
LrA_89:
    s_sub_u32 s20, s20, 1
    s_cbranch_scc1 L_R_abort
    buffer_load_dwordx4 v[104:107], v8, s[8:11], s21 offen offset:2048 sc1
    buffer_load_dwordx4 v[108:111], v8, s[8:11], s21 offen offset:3072 sc1
    s_waitcnt vmcnt(1)
    s_branch LpA_88
LrA_92:
    s_sub_u32 s20, s20, 1
    s_cbranch_scc1 L_R_abort
    buffer_load_dwordx4 v[108:111], v8, s[8:11], s21 offen offset:3072 sc1
    s_waitcnt vmcnt(0)
    s_branch LpA_91
Lk0h_94:
    s_cmp_lg_u32 s3, 0
    s_cbranch_scc1 Lwb_97_ok
    v_mov_b32 v4, 102773248
Lwb_97:
    buffer_load_dword v5, v4, s[8:11], 0 offen sc1
    s_waitcnt vmcnt(0)
    v_cmp_le_u32 vcc, 128, v5
    s_cbranch_vccnz Lwb_97_ok
    s_sleep 2
    s_sub_u32 s20, s20, 1
    s_cbranch_scc0 Lwb_97
    s_branch L_R_abort
Lwb_97_ok:
    s_barrier
    s_lshr_b32 s4, s19, 3
    s_lshl_b32 s4, s4, 21
    s_and_b32 s5, s19, 7
    s_lshl_b32 s5, s5, 9
    s_add_u32 s4, s4, s5
    s_add_u32 s31, s4, s76
    s_lshl_b32 s4, s19, 18
    s_add_u32 s32, s4, s77
    s_and_b32 s4, s19, 1
    s_mul_i32 s4, s4, 10240
    s_add_u32 s34, s4, 26624
    s_lshl_b32 s6, s3, 10
    s_add_u32 s6, s6, s34
    s_mov_b32 m0, s6
    s_add_u32 s6, s6, 3840
    buffer_load_dwordx4 v17, s[8:11], s31 offen sc1 lds
    s_mov_b32 m0, s6
    s_add_u32 s6, s6, 4352
    buffer_load_dwordx4 v17, s[8:11], s31 offen offset:256 sc1 lds
    s_mov_b32 s37, 1
    s_lshr_b32 s4, s37, 3
    s_lshl_b32 s4, s4, 21
    s_and_b32 s5, s37, 7
    s_lshl_b32 s5, s5, 9
    s_add_u32 s4, s4, s5
    s_add_u32 s31, s4, s76
    s_lshl_b32 s4, s37, 18
    s_add_u32 s32, s4, s77
    s_and_b32 s4, s37, 1
    s_mul_i32 s4, s4, 10240
    s_add_u32 s34, s4, 26624
    s_waitcnt vmcnt(0)
    s_barrier
    s_branch Lk0b_95
LrB_99:
    s_sub_u32 s20, s20, 1
    s_cbranch_scc1 L_R_abort
    buffer_load_dwordx4 v[192:195], v9, s[8:11], s22 offen offset:0 sc1
    buffer_load_dwordx4 v[196:199], v9, s[8:11], s22 offen offset:1024 sc1
    buffer_load_dwordx4 v[200:203], v9, s[8:11], s22 offen offset:2048 sc1
    buffer_load_dwordx4 v[204:207], v9, s[8:11], s22 offen offset:3072 sc1
    s_branch LpB_98
LrO_101:
    s_sub_u32 s20, s20, 1
    s_cbranch_scc1 L_R_abort
    buffer_load_dwordx4 v[144:147], v13, s[8:11], s23 offen offset:0 sc1
    buffer_load_dwordx4 v[148:151], v13, s[8:11], s23 offen offset:1024 sc1
    s_branch LpO_100
LrC_103:
    s_sub_u32 s20, s20, 1
    s_cbranch_scc1 L_R_abort
    buffer_load_dwordx4 v[68:71], v15, s[8:11], s24 offen sc1
    s_branch LpC_102
LrA_105:
    s_sub_u32 s20, s20, 1
    s_cbranch_scc1 L_R_abort
    buffer_load_dwordx4 v[96:99], v8, s[8:11], s21 offen offset:0 sc1
    buffer_load_dwordx4 v[100:103], v8, s[8:11], s21 offen offset:1024 sc1
    buffer_load_dwordx4 v[104:107], v8, s[8:11], s21 offen offset:2048 sc1
    buffer_load_dwordx4 v[108:111], v8, s[8:11], s21 offen offset:3072 sc1
    s_waitcnt vmcnt(3)
    s_branch LpA_104
LrA_108:
    s_sub_u32 s20, s20, 1
    s_cbranch_scc1 L_R_abort
    buffer_load_dwordx4 v[100:103], v8, s[8:11], s21 offen offset:1024 sc1
    buffer_load_dwordx4 v[104:107], v8, s[8:11], s21 offen offset:2048 sc1
    buffer_load_dwordx4 v[108:111], v8, s[8:11], s21 offen offset:3072 sc1
    s_waitcnt vmcnt(2)
    s_branch LpA_107
LrA_111:
    s_sub_u32 s20, s20, 1
    s_cbranch_scc1 L_R_abort
    buffer_load_dwordx4 v[104:107], v8, s[8:11], s21 offen offset:2048 sc1
    buffer_load_dwordx4 v[108:111], v8, s[8:11], s21 offen offset:3072 sc1
    s_waitcnt vmcnt(1)
    s_branch LpA_110
LrA_114:
    s_sub_u32 s20, s20, 1
    s_cbranch_scc1 L_R_abort
    buffer_load_dwordx4 v[108:111], v8, s[8:11], s21 offen offset:3072 sc1
    s_waitcnt vmcnt(0)
    s_branch LpA_113
LrA_119:
    s_sub_u32 s20, s20, 1
    s_cbranch_scc1 L_R_abort
    buffer_load_dwordx4 v[96:99], v8, s[8:11], s21 offen offset:0 sc1
    buffer_load_dwordx4 v[100:103], v8, s[8:11], s21 offen offset:1024 sc1
    buffer_load_dwordx4 v[104:107], v8, s[8:11], s21 offen offset:2048 sc1
    buffer_load_dwordx4 v[108:111], v8, s[8:11], s21 offen offset:3072 sc1
    s_waitcnt vmcnt(3)
    s_branch LpA_118
LrA_122:
    s_sub_u32 s20, s20, 1
    s_cbranch_scc1 L_R_abort
    buffer_load_dwordx4 v[100:103], v8, s[8:11], s21 offen offset:1024 sc1
    buffer_load_dwordx4 v[104:107], v8, s[8:11], s21 offen offset:2048 sc1
    buffer_load_dwordx4 v[108:111], v8, s[8:11], s21 offen offset:3072 sc1
    s_waitcnt vmcnt(2)
    s_branch LpA_121
LrA_125:
    s_sub_u32 s20, s20, 1
    s_cbranch_scc1 L_R_abort
    buffer_load_dwordx4 v[104:107], v8, s[8:11], s21 offen offset:2048 sc1
    buffer_load_dwordx4 v[108:111], v8, s[8:11], s21 offen offset:3072 sc1
    s_waitcnt vmcnt(1)
    s_branch LpA_124
LrA_128:
    s_sub_u32 s20, s20, 1
    s_cbranch_scc1 L_R_abort
    buffer_load_dwordx4 v[108:111], v8, s[8:11], s21 offen offset:3072 sc1
    s_waitcnt vmcnt(0)
    s_branch LpA_127
Lk0h_130:
    s_cmp_lg_u32 s3, 0
    s_cbranch_scc1 Lwb_133_ok
    v_mov_b32 v4, 102773248
Lwb_133:
    buffer_load_dword v5, v4, s[8:11], 0 offen sc1
    s_waitcnt vmcnt(0)
    v_cmp_le_u32 vcc, 128, v5
    s_cbranch_vccnz Lwb_133_ok
    s_sleep 2
    s_sub_u32 s20, s20, 1
    s_cbranch_scc0 Lwb_133
    s_branch L_R_abort
Lwb_133_ok:
    s_barrier
    s_lshr_b32 s4, s19, 3
    s_lshl_b32 s4, s4, 21
    s_and_b32 s5, s19, 7
    s_lshl_b32 s5, s5, 9
    s_add_u32 s4, s4, s5
    s_add_u32 s31, s4, s76
    s_lshl_b32 s4, s19, 18
    s_add_u32 s32, s4, s77
    s_and_b32 s4, s19, 1
    s_mul_i32 s4, s4, 10240
    s_add_u32 s34, s4, 26624
    s_lshl_b32 s6, s3, 10
    s_add_u32 s6, s6, s34
    s_mov_b32 m0, s6
    s_add_u32 s6, s6, 3840
    buffer_load_dwordx4 v17, s[8:11], s31 offen sc1 lds
    s_mov_b32 m0, s6
    s_add_u32 s6, s6, 4352
    buffer_load_dwordx4 v17, s[8:11], s31 offen offset:256 sc1 lds
    s_mov_b32 s37, 1
    s_lshr_b32 s4, s37, 3
    s_lshl_b32 s4, s4, 21
    s_and_b32 s5, s37, 7
    s_lshl_b32 s5, s5, 9
    s_add_u32 s4, s4, s5
    s_add_u32 s31, s4, s76
    s_lshl_b32 s4, s37, 18
    s_add_u32 s32, s4, s77
    s_and_b32 s4, s37, 1
    s_mul_i32 s4, s4, 10240
    s_add_u32 s34, s4, 26624
    s_waitcnt vmcnt(0)
    s_barrier
    s_branch Lk0b_131
LrB_135:
    s_sub_u32 s20, s20, 1
    s_cbranch_scc1 L_R_abort
    buffer_load_dwordx4 v[192:195], v9, s[8:11], s22 offen offset:0 sc1
    buffer_load_dwordx4 v[196:199], v9, s[8:11], s22 offen offset:1024 sc1
    buffer_load_dwordx4 v[200:203], v9, s[8:11], s22 offen offset:2048 sc1
    buffer_load_dwordx4 v[204:207], v9, s[8:11], s22 offen offset:3072 sc1
    s_branch LpB_134
LrO_137:
    s_sub_u32 s20, s20, 1
    s_cbranch_scc1 L_R_abort
    buffer_load_dwordx4 v[152:155], v13, s[8:11], s23 offen offset:0 sc1
    buffer_load_dwordx4 v[156:159], v13, s[8:11], s23 offen offset:1024 sc1
    s_branch LpO_136
LrC_139:
    s_sub_u32 s20, s20, 1
    s_cbranch_scc1 L_R_abort
    buffer_load_dwordx4 v[68:71], v15, s[8:11], s24 offen sc1
    s_branch LpC_138
LrA_141:
    s_sub_u32 s20, s20, 1
    s_cbranch_scc1 L_R_abort
    buffer_load_dwordx4 v[96:99], v8, s[8:11], s21 offen offset:0 sc1
    buffer_load_dwordx4 v[100:103], v8, s[8:11], s21 offen offset:1024 sc1
    buffer_load_dwordx4 v[104:107], v8, s[8:11], s21 offen offset:2048 sc1
    buffer_load_dwordx4 v[108:111], v8, s[8:11], s21 offen offset:3072 sc1
    s_waitcnt vmcnt(3)
    s_branch LpA_140
LrA_144:
    s_sub_u32 s20, s20, 1
    s_cbranch_scc1 L_R_abort
    buffer_load_dwordx4 v[100:103], v8, s[8:11], s21 offen offset:1024 sc1
    buffer_load_dwordx4 v[104:107], v8, s[8:11], s21 offen offset:2048 sc1
    buffer_load_dwordx4 v[108:111], v8, s[8:11], s21 offen offset:3072 sc1
    s_waitcnt vmcnt(2)
    s_branch LpA_143
LrA_147:
    s_sub_u32 s20, s20, 1
    s_cbranch_scc1 L_R_abort
    buffer_load_dwordx4 v[104:107], v8, s[8:11], s21 offen offset:2048 sc1
    buffer_load_dwordx4 v[108:111], v8, s[8:11], s21 offen offset:3072 sc1
    s_waitcnt vmcnt(1)
    s_branch LpA_146
LrA_150:
    s_sub_u32 s20, s20, 1
    s_cbranch_scc1 L_R_abort
    buffer_load_dwordx4 v[108:111], v8, s[8:11], s21 offen offset:3072 sc1
    s_waitcnt vmcnt(0)
    s_branch LpA_149
L_R_abort:
    s_endpgm
L_R_done:
    s_branch L_exit
L_G:
    s_mov_b32 s23, s90
    s_and_b32 s25, s91, 31
    v_lshlrev_b32 v25, 2, v0
    v_mov_b32 v24, 1
    v_mov_b32 v26, 0x80000000
    s_cmp_eq_u32 s3, 0
    s_cselect_b32 s5, 0, 0x80000000
    v_mov_b32 v1, s5
    v_mov_b32 v2, 0x80000000
    v_cmp_eq_u32 vcc, 0, v0
    s_nop 1
    v_cndmask_b32 v23, v2, v1, vcc
    s_mov_b32 s22, 400000
    v_and_b32 v1, 15, v0
    v_lshrrev_b32 v2, 4, v0
    v_lshlrev_b32 v4, 4, v1
    v_lshlrev_b32 v5, 12, v2
    v_add_u32 v228, v4, v5
    s_lshr_b32 s4, s3, 1
    s_lshl_b32 s5, s4, 11
    v_add_u32 v8, s5, v228
    v_add_u32 v9, 0x10000, v8
    v_mov_b32 v30, v8
    v_bfe_u32 v3, v0, 2, 2
    v_lshlrev_b32 v4, 2, v2
    v_add_u32 v4, v4, v3
    v_and_b32 v6, 7, v4
    v_lshlrev_b32 v4, 8, v4
    v_and_b32 v5, 3, v0
    v_lshlrev_b32 v5, 3, v5
    v_add_u32 v4, v4, v5
    s_and_b32 s5, s3, 1
    s_lshl_b32 s5, s5, 2
    s_add_u32 s6, s5, 0
    v_xor_b32 v5, s6, v6
    v_lshlrev_b32 v5, 5, v5
    v_add_u32 v10, v4, v5
    v_add_u32 v14, 0x10000, v10
    s_add_u32 s6, s5, 1
    v_xor_b32 v5, s6, v6
    v_lshlrev_b32 v5, 5, v5
    v_add_u32 v11, v4, v5
    v_add_u32 v15, 0x10000, v11
    s_add_u32 s6, s5, 2
    v_xor_b32 v5, s6, v6
    v_lshlrev_b32 v5, 5, v5
    v_add_u32 v12, v4, v5
    v_add_u32 v16, 0x10000, v12
    s_add_u32 s6, s5, 3
    v_xor_b32 v5, s6, v6
    v_lshlrev_b32 v5, 5, v5
    v_add_u32 v13, v4, v5
    v_add_u32 v17, 0x10000, v13
    v_lshlrev_b32 v4, 4, v0
    s_lshl_b32 s5, s3, 12
    v_add_u32 v18, s5, v4
    v_lshrrev_b32 v1, 4, v0
    v_and_b32 v2, 15, v0
    v_add_u32 v3, 0, v1
    v_lshlrev_b32 v3, 1, v3
    v_xor_b32 v3, v2, v3
    v_lshlrev_b32 v20, 4, v3
    v_add_u32 v3, 4, v1
    v_lshlrev_b32 v3, 1, v3
    v_xor_b32 v3, v2, v3
    v_lshlrev_b32 v21, 4, v3
    s_lshr_b32 s5, s3, 1
    s_lshl_b32 s5, s5, 4
    v_add_u32 v19, s5, v1
    s_lshl_b32 s19, s3, 12
    s_and_b32 s6, s3, 1
    s_lshl_b32 s6, s6, 13
    s_lshr_b32 s7, s3, 1
    s_lshl_b32 s7, s7, 12
    s_add_u32 s6, s6, s7
    s_add_u32 s20, s6, 16384
    s_mov_b32 s48, s8
    s_mov_b32 s49, s9
    s_mov_b32 s50, 0
    s_mov_b32 s51, 0x20000
    v_and_b32 v1, 15, v0
    v_lshrrev_b32 v2, 4, v0
    v_lshlrev_b32 v4, 16, v2
    v_lshlrev_b32 v5, 4, v1
    v_add_u32 v230, v4, v5
    v_bfe_u32 v4, v1, 2, 1
    v_lshlrev_b32 v4, 2, v4
    v_lshrrev_b32 v5, 3, v1
    v_lshlrev_b32 v5, 1, v5
    v_add_u32 v4, v4, v5
    v_and_b32 v5, 1, v1
    v_add_u32 v4, v4, v5
    v_lshlrev_b32 v4, 4, v4
    v_lshlrev_b32 v5, 7, v2
    v_add_u32 v229, v4, v5
    v_mov_b32 v231, 0xff61b1e6
    v_lshlrev_b32 v4, 2, v2
    v_add_u32 v5, 0, v4
    v_cmp_le_u32 s[52:53], v5, v1
    v_add_u32 v5, 1, v4
    v_cmp_le_u32 s[54:55], v5, v1
    v_add_u32 v5, 2, v4
    v_cmp_le_u32 s[56:57], v5, v1
    v_add_u32 v5, 3, v4
    v_cmp_le_u32 s[58:59], v5, v1
    v_lshlrev_b32 v227, 4, v0
    s_add_u32 s4, s3, 0
    s_and_b32 s4, s4, 3
    s_lshl_b32 s4, s4, 9
    v_add_u32 v208, s4, v228
    s_add_u32 s4, s3, 1
    s_and_b32 s4, s4, 3
    s_lshl_b32 s4, s4, 9
    v_add_u32 v209, s4, v228
    s_add_u32 s4, s3, 2
    s_and_b32 s4, s4, 3
    s_lshl_b32 s4, s4, 9
    v_add_u32 v210, s4, v228
    s_add_u32 s4, s3, 3
    s_and_b32 s4, s4, 3
    s_lshl_b32 s4, s4, 9
    v_add_u32 v211, s4, v228
    v_lshrrev_b32 v1, 3, v0
    v_lshlrev_b32 v1, 13, v1
    v_bfe_u32 v2, v0, 1, 2
    v_lshrrev_b32 v3, 4, v0
    v_xor_b32 v2, v2, v3
    v_lshlrev_b32 v2, 5, v2
    v_add_u32 v1, v1, v2
    v_and_b32 v2, 1, v0
    v_lshlrev_b32 v2, 4, v2
    v_add_u32 v212, v1, v2
    v_add_u32 v213, 64512, v212
    v_add_u32 v214, 129024, v212
    v_add_u32 v215, 193536, v212
    v_lshrrev_b32 v1, 4, v0
    v_lshlrev_b32 v1, 2, v1
    v_bfe_u32 v2, v0, 2, 2
    v_add_u32 v1, v1, v2
    v_bfe_u32 v2, v1, 1, 2
    v_lshlrev_b32 v1, 7, v1
    v_and_b32 v3, 3, v0
    v_lshlrev_b32 v3, 3, v3
    v_add_u32 v1, v1, v3
    s_lshl_b32 s4, s3, 15
    v_add_u32 v1, s4, v1
    v_xor_b32 v3, 0, v2
    v_lshlrev_b32 v3, 5, v3
    v_add_u32 v216, v1, v3
    v_xor_b32 v3, 1, v2
    v_lshlrev_b32 v3, 5, v3
    v_add_u32 v217, v1, v3
    v_xor_b32 v3, 2, v2
    v_lshlrev_b32 v3, 5, v3
    v_add_u32 v218, v1, v3
    v_xor_b32 v3, 3, v2
    v_lshlrev_b32 v3, 5, v3
    v_add_u32 v219, v1, v3
    s_lshl_b32 s4, s3, 15
    v_add_u32 v220, s4, v227
    v_add_u32 v221, 8192, v220
    v_add_u32 v222, 16384, v220
    s_sub_u32 s4, s3, 1
    s_and_b32 s4, s4, 3
    s_lshl_b32 s4, s4, 15
    s_add_u32 s4, s4, 0
    v_add_u32 v223, s4, v227
    s_sub_u32 s4, s3, 2
    s_and_b32 s4, s4, 3
    s_lshl_b32 s4, s4, 15
    s_add_u32 s4, s4, 8192
    v_add_u32 v224, s4, v227
    s_sub_u32 s4, s3, 3
    s_and_b32 s4, s4, 3
    s_lshl_b32 s4, s4, 15
    s_add_u32 s4, s4, 16384
    v_add_u32 v225, s4, v227
    s_mov_b32 s60, 0
    s_lshl_b32 s4, s23, 5
    s_add_u32 s5, s4, s25
    s_mov_b32 s26, 0
    s_mov_b32 s40, 102773248
    s_cmp_eq_u32 s60, 0
    s_cbranch_scc1 Lk0_154
    s_add_u32 s5, s5, s25
    s_add_u32 s5, s5, s60
    s_sub_u32 s5, s5, 1
    s_mov_b32 s26, 1
    s_mov_b32 s40, 102760448
Lk0_154:
    s_and_b32 s27, s5, 63
    s_lshr_b32 s4, s23, 1
    s_lshl_b32 s4, s4, 3
    s_add_u32 s4, s4, 24
    s_load_dwordx2 s[12:13], s[0:1], s4
    s_mov_b32 s14, 8388608
    s_mov_b32 s15, 0x20000
    s_lshl_b32 s16, s3, 17
    s_lshl_b32 s4, s26, 11
    s_add_u32 s16, s16, s4
    s_add_u32 s16, s16, 0
    s_lshl_b32 s17, s3, 21
    s_lshl_b32 s4, s27, 7
    s_add_u32 s17, s17, s4
    s_lshl_b32 s41, s3, 15
    s_cmp_ge_u32 s23, 2
    s_cbranch_scc1 Lk0_155
    s_lshl_b32 s4, s27, 15
    s_lshl_b32 s5, s26, 11
    s_add_u32 s4, s4, s5
    s_lshl_b32 s5, s3, 9
    s_add_u32 s4, s4, s5
    s_add_u32 s29, s4, 4194304
    s_branch Lk0_156
Lk0_155:
    s_lshl_b32 s4, s26, 2
    s_add_u32 s4, s4, s3
    s_lshl_b32 s4, s4, 18
    s_lshl_b32 s5, s27, 10
    s_add_u32 s4, s4, s5
    s_add_u32 s29, s4, 20971520
Lk0_156:
    s_waitcnt lgkmcnt(0)
    s_cmp_lg_u32 s91, 0
    s_cbranch_scc1 Lini_152
    v_lshlrev_b32 v1, 8, v0
    v_mov_b32 v2, 0
    s_mov_b32 s4, 102760448
    buffer_store_dword v2, v1, s[8:11], s4 offen sc1
    s_add_u32 s4, s4, 16384
    buffer_store_dword v2, v1, s[8:11], s4 offen sc1
    s_add_u32 s4, s4, 16384
    buffer_store_dword v2, v1, s[8:11], s4 offen sc1
Lini_152:
    s_lshl_b32 s62, s25, 2
    s_add_u32 s62, s62, s23
    s_load_dwordx2 s[44:45], s[0:1], 0
    s_mov_b32 s46, 4194304
    s_mov_b32 s47, 0x20000
    v_and_b32 v1, 15, v0
    v_lshrrev_b32 v2, 4, v0
    v_lshlrev_b32 v4, 11, v1
    v_lshlrev_b32 v5, 3, v2
    v_add_u32 v4, v4, v5
    s_lshl_b32 s4, s62, 15
    s_lshl_b32 s5, s3, 9
    s_add_u32 s4, s4, s5
    s_waitcnt lgkmcnt(0)
    buffer_load_dwordx2 v[32:33], v4, s[44:47], s4 offen offset:0
    buffer_load_dwordx2 v[34:35], v4, s[44:47], s4 offen offset:32
    buffer_load_dwordx2 v[36:37], v4, s[44:47], s4 offen offset:64
    buffer_load_dwordx2 v[38:39], v4, s[44:47], s4 offen offset:96
    buffer_load_dwordx2 v[40:41], v4, s[44:47], s4 offen offset:128
    buffer_load_dwordx2 v[42:43], v4, s[44:47], s4 offen offset:160
    buffer_load_dwordx2 v[44:45], v4, s[44:47], s4 offen offset:192
    buffer_load_dwordx2 v[46:47], v4, s[44:47], s4 offen offset:224
    buffer_load_dwordx2 v[48:49], v4, s[44:47], s4 offen offset:256
    buffer_load_dwordx2 v[50:51], v4, s[44:47], s4 offen offset:288
    buffer_load_dwordx2 v[52:53], v4, s[44:47], s4 offen offset:320
    buffer_load_dwordx2 v[54:55], v4, s[44:47], s4 offen offset:352
    buffer_load_dwordx2 v[56:57], v4, s[44:47], s4 offen offset:384
    buffer_load_dwordx2 v[58:59], v4, s[44:47], s4 offen offset:416
    buffer_load_dwordx2 v[60:61], v4, s[44:47], s4 offen offset:448
    buffer_load_dwordx2 v[62:63], v4, s[44:47], s4 offen offset:480
    s_lshl_b32 s5, s3, 6
    v_lshlrev_b32 v5, 2, v1
    v_add_u32 v6, s5, v5
    v_add_u32 v6, 131136, v6
    v_add_u32 v7, 131136, v5
    s_add_u32 m0, s41, 0
    s_nop 0
    buffer_load_dwordx4 v212, s[12:15], s17 offen lds
    buffer_load_dwordx4 v213, s[12:15], s17 offen offset:1024 lds
    buffer_load_dwordx4 v214, s[12:15], s17 offen offset:2048 lds
    buffer_load_dwordx4 v215, s[12:15], s17 offen offset:3072 lds
    s_add_u32 s17, s17, 262144
    s_add_u32 m0, s41, 4096
    s_nop 0
    buffer_load_dwordx4 v212, s[12:15], s17 offen lds
    buffer_load_dwordx4 v213, s[12:15], s17 offen offset:1024 lds
    buffer_load_dwordx4 v214, s[12:15], s17 offen offset:2048 lds
    buffer_load_dwordx4 v215, s[12:15], s17 offen offset:3072 lds
    s_add_u32 s17, s17, 262144
    s_add_u32 m0, s41, 8192
    s_nop 0
    buffer_load_dwordx4 v212, s[12:15], s17 offen lds
    buffer_load_dwordx4 v213, s[12:15], s17 offen offset:1024 lds
    buffer_load_dwordx4 v214, s[12:15], s17 offen offset:2048 lds
    buffer_load_dwordx4 v215, s[12:15], s17 offen offset:3072 lds
    s_add_u32 s17, s17, 262144
    s_add_u32 m0, s41, 12288
    s_nop 0
    buffer_load_dwordx4 v212, s[12:15], s17 offen lds
    buffer_load_dwordx4 v213, s[12:15], s17 offen offset:1024 lds
    buffer_load_dwordx4 v214, s[12:15], s17 offen offset:2048 lds
    buffer_load_dwordx4 v215, s[12:15], s17 offen offset:3072 lds
    s_add_u32 s17, s17, 262144
    s_waitcnt vmcnt(16)
    v_lshlrev_b32 v64, 16, v32
    v_and_b32 v65, 0xffff0000, v32
    v_lshlrev_b32 v66, 16, v33
    v_and_b32 v67, 0xffff0000, v33
    v_lshlrev_b32 v68, 16, v34
    v_and_b32 v69, 0xffff0000, v34
    v_lshlrev_b32 v70, 16, v35
    v_and_b32 v71, 0xffff0000, v35
    v_lshlrev_b32 v72, 16, v36
    v_and_b32 v73, 0xffff0000, v36
    v_lshlrev_b32 v74, 16, v37
    v_and_b32 v75, 0xffff0000, v37
    v_lshlrev_b32 v76, 16, v38
    v_and_b32 v77, 0xffff0000, v38
    v_lshlrev_b32 v78, 16, v39
    v_and_b32 v79, 0xffff0000, v39
    v_lshlrev_b32 v80, 16, v40
    v_and_b32 v81, 0xffff0000, v40
    v_lshlrev_b32 v82, 16, v41
    v_and_b32 v83, 0xffff0000, v41
    v_lshlrev_b32 v84, 16, v42
    v_and_b32 v85, 0xffff0000, v42
    v_lshlrev_b32 v86, 16, v43
    v_and_b32 v87, 0xffff0000, v43
    v_lshlrev_b32 v88, 16, v44
    v_and_b32 v89, 0xffff0000, v44
    v_lshlrev_b32 v90, 16, v45
    v_and_b32 v91, 0xffff0000, v45
    v_lshlrev_b32 v92, 16, v46
    v_and_b32 v93, 0xffff0000, v46
    v_lshlrev_b32 v94, 16, v47
    v_and_b32 v95, 0xffff0000, v47
    v_lshlrev_b32 v96, 16, v48
    v_and_b32 v97, 0xffff0000, v48
    v_lshlrev_b32 v98, 16, v49
    v_and_b32 v99, 0xffff0000, v49
    v_lshlrev_b32 v100, 16, v50
    v_and_b32 v101, 0xffff0000, v50
    v_lshlrev_b32 v102, 16, v51
    v_and_b32 v103, 0xffff0000, v51
    v_lshlrev_b32 v104, 16, v52
    v_and_b32 v105, 0xffff0000, v52
    v_lshlrev_b32 v106, 16, v53
    v_and_b32 v107, 0xffff0000, v53
    v_lshlrev_b32 v108, 16, v54
    v_and_b32 v109, 0xffff0000, v54
    v_lshlrev_b32 v110, 16, v55
    v_and_b32 v111, 0xffff0000, v55
    v_lshlrev_b32 v112, 16, v56
    v_and_b32 v113, 0xffff0000, v56
    v_lshlrev_b32 v114, 16, v57
    v_and_b32 v115, 0xffff0000, v57
    v_lshlrev_b32 v116, 16, v58
    v_and_b32 v117, 0xffff0000, v58
    v_lshlrev_b32 v118, 16, v59
    v_and_b32 v119, 0xffff0000, v59
    v_lshlrev_b32 v120, 16, v60
    v_and_b32 v121, 0xffff0000, v60
    v_lshlrev_b32 v122, 16, v61
    v_and_b32 v123, 0xffff0000, v61
    v_lshlrev_b32 v124, 16, v62
    v_and_b32 v125, 0xffff0000, v62
    v_lshlrev_b32 v126, 16, v63
    v_and_b32 v127, 0xffff0000, v63
    v_pk_add_f32 v[128:129], v[64:65], v[66:67]
    v_pk_add_f32 v[130:131], v[68:69], v[70:71]
    v_pk_add_f32 v[132:133], v[72:73], v[74:75]
    v_pk_add_f32 v[134:135], v[76:77], v[78:79]
    v_pk_add_f32 v[136:137], v[80:81], v[82:83]
    v_pk_add_f32 v[138:139], v[84:85], v[86:87]
    v_pk_add_f32 v[140:141], v[88:89], v[90:91]
    v_pk_add_f32 v[142:143], v[92:93], v[94:95]
    v_pk_add_f32 v[144:145], v[96:97], v[98:99]
    v_pk_add_f32 v[146:147], v[100:101], v[102:103]
    v_pk_add_f32 v[148:149], v[104:105], v[106:107]
    v_pk_add_f32 v[150:151], v[108:109], v[110:111]
    v_pk_add_f32 v[152:153], v[112:113], v[114:115]
    v_pk_add_f32 v[154:155], v[116:117], v[118:119]
    v_pk_add_f32 v[156:157], v[120:121], v[122:123]
    v_pk_add_f32 v[158:159], v[124:125], v[126:127]
    v_pk_add_f32 v[128:129], v[128:129], v[144:145]
    v_pk_add_f32 v[130:131], v[130:131], v[146:147]
    v_pk_add_f32 v[132:133], v[132:133], v[148:149]
    v_pk_add_f32 v[134:135], v[134:135], v[150:151]
    v_pk_add_f32 v[136:137], v[136:137], v[152:153]
    v_pk_add_f32 v[138:139], v[138:139], v[154:155]
    v_pk_add_f32 v[140:141], v[140:141], v[156:157]
    v_pk_add_f32 v[142:143], v[142:143], v[158:159]
    v_pk_add_f32 v[128:129], v[128:129], v[136:137]
    v_pk_add_f32 v[130:131], v[130:131], v[138:139]
    v_pk_add_f32 v[132:133], v[132:133], v[140:141]
    v_pk_add_f32 v[134:135], v[134:135], v[142:143]
    v_pk_add_f32 v[128:129], v[128:129], v[132:133]
    v_pk_add_f32 v[130:131], v[130:131], v[134:135]
    v_pk_add_f32 v[128:129], v[128:129], v[130:131]
    v_add_f32 v2, v128, v129
    v_mov_b32 v3, v2
    s_nop 1
    v_permlane32_swap_b32 v3, v2
    v_add_f32 v2, v2, v3
    v_mov_b32 v3, v2
    s_nop 1
    v_permlane16_swap_b32 v3, v2
    v_add_f32 v2, v2, v3
    ds_write_b32 v6, v2 offset:0
    s_waitcnt lgkmcnt(0)
    s_barrier
    ds_read_b32 v128, v7 offset:0
    ds_read_b32 v129, v7 offset:64
    ds_read_b32 v130, v7 offset:128
    ds_read_b32 v131, v7 offset:192
    s_waitcnt lgkmcnt(0)
    v_add_f32 v128, v128, v129
    v_add_f32 v130, v130, v131
    v_add_f32 v2, v128, v130
    v_mul_f32 v2, 0x3a800000, v2
    v_mov_b32 v5, v2
    v_sub_f32 v160, v64, v5
    v_sub_f32 v161, v65, v5
    v_sub_f32 v162, v66, v5
    v_sub_f32 v163, v67, v5
    v_sub_f32 v164, v68, v5
    v_sub_f32 v165, v69, v5
    v_sub_f32 v166, v70, v5
    v_sub_f32 v167, v71, v5
    v_sub_f32 v168, v72, v5
    v_sub_f32 v169, v73, v5
    v_sub_f32 v170, v74, v5
    v_sub_f32 v171, v75, v5
    v_sub_f32 v172, v76, v5
    v_sub_f32 v173, v77, v5
    v_sub_f32 v174, v78, v5
    v_sub_f32 v175, v79, v5
    v_sub_f32 v176, v80, v5
    v_sub_f32 v177, v81, v5
    v_sub_f32 v178, v82, v5
    v_sub_f32 v179, v83, v5
    v_sub_f32 v180, v84, v5
    v_sub_f32 v181, v85, v5
    v_sub_f32 v182, v86, v5
    v_sub_f32 v183, v87, v5
    v_sub_f32 v184, v88, v5
    v_sub_f32 v185, v89, v5
    v_sub_f32 v186, v90, v5
    v_sub_f32 v187, v91, v5
    v_sub_f32 v188, v92, v5
    v_sub_f32 v189, v93, v5
    v_sub_f32 v190, v94, v5
    v_sub_f32 v191, v95, v5
    v_sub_f32 v192, v96, v5
    v_sub_f32 v193, v97, v5
    v_sub_f32 v194, v98, v5
    v_sub_f32 v195, v99, v5
    v_sub_f32 v196, v100, v5
    v_sub_f32 v197, v101, v5
    v_sub_f32 v198, v102, v5
    v_sub_f32 v199, v103, v5
    v_sub_f32 v200, v104, v5
    v_sub_f32 v201, v105, v5
    v_sub_f32 v202, v106, v5
    v_sub_f32 v203, v107, v5
    v_sub_f32 v204, v108, v5
    v_sub_f32 v205, v109, v5
    v_sub_f32 v206, v110, v5
    v_sub_f32 v207, v111, v5
    v_sub_f32 v208, v112, v5
    v_sub_f32 v209, v113, v5
    v_sub_f32 v210, v114, v5
    v_sub_f32 v211, v115, v5
    v_sub_f32 v212, v116, v5
    v_sub_f32 v213, v117, v5
    v_sub_f32 v214, v118, v5
    v_sub_f32 v215, v119, v5
    v_sub_f32 v216, v120, v5
    v_sub_f32 v217, v121, v5
    v_sub_f32 v218, v122, v5
    v_sub_f32 v219, v123, v5
    v_sub_f32 v220, v124, v5
    v_sub_f32 v221, v125, v5
    v_sub_f32 v222, v126, v5
    v_sub_f32 v223, v127, v5
    v_pk_mul_f32 v[160:161], v[160:161], v[160:161]
    v_pk_mul_f32 v[162:163], v[162:163], v[162:163]
    v_pk_mul_f32 v[164:165], v[164:165], v[164:165]
    v_pk_mul_f32 v[166:167], v[166:167], v[166:167]
    v_pk_mul_f32 v[168:169], v[168:169], v[168:169]
    v_pk_mul_f32 v[170:171], v[170:171], v[170:171]
    v_pk_mul_f32 v[172:173], v[172:173], v[172:173]
    v_pk_mul_f32 v[174:175], v[174:175], v[174:175]
    v_pk_mul_f32 v[176:177], v[176:177], v[176:177]
    v_pk_mul_f32 v[178:179], v[178:179], v[178:179]
    v_pk_mul_f32 v[180:181], v[180:181], v[180:181]
    v_pk_mul_f32 v[182:183], v[182:183], v[182:183]
    v_pk_mul_f32 v[184:185], v[184:185], v[184:185]
    v_pk_mul_f32 v[186:187], v[186:187], v[186:187]
    v_pk_mul_f32 v[188:189], v[188:189], v[188:189]
    v_pk_mul_f32 v[190:191], v[190:191], v[190:191]
    v_pk_mul_f32 v[192:193], v[192:193], v[192:193]
    v_pk_mul_f32 v[194:195], v[194:195], v[194:195]
    v_pk_mul_f32 v[196:197], v[196:197], v[196:197]
    v_pk_mul_f32 v[198:199], v[198:199], v[198:199]
    v_pk_mul_f32 v[200:201], v[200:201], v[200:201]
    v_pk_mul_f32 v[202:203], v[202:203], v[202:203]
    v_pk_mul_f32 v[204:205], v[204:205], v[204:205]
    v_pk_mul_f32 v[206:207], v[206:207], v[206:207]
    v_pk_mul_f32 v[208:209], v[208:209], v[208:209]
    v_pk_mul_f32 v[210:211], v[210:211], v[210:211]
    v_pk_mul_f32 v[212:213], v[212:213], v[212:213]
    v_pk_mul_f32 v[214:215], v[214:215], v[214:215]
    v_pk_mul_f32 v[216:217], v[216:217], v[216:217]
    v_pk_mul_f32 v[218:219], v[218:219], v[218:219]
    v_pk_mul_f32 v[220:221], v[220:221], v[220:221]
    v_pk_mul_f32 v[222:223], v[222:223], v[222:223]
    v_pk_add_f32 v[128:129], v[160:161], v[162:163]
    v_pk_add_f32 v[130:131], v[164:165], v[166:167]
    v_pk_add_f32 v[132:133], v[168:169], v[170:171]
    v_pk_add_f32 v[134:135], v[172:173], v[174:175]
    v_pk_add_f32 v[136:137], v[176:177], v[178:179]
    v_pk_add_f32 v[138:139], v[180:181], v[182:183]
    v_pk_add_f32 v[140:141], v[184:185], v[186:187]
    v_pk_add_f32 v[142:143], v[188:189], v[190:191]
    v_pk_add_f32 v[144:145], v[192:193], v[194:195]
    v_pk_add_f32 v[146:147], v[196:197], v[198:199]
    v_pk_add_f32 v[148:149], v[200:201], v[202:203]
    v_pk_add_f32 v[150:151], v[204:205], v[206:207]
    v_pk_add_f32 v[152:153], v[208:209], v[210:211]
    v_pk_add_f32 v[154:155], v[212:213], v[214:215]
    v_pk_add_f32 v[156:157], v[216:217], v[218:219]
    v_pk_add_f32 v[158:159], v[220:221], v[222:223]
    v_pk_add_f32 v[128:129], v[128:129], v[144:145]
    v_pk_add_f32 v[130:131], v[130:131], v[146:147]
    v_pk_add_f32 v[132:133], v[132:133], v[148:149]
    v_pk_add_f32 v[134:135], v[134:135], v[150:151]
    v_pk_add_f32 v[136:137], v[136:137], v[152:153]
    v_pk_add_f32 v[138:139], v[138:139], v[154:155]
    v_pk_add_f32 v[140:141], v[140:141], v[156:157]
    v_pk_add_f32 v[142:143], v[142:143], v[158:159]
    v_pk_add_f32 v[128:129], v[128:129], v[136:137]
    v_pk_add_f32 v[130:131], v[130:131], v[138:139]
    v_pk_add_f32 v[132:133], v[132:133], v[140:141]
    v_pk_add_f32 v[134:135], v[134:135], v[142:143]
    v_pk_add_f32 v[128:129], v[128:129], v[132:133]
    v_pk_add_f32 v[130:131], v[130:131], v[134:135]
    v_pk_add_f32 v[128:129], v[128:129], v[130:131]
    v_add_f32 v2, v128, v129
    v_mov_b32 v3, v2
    s_nop 1
    v_permlane32_swap_b32 v3, v2
    v_add_f32 v2, v2, v3
    v_mov_b32 v3, v2
    s_nop 1
    v_permlane16_swap_b32 v3, v2
    v_add_f32 v2, v2, v3
    ds_write_b32 v6, v2 offset:256
    s_waitcnt lgkmcnt(0)
    s_barrier
    ds_read_b32 v128, v7 offset:256
    ds_read_b32 v129, v7 offset:320
    ds_read_b32 v130, v7 offset:384
    ds_read_b32 v131, v7 offset:448
    s_waitcnt lgkmcnt(0)
    v_add_f32 v128, v128, v129
    v_add_f32 v130, v130, v131
    v_add_f32 v2, v128, v130
    v_mul_f32 v2, 0x3a800000, v2
    v_cvt_pk_bf16_f32 v5, v5, v5
    v_cvt_pk_bf16_f32 v2, v2, v2
    v_lshlrev_b32 v5, 16, v5
    v_lshlrev_b32 v2, 16, v2
    v_add_f32 v2, 0x3727c5ac, v2
    v_cvt_pk_bf16_f32 v2, v2, v2
    v_lshlrev_b32 v2, 16, v2
    v_sqrt_f32 v2, v2
    s_nop 0
    v_cvt_pk_bf16_f32 v2, v2, v2
    v_lshlrev_b32 v2, 16, v2
    v_rcp_f32 v2, v2
    v_sub_f32 v64, v64, v5
    v_sub_f32 v65, v65, v5
    v_sub_f32 v66, v66, v5
    v_sub_f32 v67, v67, v5
    v_sub_f32 v68, v68, v5
    v_sub_f32 v69, v69, v5
    v_sub_f32 v70, v70, v5
    v_sub_f32 v71, v71, v5
    v_sub_f32 v72, v72, v5
    v_sub_f32 v73, v73, v5
    v_sub_f32 v74, v74, v5
    v_sub_f32 v75, v75, v5
    v_sub_f32 v76, v76, v5
    v_sub_f32 v77, v77, v5
    v_sub_f32 v78, v78, v5
    v_sub_f32 v79, v79, v5
    v_sub_f32 v80, v80, v5
    v_sub_f32 v81, v81, v5
    v_sub_f32 v82, v82, v5
    v_sub_f32 v83, v83, v5
    v_sub_f32 v84, v84, v5
    v_sub_f32 v85, v85, v5
    v_sub_f32 v86, v86, v5
    v_sub_f32 v87, v87, v5
    v_sub_f32 v88, v88, v5
    v_sub_f32 v89, v89, v5
    v_sub_f32 v90, v90, v5
    v_sub_f32 v91, v91, v5
    v_sub_f32 v92, v92, v5
    v_sub_f32 v93, v93, v5
    v_sub_f32 v94, v94, v5
    v_sub_f32 v95, v95, v5
    v_sub_f32 v96, v96, v5
    v_sub_f32 v97, v97, v5
    v_sub_f32 v98, v98, v5
    v_sub_f32 v99, v99, v5
    v_sub_f32 v100, v100, v5
    v_sub_f32 v101, v101, v5
    v_sub_f32 v102, v102, v5
    v_sub_f32 v103, v103, v5
    v_sub_f32 v104, v104, v5
    v_sub_f32 v105, v105, v5
    v_sub_f32 v106, v106, v5
    v_sub_f32 v107, v107, v5
    v_sub_f32 v108, v108, v5
    v_sub_f32 v109, v109, v5
    v_sub_f32 v110, v110, v5
    v_sub_f32 v111, v111, v5
    v_sub_f32 v112, v112, v5
    v_sub_f32 v113, v113, v5
    v_sub_f32 v114, v114, v5
    v_sub_f32 v115, v115, v5
    v_sub_f32 v116, v116, v5
    v_sub_f32 v117, v117, v5
    v_sub_f32 v118, v118, v5
    v_sub_f32 v119, v119, v5
    v_sub_f32 v120, v120, v5
    v_sub_f32 v121, v121, v5
    v_sub_f32 v122, v122, v5
    v_sub_f32 v123, v123, v5
    v_sub_f32 v124, v124, v5
    v_sub_f32 v125, v125, v5
    v_sub_f32 v126, v126, v5
    v_sub_f32 v127, v127, v5
    v_cvt_pk_bf16_f32 v32, v64, v65
    v_cvt_pk_bf16_f32 v33, v66, v67
    v_cvt_pk_bf16_f32 v34, v68, v69
    v_cvt_pk_bf16_f32 v35, v70, v71
    v_cvt_pk_bf16_f32 v36, v72, v73
    v_cvt_pk_bf16_f32 v37, v74, v75
    v_cvt_pk_bf16_f32 v38, v76, v77
    v_cvt_pk_bf16_f32 v39, v78, v79
    v_cvt_pk_bf16_f32 v40, v80, v81
    v_cvt_pk_bf16_f32 v41, v82, v83
    v_cvt_pk_bf16_f32 v42, v84, v85
    v_cvt_pk_bf16_f32 v43, v86, v87
    v_cvt_pk_bf16_f32 v44, v88, v89
    v_cvt_pk_bf16_f32 v45, v90, v91
    v_cvt_pk_bf16_f32 v46, v92, v93
    v_cvt_pk_bf16_f32 v47, v94, v95
    v_cvt_pk_bf16_f32 v48, v96, v97
    v_cvt_pk_bf16_f32 v49, v98, v99
    v_cvt_pk_bf16_f32 v50, v100, v101
    v_cvt_pk_bf16_f32 v51, v102, v103
    v_cvt_pk_bf16_f32 v52, v104, v105
    v_cvt_pk_bf16_f32 v53, v106, v107
    v_cvt_pk_bf16_f32 v54, v108, v109
    v_cvt_pk_bf16_f32 v55, v110, v111
    v_cvt_pk_bf16_f32 v56, v112, v113
    v_cvt_pk_bf16_f32 v57, v114, v115
    v_cvt_pk_bf16_f32 v58, v116, v117
    v_cvt_pk_bf16_f32 v59, v118, v119
    v_cvt_pk_bf16_f32 v60, v120, v121
    v_cvt_pk_bf16_f32 v61, v122, v123
    v_cvt_pk_bf16_f32 v62, v124, v125
    v_cvt_pk_bf16_f32 v63, v126, v127
    v_lshlrev_b32 v64, 16, v32
    v_and_b32 v65, 0xffff0000, v32
    v_lshlrev_b32 v66, 16, v33
    v_and_b32 v67, 0xffff0000, v33
    v_lshlrev_b32 v68, 16, v34
    v_and_b32 v69, 0xffff0000, v34
    v_lshlrev_b32 v70, 16, v35
    v_and_b32 v71, 0xffff0000, v35
    v_lshlrev_b32 v72, 16, v36
    v_and_b32 v73, 0xffff0000, v36
    v_lshlrev_b32 v74, 16, v37
    v_and_b32 v75, 0xffff0000, v37
    v_lshlrev_b32 v76, 16, v38
    v_and_b32 v77, 0xffff0000, v38
    v_lshlrev_b32 v78, 16, v39
    v_and_b32 v79, 0xffff0000, v39
    v_lshlrev_b32 v80, 16, v40
    v_and_b32 v81, 0xffff0000, v40
    v_lshlrev_b32 v82, 16, v41
    v_and_b32 v83, 0xffff0000, v41
    v_lshlrev_b32 v84, 16, v42
    v_and_b32 v85, 0xffff0000, v42
    v_lshlrev_b32 v86, 16, v43
    v_and_b32 v87, 0xffff0000, v43
    v_lshlrev_b32 v88, 16, v44
    v_and_b32 v89, 0xffff0000, v44
    v_lshlrev_b32 v90, 16, v45
    v_and_b32 v91, 0xffff0000, v45
    v_lshlrev_b32 v92, 16, v46
    v_and_b32 v93, 0xffff0000, v46
    v_lshlrev_b32 v94, 16, v47
    v_and_b32 v95, 0xffff0000, v47
    v_lshlrev_b32 v96, 16, v48
    v_and_b32 v97, 0xffff0000, v48
    v_lshlrev_b32 v98, 16, v49
    v_and_b32 v99, 0xffff0000, v49
    v_lshlrev_b32 v100, 16, v50
    v_and_b32 v101, 0xffff0000, v50
    v_lshlrev_b32 v102, 16, v51
    v_and_b32 v103, 0xffff0000, v51
    v_lshlrev_b32 v104, 16, v52
    v_and_b32 v105, 0xffff0000, v52
    v_lshlrev_b32 v106, 16, v53
    v_and_b32 v107, 0xffff0000, v53
    v_lshlrev_b32 v108, 16, v54
    v_and_b32 v109, 0xffff0000, v54
    v_lshlrev_b32 v110, 16, v55
    v_and_b32 v111, 0xffff0000, v55
    v_lshlrev_b32 v112, 16, v56
    v_and_b32 v113, 0xffff0000, v56
    v_lshlrev_b32 v114, 16, v57
    v_and_b32 v115, 0xffff0000, v57
    v_lshlrev_b32 v116, 16, v58
    v_and_b32 v117, 0xffff0000, v58
    v_lshlrev_b32 v118, 16, v59
    v_and_b32 v119, 0xffff0000, v59
    v_lshlrev_b32 v120, 16, v60
    v_and_b32 v121, 0xffff0000, v60
    v_lshlrev_b32 v122, 16, v61
    v_and_b32 v123, 0xffff0000, v61
    v_lshlrev_b32 v124, 16, v62
    v_and_b32 v125, 0xffff0000, v62
    v_lshlrev_b32 v126, 16, v63
    v_and_b32 v127, 0xffff0000, v63
    v_mul_f32 v64, v64, v2
    v_mul_f32 v65, v65, v2
    v_mul_f32 v66, v66, v2
    v_mul_f32 v67, v67, v2
    v_mul_f32 v68, v68, v2
    v_mul_f32 v69, v69, v2
    v_mul_f32 v70, v70, v2
    v_mul_f32 v71, v71, v2
    v_mul_f32 v72, v72, v2
    v_mul_f32 v73, v73, v2
    v_mul_f32 v74, v74, v2
    v_mul_f32 v75, v75, v2
    v_mul_f32 v76, v76, v2
    v_mul_f32 v77, v77, v2
    v_mul_f32 v78, v78, v2
    v_mul_f32 v79, v79, v2
    v_mul_f32 v80, v80, v2
    v_mul_f32 v81, v81, v2
    v_mul_f32 v82, v82, v2
    v_mul_f32 v83, v83, v2
    v_mul_f32 v84, v84, v2
    v_mul_f32 v85, v85, v2
    v_mul_f32 v86, v86, v2
    v_mul_f32 v87, v87, v2
    v_mul_f32 v88, v88, v2
    v_mul_f32 v89, v89, v2
    v_mul_f32 v90, v90, v2
    v_mul_f32 v91, v91, v2
    v_mul_f32 v92, v92, v2
    v_mul_f32 v93, v93, v2
    v_mul_f32 v94, v94, v2
    v_mul_f32 v95, v95, v2
    v_mul_f32 v96, v96, v2
    v_mul_f32 v97, v97, v2
    v_mul_f32 v98, v98, v2
    v_mul_f32 v99, v99, v2
    v_mul_f32 v100, v100, v2
    v_mul_f32 v101, v101, v2
    v_mul_f32 v102, v102, v2
    v_mul_f32 v103, v103, v2
    v_mul_f32 v104, v104, v2
    v_mul_f32 v105, v105, v2
    v_mul_f32 v106, v106, v2
    v_mul_f32 v107, v107, v2
    v_mul_f32 v108, v108, v2
    v_mul_f32 v109, v109, v2
    v_mul_f32 v110, v110, v2
    v_mul_f32 v111, v111, v2
    v_mul_f32 v112, v112, v2
    v_mul_f32 v113, v113, v2
    v_mul_f32 v114, v114, v2
    v_mul_f32 v115, v115, v2
    v_mul_f32 v116, v116, v2
    v_mul_f32 v117, v117, v2
    v_mul_f32 v118, v118, v2
    v_mul_f32 v119, v119, v2
    v_mul_f32 v120, v120, v2
    v_mul_f32 v121, v121, v2
    v_mul_f32 v122, v122, v2
    v_mul_f32 v123, v123, v2
    v_mul_f32 v124, v124, v2
    v_mul_f32 v125, v125, v2
    v_mul_f32 v126, v126, v2
    v_mul_f32 v127, v127, v2
    v_cvt_pk_bf16_f32 v32, v64, v65
    v_cvt_pk_bf16_f32 v33, v66, v67
    v_cvt_pk_bf16_f32 v34, v68, v69
    v_cvt_pk_bf16_f32 v35, v70, v71
    v_cvt_pk_bf16_f32 v36, v72, v73
    v_cvt_pk_bf16_f32 v37, v74, v75
    v_cvt_pk_bf16_f32 v38, v76, v77
    v_cvt_pk_bf16_f32 v39, v78, v79
    v_cvt_pk_bf16_f32 v40, v80, v81
    v_cvt_pk_bf16_f32 v41, v82, v83
    v_cvt_pk_bf16_f32 v42, v84, v85
    v_cvt_pk_bf16_f32 v43, v86, v87
    v_cvt_pk_bf16_f32 v44, v88, v89
    v_cvt_pk_bf16_f32 v45, v90, v91
    v_cvt_pk_bf16_f32 v46, v92, v93
    v_cvt_pk_bf16_f32 v47, v94, v95
    v_cvt_pk_bf16_f32 v48, v96, v97
    v_cvt_pk_bf16_f32 v49, v98, v99
    v_cvt_pk_bf16_f32 v50, v100, v101
    v_cvt_pk_bf16_f32 v51, v102, v103
    v_cvt_pk_bf16_f32 v52, v104, v105
    v_cvt_pk_bf16_f32 v53, v106, v107
    v_cvt_pk_bf16_f32 v54, v108, v109
    v_cvt_pk_bf16_f32 v55, v110, v111
    v_cvt_pk_bf16_f32 v56, v112, v113
    v_cvt_pk_bf16_f32 v57, v114, v115
    v_cvt_pk_bf16_f32 v58, v116, v117
    v_cvt_pk_bf16_f32 v59, v118, v119
    v_cvt_pk_bf16_f32 v60, v120, v121
    v_cvt_pk_bf16_f32 v61, v122, v123
    v_cvt_pk_bf16_f32 v62, v124, v125
    v_cvt_pk_bf16_f32 v63, v126, v127
    s_lshr_b32 s4, s62, 4
    s_lshl_b32 s4, s4, 19
    s_and_b32 s5, s62, 15
    s_lshl_b32 s5, s5, 8
    s_add_u32 s4, s4, s5
    s_lshl_b32 s5, s3, 17
    s_add_u32 s4, s4, s5
    s_add_u32 s4, s4, 0
    buffer_store_dwordx4 v[32:35], v228, s[8:11], s4 offen sc1
    s_add_u32 s4, s4, 16384
    buffer_store_dwordx4 v[36:39], v228, s[8:11], s4 offen sc1
    s_add_u32 s4, s4, 16384
    buffer_store_dwordx4 v[40:43], v228, s[8:11], s4 offen sc1
    s_add_u32 s4, s4, 16384
    buffer_store_dwordx4 v[44:47], v228, s[8:11], s4 offen sc1
    s_add_u32 s4, s4, 16384
    buffer_store_dwordx4 v[48:51], v228, s[8:11], s4 offen sc1
    s_add_u32 s4, s4, 16384
    buffer_store_dwordx4 v[52:55], v228, s[8:11], s4 offen sc1
    s_add_u32 s4, s4, 16384
    buffer_store_dwordx4 v[56:59], v228, s[8:11], s4 offen sc1
    s_add_u32 s4, s4, 16384
    buffer_store_dwordx4 v[60:63], v228, s[8:11], s4 offen sc1
    v_lshlrev_b32 v227, 4, v0
    s_add_u32 s4, s3, 0
    s_and_b32 s4, s4, 3
    s_lshl_b32 s4, s4, 9
    v_add_u32 v208, s4, v228
    s_add_u32 s4, s3, 1
    s_and_b32 s4, s4, 3
    s_lshl_b32 s4, s4, 9
    v_add_u32 v209, s4, v228
    s_add_u32 s4, s3, 2
    s_and_b32 s4, s4, 3
    s_lshl_b32 s4, s4, 9
    v_add_u32 v210, s4, v228
    s_add_u32 s4, s3, 3
    s_and_b32 s4, s4, 3
    s_lshl_b32 s4, s4, 9
    v_add_u32 v211, s4, v228
    v_lshrrev_b32 v1, 3, v0
    v_lshlrev_b32 v1, 13, v1
    v_bfe_u32 v2, v0, 1, 2
    v_lshrrev_b32 v3, 4, v0
    v_xor_b32 v2, v2, v3
    v_lshlrev_b32 v2, 5, v2
    v_add_u32 v1, v1, v2
    v_and_b32 v2, 1, v0
    v_lshlrev_b32 v2, 4, v2
    v_add_u32 v212, v1, v2
    v_add_u32 v213, 64512, v212
    v_add_u32 v214, 129024, v212
    v_add_u32 v215, 193536, v212
    v_lshrrev_b32 v1, 4, v0
    v_lshlrev_b32 v1, 2, v1
    v_bfe_u32 v2, v0, 2, 2
    v_add_u32 v1, v1, v2
    v_bfe_u32 v2, v1, 1, 2
    v_lshlrev_b32 v1, 7, v1
    v_and_b32 v3, 3, v0
    v_lshlrev_b32 v3, 3, v3
    v_add_u32 v1, v1, v3
    s_lshl_b32 s4, s3, 15
    v_add_u32 v1, s4, v1
    v_xor_b32 v3, 0, v2
    v_lshlrev_b32 v3, 5, v3
    v_add_u32 v216, v1, v3
    v_xor_b32 v3, 1, v2
    v_lshlrev_b32 v3, 5, v3
    v_add_u32 v217, v1, v3
    v_xor_b32 v3, 2, v2
    v_lshlrev_b32 v3, 5, v3
    v_add_u32 v218, v1, v3
    v_xor_b32 v3, 3, v2
    v_lshlrev_b32 v3, 5, v3
    v_add_u32 v219, v1, v3
    s_lshl_b32 s4, s3, 15
    v_add_u32 v220, s4, v227
    v_add_u32 v221, 8192, v220
    v_add_u32 v222, 16384, v220
    s_sub_u32 s4, s3, 1
    s_and_b32 s4, s4, 3
    s_lshl_b32 s4, s4, 15
    s_add_u32 s4, s4, 0
    v_add_u32 v223, s4, v227
    s_sub_u32 s4, s3, 2
    s_and_b32 s4, s4, 3
    s_lshl_b32 s4, s4, 15
    s_add_u32 s4, s4, 8192
    v_add_u32 v224, s4, v227
    s_sub_u32 s4, s3, 3
    s_and_b32 s4, s4, 3
    s_lshl_b32 s4, s4, 15
    s_add_u32 s4, s4, 16384
    v_add_u32 v225, s4, v227
    s_add_u32 s4, s25, 520
    s_mov_b32 s80, s4
    s_add_u32 s4, s25, 264
    s_cmp_ge_u32 s25, 8
    s_cselect_b32 s80, s4, s80
    s_add_u32 s4, s25, 248
    s_cmp_ge_u32 s25, 16
    s_cselect_b32 s80, s4, s80
    s_add_u32 s4, s25, 488
    s_cmp_ge_u32 s25, 24
    s_cselect_b32 s80, s4, s80
    s_add_u32 s4, s25, 544
    s_mov_b32 s81, s4
    s_add_u32 s4, s25, 544
    s_cmp_ge_u32 s25, 8
    s_cselect_b32 s81, s4, s81
    s_add_u32 s4, s25, 512
    s_cmp_ge_u32 s25, 16
    s_cselect_b32 s81, s4, s81
    s_add_u32 s4, s25, 512
    s_cmp_ge_u32 s25, 24
    s_cselect_b32 s81, s4, s81
    s_add_u32 s4, s25, 768
    s_mov_b32 s82, s4
    s_add_u32 s4, s25, 280
    s_cmp_ge_u32 s25, 8
    s_cselect_b32 s82, s4, s82
    s_add_u32 s4, s25, 264
    s_cmp_ge_u32 s25, 16
    s_cselect_b32 s82, s4, s82
    s_add_u32 s4, s25, 1000
    s_cmp_ge_u32 s25, 24
    s_cselect_b32 s82, s4, s82
    s_add_u32 s4, s25, 766
    s_cmp_ge_u32 s25, 28
    s_cselect_b32 s82, s4, s82
    s_add_u32 s4, s25, 768
    s_cmp_ge_u32 s25, 30
    s_cselect_b32 s82, s4, s82
    s_add_u32 s4, s25, 776
    s_mov_b32 s83, s4
    s_add_u32 s4, s25, 776
    s_cmp_ge_u32 s25, 8
    s_cselect_b32 s83, s4, s83
    s_add_u32 s4, s25, 544
    s_cmp_ge_u32 s25, 16
    s_cselect_b32 s83, s4, s83
    s_add_u32 s4, s25, 772
    s_cmp_ge_u32 s25, 24
    s_cselect_b32 s83, s4, s83
    s_mov_b32 s4, 0
    s_cmp_ge_u32 s25, 26
    s_cselect_b32 s83, s4, s83
    s_add_u32 s4, s25, 1000
    s_cmp_ge_u32 s25, 28
    s_cselect_b32 s83, s4, s83
    s_add_u32 s4, s25, 762
    s_cmp_ge_u32 s25, 30
    s_cselect_b32 s83, s4, s83
    s_mov_b32 s4, 0
    s_mov_b32 s84, s4
    s_add_u32 s4, s25, 296
    s_cmp_ge_u32 s25, 8
    s_cselect_b32 s84, s4, s84
    s_add_u32 s4, s25, 280
    s_cmp_ge_u32 s25, 16
    s_cselect_b32 s84, s4, s84
    s_mov_b32 s4, 0
    s_cmp_ge_u32 s25, 24
    s_cselect_b32 s84, s4, s84
    s_add_u32 s4, s25, 1000
    s_cmp_ge_u32 s25, 30
    s_cselect_b32 s84, s4, s84
    s_mov_b32 s4, 0
    s_mov_b32 s85, s4
    s_add_u32 s4, s25, 296
    s_cmp_ge_u32 s25, 16
    s_cselect_b32 s85, s4, s85
    s_mov_b32 s4, 0
    s_cmp_ge_u32 s25, 24
    s_cselect_b32 s85, s4, s85
    s_mov_b32 s4, 0
    s_mov_b32 s86, s4
    s_mov_b32 s4, 0
    s_mov_b32 s87, s4
    s_waitcnt vmcnt(0) lgkmcnt(0)
    s_barrier
    buffer_atomic_add v24, v23, s[64:67], 0 offen offset:32 sc1
    s_cmp_ge_u32 s62, 16
    s_cbranch_scc1 Lln0_153
    buffer_atomic_add v24, v23, s[64:67], 0 offen offset:176 sc1
    s_cmp_ge_u32 s62, 8
    s_cbranch_scc1 Lln0_153
    buffer_atomic_add v24, v23, s[64:67], 0 offen offset:192 sc1
Lln0_153:
    s_add_u32 m0, s41, 16384
    s_nop 0
    buffer_load_dwordx4 v212, s[12:15], s17 offen lds
    buffer_load_dwordx4 v213, s[12:15], s17 offen offset:1024 lds
    buffer_load_dwordx4 v214, s[12:15], s17 offen offset:2048 lds
    buffer_load_dwordx4 v215, s[12:15], s17 offen offset:3072 lds
    s_add_u32 s17, s17, 262144
    s_add_u32 m0, s41, 20480
    s_nop 0
    buffer_load_dwordx4 v212, s[12:15], s17 offen lds
    buffer_load_dwordx4 v213, s[12:15], s17 offen offset:1024 lds
    buffer_load_dwordx4 v214, s[12:15], s17 offen offset:2048 lds
    buffer_load_dwordx4 v215, s[12:15], s17 offen offset:3072 lds
    s_add_u32 s17, s17, 262144
    s_add_u32 m0, s41, 24576
    s_nop 0
    buffer_load_dwordx4 v212, s[12:15], s17 offen lds
    buffer_load_dwordx4 v213, s[12:15], s17 offen offset:1024 lds
    buffer_load_dwordx4 v214, s[12:15], s17 offen offset:2048 lds
    buffer_load_dwordx4 v215, s[12:15], s17 offen offset:3072 lds
    s_add_u32 s17, s17, 262144
    s_add_u32 m0, s41, 28672
    s_nop 0
    buffer_load_dwordx4 v212, s[12:15], s17 offen lds
    buffer_load_dwordx4 v213, s[12:15], s17 offen offset:1024 lds
    buffer_load_dwordx4 v214, s[12:15], s17 offen offset:2048 lds
    buffer_load_dwordx4 v215, s[12:15], s17 offen offset:3072 lds
    s_add_u32 s17, s17, 262144
    s_cmp_lg_u32 s3, 0
    s_cbranch_scc1 Lwwo_159
    v_mov_b32 v1, 192
Lww_158:
    buffer_load_dword v2, v1, s[64:67], 0 offen sc1
    s_waitcnt vmcnt(0)
    v_cmp_le_u32 vcc, 8, v2
    s_cbranch_vccnz Lwwo_159
    s_sleep 2
    s_sub_u32 s22, s22, 1
    s_cbranch_scc0 Lww_158
    s_branch L_abort
Lwwo_159:
    s_barrier
    s_mov_b32 s62, 102772992
L_kv0:
    s_cmp_eq_u32 s60, 2
    s_cbranch_scc1 L_kv0c
    s_cmp_ge_u32 s23, 2
    s_cbranch_scc1 L_kv0V
    buffer_load_dwordx4 v[32:35], v208, s[8:11], s16 offen offset:0 sc1
    buffer_load_dwordx4 v[36:39], v208, s[8:11], s16 offen offset:256 sc1
    buffer_load_dwordx4 v[40:43], v209, s[8:11], s16 offen offset:0 sc1
    buffer_load_dwordx4 v[44:47], v209, s[8:11], s16 offen offset:256 sc1
    buffer_load_dwordx4 v[48:51], v210, s[8:11], s16 offen offset:0 sc1
    buffer_load_dwordx4 v[52:55], v210, s[8:11], s16 offen offset:256 sc1
    buffer_load_dwordx4 v[56:59], v211, s[8:11], s16 offen offset:0 sc1
    buffer_load_dwordx4 v[60:63], v211, s[8:11], s16 offen offset:256 sc1
    s_add_u32 s16, s16, 16384
    buffer_load_dwordx4 v[64:67], v208, s[8:11], s16 offen offset:0 sc1
    buffer_load_dwordx4 v[68:71], v208, s[8:11], s16 offen offset:256 sc1
    buffer_load_dwordx4 v[72:75], v209, s[8:11], s16 offen offset:0 sc1
    buffer_load_dwordx4 v[76:79], v209, s[8:11], s16 offen offset:256 sc1
    buffer_load_dwordx4 v[80:83], v210, s[8:11], s16 offen offset:0 sc1
    buffer_load_dwordx4 v[84:87], v210, s[8:11], s16 offen offset:256 sc1
    buffer_load_dwordx4 v[88:91], v211, s[8:11], s16 offen offset:0 sc1
    buffer_load_dwordx4 v[92:95], v211, s[8:11], s16 offen offset:256 sc1
    s_add_u32 s16, s16, 16384
    buffer_load_dwordx4 v[96:99], v208, s[8:11], s16 offen offset:0 sc1
    buffer_load_dwordx4 v[100:103], v208, s[8:11], s16 offen offset:256 sc1
    buffer_load_dwordx4 v[104:107], v209, s[8:11], s16 offen offset:0 sc1
    buffer_load_dwordx4 v[108:111], v209, s[8:11], s16 offen offset:256 sc1
    buffer_load_dwordx4 v[112:115], v210, s[8:11], s16 offen offset:0 sc1
    buffer_load_dwordx4 v[116:119], v210, s[8:11], s16 offen offset:256 sc1
    buffer_load_dwordx4 v[120:123], v211, s[8:11], s16 offen offset:0 sc1
    buffer_load_dwordx4 v[124:127], v211, s[8:11], s16 offen offset:256 sc1
    s_add_u32 s16, s16, 16384
    s_waitcnt vmcnt(16)
    ds_read_b64_tr_b16 v[160:161], v216 offset:0
    ds_read_b64_tr_b16 v[162:163], v216 offset:2048
    ds_read_b64_tr_b16 v[164:165], v217 offset:0
    ds_read_b64_tr_b16 v[166:167], v217 offset:2048
    ds_read_b64_tr_b16 v[168:169], v218 offset:0
    ds_read_b64_tr_b16 v[170:171], v218 offset:2048
    ds_read_b64_tr_b16 v[172:173], v219 offset:0
    ds_read_b64_tr_b16 v[174:175], v219 offset:2048
    s_waitcnt vmcnt(16) lgkmcnt(0)
    v_mfma_f32_16x16x32_bf16 a[0:3], v[160:163], v[32:35], 0
    v_mfma_f32_16x16x32_bf16 a[4:7], v[164:167], v[32:35], 0
    v_mfma_f32_16x16x32_bf16 a[8:11], v[168:171], v[32:35], 0
    v_mfma_f32_16x16x32_bf16 a[12:15], v[172:175], v[32:35], 0
    buffer_load_dwordx4 v[128:131], v208, s[8:11], s16 offen offset:0 sc1
    v_mfma_f32_16x16x32_bf16 a[16:19], v[160:163], v[36:39], 0
    ds_read_b64_tr_b16 v[176:177], v216 offset:4096
    v_mfma_f32_16x16x32_bf16 a[20:23], v[164:167], v[36:39], 0
    ds_read_b64_tr_b16 v[178:179], v216 offset:6144
    v_mfma_f32_16x16x32_bf16 a[24:27], v[168:171], v[36:39], 0
    ds_read_b64_tr_b16 v[180:181], v217 offset:4096
    v_mfma_f32_16x16x32_bf16 a[28:31], v[172:175], v[36:39], 0
    buffer_load_dwordx4 v[132:135], v208, s[8:11], s16 offen offset:256 sc1
    v_mfma_f32_16x16x32_bf16 a[32:35], v[160:163], v[40:43], 0
    ds_read_b64_tr_b16 v[182:183], v217 offset:6144
    v_mfma_f32_16x16x32_bf16 a[36:39], v[164:167], v[40:43], 0
    ds_read_b64_tr_b16 v[184:185], v218 offset:4096
    v_mfma_f32_16x16x32_bf16 a[40:43], v[168:171], v[40:43], 0
    ds_read_b64_tr_b16 v[186:187], v218 offset:6144
    v_mfma_f32_16x16x32_bf16 a[44:47], v[172:175], v[40:43], 0
    buffer_load_dwordx4 v[136:139], v209, s[8:11], s16 offen offset:0 sc1
    v_mfma_f32_16x16x32_bf16 a[48:51], v[160:163], v[44:47], 0
    ds_read_b64_tr_b16 v[188:189], v219 offset:4096
    v_mfma_f32_16x16x32_bf16 a[52:55], v[164:167], v[44:47], 0
    ds_read_b64_tr_b16 v[190:191], v219 offset:6144
    v_mfma_f32_16x16x32_bf16 a[56:59], v[168:171], v[44:47], 0
    v_mfma_f32_16x16x32_bf16 a[60:63], v[172:175], v[44:47], 0
    buffer_load_dwordx4 v[140:143], v209, s[8:11], s16 offen offset:256 sc1
    v_mfma_f32_16x16x32_bf16 a[64:67], v[160:163], v[48:51], 0
    v_mfma_f32_16x16x32_bf16 a[68:71], v[164:167], v[48:51], 0
    v_mfma_f32_16x16x32_bf16 a[72:75], v[168:171], v[48:51], 0
    v_mfma_f32_16x16x32_bf16 a[76:79], v[172:175], v[48:51], 0
    buffer_load_dwordx4 v[144:147], v210, s[8:11], s16 offen offset:0 sc1
    v_mfma_f32_16x16x32_bf16 a[80:83], v[160:163], v[52:55], 0
    v_mfma_f32_16x16x32_bf16 a[84:87], v[164:167], v[52:55], 0
    v_mfma_f32_16x16x32_bf16 a[88:91], v[168:171], v[52:55], 0
    v_mfma_f32_16x16x32_bf16 a[92:95], v[172:175], v[52:55], 0
    buffer_load_dwordx4 v[148:151], v210, s[8:11], s16 offen offset:256 sc1
    v_mfma_f32_16x16x32_bf16 a[96:99], v[160:163], v[56:59], 0
    v_mfma_f32_16x16x32_bf16 a[100:103], v[164:167], v[56:59], 0
    v_mfma_f32_16x16x32_bf16 a[104:107], v[168:171], v[56:59], 0
    v_mfma_f32_16x16x32_bf16 a[108:111], v[172:175], v[56:59], 0
    buffer_load_dwordx4 v[152:155], v211, s[8:11], s16 offen offset:0 sc1
    v_mfma_f32_16x16x32_bf16 a[112:115], v[160:163], v[60:63], 0
    v_mfma_f32_16x16x32_bf16 a[116:119], v[164:167], v[60:63], 0
    v_mfma_f32_16x16x32_bf16 a[120:123], v[168:171], v[60:63], 0
    v_mfma_f32_16x16x32_bf16 a[124:127], v[172:175], v[60:63], 0
    buffer_load_dwordx4 v[156:159], v211, s[8:11], s16 offen offset:256 sc1
    s_add_u32 s16, s16, 16384
    s_waitcnt vmcnt(16) lgkmcnt(0)
    v_mfma_f32_16x16x32_bf16 a[0:3], v[176:179], v[64:67], a[0:3]
    v_mfma_f32_16x16x32_bf16 a[4:7], v[180:183], v[64:67], a[4:7]
    v_mfma_f32_16x16x32_bf16 a[8:11], v[184:187], v[64:67], a[8:11]
    v_mfma_f32_16x16x32_bf16 a[12:15], v[188:191], v[64:67], a[12:15]
    buffer_load_dwordx4 a[128:131], v208, s[8:11], s16 offen offset:0 sc1
    v_mfma_f32_16x16x32_bf16 a[16:19], v[176:179], v[68:71], a[16:19]
    ds_read_b64_tr_b16 v[160:161], v216 offset:8192
    v_mfma_f32_16x16x32_bf16 a[20:23], v[180:183], v[68:71], a[20:23]
    ds_read_b64_tr_b16 v[162:163], v216 offset:10240
    v_mfma_f32_16x16x32_bf16 a[24:27], v[184:187], v[68:71], a[24:27]
    ds_read_b64_tr_b16 v[164:165], v217 offset:8192
    v_mfma_f32_16x16x32_bf16 a[28:31], v[188:191], v[68:71], a[28:31]
    buffer_load_dwordx4 a[132:135], v208, s[8:11], s16 offen offset:256 sc1
    v_mfma_f32_16x16x32_bf16 a[32:35], v[176:179], v[72:75], a[32:35]
    ds_read_b64_tr_b16 v[166:167], v217 offset:10240
    v_mfma_f32_16x16x32_bf16 a[36:39], v[180:183], v[72:75], a[36:39]
    ds_read_b64_tr_b16 v[168:169], v218 offset:8192
    v_mfma_f32_16x16x32_bf16 a[40:43], v[184:187], v[72:75], a[40:43]
    ds_read_b64_tr_b16 v[170:171], v218 offset:10240
    v_mfma_f32_16x16x32_bf16 a[44:47], v[188:191], v[72:75], a[44:47]
    buffer_load_dwordx4 a[136:139], v209, s[8:11], s16 offen offset:0 sc1
    v_mfma_f32_16x16x32_bf16 a[48:51], v[176:179], v[76:79], a[48:51]
    ds_read_b64_tr_b16 v[172:173], v219 offset:8192
    v_mfma_f32_16x16x32_bf16 a[52:55], v[180:183], v[76:79], a[52:55]
    ds_read_b64_tr_b16 v[174:175], v219 offset:10240
    v_mfma_f32_16x16x32_bf16 a[56:59], v[184:187], v[76:79], a[56:59]
    v_mfma_f32_16x16x32_bf16 a[60:63], v[188:191], v[76:79], a[60:63]
    buffer_load_dwordx4 a[140:143], v209, s[8:11], s16 offen offset:256 sc1
    v_mfma_f32_16x16x32_bf16 a[64:67], v[176:179], v[80:83], a[64:67]
    v_mfma_f32_16x16x32_bf16 a[68:71], v[180:183], v[80:83], a[68:71]
    v_mfma_f32_16x16x32_bf16 a[72:75], v[184:187], v[80:83], a[72:75]
    v_mfma_f32_16x16x32_bf16 a[76:79], v[188:191], v[80:83], a[76:79]
    buffer_load_dwordx4 a[144:147], v210, s[8:11], s16 offen offset:0 sc1
    v_mfma_f32_16x16x32_bf16 a[80:83], v[176:179], v[84:87], a[80:83]
    v_mfma_f32_16x16x32_bf16 a[84:87], v[180:183], v[84:87], a[84:87]
    v_mfma_f32_16x16x32_bf16 a[88:91], v[184:187], v[84:87], a[88:91]
    v_mfma_f32_16x16x32_bf16 a[92:95], v[188:191], v[84:87], a[92:95]
    buffer_load_dwordx4 a[148:151], v210, s[8:11], s16 offen offset:256 sc1
    v_mfma_f32_16x16x32_bf16 a[96:99], v[176:179], v[88:91], a[96:99]
    v_mfma_f32_16x16x32_bf16 a[100:103], v[180:183], v[88:91], a[100:103]
    v_mfma_f32_16x16x32_bf16 a[104:107], v[184:187], v[88:91], a[104:107]
    v_mfma_f32_16x16x32_bf16 a[108:111], v[188:191], v[88:91], a[108:111]
    buffer_load_dwordx4 a[152:155], v211, s[8:11], s16 offen offset:0 sc1
    v_mfma_f32_16x16x32_bf16 a[112:115], v[176:179], v[92:95], a[112:115]
    v_mfma_f32_16x16x32_bf16 a[116:119], v[180:183], v[92:95], a[116:119]
    v_mfma_f32_16x16x32_bf16 a[120:123], v[184:187], v[92:95], a[120:123]
    v_mfma_f32_16x16x32_bf16 a[124:127], v[188:191], v[92:95], a[124:127]
    buffer_load_dwordx4 a[156:159], v211, s[8:11], s16 offen offset:256 sc1
    s_add_u32 s16, s16, 16384
    s_waitcnt vmcnt(16) lgkmcnt(0)
    v_mfma_f32_16x16x32_bf16 a[0:3], v[160:163], v[96:99], a[0:3]
    v_mfma_f32_16x16x32_bf16 a[4:7], v[164:167], v[96:99], a[4:7]
    v_mfma_f32_16x16x32_bf16 a[8:11], v[168:171], v[96:99], a[8:11]
    v_mfma_f32_16x16x32_bf16 a[12:15], v[172:175], v[96:99], a[12:15]
    buffer_load_dwordx4 a[160:163], v208, s[8:11], s16 offen offset:0 sc1
    v_mfma_f32_16x16x32_bf16 a[16:19], v[160:163], v[100:103], a[16:19]
    ds_read_b64_tr_b16 v[176:177], v216 offset:12288
    v_mfma_f32_16x16x32_bf16 a[20:23], v[164:167], v[100:103], a[20:23]
    ds_read_b64_tr_b16 v[178:179], v216 offset:14336
    v_mfma_f32_16x16x32_bf16 a[24:27], v[168:171], v[100:103], a[24:27]
    ds_read_b64_tr_b16 v[180:181], v217 offset:12288
    v_mfma_f32_16x16x32_bf16 a[28:31], v[172:175], v[100:103], a[28:31]
    buffer_load_dwordx4 a[164:167], v208, s[8:11], s16 offen offset:256 sc1
    v_mfma_f32_16x16x32_bf16 a[32:35], v[160:163], v[104:107], a[32:35]
    ds_read_b64_tr_b16 v[182:183], v217 offset:14336
    v_mfma_f32_16x16x32_bf16 a[36:39], v[164:167], v[104:107], a[36:39]
    ds_read_b64_tr_b16 v[184:185], v218 offset:12288
    v_mfma_f32_16x16x32_bf16 a[40:43], v[168:171], v[104:107], a[40:43]
    ds_read_b64_tr_b16 v[186:187], v218 offset:14336
    v_mfma_f32_16x16x32_bf16 a[44:47], v[172:175], v[104:107], a[44:47]
    buffer_load_dwordx4 a[168:171], v209, s[8:11], s16 offen offset:0 sc1
    v_mfma_f32_16x16x32_bf16 a[48:51], v[160:163], v[108:111], a[48:51]
    ds_read_b64_tr_b16 v[188:189], v219 offset:12288
    v_mfma_f32_16x16x32_bf16 a[52:55], v[164:167], v[108:111], a[52:55]
    ds_read_b64_tr_b16 v[190:191], v219 offset:14336
    v_mfma_f32_16x16x32_bf16 a[56:59], v[168:171], v[108:111], a[56:59]
    v_mfma_f32_16x16x32_bf16 a[60:63], v[172:175], v[108:111], a[60:63]
    buffer_load_dwordx4 a[172:175], v209, s[8:11], s16 offen offset:256 sc1
    v_mfma_f32_16x16x32_bf16 a[64:67], v[160:163], v[112:115], a[64:67]
    v_mfma_f32_16x16x32_bf16 a[68:71], v[164:167], v[112:115], a[68:71]
    v_mfma_f32_16x16x32_bf16 a[72:75], v[168:171], v[112:115], a[72:75]
    v_mfma_f32_16x16x32_bf16 a[76:79], v[172:175], v[112:115], a[76:79]
    buffer_load_dwordx4 a[176:179], v210, s[8:11], s16 offen offset:0 sc1
    v_mfma_f32_16x16x32_bf16 a[80:83], v[160:163], v[116:119], a[80:83]
    v_mfma_f32_16x16x32_bf16 a[84:87], v[164:167], v[116:119], a[84:87]
    v_mfma_f32_16x16x32_bf16 a[88:91], v[168:171], v[116:119], a[88:91]
    v_mfma_f32_16x16x32_bf16 a[92:95], v[172:175], v[116:119], a[92:95]
    buffer_load_dwordx4 a[180:183], v210, s[8:11], s16 offen offset:256 sc1
    v_mfma_f32_16x16x32_bf16 a[96:99], v[160:163], v[120:123], a[96:99]
    v_mfma_f32_16x16x32_bf16 a[100:103], v[164:167], v[120:123], a[100:103]
    v_mfma_f32_16x16x32_bf16 a[104:107], v[168:171], v[120:123], a[104:107]
    v_mfma_f32_16x16x32_bf16 a[108:111], v[172:175], v[120:123], a[108:111]
    buffer_load_dwordx4 a[184:187], v211, s[8:11], s16 offen offset:0 sc1
    v_mfma_f32_16x16x32_bf16 a[112:115], v[160:163], v[124:127], a[112:115]
    v_mfma_f32_16x16x32_bf16 a[116:119], v[164:167], v[124:127], a[116:119]
    v_mfma_f32_16x16x32_bf16 a[120:123], v[168:171], v[124:127], a[120:123]
    v_mfma_f32_16x16x32_bf16 a[124:127], v[172:175], v[124:127], a[124:127]
    buffer_load_dwordx4 a[188:191], v211, s[8:11], s16 offen offset:256 sc1
    s_add_u32 s16, s16, 16384
    s_waitcnt vmcnt(16) lgkmcnt(0)
    v_mfma_f32_16x16x32_bf16 a[0:3], v[176:179], v[128:131], a[0:3]
    v_mfma_f32_16x16x32_bf16 a[4:7], v[180:183], v[128:131], a[4:7]
    v_mfma_f32_16x16x32_bf16 a[8:11], v[184:187], v[128:131], a[8:11]
    v_mfma_f32_16x16x32_bf16 a[12:15], v[188:191], v[128:131], a[12:15]
    buffer_load_dwordx4 a[192:195], v208, s[8:11], s16 offen offset:0 sc1
    v_mfma_f32_16x16x32_bf16 a[16:19], v[176:179], v[132:135], a[16:19]
    ds_read_b64_tr_b16 v[160:161], v216 offset:16384
    v_mfma_f32_16x16x32_bf16 a[20:23], v[180:183], v[132:135], a[20:23]
    ds_read_b64_tr_b16 v[162:163], v216 offset:18432
    v_mfma_f32_16x16x32_bf16 a[24:27], v[184:187], v[132:135], a[24:27]
    ds_read_b64_tr_b16 v[164:165], v217 offset:16384
    v_mfma_f32_16x16x32_bf16 a[28:31], v[188:191], v[132:135], a[28:31]
    buffer_load_dwordx4 a[196:199], v208, s[8:11], s16 offen offset:256 sc1
    v_mfma_f32_16x16x32_bf16 a[32:35], v[176:179], v[136:139], a[32:35]
    ds_read_b64_tr_b16 v[166:167], v217 offset:18432
    v_mfma_f32_16x16x32_bf16 a[36:39], v[180:183], v[136:139], a[36:39]
    ds_read_b64_tr_b16 v[168:169], v218 offset:16384
    v_mfma_f32_16x16x32_bf16 a[40:43], v[184:187], v[136:139], a[40:43]
    ds_read_b64_tr_b16 v[170:171], v218 offset:18432
    v_mfma_f32_16x16x32_bf16 a[44:47], v[188:191], v[136:139], a[44:47]
    buffer_load_dwordx4 a[200:203], v209, s[8:11], s16 offen offset:0 sc1
    v_mfma_f32_16x16x32_bf16 a[48:51], v[176:179], v[140:143], a[48:51]
    ds_read_b64_tr_b16 v[172:173], v219 offset:16384
    v_mfma_f32_16x16x32_bf16 a[52:55], v[180:183], v[140:143], a[52:55]
    ds_read_b64_tr_b16 v[174:175], v219 offset:18432
    v_mfma_f32_16x16x32_bf16 a[56:59], v[184:187], v[140:143], a[56:59]
    v_mfma_f32_16x16x32_bf16 a[60:63], v[188:191], v[140:143], a[60:63]
    buffer_load_dwordx4 a[204:207], v209, s[8:11], s16 offen offset:256 sc1
    v_mfma_f32_16x16x32_bf16 a[64:67], v[176:179], v[144:147], a[64:67]
    v_mfma_f32_16x16x32_bf16 a[68:71], v[180:183], v[144:147], a[68:71]
    v_mfma_f32_16x16x32_bf16 a[72:75], v[184:187], v[144:147], a[72:75]
    v_mfma_f32_16x16x32_bf16 a[76:79], v[188:191], v[144:147], a[76:79]
    buffer_load_dwordx4 a[208:211], v210, s[8:11], s16 offen offset:0 sc1
    v_mfma_f32_16x16x32_bf16 a[80:83], v[176:179], v[148:151], a[80:83]
    v_mfma_f32_16x16x32_bf16 a[84:87], v[180:183], v[148:151], a[84:87]
    v_mfma_f32_16x16x32_bf16 a[88:91], v[184:187], v[148:151], a[88:91]
    v_mfma_f32_16x16x32_bf16 a[92:95], v[188:191], v[148:151], a[92:95]
    buffer_load_dwordx4 a[212:215], v210, s[8:11], s16 offen offset:256 sc1
    v_mfma_f32_16x16x32_bf16 a[96:99], v[176:179], v[152:155], a[96:99]
    v_mfma_f32_16x16x32_bf16 a[100:103], v[180:183], v[152:155], a[100:103]
    v_mfma_f32_16x16x32_bf16 a[104:107], v[184:187], v[152:155], a[104:107]
    v_mfma_f32_16x16x32_bf16 a[108:111], v[188:191], v[152:155], a[108:111]
    buffer_load_dwordx4 a[216:219], v211, s[8:11], s16 offen offset:0 sc1
    v_mfma_f32_16x16x32_bf16 a[112:115], v[176:179], v[156:159], a[112:115]
    v_mfma_f32_16x16x32_bf16 a[116:119], v[180:183], v[156:159], a[116:119]
    v_mfma_f32_16x16x32_bf16 a[120:123], v[184:187], v[156:159], a[120:123]
    v_mfma_f32_16x16x32_bf16 a[124:127], v[188:191], v[156:159], a[124:127]
    buffer_load_dwordx4 a[220:223], v211, s[8:11], s16 offen offset:256 sc1
    s_add_u32 s16, s16, 16384
    s_waitcnt vmcnt(16) lgkmcnt(0)
    v_mfma_f32_16x16x32_bf16 a[0:3], v[160:163], a[128:131], a[0:3]
    v_mfma_f32_16x16x32_bf16 a[4:7], v[164:167], a[128:131], a[4:7]
    v_mfma_f32_16x16x32_bf16 a[8:11], v[168:171], a[128:131], a[8:11]
    v_mfma_f32_16x16x32_bf16 a[12:15], v[172:175], a[128:131], a[12:15]
    buffer_load_dwordx4 a[224:227], v208, s[8:11], s16 offen offset:0 sc1
    v_mfma_f32_16x16x32_bf16 a[16:19], v[160:163], a[132:135], a[16:19]
    ds_read_b64_tr_b16 v[176:177], v216 offset:20480
    v_mfma_f32_16x16x32_bf16 a[20:23], v[164:167], a[132:135], a[20:23]
    ds_read_b64_tr_b16 v[178:179], v216 offset:22528
    v_mfma_f32_16x16x32_bf16 a[24:27], v[168:171], a[132:135], a[24:27]
    ds_read_b64_tr_b16 v[180:181], v217 offset:20480
    v_mfma_f32_16x16x32_bf16 a[28:31], v[172:175], a[132:135], a[28:31]
    buffer_load_dwordx4 a[228:231], v208, s[8:11], s16 offen offset:256 sc1
    v_mfma_f32_16x16x32_bf16 a[32:35], v[160:163], a[136:139], a[32:35]
    ds_read_b64_tr_b16 v[182:183], v217 offset:22528
    v_mfma_f32_16x16x32_bf16 a[36:39], v[164:167], a[136:139], a[36:39]
    ds_read_b64_tr_b16 v[184:185], v218 offset:20480
    v_mfma_f32_16x16x32_bf16 a[40:43], v[168:171], a[136:139], a[40:43]
    ds_read_b64_tr_b16 v[186:187], v218 offset:22528
    v_mfma_f32_16x16x32_bf16 a[44:47], v[172:175], a[136:139], a[44:47]
    buffer_load_dwordx4 a[232:235], v209, s[8:11], s16 offen offset:0 sc1
    v_mfma_f32_16x16x32_bf16 a[48:51], v[160:163], a[140:143], a[48:51]
    ds_read_b64_tr_b16 v[188:189], v219 offset:20480
    v_mfma_f32_16x16x32_bf16 a[52:55], v[164:167], a[140:143], a[52:55]
    ds_read_b64_tr_b16 v[190:191], v219 offset:22528
    v_mfma_f32_16x16x32_bf16 a[56:59], v[168:171], a[140:143], a[56:59]
    v_mfma_f32_16x16x32_bf16 a[60:63], v[172:175], a[140:143], a[60:63]
    buffer_load_dwordx4 a[236:239], v209, s[8:11], s16 offen offset:256 sc1
    v_mfma_f32_16x16x32_bf16 a[64:67], v[160:163], a[144:147], a[64:67]
    v_mfma_f32_16x16x32_bf16 a[68:71], v[164:167], a[144:147], a[68:71]
    v_mfma_f32_16x16x32_bf16 a[72:75], v[168:171], a[144:147], a[72:75]
    v_mfma_f32_16x16x32_bf16 a[76:79], v[172:175], a[144:147], a[76:79]
    buffer_load_dwordx4 a[240:243], v210, s[8:11], s16 offen offset:0 sc1
    v_mfma_f32_16x16x32_bf16 a[80:83], v[160:163], a[148:151], a[80:83]
    v_mfma_f32_16x16x32_bf16 a[84:87], v[164:167], a[148:151], a[84:87]
    v_mfma_f32_16x16x32_bf16 a[88:91], v[168:171], a[148:151], a[88:91]
    v_mfma_f32_16x16x32_bf16 a[92:95], v[172:175], a[148:151], a[92:95]
    buffer_load_dwordx4 a[244:247], v210, s[8:11], s16 offen offset:256 sc1
    v_mfma_f32_16x16x32_bf16 a[96:99], v[160:163], a[152:155], a[96:99]
    v_mfma_f32_16x16x32_bf16 a[100:103], v[164:167], a[152:155], a[100:103]
    v_mfma_f32_16x16x32_bf16 a[104:107], v[168:171], a[152:155], a[104:107]
    v_mfma_f32_16x16x32_bf16 a[108:111], v[172:175], a[152:155], a[108:111]
    buffer_load_dwordx4 a[248:251], v211, s[8:11], s16 offen offset:0 sc1
    v_mfma_f32_16x16x32_bf16 a[112:115], v[160:163], a[156:159], a[112:115]
    v_mfma_f32_16x16x32_bf16 a[116:119], v[164:167], a[156:159], a[116:119]
    v_mfma_f32_16x16x32_bf16 a[120:123], v[168:171], a[156:159], a[120:123]
    v_mfma_f32_16x16x32_bf16 a[124:127], v[172:175], a[156:159], a[124:127]
    buffer_load_dwordx4 a[252:255], v211, s[8:11], s16 offen offset:256 sc1
    s_add_u32 s16, s16, 16384
    s_waitcnt vmcnt(16) lgkmcnt(0)
    v_mfma_f32_16x16x32_bf16 a[0:3], v[176:179], a[160:163], a[0:3]
    v_mfma_f32_16x16x32_bf16 a[4:7], v[180:183], a[160:163], a[4:7]
    v_mfma_f32_16x16x32_bf16 a[8:11], v[184:187], a[160:163], a[8:11]
    v_mfma_f32_16x16x32_bf16 a[12:15], v[188:191], a[160:163], a[12:15]
    v_mfma_f32_16x16x32_bf16 a[16:19], v[176:179], a[164:167], a[16:19]
    ds_read_b64_tr_b16 v[160:161], v216 offset:24576
    v_mfma_f32_16x16x32_bf16 a[20:23], v[180:183], a[164:167], a[20:23]
    ds_read_b64_tr_b16 v[162:163], v216 offset:26624
    v_mfma_f32_16x16x32_bf16 a[24:27], v[184:187], a[164:167], a[24:27]
    ds_read_b64_tr_b16 v[164:165], v217 offset:24576
    v_mfma_f32_16x16x32_bf16 a[28:31], v[188:191], a[164:167], a[28:31]
    v_mfma_f32_16x16x32_bf16 a[32:35], v[176:179], a[168:171], a[32:35]
    ds_read_b64_tr_b16 v[166:167], v217 offset:26624
    v_mfma_f32_16x16x32_bf16 a[36:39], v[180:183], a[168:171], a[36:39]
    ds_read_b64_tr_b16 v[168:169], v218 offset:24576
    v_mfma_f32_16x16x32_bf16 a[40:43], v[184:187], a[168:171], a[40:43]
    ds_read_b64_tr_b16 v[170:171], v218 offset:26624
    v_mfma_f32_16x16x32_bf16 a[44:47], v[188:191], a[168:171], a[44:47]
    v_mfma_f32_16x16x32_bf16 a[48:51], v[176:179], a[172:175], a[48:51]
    ds_read_b64_tr_b16 v[172:173], v219 offset:24576
    v_mfma_f32_16x16x32_bf16 a[52:55], v[180:183], a[172:175], a[52:55]
    ds_read_b64_tr_b16 v[174:175], v219 offset:26624
    v_mfma_f32_16x16x32_bf16 a[56:59], v[184:187], a[172:175], a[56:59]
    v_mfma_f32_16x16x32_bf16 a[60:63], v[188:191], a[172:175], a[60:63]
    v_mfma_f32_16x16x32_bf16 a[64:67], v[176:179], a[176:179], a[64:67]
    v_mfma_f32_16x16x32_bf16 a[68:71], v[180:183], a[176:179], a[68:71]
    v_mfma_f32_16x16x32_bf16 a[72:75], v[184:187], a[176:179], a[72:75]
    v_mfma_f32_16x16x32_bf16 a[76:79], v[188:191], a[176:179], a[76:79]
    v_mfma_f32_16x16x32_bf16 a[80:83], v[176:179], a[180:183], a[80:83]
    v_mfma_f32_16x16x32_bf16 a[84:87], v[180:183], a[180:183], a[84:87]
    v_mfma_f32_16x16x32_bf16 a[88:91], v[184:187], a[180:183], a[88:91]
    v_mfma_f32_16x16x32_bf16 a[92:95], v[188:191], a[180:183], a[92:95]
    v_mfma_f32_16x16x32_bf16 a[96:99], v[176:179], a[184:187], a[96:99]
    v_mfma_f32_16x16x32_bf16 a[100:103], v[180:183], a[184:187], a[100:103]
    v_mfma_f32_16x16x32_bf16 a[104:107], v[184:187], a[184:187], a[104:107]
    v_mfma_f32_16x16x32_bf16 a[108:111], v[188:191], a[184:187], a[108:111]
    v_mfma_f32_16x16x32_bf16 a[112:115], v[176:179], a[188:191], a[112:115]
    v_mfma_f32_16x16x32_bf16 a[116:119], v[180:183], a[188:191], a[116:119]
    v_mfma_f32_16x16x32_bf16 a[120:123], v[184:187], a[188:191], a[120:123]
    v_mfma_f32_16x16x32_bf16 a[124:127], v[188:191], a[188:191], a[124:127]
    s_waitcnt vmcnt(8) lgkmcnt(0)
    v_mfma_f32_16x16x32_bf16 a[0:3], v[160:163], a[192:195], a[0:3]
    v_mfma_f32_16x16x32_bf16 a[4:7], v[164:167], a[192:195], a[4:7]
    v_mfma_f32_16x16x32_bf16 a[8:11], v[168:171], a[192:195], a[8:11]
    v_mfma_f32_16x16x32_bf16 a[12:15], v[172:175], a[192:195], a[12:15]
    v_mfma_f32_16x16x32_bf16 a[16:19], v[160:163], a[196:199], a[16:19]
    ds_read_b64_tr_b16 v[176:177], v216 offset:28672
    v_mfma_f32_16x16x32_bf16 a[20:23], v[164:167], a[196:199], a[20:23]
    ds_read_b64_tr_b16 v[178:179], v216 offset:30720
    v_mfma_f32_16x16x32_bf16 a[24:27], v[168:171], a[196:199], a[24:27]
    ds_read_b64_tr_b16 v[180:181], v217 offset:28672
    v_mfma_f32_16x16x32_bf16 a[28:31], v[172:175], a[196:199], a[28:31]
    v_mfma_f32_16x16x32_bf16 a[32:35], v[160:163], a[200:203], a[32:35]
    ds_read_b64_tr_b16 v[182:183], v217 offset:30720
    v_mfma_f32_16x16x32_bf16 a[36:39], v[164:167], a[200:203], a[36:39]
    ds_read_b64_tr_b16 v[184:185], v218 offset:28672
    v_mfma_f32_16x16x32_bf16 a[40:43], v[168:171], a[200:203], a[40:43]
    ds_read_b64_tr_b16 v[186:187], v218 offset:30720
    v_mfma_f32_16x16x32_bf16 a[44:47], v[172:175], a[200:203], a[44:47]
    v_mfma_f32_16x16x32_bf16 a[48:51], v[160:163], a[204:207], a[48:51]
    ds_read_b64_tr_b16 v[188:189], v219 offset:28672
    v_mfma_f32_16x16x32_bf16 a[52:55], v[164:167], a[204:207], a[52:55]
    ds_read_b64_tr_b16 v[190:191], v219 offset:30720
    v_mfma_f32_16x16x32_bf16 a[56:59], v[168:171], a[204:207], a[56:59]
    v_mfma_f32_16x16x32_bf16 a[60:63], v[172:175], a[204:207], a[60:63]
    v_mfma_f32_16x16x32_bf16 a[64:67], v[160:163], a[208:211], a[64:67]
    v_mfma_f32_16x16x32_bf16 a[68:71], v[164:167], a[208:211], a[68:71]
    v_mfma_f32_16x16x32_bf16 a[72:75], v[168:171], a[208:211], a[72:75]
    v_mfma_f32_16x16x32_bf16 a[76:79], v[172:175], a[208:211], a[76:79]
    v_mfma_f32_16x16x32_bf16 a[80:83], v[160:163], a[212:215], a[80:83]
    v_mfma_f32_16x16x32_bf16 a[84:87], v[164:167], a[212:215], a[84:87]
    v_mfma_f32_16x16x32_bf16 a[88:91], v[168:171], a[212:215], a[88:91]
    v_mfma_f32_16x16x32_bf16 a[92:95], v[172:175], a[212:215], a[92:95]
    v_mfma_f32_16x16x32_bf16 a[96:99], v[160:163], a[216:219], a[96:99]
    v_mfma_f32_16x16x32_bf16 a[100:103], v[164:167], a[216:219], a[100:103]
    v_mfma_f32_16x16x32_bf16 a[104:107], v[168:171], a[216:219], a[104:107]
    v_mfma_f32_16x16x32_bf16 a[108:111], v[172:175], a[216:219], a[108:111]
    v_mfma_f32_16x16x32_bf16 a[112:115], v[160:163], a[220:223], a[112:115]
    v_mfma_f32_16x16x32_bf16 a[116:119], v[164:167], a[220:223], a[116:119]
    v_mfma_f32_16x16x32_bf16 a[120:123], v[168:171], a[220:223], a[120:123]
    v_mfma_f32_16x16x32_bf16 a[124:127], v[172:175], a[220:223], a[124:127]
    s_waitcnt vmcnt(0) lgkmcnt(0)
    v_mfma_f32_16x16x32_bf16 a[0:3], v[176:179], a[224:227], a[0:3]
    v_mfma_f32_16x16x32_bf16 a[4:7], v[180:183], a[224:227], a[4:7]
    v_mfma_f32_16x16x32_bf16 a[8:11], v[184:187], a[224:227], a[8:11]
    v_mfma_f32_16x16x32_bf16 a[12:15], v[188:191], a[224:227], a[12:15]
    v_mfma_f32_16x16x32_bf16 a[16:19], v[176:179], a[228:231], a[16:19]
    v_mfma_f32_16x16x32_bf16 a[20:23], v[180:183], a[228:231], a[20:23]
    v_mfma_f32_16x16x32_bf16 a[24:27], v[184:187], a[228:231], a[24:27]
    v_mfma_f32_16x16x32_bf16 a[28:31], v[188:191], a[228:231], a[28:31]
    v_mfma_f32_16x16x32_bf16 a[32:35], v[176:179], a[232:235], a[32:35]
    v_mfma_f32_16x16x32_bf16 a[36:39], v[180:183], a[232:235], a[36:39]
    v_mfma_f32_16x16x32_bf16 a[40:43], v[184:187], a[232:235], a[40:43]
    v_mfma_f32_16x16x32_bf16 a[44:47], v[188:191], a[232:235], a[44:47]
    v_mfma_f32_16x16x32_bf16 a[48:51], v[176:179], a[236:239], a[48:51]
    v_mfma_f32_16x16x32_bf16 a[52:55], v[180:183], a[236:239], a[52:55]
    v_mfma_f32_16x16x32_bf16 a[56:59], v[184:187], a[236:239], a[56:59]
    v_mfma_f32_16x16x32_bf16 a[60:63], v[188:191], a[236:239], a[60:63]
    v_mfma_f32_16x16x32_bf16 a[64:67], v[176:179], a[240:243], a[64:67]
    v_mfma_f32_16x16x32_bf16 a[68:71], v[180:183], a[240:243], a[68:71]
    v_mfma_f32_16x16x32_bf16 a[72:75], v[184:187], a[240:243], a[72:75]
    v_mfma_f32_16x16x32_bf16 a[76:79], v[188:191], a[240:243], a[76:79]
    v_mfma_f32_16x16x32_bf16 a[80:83], v[176:179], a[244:247], a[80:83]
    v_mfma_f32_16x16x32_bf16 a[84:87], v[180:183], a[244:247], a[84:87]
    v_mfma_f32_16x16x32_bf16 a[88:91], v[184:187], a[244:247], a[88:91]
    v_mfma_f32_16x16x32_bf16 a[92:95], v[188:191], a[244:247], a[92:95]
    v_mfma_f32_16x16x32_bf16 a[96:99], v[176:179], a[248:251], a[96:99]
    v_mfma_f32_16x16x32_bf16 a[100:103], v[180:183], a[248:251], a[100:103]
    v_mfma_f32_16x16x32_bf16 a[104:107], v[184:187], a[248:251], a[104:107]
    v_mfma_f32_16x16x32_bf16 a[108:111], v[188:191], a[248:251], a[108:111]
    v_mfma_f32_16x16x32_bf16 a[112:115], v[176:179], a[252:255], a[112:115]
    v_mfma_f32_16x16x32_bf16 a[116:119], v[180:183], a[252:255], a[116:119]
    v_mfma_f32_16x16x32_bf16 a[120:123], v[184:187], a[252:255], a[120:123]
    v_mfma_f32_16x16x32_bf16 a[124:127], v[188:191], a[252:255], a[124:127]
L_kv0Kr:
    v_mov_b32 v6, 176
    buffer_load_dword v7, v6, s[64:67], 0 offen sc1
    s_nop 7
    ds_write_b128 v220, a[32:35] offset:0
    ds_write_b128 v220, a[36:39] offset:1024
    ds_write_b128 v220, a[40:43] offset:2048
    ds_write_b128 v220, a[44:47] offset:3072
    ds_write_b128 v220, a[48:51] offset:4096
    ds_write_b128 v220, a[52:55] offset:5120
    ds_write_b128 v220, a[56:59] offset:6144
    ds_write_b128 v220, a[60:63] offset:7168
    ds_write_b128 v221, a[64:67] offset:0
    ds_write_b128 v221, a[68:71] offset:1024
    ds_write_b128 v221, a[72:75] offset:2048
    ds_write_b128 v221, a[76:79] offset:3072
    ds_write_b128 v221, a[80:83] offset:4096
    ds_write_b128 v221, a[84:87] offset:5120
    ds_write_b128 v221, a[88:91] offset:6144
    ds_write_b128 v221, a[92:95] offset:7168
    ds_write_b128 v222, a[96:99] offset:0
    ds_write_b128 v222, a[100:103] offset:1024
    ds_write_b128 v222, a[104:107] offset:2048
    ds_write_b128 v222, a[108:111] offset:3072
    ds_write_b128 v222, a[112:115] offset:4096
    ds_write_b128 v222, a[116:119] offset:5120
    ds_write_b128 v222, a[120:123] offset:6144
    ds_write_b128 v222, a[124:127] offset:7168
    v_accvgpr_read_b32 v160, a0
    v_accvgpr_read_b32 v161, a1
    v_accvgpr_read_b32 v162, a2
    v_accvgpr_read_b32 v163, a3
    v_accvgpr_read_b32 v164, a4
    v_accvgpr_read_b32 v165, a5
    v_accvgpr_read_b32 v166, a6
    v_accvgpr_read_b32 v167, a7
    v_accvgpr_read_b32 v168, a8
    v_accvgpr_read_b32 v169, a9
    v_accvgpr_read_b32 v170, a10
    v_accvgpr_read_b32 v171, a11
    v_accvgpr_read_b32 v172, a12
    v_accvgpr_read_b32 v173, a13
    v_accvgpr_read_b32 v174, a14
    v_accvgpr_read_b32 v175, a15
    v_accvgpr_read_b32 v176, a16
    v_accvgpr_read_b32 v177, a17
    v_accvgpr_read_b32 v178, a18
    v_accvgpr_read_b32 v179, a19
    v_accvgpr_read_b32 v180, a20
    v_accvgpr_read_b32 v181, a21
    v_accvgpr_read_b32 v182, a22
    v_accvgpr_read_b32 v183, a23
    v_accvgpr_read_b32 v184, a24
    v_accvgpr_read_b32 v185, a25
    v_accvgpr_read_b32 v186, a26
    v_accvgpr_read_b32 v187, a27
    v_accvgpr_read_b32 v188, a28
    v_accvgpr_read_b32 v189, a29
    v_accvgpr_read_b32 v190, a30
    v_accvgpr_read_b32 v191, a31
    s_waitcnt lgkmcnt(0)
    s_barrier
    ds_read_b128 v[192:195], v223 offset:0
    ds_read_b128 v[196:199], v223 offset:1024
    ds_read_b128 v[200:203], v223 offset:2048
    ds_read_b128 v[204:207], v223 offset:3072
    ds_read_b128 v[232:235], v223 offset:4096
    ds_read_b128 v[236:239], v223 offset:5120
    ds_read_b128 v[240:243], v223 offset:6144
    ds_read_b128 v[244:247], v223 offset:7168
    s_waitcnt lgkmcnt(4)
    v_pk_add_f32 v[160:161], v[160:161], v[192:193]
    v_pk_add_f32 v[162:163], v[162:163], v[194:195]
    v_pk_add_f32 v[164:165], v[164:165], v[196:197]
    v_pk_add_f32 v[166:167], v[166:167], v[198:199]
    v_pk_add_f32 v[168:169], v[168:169], v[200:201]
    v_pk_add_f32 v[170:171], v[170:171], v[202:203]
    v_pk_add_f32 v[172:173], v[172:173], v[204:205]
    v_pk_add_f32 v[174:175], v[174:175], v[206:207]
    ds_read_b128 v[192:195], v224 offset:0
    ds_read_b128 v[196:199], v224 offset:1024
    ds_read_b128 v[200:203], v224 offset:2048
    ds_read_b128 v[204:207], v224 offset:3072
    s_waitcnt lgkmcnt(4)
    v_pk_add_f32 v[176:177], v[176:177], v[232:233]
    v_pk_add_f32 v[178:179], v[178:179], v[234:235]
    v_pk_add_f32 v[180:181], v[180:181], v[236:237]
    v_pk_add_f32 v[182:183], v[182:183], v[238:239]
    v_pk_add_f32 v[184:185], v[184:185], v[240:241]
    v_pk_add_f32 v[186:187], v[186:187], v[242:243]
    v_pk_add_f32 v[188:189], v[188:189], v[244:245]
    v_pk_add_f32 v[190:191], v[190:191], v[246:247]
    ds_read_b128 v[232:235], v224 offset:4096
    ds_read_b128 v[236:239], v224 offset:5120
    ds_read_b128 v[240:243], v224 offset:6144
    ds_read_b128 v[244:247], v224 offset:7168
    s_waitcnt lgkmcnt(4)
    v_pk_add_f32 v[160:161], v[160:161], v[192:193]
    v_pk_add_f32 v[162:163], v[162:163], v[194:195]
    v_pk_add_f32 v[164:165], v[164:165], v[196:197]
    v_pk_add_f32 v[166:167], v[166:167], v[198:199]
    v_pk_add_f32 v[168:169], v[168:169], v[200:201]
    v_pk_add_f32 v[170:171], v[170:171], v[202:203]
    v_pk_add_f32 v[172:173], v[172:173], v[204:205]
    v_pk_add_f32 v[174:175], v[174:175], v[206:207]
    ds_read_b128 v[192:195], v225 offset:0
    ds_read_b128 v[196:199], v225 offset:1024
    ds_read_b128 v[200:203], v225 offset:2048
    ds_read_b128 v[204:207], v225 offset:3072
    s_waitcnt lgkmcnt(4)
    v_pk_add_f32 v[176:177], v[176:177], v[232:233]
    v_pk_add_f32 v[178:179], v[178:179], v[234:235]
    v_pk_add_f32 v[180:181], v[180:181], v[236:237]
    v_pk_add_f32 v[182:183], v[182:183], v[238:239]
    v_pk_add_f32 v[184:185], v[184:185], v[240:241]
    v_pk_add_f32 v[186:187], v[186:187], v[242:243]
    v_pk_add_f32 v[188:189], v[188:189], v[244:245]
    v_pk_add_f32 v[190:191], v[190:191], v[246:247]
    ds_read_b128 v[232:235], v225 offset:4096
    ds_read_b128 v[236:239], v225 offset:5120
    ds_read_b128 v[240:243], v225 offset:6144
    ds_read_b128 v[244:247], v225 offset:7168
    s_waitcnt lgkmcnt(4)
    v_pk_add_f32 v[160:161], v[160:161], v[192:193]
    v_pk_add_f32 v[162:163], v[162:163], v[194:195]
    v_pk_add_f32 v[164:165], v[164:165], v[196:197]
    v_pk_add_f32 v[166:167], v[166:167], v[198:199]
    v_pk_add_f32 v[168:169], v[168:169], v[200:201]
    v_pk_add_f32 v[170:171], v[170:171], v[202:203]
    v_pk_add_f32 v[172:173], v[172:173], v[204:205]
    v_pk_add_f32 v[174:175], v[174:175], v[206:207]
    s_waitcnt lgkmcnt(0)
    v_pk_add_f32 v[176:177], v[176:177], v[232:233]
    v_pk_add_f32 v[178:179], v[178:179], v[234:235]
    v_pk_add_f32 v[180:181], v[180:181], v[236:237]
    v_pk_add_f32 v[182:183], v[182:183], v[238:239]
    v_pk_add_f32 v[184:185], v[184:185], v[240:241]
    v_pk_add_f32 v[186:187], v[186:187], v[242:243]
    v_pk_add_f32 v[188:189], v[188:189], v[244:245]
    v_pk_add_f32 v[190:191], v[190:191], v[246:247]
Ll0_160:
    s_waitcnt vmcnt(0)
    v_cmp_le_u32 vcc, 16, v7
    s_cbranch_vccnz Ll0o_161
    s_sub_u32 s22, s22, 1
    s_cbranch_scc1 L_abort
    s_sleep 2
    buffer_load_dword v7, v6, s[64:67], 0 offen sc1
    s_branch Ll0_160
Ll0o_161:
    v_cvt_pk_bf16_f32 v192, v160, v161
    v_cvt_pk_bf16_f32 v193, v162, v163
    v_cvt_pk_bf16_f32 v194, v164, v165
    v_cvt_pk_bf16_f32 v195, v166, v167
    v_cvt_pk_bf16_f32 v196, v168, v169
    v_cvt_pk_bf16_f32 v197, v170, v171
    v_cvt_pk_bf16_f32 v198, v172, v173
    v_cvt_pk_bf16_f32 v199, v174, v175
    v_cvt_pk_bf16_f32 v200, v176, v177
    v_cvt_pk_bf16_f32 v201, v178, v179
    v_cvt_pk_bf16_f32 v202, v180, v181
    v_cvt_pk_bf16_f32 v203, v182, v183
    v_cvt_pk_bf16_f32 v204, v184, v185
    v_cvt_pk_bf16_f32 v205, v186, v187
    v_cvt_pk_bf16_f32 v206, v188, v189
    v_cvt_pk_bf16_f32 v207, v190, v191
    s_add_u32 s5, s29, 16384
    buffer_store_dwordx4 v[192:195], v228, s[8:11], s29 offen offset:0 sc1
    buffer_store_dwordx4 v[196:199], v228, s[8:11], s5 offen offset:0 sc1
    buffer_store_dwordx4 v[200:203], v228, s[8:11], s29 offen offset:256 sc1
    buffer_store_dwordx4 v[204:207], v228, s[8:11], s5 offen offset:256 sc1
    s_branch L_kv0done
L_kv0c:
    s_cmp_ge_u32 s23, 2
    s_cbranch_scc1 L_kv0cV
    s_waitcnt vmcnt(29)
    ds_read_b64_tr_b16 v[160:161], v216 offset:0
    ds_read_b64_tr_b16 v[162:163], v216 offset:2048
    ds_read_b64_tr_b16 v[164:165], v217 offset:0
    ds_read_b64_tr_b16 v[166:167], v217 offset:2048
    ds_read_b64_tr_b16 v[168:169], v218 offset:0
    ds_read_b64_tr_b16 v[170:171], v218 offset:2048
    ds_read_b64_tr_b16 v[172:173], v219 offset:0
    ds_read_b64_tr_b16 v[174:175], v219 offset:2048
    s_waitcnt vmcnt(25) lgkmcnt(0)
    v_mfma_f32_16x16x32_bf16 a[0:3], v[160:163], v[32:35], 0
    v_mfma_f32_16x16x32_bf16 a[4:7], v[164:167], v[32:35], 0
    v_mfma_f32_16x16x32_bf16 a[8:11], v[168:171], v[32:35], 0
    v_mfma_f32_16x16x32_bf16 a[12:15], v[172:175], v[32:35], 0
    v_mfma_f32_16x16x32_bf16 a[16:19], v[160:163], v[36:39], 0
    ds_read_b64_tr_b16 v[176:177], v216 offset:4096
    v_mfma_f32_16x16x32_bf16 a[20:23], v[164:167], v[36:39], 0
    ds_read_b64_tr_b16 v[178:179], v216 offset:6144
    v_mfma_f32_16x16x32_bf16 a[24:27], v[168:171], v[36:39], 0
    ds_read_b64_tr_b16 v[180:181], v217 offset:4096
    v_mfma_f32_16x16x32_bf16 a[28:31], v[172:175], v[36:39], 0
    v_mfma_f32_16x16x32_bf16 a[32:35], v[160:163], v[40:43], 0
    ds_read_b64_tr_b16 v[182:183], v217 offset:6144
    v_mfma_f32_16x16x32_bf16 a[36:39], v[164:167], v[40:43], 0
    ds_read_b64_tr_b16 v[184:185], v218 offset:4096
    v_mfma_f32_16x16x32_bf16 a[40:43], v[168:171], v[40:43], 0
    ds_read_b64_tr_b16 v[186:187], v218 offset:6144
    v_mfma_f32_16x16x32_bf16 a[44:47], v[172:175], v[40:43], 0
    v_mfma_f32_16x16x32_bf16 a[48:51], v[160:163], v[44:47], 0
    ds_read_b64_tr_b16 v[188:189], v219 offset:4096
    v_mfma_f32_16x16x32_bf16 a[52:55], v[164:167], v[44:47], 0
    ds_read_b64_tr_b16 v[190:191], v219 offset:6144
    v_mfma_f32_16x16x32_bf16 a[56:59], v[168:171], v[44:47], 0
    v_mfma_f32_16x16x32_bf16 a[60:63], v[172:175], v[44:47], 0
    v_mfma_f32_16x16x32_bf16 a[64:67], v[160:163], v[48:51], 0
    v_mfma_f32_16x16x32_bf16 a[68:71], v[164:167], v[48:51], 0
    v_mfma_f32_16x16x32_bf16 a[72:75], v[168:171], v[48:51], 0
    v_mfma_f32_16x16x32_bf16 a[76:79], v[172:175], v[48:51], 0
    v_mfma_f32_16x16x32_bf16 a[80:83], v[160:163], v[52:55], 0
    v_mfma_f32_16x16x32_bf16 a[84:87], v[164:167], v[52:55], 0
    v_mfma_f32_16x16x32_bf16 a[88:91], v[168:171], v[52:55], 0
    v_mfma_f32_16x16x32_bf16 a[92:95], v[172:175], v[52:55], 0
    v_mfma_f32_16x16x32_bf16 a[96:99], v[160:163], v[56:59], 0
    v_mfma_f32_16x16x32_bf16 a[100:103], v[164:167], v[56:59], 0
    v_mfma_f32_16x16x32_bf16 a[104:107], v[168:171], v[56:59], 0
    v_mfma_f32_16x16x32_bf16 a[108:111], v[172:175], v[56:59], 0
    v_mfma_f32_16x16x32_bf16 a[112:115], v[160:163], v[60:63], 0
    v_mfma_f32_16x16x32_bf16 a[116:119], v[164:167], v[60:63], 0
    v_mfma_f32_16x16x32_bf16 a[120:123], v[168:171], v[60:63], 0
    v_mfma_f32_16x16x32_bf16 a[124:127], v[172:175], v[60:63], 0
    s_waitcnt vmcnt(21) lgkmcnt(0)
    v_mfma_f32_16x16x32_bf16 a[0:3], v[176:179], v[64:67], a[0:3]
    v_mfma_f32_16x16x32_bf16 a[4:7], v[180:183], v[64:67], a[4:7]
    v_mfma_f32_16x16x32_bf16 a[8:11], v[184:187], v[64:67], a[8:11]
    v_mfma_f32_16x16x32_bf16 a[12:15], v[188:191], v[64:67], a[12:15]
    v_mfma_f32_16x16x32_bf16 a[16:19], v[176:179], v[68:71], a[16:19]
    ds_read_b64_tr_b16 v[160:161], v216 offset:8192
    v_mfma_f32_16x16x32_bf16 a[20:23], v[180:183], v[68:71], a[20:23]
    ds_read_b64_tr_b16 v[162:163], v216 offset:10240
    v_mfma_f32_16x16x32_bf16 a[24:27], v[184:187], v[68:71], a[24:27]
    ds_read_b64_tr_b16 v[164:165], v217 offset:8192
    v_mfma_f32_16x16x32_bf16 a[28:31], v[188:191], v[68:71], a[28:31]
    v_mfma_f32_16x16x32_bf16 a[32:35], v[176:179], v[72:75], a[32:35]
    ds_read_b64_tr_b16 v[166:167], v217 offset:10240
    v_mfma_f32_16x16x32_bf16 a[36:39], v[180:183], v[72:75], a[36:39]
    ds_read_b64_tr_b16 v[168:169], v218 offset:8192
    v_mfma_f32_16x16x32_bf16 a[40:43], v[184:187], v[72:75], a[40:43]
    ds_read_b64_tr_b16 v[170:171], v218 offset:10240
    v_mfma_f32_16x16x32_bf16 a[44:47], v[188:191], v[72:75], a[44:47]
    v_mfma_f32_16x16x32_bf16 a[48:51], v[176:179], v[76:79], a[48:51]
    ds_read_b64_tr_b16 v[172:173], v219 offset:8192
    v_mfma_f32_16x16x32_bf16 a[52:55], v[180:183], v[76:79], a[52:55]
    ds_read_b64_tr_b16 v[174:175], v219 offset:10240
    v_mfma_f32_16x16x32_bf16 a[56:59], v[184:187], v[76:79], a[56:59]
    v_mfma_f32_16x16x32_bf16 a[60:63], v[188:191], v[76:79], a[60:63]
    v_mfma_f32_16x16x32_bf16 a[64:67], v[176:179], v[80:83], a[64:67]
    v_mfma_f32_16x16x32_bf16 a[68:71], v[180:183], v[80:83], a[68:71]
    v_mfma_f32_16x16x32_bf16 a[72:75], v[184:187], v[80:83], a[72:75]
    v_mfma_f32_16x16x32_bf16 a[76:79], v[188:191], v[80:83], a[76:79]
    v_mfma_f32_16x16x32_bf16 a[80:83], v[176:179], v[84:87], a[80:83]
    v_mfma_f32_16x16x32_bf16 a[84:87], v[180:183], v[84:87], a[84:87]
    v_mfma_f32_16x16x32_bf16 a[88:91], v[184:187], v[84:87], a[88:91]
    v_mfma_f32_16x16x32_bf16 a[92:95], v[188:191], v[84:87], a[92:95]
    v_mfma_f32_16x16x32_bf16 a[96:99], v[176:179], v[88:91], a[96:99]
    v_mfma_f32_16x16x32_bf16 a[100:103], v[180:183], v[88:91], a[100:103]
    v_mfma_f32_16x16x32_bf16 a[104:107], v[184:187], v[88:91], a[104:107]
    v_mfma_f32_16x16x32_bf16 a[108:111], v[188:191], v[88:91], a[108:111]
    v_mfma_f32_16x16x32_bf16 a[112:115], v[176:179], v[92:95], a[112:115]
    v_mfma_f32_16x16x32_bf16 a[116:119], v[180:183], v[92:95], a[116:119]
    v_mfma_f32_16x16x32_bf16 a[120:123], v[184:187], v[92:95], a[120:123]
    v_mfma_f32_16x16x32_bf16 a[124:127], v[188:191], v[92:95], a[124:127]
    s_waitcnt vmcnt(17) lgkmcnt(0)
    v_mfma_f32_16x16x32_bf16 a[0:3], v[160:163], v[96:99], a[0:3]
    v_mfma_f32_16x16x32_bf16 a[4:7], v[164:167], v[96:99], a[4:7]
    v_mfma_f32_16x16x32_bf16 a[8:11], v[168:171], v[96:99], a[8:11]
    v_mfma_f32_16x16x32_bf16 a[12:15], v[172:175], v[96:99], a[12:15]
    v_mfma_f32_16x16x32_bf16 a[16:19], v[160:163], v[100:103], a[16:19]
    ds_read_b64_tr_b16 v[176:177], v216 offset:12288
    v_mfma_f32_16x16x32_bf16 a[20:23], v[164:167], v[100:103], a[20:23]
    ds_read_b64_tr_b16 v[178:179], v216 offset:14336
    v_mfma_f32_16x16x32_bf16 a[24:27], v[168:171], v[100:103], a[24:27]
    ds_read_b64_tr_b16 v[180:181], v217 offset:12288
    v_mfma_f32_16x16x32_bf16 a[28:31], v[172:175], v[100:103], a[28:31]
    v_mfma_f32_16x16x32_bf16 a[32:35], v[160:163], v[104:107], a[32:35]
    ds_read_b64_tr_b16 v[182:183], v217 offset:14336
    v_mfma_f32_16x16x32_bf16 a[36:39], v[164:167], v[104:107], a[36:39]
    ds_read_b64_tr_b16 v[184:185], v218 offset:12288
    v_mfma_f32_16x16x32_bf16 a[40:43], v[168:171], v[104:107], a[40:43]
    ds_read_b64_tr_b16 v[186:187], v218 offset:14336
    v_mfma_f32_16x16x32_bf16 a[44:47], v[172:175], v[104:107], a[44:47]
    v_mfma_f32_16x16x32_bf16 a[48:51], v[160:163], v[108:111], a[48:51]
    ds_read_b64_tr_b16 v[188:189], v219 offset:12288
    v_mfma_f32_16x16x32_bf16 a[52:55], v[164:167], v[108:111], a[52:55]
    ds_read_b64_tr_b16 v[190:191], v219 offset:14336
    v_mfma_f32_16x16x32_bf16 a[56:59], v[168:171], v[108:111], a[56:59]
    v_mfma_f32_16x16x32_bf16 a[60:63], v[172:175], v[108:111], a[60:63]
    v_mfma_f32_16x16x32_bf16 a[64:67], v[160:163], v[112:115], a[64:67]
    v_mfma_f32_16x16x32_bf16 a[68:71], v[164:167], v[112:115], a[68:71]
    v_mfma_f32_16x16x32_bf16 a[72:75], v[168:171], v[112:115], a[72:75]
    v_mfma_f32_16x16x32_bf16 a[76:79], v[172:175], v[112:115], a[76:79]
    v_mfma_f32_16x16x32_bf16 a[80:83], v[160:163], v[116:119], a[80:83]
    v_mfma_f32_16x16x32_bf16 a[84:87], v[164:167], v[116:119], a[84:87]
    v_mfma_f32_16x16x32_bf16 a[88:91], v[168:171], v[116:119], a[88:91]
    v_mfma_f32_16x16x32_bf16 a[92:95], v[172:175], v[116:119], a[92:95]
    v_mfma_f32_16x16x32_bf16 a[96:99], v[160:163], v[120:123], a[96:99]
    v_mfma_f32_16x16x32_bf16 a[100:103], v[164:167], v[120:123], a[100:103]
    v_mfma_f32_16x16x32_bf16 a[104:107], v[168:171], v[120:123], a[104:107]
    v_mfma_f32_16x16x32_bf16 a[108:111], v[172:175], v[120:123], a[108:111]
    v_mfma_f32_16x16x32_bf16 a[112:115], v[160:163], v[124:127], a[112:115]
    v_mfma_f32_16x16x32_bf16 a[116:119], v[164:167], v[124:127], a[116:119]
    v_mfma_f32_16x16x32_bf16 a[120:123], v[168:171], v[124:127], a[120:123]
    v_mfma_f32_16x16x32_bf16 a[124:127], v[172:175], v[124:127], a[124:127]
    s_waitcnt vmcnt(13) lgkmcnt(0)
    v_mfma_f32_16x16x32_bf16 a[0:3], v[176:179], v[128:131], a[0:3]
    v_mfma_f32_16x16x32_bf16 a[4:7], v[180:183], v[128:131], a[4:7]
    v_mfma_f32_16x16x32_bf16 a[8:11], v[184:187], v[128:131], a[8:11]
    v_mfma_f32_16x16x32_bf16 a[12:15], v[188:191], v[128:131], a[12:15]
    v_mfma_f32_16x16x32_bf16 a[16:19], v[176:179], v[132:135], a[16:19]
    ds_read_b64_tr_b16 v[160:161], v216 offset:16384
    v_mfma_f32_16x16x32_bf16 a[20:23], v[180:183], v[132:135], a[20:23]
    ds_read_b64_tr_b16 v[162:163], v216 offset:18432
    v_mfma_f32_16x16x32_bf16 a[24:27], v[184:187], v[132:135], a[24:27]
    ds_read_b64_tr_b16 v[164:165], v217 offset:16384
    v_mfma_f32_16x16x32_bf16 a[28:31], v[188:191], v[132:135], a[28:31]
    v_mfma_f32_16x16x32_bf16 a[32:35], v[176:179], v[136:139], a[32:35]
    ds_read_b64_tr_b16 v[166:167], v217 offset:18432
    v_mfma_f32_16x16x32_bf16 a[36:39], v[180:183], v[136:139], a[36:39]
    ds_read_b64_tr_b16 v[168:169], v218 offset:16384
    v_mfma_f32_16x16x32_bf16 a[40:43], v[184:187], v[136:139], a[40:43]
    ds_read_b64_tr_b16 v[170:171], v218 offset:18432
    v_mfma_f32_16x16x32_bf16 a[44:47], v[188:191], v[136:139], a[44:47]
    v_mfma_f32_16x16x32_bf16 a[48:51], v[176:179], v[140:143], a[48:51]
    ds_read_b64_tr_b16 v[172:173], v219 offset:16384
    v_mfma_f32_16x16x32_bf16 a[52:55], v[180:183], v[140:143], a[52:55]
    ds_read_b64_tr_b16 v[174:175], v219 offset:18432
    v_mfma_f32_16x16x32_bf16 a[56:59], v[184:187], v[140:143], a[56:59]
    v_mfma_f32_16x16x32_bf16 a[60:63], v[188:191], v[140:143], a[60:63]
    v_mfma_f32_16x16x32_bf16 a[64:67], v[176:179], v[144:147], a[64:67]
    v_mfma_f32_16x16x32_bf16 a[68:71], v[180:183], v[144:147], a[68:71]
    v_mfma_f32_16x16x32_bf16 a[72:75], v[184:187], v[144:147], a[72:75]
    v_mfma_f32_16x16x32_bf16 a[76:79], v[188:191], v[144:147], a[76:79]
    v_mfma_f32_16x16x32_bf16 a[80:83], v[176:179], v[148:151], a[80:83]
    v_mfma_f32_16x16x32_bf16 a[84:87], v[180:183], v[148:151], a[84:87]
    v_mfma_f32_16x16x32_bf16 a[88:91], v[184:187], v[148:151], a[88:91]
    v_mfma_f32_16x16x32_bf16 a[92:95], v[188:191], v[148:151], a[92:95]
    v_mfma_f32_16x16x32_bf16 a[96:99], v[176:179], v[152:155], a[96:99]
    v_mfma_f32_16x16x32_bf16 a[100:103], v[180:183], v[152:155], a[100:103]
    v_mfma_f32_16x16x32_bf16 a[104:107], v[184:187], v[152:155], a[104:107]
    v_mfma_f32_16x16x32_bf16 a[108:111], v[188:191], v[152:155], a[108:111]
    v_mfma_f32_16x16x32_bf16 a[112:115], v[176:179], v[156:159], a[112:115]
    v_mfma_f32_16x16x32_bf16 a[116:119], v[180:183], v[156:159], a[116:119]
    v_mfma_f32_16x16x32_bf16 a[120:123], v[184:187], v[156:159], a[120:123]
    v_mfma_f32_16x16x32_bf16 a[124:127], v[188:191], v[156:159], a[124:127]
    s_waitcnt vmcnt(8) lgkmcnt(0)
    v_mfma_f32_16x16x32_bf16 a[0:3], v[160:163], a[128:131], a[0:3]
    v_mfma_f32_16x16x32_bf16 a[4:7], v[164:167], a[128:131], a[4:7]
    v_mfma_f32_16x16x32_bf16 a[8:11], v[168:171], a[128:131], a[8:11]
    v_mfma_f32_16x16x32_bf16 a[12:15], v[172:175], a[128:131], a[12:15]
    v_mfma_f32_16x16x32_bf16 a[16:19], v[160:163], a[132:135], a[16:19]
    ds_read_b64_tr_b16 v[176:177], v216 offset:20480
    v_mfma_f32_16x16x32_bf16 a[20:23], v[164:167], a[132:135], a[20:23]
    ds_read_b64_tr_b16 v[178:179], v216 offset:22528
    v_mfma_f32_16x16x32_bf16 a[24:27], v[168:171], a[132:135], a[24:27]
    ds_read_b64_tr_b16 v[180:181], v217 offset:20480
    v_mfma_f32_16x16x32_bf16 a[28:31], v[172:175], a[132:135], a[28:31]
    v_mfma_f32_16x16x32_bf16 a[32:35], v[160:163], a[136:139], a[32:35]
    ds_read_b64_tr_b16 v[182:183], v217 offset:22528
    v_mfma_f32_16x16x32_bf16 a[36:39], v[164:167], a[136:139], a[36:39]
    ds_read_b64_tr_b16 v[184:185], v218 offset:20480
    v_mfma_f32_16x16x32_bf16 a[40:43], v[168:171], a[136:139], a[40:43]
    ds_read_b64_tr_b16 v[186:187], v218 offset:22528
    v_mfma_f32_16x16x32_bf16 a[44:47], v[172:175], a[136:139], a[44:47]
    v_mfma_f32_16x16x32_bf16 a[48:51], v[160:163], a[140:143], a[48:51]
    ds_read_b64_tr_b16 v[188:189], v219 offset:20480
    v_mfma_f32_16x16x32_bf16 a[52:55], v[164:167], a[140:143], a[52:55]
    ds_read_b64_tr_b16 v[190:191], v219 offset:22528
    v_mfma_f32_16x16x32_bf16 a[56:59], v[168:171], a[140:143], a[56:59]
    v_mfma_f32_16x16x32_bf16 a[60:63], v[172:175], a[140:143], a[60:63]
    v_mfma_f32_16x16x32_bf16 a[64:67], v[160:163], a[144:147], a[64:67]
    v_mfma_f32_16x16x32_bf16 a[68:71], v[164:167], a[144:147], a[68:71]
    v_mfma_f32_16x16x32_bf16 a[72:75], v[168:171], a[144:147], a[72:75]
    v_mfma_f32_16x16x32_bf16 a[76:79], v[172:175], a[144:147], a[76:79]
    v_mfma_f32_16x16x32_bf16 a[80:83], v[160:163], a[148:151], a[80:83]
    v_mfma_f32_16x16x32_bf16 a[84:87], v[164:167], a[148:151], a[84:87]
    v_mfma_f32_16x16x32_bf16 a[88:91], v[168:171], a[148:151], a[88:91]
    v_mfma_f32_16x16x32_bf16 a[92:95], v[172:175], a[148:151], a[92:95]
    v_mfma_f32_16x16x32_bf16 a[96:99], v[160:163], a[152:155], a[96:99]
    v_mfma_f32_16x16x32_bf16 a[100:103], v[164:167], a[152:155], a[100:103]
    v_mfma_f32_16x16x32_bf16 a[104:107], v[168:171], a[152:155], a[104:107]
    v_mfma_f32_16x16x32_bf16 a[108:111], v[172:175], a[152:155], a[108:111]
    v_mfma_f32_16x16x32_bf16 a[112:115], v[160:163], a[156:159], a[112:115]
    v_mfma_f32_16x16x32_bf16 a[116:119], v[164:167], a[156:159], a[116:119]
    v_mfma_f32_16x16x32_bf16 a[120:123], v[168:171], a[156:159], a[120:123]
    v_mfma_f32_16x16x32_bf16 a[124:127], v[172:175], a[156:159], a[124:127]
    s_waitcnt vmcnt(4) lgkmcnt(0)
    v_mfma_f32_16x16x32_bf16 a[0:3], v[176:179], a[160:163], a[0:3]
    v_mfma_f32_16x16x32_bf16 a[4:7], v[180:183], a[160:163], a[4:7]
    v_mfma_f32_16x16x32_bf16 a[8:11], v[184:187], a[160:163], a[8:11]
    v_mfma_f32_16x16x32_bf16 a[12:15], v[188:191], a[160:163], a[12:15]
    v_mfma_f32_16x16x32_bf16 a[16:19], v[176:179], a[164:167], a[16:19]
    ds_read_b64_tr_b16 v[160:161], v216 offset:24576
    v_mfma_f32_16x16x32_bf16 a[20:23], v[180:183], a[164:167], a[20:23]
    ds_read_b64_tr_b16 v[162:163], v216 offset:26624
    v_mfma_f32_16x16x32_bf16 a[24:27], v[184:187], a[164:167], a[24:27]
    ds_read_b64_tr_b16 v[164:165], v217 offset:24576
    v_mfma_f32_16x16x32_bf16 a[28:31], v[188:191], a[164:167], a[28:31]
    v_mfma_f32_16x16x32_bf16 a[32:35], v[176:179], a[168:171], a[32:35]
    ds_read_b64_tr_b16 v[166:167], v217 offset:26624
    v_mfma_f32_16x16x32_bf16 a[36:39], v[180:183], a[168:171], a[36:39]
    ds_read_b64_tr_b16 v[168:169], v218 offset:24576
    v_mfma_f32_16x16x32_bf16 a[40:43], v[184:187], a[168:171], a[40:43]
    ds_read_b64_tr_b16 v[170:171], v218 offset:26624
    v_mfma_f32_16x16x32_bf16 a[44:47], v[188:191], a[168:171], a[44:47]
    v_mfma_f32_16x16x32_bf16 a[48:51], v[176:179], a[172:175], a[48:51]
    ds_read_b64_tr_b16 v[172:173], v219 offset:24576
    v_mfma_f32_16x16x32_bf16 a[52:55], v[180:183], a[172:175], a[52:55]
    ds_read_b64_tr_b16 v[174:175], v219 offset:26624
    v_mfma_f32_16x16x32_bf16 a[56:59], v[184:187], a[172:175], a[56:59]
    v_mfma_f32_16x16x32_bf16 a[60:63], v[188:191], a[172:175], a[60:63]
    v_mfma_f32_16x16x32_bf16 a[64:67], v[176:179], a[176:179], a[64:67]
    v_mfma_f32_16x16x32_bf16 a[68:71], v[180:183], a[176:179], a[68:71]
    v_mfma_f32_16x16x32_bf16 a[72:75], v[184:187], a[176:179], a[72:75]
    v_mfma_f32_16x16x32_bf16 a[76:79], v[188:191], a[176:179], a[76:79]
    v_mfma_f32_16x16x32_bf16 a[80:83], v[176:179], a[180:183], a[80:83]
    v_mfma_f32_16x16x32_bf16 a[84:87], v[180:183], a[180:183], a[84:87]
    v_mfma_f32_16x16x32_bf16 a[88:91], v[184:187], a[180:183], a[88:91]
    v_mfma_f32_16x16x32_bf16 a[92:95], v[188:191], a[180:183], a[92:95]
    v_mfma_f32_16x16x32_bf16 a[96:99], v[176:179], a[184:187], a[96:99]
    v_mfma_f32_16x16x32_bf16 a[100:103], v[180:183], a[184:187], a[100:103]
    v_mfma_f32_16x16x32_bf16 a[104:107], v[184:187], a[184:187], a[104:107]
    v_mfma_f32_16x16x32_bf16 a[108:111], v[188:191], a[184:187], a[108:111]
    v_mfma_f32_16x16x32_bf16 a[112:115], v[176:179], a[188:191], a[112:115]
    v_mfma_f32_16x16x32_bf16 a[116:119], v[180:183], a[188:191], a[116:119]
    v_mfma_f32_16x16x32_bf16 a[120:123], v[184:187], a[188:191], a[120:123]
    v_mfma_f32_16x16x32_bf16 a[124:127], v[188:191], a[188:191], a[124:127]
    s_waitcnt vmcnt(0) lgkmcnt(0)
    v_mfma_f32_16x16x32_bf16 a[0:3], v[160:163], a[192:195], a[0:3]
    v_mfma_f32_16x16x32_bf16 a[4:7], v[164:167], a[192:195], a[4:7]
    v_mfma_f32_16x16x32_bf16 a[8:11], v[168:171], a[192:195], a[8:11]
    v_mfma_f32_16x16x32_bf16 a[12:15], v[172:175], a[192:195], a[12:15]
    v_mfma_f32_16x16x32_bf16 a[16:19], v[160:163], a[196:199], a[16:19]
    ds_read_b64_tr_b16 v[176:177], v216 offset:28672
    v_mfma_f32_16x16x32_bf16 a[20:23], v[164:167], a[196:199], a[20:23]
    ds_read_b64_tr_b16 v[178:179], v216 offset:30720
    v_mfma_f32_16x16x32_bf16 a[24:27], v[168:171], a[196:199], a[24:27]
    ds_read_b64_tr_b16 v[180:181], v217 offset:28672
    v_mfma_f32_16x16x32_bf16 a[28:31], v[172:175], a[196:199], a[28:31]
    v_mfma_f32_16x16x32_bf16 a[32:35], v[160:163], a[200:203], a[32:35]
    ds_read_b64_tr_b16 v[182:183], v217 offset:30720
    v_mfma_f32_16x16x32_bf16 a[36:39], v[164:167], a[200:203], a[36:39]
    ds_read_b64_tr_b16 v[184:185], v218 offset:28672
    v_mfma_f32_16x16x32_bf16 a[40:43], v[168:171], a[200:203], a[40:43]
    ds_read_b64_tr_b16 v[186:187], v218 offset:30720
    v_mfma_f32_16x16x32_bf16 a[44:47], v[172:175], a[200:203], a[44:47]
    v_mfma_f32_16x16x32_bf16 a[48:51], v[160:163], a[204:207], a[48:51]
    ds_read_b64_tr_b16 v[188:189], v219 offset:28672
    v_mfma_f32_16x16x32_bf16 a[52:55], v[164:167], a[204:207], a[52:55]
    ds_read_b64_tr_b16 v[190:191], v219 offset:30720
    v_mfma_f32_16x16x32_bf16 a[56:59], v[168:171], a[204:207], a[56:59]
    v_mfma_f32_16x16x32_bf16 a[60:63], v[172:175], a[204:207], a[60:63]
    v_mfma_f32_16x16x32_bf16 a[64:67], v[160:163], a[208:211], a[64:67]
    v_mfma_f32_16x16x32_bf16 a[68:71], v[164:167], a[208:211], a[68:71]
    v_mfma_f32_16x16x32_bf16 a[72:75], v[168:171], a[208:211], a[72:75]
    v_mfma_f32_16x16x32_bf16 a[76:79], v[172:175], a[208:211], a[76:79]
    v_mfma_f32_16x16x32_bf16 a[80:83], v[160:163], a[212:215], a[80:83]
    v_mfma_f32_16x16x32_bf16 a[84:87], v[164:167], a[212:215], a[84:87]
    v_mfma_f32_16x16x32_bf16 a[88:91], v[168:171], a[212:215], a[88:91]
    v_mfma_f32_16x16x32_bf16 a[92:95], v[172:175], a[212:215], a[92:95]
    v_mfma_f32_16x16x32_bf16 a[96:99], v[160:163], a[216:219], a[96:99]
    v_mfma_f32_16x16x32_bf16 a[100:103], v[164:167], a[216:219], a[100:103]
    v_mfma_f32_16x16x32_bf16 a[104:107], v[168:171], a[216:219], a[104:107]
    v_mfma_f32_16x16x32_bf16 a[108:111], v[172:175], a[216:219], a[108:111]
    v_mfma_f32_16x16x32_bf16 a[112:115], v[160:163], a[220:223], a[112:115]
    v_mfma_f32_16x16x32_bf16 a[116:119], v[164:167], a[220:223], a[116:119]
    v_mfma_f32_16x16x32_bf16 a[120:123], v[168:171], a[220:223], a[120:123]
    v_mfma_f32_16x16x32_bf16 a[124:127], v[172:175], a[220:223], a[124:127]
    s_waitcnt vmcnt(0) lgkmcnt(0)
    v_mfma_f32_16x16x32_bf16 a[0:3], v[176:179], a[224:227], a[0:3]
    v_mfma_f32_16x16x32_bf16 a[4:7], v[180:183], a[224:227], a[4:7]
    v_mfma_f32_16x16x32_bf16 a[8:11], v[184:187], a[224:227], a[8:11]
    v_mfma_f32_16x16x32_bf16 a[12:15], v[188:191], a[224:227], a[12:15]
    v_mfma_f32_16x16x32_bf16 a[16:19], v[176:179], a[228:231], a[16:19]
    v_mfma_f32_16x16x32_bf16 a[20:23], v[180:183], a[228:231], a[20:23]
    v_mfma_f32_16x16x32_bf16 a[24:27], v[184:187], a[228:231], a[24:27]
    v_mfma_f32_16x16x32_bf16 a[28:31], v[188:191], a[228:231], a[28:31]
    v_mfma_f32_16x16x32_bf16 a[32:35], v[176:179], a[232:235], a[32:35]
    v_mfma_f32_16x16x32_bf16 a[36:39], v[180:183], a[232:235], a[36:39]
    v_mfma_f32_16x16x32_bf16 a[40:43], v[184:187], a[232:235], a[40:43]
    v_mfma_f32_16x16x32_bf16 a[44:47], v[188:191], a[232:235], a[44:47]
    v_mfma_f32_16x16x32_bf16 a[48:51], v[176:179], a[236:239], a[48:51]
    v_mfma_f32_16x16x32_bf16 a[52:55], v[180:183], a[236:239], a[52:55]
    v_mfma_f32_16x16x32_bf16 a[56:59], v[184:187], a[236:239], a[56:59]
    v_mfma_f32_16x16x32_bf16 a[60:63], v[188:191], a[236:239], a[60:63]
    v_mfma_f32_16x16x32_bf16 a[64:67], v[176:179], a[240:243], a[64:67]
    v_mfma_f32_16x16x32_bf16 a[68:71], v[180:183], a[240:243], a[68:71]
    v_mfma_f32_16x16x32_bf16 a[72:75], v[184:187], a[240:243], a[72:75]
    v_mfma_f32_16x16x32_bf16 a[76:79], v[188:191], a[240:243], a[76:79]
    v_mfma_f32_16x16x32_bf16 a[80:83], v[176:179], a[244:247], a[80:83]
    v_mfma_f32_16x16x32_bf16 a[84:87], v[180:183], a[244:247], a[84:87]
    v_mfma_f32_16x16x32_bf16 a[88:91], v[184:187], a[244:247], a[88:91]
    v_mfma_f32_16x16x32_bf16 a[92:95], v[188:191], a[244:247], a[92:95]
    v_mfma_f32_16x16x32_bf16 a[96:99], v[176:179], a[248:251], a[96:99]
    v_mfma_f32_16x16x32_bf16 a[100:103], v[180:183], a[248:251], a[100:103]
    v_mfma_f32_16x16x32_bf16 a[104:107], v[184:187], a[248:251], a[104:107]
    v_mfma_f32_16x16x32_bf16 a[108:111], v[188:191], a[248:251], a[108:111]
    v_mfma_f32_16x16x32_bf16 a[112:115], v[176:179], a[252:255], a[112:115]
    v_mfma_f32_16x16x32_bf16 a[116:119], v[180:183], a[252:255], a[116:119]
    v_mfma_f32_16x16x32_bf16 a[120:123], v[184:187], a[252:255], a[120:123]
    v_mfma_f32_16x16x32_bf16 a[124:127], v[188:191], a[252:255], a[124:127]
    s_branch L_kv0Kr
L_kv0cV:
    s_waitcnt vmcnt(29)
    ds_read_b64_tr_b16 v[160:161], v216 offset:0
    ds_read_b64_tr_b16 v[162:163], v216 offset:2048
    ds_read_b64_tr_b16 v[164:165], v217 offset:0
    ds_read_b64_tr_b16 v[166:167], v217 offset:2048
    ds_read_b64_tr_b16 v[168:169], v218 offset:0
    ds_read_b64_tr_b16 v[170:171], v218 offset:2048
    ds_read_b64_tr_b16 v[172:173], v219 offset:0
    ds_read_b64_tr_b16 v[174:175], v219 offset:2048
    s_waitcnt vmcnt(25) lgkmcnt(0)
    v_mfma_f32_16x16x32_bf16 a[0:3], v[32:35], v[160:163], 0
    v_mfma_f32_16x16x32_bf16 a[4:7], v[32:35], v[164:167], 0
    v_mfma_f32_16x16x32_bf16 a[8:11], v[32:35], v[168:171], 0
    v_mfma_f32_16x16x32_bf16 a[12:15], v[32:35], v[172:175], 0
    v_mfma_f32_16x16x32_bf16 a[16:19], v[36:39], v[160:163], 0
    ds_read_b64_tr_b16 v[176:177], v216 offset:4096
    v_mfma_f32_16x16x32_bf16 a[20:23], v[36:39], v[164:167], 0
    ds_read_b64_tr_b16 v[178:179], v216 offset:6144
    v_mfma_f32_16x16x32_bf16 a[24:27], v[36:39], v[168:171], 0
    ds_read_b64_tr_b16 v[180:181], v217 offset:4096
    v_mfma_f32_16x16x32_bf16 a[28:31], v[36:39], v[172:175], 0
    v_mfma_f32_16x16x32_bf16 a[32:35], v[40:43], v[160:163], 0
    ds_read_b64_tr_b16 v[182:183], v217 offset:6144
    v_mfma_f32_16x16x32_bf16 a[36:39], v[40:43], v[164:167], 0
    ds_read_b64_tr_b16 v[184:185], v218 offset:4096
    v_mfma_f32_16x16x32_bf16 a[40:43], v[40:43], v[168:171], 0
    ds_read_b64_tr_b16 v[186:187], v218 offset:6144
    v_mfma_f32_16x16x32_bf16 a[44:47], v[40:43], v[172:175], 0
    v_mfma_f32_16x16x32_bf16 a[48:51], v[44:47], v[160:163], 0
    ds_read_b64_tr_b16 v[188:189], v219 offset:4096
    v_mfma_f32_16x16x32_bf16 a[52:55], v[44:47], v[164:167], 0
    ds_read_b64_tr_b16 v[190:191], v219 offset:6144
    v_mfma_f32_16x16x32_bf16 a[56:59], v[44:47], v[168:171], 0
    v_mfma_f32_16x16x32_bf16 a[60:63], v[44:47], v[172:175], 0
    v_mfma_f32_16x16x32_bf16 a[64:67], v[48:51], v[160:163], 0
    v_mfma_f32_16x16x32_bf16 a[68:71], v[48:51], v[164:167], 0
    v_mfma_f32_16x16x32_bf16 a[72:75], v[48:51], v[168:171], 0
    v_mfma_f32_16x16x32_bf16 a[76:79], v[48:51], v[172:175], 0
    v_mfma_f32_16x16x32_bf16 a[80:83], v[52:55], v[160:163], 0
    v_mfma_f32_16x16x32_bf16 a[84:87], v[52:55], v[164:167], 0
    v_mfma_f32_16x16x32_bf16 a[88:91], v[52:55], v[168:171], 0
    v_mfma_f32_16x16x32_bf16 a[92:95], v[52:55], v[172:175], 0
    v_mfma_f32_16x16x32_bf16 a[96:99], v[56:59], v[160:163], 0
    v_mfma_f32_16x16x32_bf16 a[100:103], v[56:59], v[164:167], 0
    v_mfma_f32_16x16x32_bf16 a[104:107], v[56:59], v[168:171], 0
    v_mfma_f32_16x16x32_bf16 a[108:111], v[56:59], v[172:175], 0
    v_mfma_f32_16x16x32_bf16 a[112:115], v[60:63], v[160:163], 0
    v_mfma_f32_16x16x32_bf16 a[116:119], v[60:63], v[164:167], 0
    v_mfma_f32_16x16x32_bf16 a[120:123], v[60:63], v[168:171], 0
    v_mfma_f32_16x16x32_bf16 a[124:127], v[60:63], v[172:175], 0
    s_waitcnt vmcnt(21) lgkmcnt(0)
    v_mfma_f32_16x16x32_bf16 a[0:3], v[64:67], v[176:179], a[0:3]
    v_mfma_f32_16x16x32_bf16 a[4:7], v[64:67], v[180:183], a[4:7]
    v_mfma_f32_16x16x32_bf16 a[8:11], v[64:67], v[184:187], a[8:11]
    v_mfma_f32_16x16x32_bf16 a[12:15], v[64:67], v[188:191], a[12:15]
    v_mfma_f32_16x16x32_bf16 a[16:19], v[68:71], v[176:179], a[16:19]
    ds_read_b64_tr_b16 v[160:161], v216 offset:8192
    v_mfma_f32_16x16x32_bf16 a[20:23], v[68:71], v[180:183], a[20:23]
    ds_read_b64_tr_b16 v[162:163], v216 offset:10240
    v_mfma_f32_16x16x32_bf16 a[24:27], v[68:71], v[184:187], a[24:27]
    ds_read_b64_tr_b16 v[164:165], v217 offset:8192
    v_mfma_f32_16x16x32_bf16 a[28:31], v[68:71], v[188:191], a[28:31]
    v_mfma_f32_16x16x32_bf16 a[32:35], v[72:75], v[176:179], a[32:35]
    ds_read_b64_tr_b16 v[166:167], v217 offset:10240
    v_mfma_f32_16x16x32_bf16 a[36:39], v[72:75], v[180:183], a[36:39]
    ds_read_b64_tr_b16 v[168:169], v218 offset:8192
    v_mfma_f32_16x16x32_bf16 a[40:43], v[72:75], v[184:187], a[40:43]
    ds_read_b64_tr_b16 v[170:171], v218 offset:10240
    v_mfma_f32_16x16x32_bf16 a[44:47], v[72:75], v[188:191], a[44:47]
    v_mfma_f32_16x16x32_bf16 a[48:51], v[76:79], v[176:179], a[48:51]
    ds_read_b64_tr_b16 v[172:173], v219 offset:8192
    v_mfma_f32_16x16x32_bf16 a[52:55], v[76:79], v[180:183], a[52:55]
    ds_read_b64_tr_b16 v[174:175], v219 offset:10240
    v_mfma_f32_16x16x32_bf16 a[56:59], v[76:79], v[184:187], a[56:59]
    v_mfma_f32_16x16x32_bf16 a[60:63], v[76:79], v[188:191], a[60:63]
    v_mfma_f32_16x16x32_bf16 a[64:67], v[80:83], v[176:179], a[64:67]
    v_mfma_f32_16x16x32_bf16 a[68:71], v[80:83], v[180:183], a[68:71]
    v_mfma_f32_16x16x32_bf16 a[72:75], v[80:83], v[184:187], a[72:75]
    v_mfma_f32_16x16x32_bf16 a[76:79], v[80:83], v[188:191], a[76:79]
    v_mfma_f32_16x16x32_bf16 a[80:83], v[84:87], v[176:179], a[80:83]
    v_mfma_f32_16x16x32_bf16 a[84:87], v[84:87], v[180:183], a[84:87]
    v_mfma_f32_16x16x32_bf16 a[88:91], v[84:87], v[184:187], a[88:91]
    v_mfma_f32_16x16x32_bf16 a[92:95], v[84:87], v[188:191], a[92:95]
    v_mfma_f32_16x16x32_bf16 a[96:99], v[88:91], v[176:179], a[96:99]
    v_mfma_f32_16x16x32_bf16 a[100:103], v[88:91], v[180:183], a[100:103]
    v_mfma_f32_16x16x32_bf16 a[104:107], v[88:91], v[184:187], a[104:107]
    v_mfma_f32_16x16x32_bf16 a[108:111], v[88:91], v[188:191], a[108:111]
    v_mfma_f32_16x16x32_bf16 a[112:115], v[92:95], v[176:179], a[112:115]
    v_mfma_f32_16x16x32_bf16 a[116:119], v[92:95], v[180:183], a[116:119]
    v_mfma_f32_16x16x32_bf16 a[120:123], v[92:95], v[184:187], a[120:123]
    v_mfma_f32_16x16x32_bf16 a[124:127], v[92:95], v[188:191], a[124:127]
    s_waitcnt vmcnt(17) lgkmcnt(0)
    v_mfma_f32_16x16x32_bf16 a[0:3], v[96:99], v[160:163], a[0:3]
    v_mfma_f32_16x16x32_bf16 a[4:7], v[96:99], v[164:167], a[4:7]
    v_mfma_f32_16x16x32_bf16 a[8:11], v[96:99], v[168:171], a[8:11]
    v_mfma_f32_16x16x32_bf16 a[12:15], v[96:99], v[172:175], a[12:15]
    v_mfma_f32_16x16x32_bf16 a[16:19], v[100:103], v[160:163], a[16:19]
    ds_read_b64_tr_b16 v[176:177], v216 offset:12288
    v_mfma_f32_16x16x32_bf16 a[20:23], v[100:103], v[164:167], a[20:23]
    ds_read_b64_tr_b16 v[178:179], v216 offset:14336
    v_mfma_f32_16x16x32_bf16 a[24:27], v[100:103], v[168:171], a[24:27]
    ds_read_b64_tr_b16 v[180:181], v217 offset:12288
    v_mfma_f32_16x16x32_bf16 a[28:31], v[100:103], v[172:175], a[28:31]
    v_mfma_f32_16x16x32_bf16 a[32:35], v[104:107], v[160:163], a[32:35]
    ds_read_b64_tr_b16 v[182:183], v217 offset:14336
    v_mfma_f32_16x16x32_bf16 a[36:39], v[104:107], v[164:167], a[36:39]
    ds_read_b64_tr_b16 v[184:185], v218 offset:12288
    v_mfma_f32_16x16x32_bf16 a[40:43], v[104:107], v[168:171], a[40:43]
    ds_read_b64_tr_b16 v[186:187], v218 offset:14336
    v_mfma_f32_16x16x32_bf16 a[44:47], v[104:107], v[172:175], a[44:47]
    v_mfma_f32_16x16x32_bf16 a[48:51], v[108:111], v[160:163], a[48:51]
    ds_read_b64_tr_b16 v[188:189], v219 offset:12288
    v_mfma_f32_16x16x32_bf16 a[52:55], v[108:111], v[164:167], a[52:55]
    ds_read_b64_tr_b16 v[190:191], v219 offset:14336
    v_mfma_f32_16x16x32_bf16 a[56:59], v[108:111], v[168:171], a[56:59]
    v_mfma_f32_16x16x32_bf16 a[60:63], v[108:111], v[172:175], a[60:63]
    v_mfma_f32_16x16x32_bf16 a[64:67], v[112:115], v[160:163], a[64:67]
    v_mfma_f32_16x16x32_bf16 a[68:71], v[112:115], v[164:167], a[68:71]
    v_mfma_f32_16x16x32_bf16 a[72:75], v[112:115], v[168:171], a[72:75]
    v_mfma_f32_16x16x32_bf16 a[76:79], v[112:115], v[172:175], a[76:79]
    v_mfma_f32_16x16x32_bf16 a[80:83], v[116:119], v[160:163], a[80:83]
    v_mfma_f32_16x16x32_bf16 a[84:87], v[116:119], v[164:167], a[84:87]
    v_mfma_f32_16x16x32_bf16 a[88:91], v[116:119], v[168:171], a[88:91]
    v_mfma_f32_16x16x32_bf16 a[92:95], v[116:119], v[172:175], a[92:95]
    v_mfma_f32_16x16x32_bf16 a[96:99], v[120:123], v[160:163], a[96:99]
    v_mfma_f32_16x16x32_bf16 a[100:103], v[120:123], v[164:167], a[100:103]
    v_mfma_f32_16x16x32_bf16 a[104:107], v[120:123], v[168:171], a[104:107]
    v_mfma_f32_16x16x32_bf16 a[108:111], v[120:123], v[172:175], a[108:111]
    v_mfma_f32_16x16x32_bf16 a[112:115], v[124:127], v[160:163], a[112:115]
    v_mfma_f32_16x16x32_bf16 a[116:119], v[124:127], v[164:167], a[116:119]
    v_mfma_f32_16x16x32_bf16 a[120:123], v[124:127], v[168:171], a[120:123]
    v_mfma_f32_16x16x32_bf16 a[124:127], v[124:127], v[172:175], a[124:127]
    s_waitcnt vmcnt(13) lgkmcnt(0)
    v_mfma_f32_16x16x32_bf16 a[0:3], v[128:131], v[176:179], a[0:3]
    v_mfma_f32_16x16x32_bf16 a[4:7], v[128:131], v[180:183], a[4:7]
    v_mfma_f32_16x16x32_bf16 a[8:11], v[128:131], v[184:187], a[8:11]
    v_mfma_f32_16x16x32_bf16 a[12:15], v[128:131], v[188:191], a[12:15]
    v_mfma_f32_16x16x32_bf16 a[16:19], v[132:135], v[176:179], a[16:19]
    ds_read_b64_tr_b16 v[160:161], v216 offset:16384
    v_mfma_f32_16x16x32_bf16 a[20:23], v[132:135], v[180:183], a[20:23]
    ds_read_b64_tr_b16 v[162:163], v216 offset:18432
    v_mfma_f32_16x16x32_bf16 a[24:27], v[132:135], v[184:187], a[24:27]
    ds_read_b64_tr_b16 v[164:165], v217 offset:16384
    v_mfma_f32_16x16x32_bf16 a[28:31], v[132:135], v[188:191], a[28:31]
    v_mfma_f32_16x16x32_bf16 a[32:35], v[136:139], v[176:179], a[32:35]
    ds_read_b64_tr_b16 v[166:167], v217 offset:18432
    v_mfma_f32_16x16x32_bf16 a[36:39], v[136:139], v[180:183], a[36:39]
    ds_read_b64_tr_b16 v[168:169], v218 offset:16384
    v_mfma_f32_16x16x32_bf16 a[40:43], v[136:139], v[184:187], a[40:43]
    ds_read_b64_tr_b16 v[170:171], v218 offset:18432
    v_mfma_f32_16x16x32_bf16 a[44:47], v[136:139], v[188:191], a[44:47]
    v_mfma_f32_16x16x32_bf16 a[48:51], v[140:143], v[176:179], a[48:51]
    ds_read_b64_tr_b16 v[172:173], v219 offset:16384
    v_mfma_f32_16x16x32_bf16 a[52:55], v[140:143], v[180:183], a[52:55]
    ds_read_b64_tr_b16 v[174:175], v219 offset:18432
    v_mfma_f32_16x16x32_bf16 a[56:59], v[140:143], v[184:187], a[56:59]
    v_mfma_f32_16x16x32_bf16 a[60:63], v[140:143], v[188:191], a[60:63]
    v_mfma_f32_16x16x32_bf16 a[64:67], v[144:147], v[176:179], a[64:67]
    v_mfma_f32_16x16x32_bf16 a[68:71], v[144:147], v[180:183], a[68:71]
    v_mfma_f32_16x16x32_bf16 a[72:75], v[144:147], v[184:187], a[72:75]
    v_mfma_f32_16x16x32_bf16 a[76:79], v[144:147], v[188:191], a[76:79]
    v_mfma_f32_16x16x32_bf16 a[80:83], v[148:151], v[176:179], a[80:83]
    v_mfma_f32_16x16x32_bf16 a[84:87], v[148:151], v[180:183], a[84:87]
    v_mfma_f32_16x16x32_bf16 a[88:91], v[148:151], v[184:187], a[88:91]
    v_mfma_f32_16x16x32_bf16 a[92:95], v[148:151], v[188:191], a[92:95]
    v_mfma_f32_16x16x32_bf16 a[96:99], v[152:155], v[176:179], a[96:99]
    v_mfma_f32_16x16x32_bf16 a[100:103], v[152:155], v[180:183], a[100:103]
    v_mfma_f32_16x16x32_bf16 a[104:107], v[152:155], v[184:187], a[104:107]
    v_mfma_f32_16x16x32_bf16 a[108:111], v[152:155], v[188:191], a[108:111]
    v_mfma_f32_16x16x32_bf16 a[112:115], v[156:159], v[176:179], a[112:115]
    v_mfma_f32_16x16x32_bf16 a[116:119], v[156:159], v[180:183], a[116:119]
    v_mfma_f32_16x16x32_bf16 a[120:123], v[156:159], v[184:187], a[120:123]
    v_mfma_f32_16x16x32_bf16 a[124:127], v[156:159], v[188:191], a[124:127]
    s_waitcnt vmcnt(8) lgkmcnt(0)
    v_mfma_f32_16x16x32_bf16 a[0:3], a[128:131], v[160:163], a[0:3]
    v_mfma_f32_16x16x32_bf16 a[4:7], a[128:131], v[164:167], a[4:7]
    v_mfma_f32_16x16x32_bf16 a[8:11], a[128:131], v[168:171], a[8:11]
    v_mfma_f32_16x16x32_bf16 a[12:15], a[128:131], v[172:175], a[12:15]
    v_mfma_f32_16x16x32_bf16 a[16:19], a[132:135], v[160:163], a[16:19]
    ds_read_b64_tr_b16 v[176:177], v216 offset:20480
    v_mfma_f32_16x16x32_bf16 a[20:23], a[132:135], v[164:167], a[20:23]
    ds_read_b64_tr_b16 v[178:179], v216 offset:22528
    v_mfma_f32_16x16x32_bf16 a[24:27], a[132:135], v[168:171], a[24:27]
    ds_read_b64_tr_b16 v[180:181], v217 offset:20480
    v_mfma_f32_16x16x32_bf16 a[28:31], a[132:135], v[172:175], a[28:31]
    v_mfma_f32_16x16x32_bf16 a[32:35], a[136:139], v[160:163], a[32:35]
    ds_read_b64_tr_b16 v[182:183], v217 offset:22528
    v_mfma_f32_16x16x32_bf16 a[36:39], a[136:139], v[164:167], a[36:39]
    ds_read_b64_tr_b16 v[184:185], v218 offset:20480
    v_mfma_f32_16x16x32_bf16 a[40:43], a[136:139], v[168:171], a[40:43]
    ds_read_b64_tr_b16 v[186:187], v218 offset:22528
    v_mfma_f32_16x16x32_bf16 a[44:47], a[136:139], v[172:175], a[44:47]
    v_mfma_f32_16x16x32_bf16 a[48:51], a[140:143], v[160:163], a[48:51]
    ds_read_b64_tr_b16 v[188:189], v219 offset:20480
    v_mfma_f32_16x16x32_bf16 a[52:55], a[140:143], v[164:167], a[52:55]
    ds_read_b64_tr_b16 v[190:191], v219 offset:22528
    v_mfma_f32_16x16x32_bf16 a[56:59], a[140:143], v[168:171], a[56:59]
    v_mfma_f32_16x16x32_bf16 a[60:63], a[140:143], v[172:175], a[60:63]
    v_mfma_f32_16x16x32_bf16 a[64:67], a[144:147], v[160:163], a[64:67]
    v_mfma_f32_16x16x32_bf16 a[68:71], a[144:147], v[164:167], a[68:71]
    v_mfma_f32_16x16x32_bf16 a[72:75], a[144:147], v[168:171], a[72:75]
    v_mfma_f32_16x16x32_bf16 a[76:79], a[144:147], v[172:175], a[76:79]
    v_mfma_f32_16x16x32_bf16 a[80:83], a[148:151], v[160:163], a[80:83]
    v_mfma_f32_16x16x32_bf16 a[84:87], a[148:151], v[164:167], a[84:87]
    v_mfma_f32_16x16x32_bf16 a[88:91], a[148:151], v[168:171], a[88:91]
    v_mfma_f32_16x16x32_bf16 a[92:95], a[148:151], v[172:175], a[92:95]
    v_mfma_f32_16x16x32_bf16 a[96:99], a[152:155], v[160:163], a[96:99]
    v_mfma_f32_16x16x32_bf16 a[100:103], a[152:155], v[164:167], a[100:103]
    v_mfma_f32_16x16x32_bf16 a[104:107], a[152:155], v[168:171], a[104:107]
    v_mfma_f32_16x16x32_bf16 a[108:111], a[152:155], v[172:175], a[108:111]
    v_mfma_f32_16x16x32_bf16 a[112:115], a[156:159], v[160:163], a[112:115]
    v_mfma_f32_16x16x32_bf16 a[116:119], a[156:159], v[164:167], a[116:119]
    v_mfma_f32_16x16x32_bf16 a[120:123], a[156:159], v[168:171], a[120:123]
    v_mfma_f32_16x16x32_bf16 a[124:127], a[156:159], v[172:175], a[124:127]
    s_waitcnt vmcnt(4) lgkmcnt(0)
    v_mfma_f32_16x16x32_bf16 a[0:3], a[160:163], v[176:179], a[0:3]
    v_mfma_f32_16x16x32_bf16 a[4:7], a[160:163], v[180:183], a[4:7]
    v_mfma_f32_16x16x32_bf16 a[8:11], a[160:163], v[184:187], a[8:11]
    v_mfma_f32_16x16x32_bf16 a[12:15], a[160:163], v[188:191], a[12:15]
    v_mfma_f32_16x16x32_bf16 a[16:19], a[164:167], v[176:179], a[16:19]
    ds_read_b64_tr_b16 v[160:161], v216 offset:24576
    v_mfma_f32_16x16x32_bf16 a[20:23], a[164:167], v[180:183], a[20:23]
    ds_read_b64_tr_b16 v[162:163], v216 offset:26624
    v_mfma_f32_16x16x32_bf16 a[24:27], a[164:167], v[184:187], a[24:27]
    ds_read_b64_tr_b16 v[164:165], v217 offset:24576
    v_mfma_f32_16x16x32_bf16 a[28:31], a[164:167], v[188:191], a[28:31]
    v_mfma_f32_16x16x32_bf16 a[32:35], a[168:171], v[176:179], a[32:35]
    ds_read_b64_tr_b16 v[166:167], v217 offset:26624
    v_mfma_f32_16x16x32_bf16 a[36:39], a[168:171], v[180:183], a[36:39]
    ds_read_b64_tr_b16 v[168:169], v218 offset:24576
    v_mfma_f32_16x16x32_bf16 a[40:43], a[168:171], v[184:187], a[40:43]
    ds_read_b64_tr_b16 v[170:171], v218 offset:26624
    v_mfma_f32_16x16x32_bf16 a[44:47], a[168:171], v[188:191], a[44:47]
    v_mfma_f32_16x16x32_bf16 a[48:51], a[172:175], v[176:179], a[48:51]
    ds_read_b64_tr_b16 v[172:173], v219 offset:24576
    v_mfma_f32_16x16x32_bf16 a[52:55], a[172:175], v[180:183], a[52:55]
    ds_read_b64_tr_b16 v[174:175], v219 offset:26624
    v_mfma_f32_16x16x32_bf16 a[56:59], a[172:175], v[184:187], a[56:59]
    v_mfma_f32_16x16x32_bf16 a[60:63], a[172:175], v[188:191], a[60:63]
    v_mfma_f32_16x16x32_bf16 a[64:67], a[176:179], v[176:179], a[64:67]
    v_mfma_f32_16x16x32_bf16 a[68:71], a[176:179], v[180:183], a[68:71]
    v_mfma_f32_16x16x32_bf16 a[72:75], a[176:179], v[184:187], a[72:75]
    v_mfma_f32_16x16x32_bf16 a[76:79], a[176:179], v[188:191], a[76:79]
    v_mfma_f32_16x16x32_bf16 a[80:83], a[180:183], v[176:179], a[80:83]
    v_mfma_f32_16x16x32_bf16 a[84:87], a[180:183], v[180:183], a[84:87]
    v_mfma_f32_16x16x32_bf16 a[88:91], a[180:183], v[184:187], a[88:91]
    v_mfma_f32_16x16x32_bf16 a[92:95], a[180:183], v[188:191], a[92:95]
    v_mfma_f32_16x16x32_bf16 a[96:99], a[184:187], v[176:179], a[96:99]
    v_mfma_f32_16x16x32_bf16 a[100:103], a[184:187], v[180:183], a[100:103]
    v_mfma_f32_16x16x32_bf16 a[104:107], a[184:187], v[184:187], a[104:107]
    v_mfma_f32_16x16x32_bf16 a[108:111], a[184:187], v[188:191], a[108:111]
    v_mfma_f32_16x16x32_bf16 a[112:115], a[188:191], v[176:179], a[112:115]
    v_mfma_f32_16x16x32_bf16 a[116:119], a[188:191], v[180:183], a[116:119]
    v_mfma_f32_16x16x32_bf16 a[120:123], a[188:191], v[184:187], a[120:123]
    v_mfma_f32_16x16x32_bf16 a[124:127], a[188:191], v[188:191], a[124:127]
    s_waitcnt vmcnt(0) lgkmcnt(0)
    v_mfma_f32_16x16x32_bf16 a[0:3], a[192:195], v[160:163], a[0:3]
    v_mfma_f32_16x16x32_bf16 a[4:7], a[192:195], v[164:167], a[4:7]
    v_mfma_f32_16x16x32_bf16 a[8:11], a[192:195], v[168:171], a[8:11]
    v_mfma_f32_16x16x32_bf16 a[12:15], a[192:195], v[172:175], a[12:15]
    v_mfma_f32_16x16x32_bf16 a[16:19], a[196:199], v[160:163], a[16:19]
    ds_read_b64_tr_b16 v[176:177], v216 offset:28672
    v_mfma_f32_16x16x32_bf16 a[20:23], a[196:199], v[164:167], a[20:23]
    ds_read_b64_tr_b16 v[178:179], v216 offset:30720
    v_mfma_f32_16x16x32_bf16 a[24:27], a[196:199], v[168:171], a[24:27]
    ds_read_b64_tr_b16 v[180:181], v217 offset:28672
    v_mfma_f32_16x16x32_bf16 a[28:31], a[196:199], v[172:175], a[28:31]
    v_mfma_f32_16x16x32_bf16 a[32:35], a[200:203], v[160:163], a[32:35]
    ds_read_b64_tr_b16 v[182:183], v217 offset:30720
    v_mfma_f32_16x16x32_bf16 a[36:39], a[200:203], v[164:167], a[36:39]
    ds_read_b64_tr_b16 v[184:185], v218 offset:28672
    v_mfma_f32_16x16x32_bf16 a[40:43], a[200:203], v[168:171], a[40:43]
    ds_read_b64_tr_b16 v[186:187], v218 offset:30720
    v_mfma_f32_16x16x32_bf16 a[44:47], a[200:203], v[172:175], a[44:47]
    v_mfma_f32_16x16x32_bf16 a[48:51], a[204:207], v[160:163], a[48:51]
    ds_read_b64_tr_b16 v[188:189], v219 offset:28672
    v_mfma_f32_16x16x32_bf16 a[52:55], a[204:207], v[164:167], a[52:55]
    ds_read_b64_tr_b16 v[190:191], v219 offset:30720
    v_mfma_f32_16x16x32_bf16 a[56:59], a[204:207], v[168:171], a[56:59]
    v_mfma_f32_16x16x32_bf16 a[60:63], a[204:207], v[172:175], a[60:63]
    v_mfma_f32_16x16x32_bf16 a[64:67], a[208:211], v[160:163], a[64:67]
    v_mfma_f32_16x16x32_bf16 a[68:71], a[208:211], v[164:167], a[68:71]
    v_mfma_f32_16x16x32_bf16 a[72:75], a[208:211], v[168:171], a[72:75]
    v_mfma_f32_16x16x32_bf16 a[76:79], a[208:211], v[172:175], a[76:79]
    v_mfma_f32_16x16x32_bf16 a[80:83], a[212:215], v[160:163], a[80:83]
    v_mfma_f32_16x16x32_bf16 a[84:87], a[212:215], v[164:167], a[84:87]
    v_mfma_f32_16x16x32_bf16 a[88:91], a[212:215], v[168:171], a[88:91]
    v_mfma_f32_16x16x32_bf16 a[92:95], a[212:215], v[172:175], a[92:95]
    v_mfma_f32_16x16x32_bf16 a[96:99], a[216:219], v[160:163], a[96:99]
    v_mfma_f32_16x16x32_bf16 a[100:103], a[216:219], v[164:167], a[100:103]
    v_mfma_f32_16x16x32_bf16 a[104:107], a[216:219], v[168:171], a[104:107]
    v_mfma_f32_16x16x32_bf16 a[108:111], a[216:219], v[172:175], a[108:111]
    v_mfma_f32_16x16x32_bf16 a[112:115], a[220:223], v[160:163], a[112:115]
    v_mfma_f32_16x16x32_bf16 a[116:119], a[220:223], v[164:167], a[116:119]
    v_mfma_f32_16x16x32_bf16 a[120:123], a[220:223], v[168:171], a[120:123]
    v_mfma_f32_16x16x32_bf16 a[124:127], a[220:223], v[172:175], a[124:127]
    s_waitcnt vmcnt(0) lgkmcnt(0)
    v_mfma_f32_16x16x32_bf16 a[0:3], a[224:227], v[176:179], a[0:3]
    v_mfma_f32_16x16x32_bf16 a[4:7], a[224:227], v[180:183], a[4:7]
    v_mfma_f32_16x16x32_bf16 a[8:11], a[224:227], v[184:187], a[8:11]
    v_mfma_f32_16x16x32_bf16 a[12:15], a[224:227], v[188:191], a[12:15]
    v_mfma_f32_16x16x32_bf16 a[16:19], a[228:231], v[176:179], a[16:19]
    v_mfma_f32_16x16x32_bf16 a[20:23], a[228:231], v[180:183], a[20:23]
    v_mfma_f32_16x16x32_bf16 a[24:27], a[228:231], v[184:187], a[24:27]
    v_mfma_f32_16x16x32_bf16 a[28:31], a[228:231], v[188:191], a[28:31]
    v_mfma_f32_16x16x32_bf16 a[32:35], a[232:235], v[176:179], a[32:35]
    v_mfma_f32_16x16x32_bf16 a[36:39], a[232:235], v[180:183], a[36:39]
    v_mfma_f32_16x16x32_bf16 a[40:43], a[232:235], v[184:187], a[40:43]
    v_mfma_f32_16x16x32_bf16 a[44:47], a[232:235], v[188:191], a[44:47]
    v_mfma_f32_16x16x32_bf16 a[48:51], a[236:239], v[176:179], a[48:51]
    v_mfma_f32_16x16x32_bf16 a[52:55], a[236:239], v[180:183], a[52:55]
    v_mfma_f32_16x16x32_bf16 a[56:59], a[236:239], v[184:187], a[56:59]
    v_mfma_f32_16x16x32_bf16 a[60:63], a[236:239], v[188:191], a[60:63]
    v_mfma_f32_16x16x32_bf16 a[64:67], a[240:243], v[176:179], a[64:67]
    v_mfma_f32_16x16x32_bf16 a[68:71], a[240:243], v[180:183], a[68:71]
    v_mfma_f32_16x16x32_bf16 a[72:75], a[240:243], v[184:187], a[72:75]
    v_mfma_f32_16x16x32_bf16 a[76:79], a[240:243], v[188:191], a[76:79]
    v_mfma_f32_16x16x32_bf16 a[80:83], a[244:247], v[176:179], a[80:83]
    v_mfma_f32_16x16x32_bf16 a[84:87], a[244:247], v[180:183], a[84:87]
    v_mfma_f32_16x16x32_bf16 a[88:91], a[244:247], v[184:187], a[88:91]
    v_mfma_f32_16x16x32_bf16 a[92:95], a[244:247], v[188:191], a[92:95]
    v_mfma_f32_16x16x32_bf16 a[96:99], a[248:251], v[176:179], a[96:99]
    v_mfma_f32_16x16x32_bf16 a[100:103], a[248:251], v[180:183], a[100:103]
    v_mfma_f32_16x16x32_bf16 a[104:107], a[248:251], v[184:187], a[104:107]
    v_mfma_f32_16x16x32_bf16 a[108:111], a[248:251], v[188:191], a[108:111]
    v_mfma_f32_16x16x32_bf16 a[112:115], a[252:255], v[176:179], a[112:115]
    v_mfma_f32_16x16x32_bf16 a[116:119], a[252:255], v[180:183], a[116:119]
    v_mfma_f32_16x16x32_bf16 a[120:123], a[252:255], v[184:187], a[120:123]
    v_mfma_f32_16x16x32_bf16 a[124:127], a[252:255], v[188:191], a[124:127]
    s_branch L_kv0Vr
L_kv0V:
    buffer_load_dwordx4 v[32:35], v208, s[8:11], s16 offen offset:0 sc1
    buffer_load_dwordx4 v[36:39], v208, s[8:11], s16 offen offset:256 sc1
    buffer_load_dwordx4 v[40:43], v209, s[8:11], s16 offen offset:0 sc1
    buffer_load_dwordx4 v[44:47], v209, s[8:11], s16 offen offset:256 sc1
    buffer_load_dwordx4 v[48:51], v210, s[8:11], s16 offen offset:0 sc1
    buffer_load_dwordx4 v[52:55], v210, s[8:11], s16 offen offset:256 sc1
    buffer_load_dwordx4 v[56:59], v211, s[8:11], s16 offen offset:0 sc1
    buffer_load_dwordx4 v[60:63], v211, s[8:11], s16 offen offset:256 sc1
    s_add_u32 s16, s16, 16384
    buffer_load_dwordx4 v[64:67], v208, s[8:11], s16 offen offset:0 sc1
    buffer_load_dwordx4 v[68:71], v208, s[8:11], s16 offen offset:256 sc1
    buffer_load_dwordx4 v[72:75], v209, s[8:11], s16 offen offset:0 sc1
    buffer_load_dwordx4 v[76:79], v209, s[8:11], s16 offen offset:256 sc1
    buffer_load_dwordx4 v[80:83], v210, s[8:11], s16 offen offset:0 sc1
    buffer_load_dwordx4 v[84:87], v210, s[8:11], s16 offen offset:256 sc1
    buffer_load_dwordx4 v[88:91], v211, s[8:11], s16 offen offset:0 sc1
    buffer_load_dwordx4 v[92:95], v211, s[8:11], s16 offen offset:256 sc1
    s_add_u32 s16, s16, 16384
    buffer_load_dwordx4 v[96:99], v208, s[8:11], s16 offen offset:0 sc1
    buffer_load_dwordx4 v[100:103], v208, s[8:11], s16 offen offset:256 sc1
    buffer_load_dwordx4 v[104:107], v209, s[8:11], s16 offen offset:0 sc1
    buffer_load_dwordx4 v[108:111], v209, s[8:11], s16 offen offset:256 sc1
    buffer_load_dwordx4 v[112:115], v210, s[8:11], s16 offen offset:0 sc1
    buffer_load_dwordx4 v[116:119], v210, s[8:11], s16 offen offset:256 sc1
    buffer_load_dwordx4 v[120:123], v211, s[8:11], s16 offen offset:0 sc1
    buffer_load_dwordx4 v[124:127], v211, s[8:11], s16 offen offset:256 sc1
    s_add_u32 s16, s16, 16384
    s_waitcnt vmcnt(16)
    ds_read_b64_tr_b16 v[160:161], v216 offset:0
    ds_read_b64_tr_b16 v[162:163], v216 offset:2048
    ds_read_b64_tr_b16 v[164:165], v217 offset:0
    ds_read_b64_tr_b16 v[166:167], v217 offset:2048
    ds_read_b64_tr_b16 v[168:169], v218 offset:0
    ds_read_b64_tr_b16 v[170:171], v218 offset:2048
    ds_read_b64_tr_b16 v[172:173], v219 offset:0
    ds_read_b64_tr_b16 v[174:175], v219 offset:2048
    s_waitcnt vmcnt(16) lgkmcnt(0)
    v_mfma_f32_16x16x32_bf16 a[0:3], v[32:35], v[160:163], 0
    v_mfma_f32_16x16x32_bf16 a[4:7], v[32:35], v[164:167], 0
    v_mfma_f32_16x16x32_bf16 a[8:11], v[32:35], v[168:171], 0
    v_mfma_f32_16x16x32_bf16 a[12:15], v[32:35], v[172:175], 0
    buffer_load_dwordx4 v[128:131], v208, s[8:11], s16 offen offset:0 sc1
    v_mfma_f32_16x16x32_bf16 a[16:19], v[36:39], v[160:163], 0
    ds_read_b64_tr_b16 v[176:177], v216 offset:4096
    v_mfma_f32_16x16x32_bf16 a[20:23], v[36:39], v[164:167], 0
    ds_read_b64_tr_b16 v[178:179], v216 offset:6144
    v_mfma_f32_16x16x32_bf16 a[24:27], v[36:39], v[168:171], 0
    ds_read_b64_tr_b16 v[180:181], v217 offset:4096
    v_mfma_f32_16x16x32_bf16 a[28:31], v[36:39], v[172:175], 0
    buffer_load_dwordx4 v[132:135], v208, s[8:11], s16 offen offset:256 sc1
    v_mfma_f32_16x16x32_bf16 a[32:35], v[40:43], v[160:163], 0
    ds_read_b64_tr_b16 v[182:183], v217 offset:6144
    v_mfma_f32_16x16x32_bf16 a[36:39], v[40:43], v[164:167], 0
    ds_read_b64_tr_b16 v[184:185], v218 offset:4096
    v_mfma_f32_16x16x32_bf16 a[40:43], v[40:43], v[168:171], 0
    ds_read_b64_tr_b16 v[186:187], v218 offset:6144
    v_mfma_f32_16x16x32_bf16 a[44:47], v[40:43], v[172:175], 0
    buffer_load_dwordx4 v[136:139], v209, s[8:11], s16 offen offset:0 sc1
    v_mfma_f32_16x16x32_bf16 a[48:51], v[44:47], v[160:163], 0
    ds_read_b64_tr_b16 v[188:189], v219 offset:4096
    v_mfma_f32_16x16x32_bf16 a[52:55], v[44:47], v[164:167], 0
    ds_read_b64_tr_b16 v[190:191], v219 offset:6144
    v_mfma_f32_16x16x32_bf16 a[56:59], v[44:47], v[168:171], 0
    v_mfma_f32_16x16x32_bf16 a[60:63], v[44:47], v[172:175], 0
    buffer_load_dwordx4 v[140:143], v209, s[8:11], s16 offen offset:256 sc1
    v_mfma_f32_16x16x32_bf16 a[64:67], v[48:51], v[160:163], 0
    v_mfma_f32_16x16x32_bf16 a[68:71], v[48:51], v[164:167], 0
    v_mfma_f32_16x16x32_bf16 a[72:75], v[48:51], v[168:171], 0
    v_mfma_f32_16x16x32_bf16 a[76:79], v[48:51], v[172:175], 0
    buffer_load_dwordx4 v[144:147], v210, s[8:11], s16 offen offset:0 sc1
    v_mfma_f32_16x16x32_bf16 a[80:83], v[52:55], v[160:163], 0
    v_mfma_f32_16x16x32_bf16 a[84:87], v[52:55], v[164:167], 0
    v_mfma_f32_16x16x32_bf16 a[88:91], v[52:55], v[168:171], 0
    v_mfma_f32_16x16x32_bf16 a[92:95], v[52:55], v[172:175], 0
    buffer_load_dwordx4 v[148:151], v210, s[8:11], s16 offen offset:256 sc1
    v_mfma_f32_16x16x32_bf16 a[96:99], v[56:59], v[160:163], 0
    v_mfma_f32_16x16x32_bf16 a[100:103], v[56:59], v[164:167], 0
    v_mfma_f32_16x16x32_bf16 a[104:107], v[56:59], v[168:171], 0
    v_mfma_f32_16x16x32_bf16 a[108:111], v[56:59], v[172:175], 0
    buffer_load_dwordx4 v[152:155], v211, s[8:11], s16 offen offset:0 sc1
    v_mfma_f32_16x16x32_bf16 a[112:115], v[60:63], v[160:163], 0
    v_mfma_f32_16x16x32_bf16 a[116:119], v[60:63], v[164:167], 0
    v_mfma_f32_16x16x32_bf16 a[120:123], v[60:63], v[168:171], 0
    v_mfma_f32_16x16x32_bf16 a[124:127], v[60:63], v[172:175], 0
    buffer_load_dwordx4 v[156:159], v211, s[8:11], s16 offen offset:256 sc1
    s_add_u32 s16, s16, 16384
    s_waitcnt vmcnt(16) lgkmcnt(0)
    v_mfma_f32_16x16x32_bf16 a[0:3], v[64:67], v[176:179], a[0:3]
    v_mfma_f32_16x16x32_bf16 a[4:7], v[64:67], v[180:183], a[4:7]
    v_mfma_f32_16x16x32_bf16 a[8:11], v[64:67], v[184:187], a[8:11]
    v_mfma_f32_16x16x32_bf16 a[12:15], v[64:67], v[188:191], a[12:15]
    buffer_load_dwordx4 a[128:131], v208, s[8:11], s16 offen offset:0 sc1
    v_mfma_f32_16x16x32_bf16 a[16:19], v[68:71], v[176:179], a[16:19]
    ds_read_b64_tr_b16 v[160:161], v216 offset:8192
    v_mfma_f32_16x16x32_bf16 a[20:23], v[68:71], v[180:183], a[20:23]
    ds_read_b64_tr_b16 v[162:163], v216 offset:10240
    v_mfma_f32_16x16x32_bf16 a[24:27], v[68:71], v[184:187], a[24:27]
    ds_read_b64_tr_b16 v[164:165], v217 offset:8192
    v_mfma_f32_16x16x32_bf16 a[28:31], v[68:71], v[188:191], a[28:31]
    buffer_load_dwordx4 a[132:135], v208, s[8:11], s16 offen offset:256 sc1
    v_mfma_f32_16x16x32_bf16 a[32:35], v[72:75], v[176:179], a[32:35]
    ds_read_b64_tr_b16 v[166:167], v217 offset:10240
    v_mfma_f32_16x16x32_bf16 a[36:39], v[72:75], v[180:183], a[36:39]
    ds_read_b64_tr_b16 v[168:169], v218 offset:8192
    v_mfma_f32_16x16x32_bf16 a[40:43], v[72:75], v[184:187], a[40:43]
    ds_read_b64_tr_b16 v[170:171], v218 offset:10240
    v_mfma_f32_16x16x32_bf16 a[44:47], v[72:75], v[188:191], a[44:47]
    buffer_load_dwordx4 a[136:139], v209, s[8:11], s16 offen offset:0 sc1
    v_mfma_f32_16x16x32_bf16 a[48:51], v[76:79], v[176:179], a[48:51]
    ds_read_b64_tr_b16 v[172:173], v219 offset:8192
    v_mfma_f32_16x16x32_bf16 a[52:55], v[76:79], v[180:183], a[52:55]
    ds_read_b64_tr_b16 v[174:175], v219 offset:10240
    v_mfma_f32_16x16x32_bf16 a[56:59], v[76:79], v[184:187], a[56:59]
    v_mfma_f32_16x16x32_bf16 a[60:63], v[76:79], v[188:191], a[60:63]
    buffer_load_dwordx4 a[140:143], v209, s[8:11], s16 offen offset:256 sc1
    v_mfma_f32_16x16x32_bf16 a[64:67], v[80:83], v[176:179], a[64:67]
    v_mfma_f32_16x16x32_bf16 a[68:71], v[80:83], v[180:183], a[68:71]
    v_mfma_f32_16x16x32_bf16 a[72:75], v[80:83], v[184:187], a[72:75]
    v_mfma_f32_16x16x32_bf16 a[76:79], v[80:83], v[188:191], a[76:79]
    buffer_load_dwordx4 a[144:147], v210, s[8:11], s16 offen offset:0 sc1
    v_mfma_f32_16x16x32_bf16 a[80:83], v[84:87], v[176:179], a[80:83]
    v_mfma_f32_16x16x32_bf16 a[84:87], v[84:87], v[180:183], a[84:87]
    v_mfma_f32_16x16x32_bf16 a[88:91], v[84:87], v[184:187], a[88:91]
    v_mfma_f32_16x16x32_bf16 a[92:95], v[84:87], v[188:191], a[92:95]
    buffer_load_dwordx4 a[148:151], v210, s[8:11], s16 offen offset:256 sc1
    v_mfma_f32_16x16x32_bf16 a[96:99], v[88:91], v[176:179], a[96:99]
    v_mfma_f32_16x16x32_bf16 a[100:103], v[88:91], v[180:183], a[100:103]
    v_mfma_f32_16x16x32_bf16 a[104:107], v[88:91], v[184:187], a[104:107]
    v_mfma_f32_16x16x32_bf16 a[108:111], v[88:91], v[188:191], a[108:111]
    buffer_load_dwordx4 a[152:155], v211, s[8:11], s16 offen offset:0 sc1
    v_mfma_f32_16x16x32_bf16 a[112:115], v[92:95], v[176:179], a[112:115]
    v_mfma_f32_16x16x32_bf16 a[116:119], v[92:95], v[180:183], a[116:119]
    v_mfma_f32_16x16x32_bf16 a[120:123], v[92:95], v[184:187], a[120:123]
    v_mfma_f32_16x16x32_bf16 a[124:127], v[92:95], v[188:191], a[124:127]
    buffer_load_dwordx4 a[156:159], v211, s[8:11], s16 offen offset:256 sc1
    s_add_u32 s16, s16, 16384
    s_waitcnt vmcnt(16) lgkmcnt(0)
    v_mfma_f32_16x16x32_bf16 a[0:3], v[96:99], v[160:163], a[0:3]
    v_mfma_f32_16x16x32_bf16 a[4:7], v[96:99], v[164:167], a[4:7]
    v_mfma_f32_16x16x32_bf16 a[8:11], v[96:99], v[168:171], a[8:11]
    v_mfma_f32_16x16x32_bf16 a[12:15], v[96:99], v[172:175], a[12:15]
    buffer_load_dwordx4 a[160:163], v208, s[8:11], s16 offen offset:0 sc1
    v_mfma_f32_16x16x32_bf16 a[16:19], v[100:103], v[160:163], a[16:19]
    ds_read_b64_tr_b16 v[176:177], v216 offset:12288
    v_mfma_f32_16x16x32_bf16 a[20:23], v[100:103], v[164:167], a[20:23]
    ds_read_b64_tr_b16 v[178:179], v216 offset:14336
    v_mfma_f32_16x16x32_bf16 a[24:27], v[100:103], v[168:171], a[24:27]
    ds_read_b64_tr_b16 v[180:181], v217 offset:12288
    v_mfma_f32_16x16x32_bf16 a[28:31], v[100:103], v[172:175], a[28:31]
    buffer_load_dwordx4 a[164:167], v208, s[8:11], s16 offen offset:256 sc1
    v_mfma_f32_16x16x32_bf16 a[32:35], v[104:107], v[160:163], a[32:35]
    ds_read_b64_tr_b16 v[182:183], v217 offset:14336
    v_mfma_f32_16x16x32_bf16 a[36:39], v[104:107], v[164:167], a[36:39]
    ds_read_b64_tr_b16 v[184:185], v218 offset:12288
    v_mfma_f32_16x16x32_bf16 a[40:43], v[104:107], v[168:171], a[40:43]
    ds_read_b64_tr_b16 v[186:187], v218 offset:14336
    v_mfma_f32_16x16x32_bf16 a[44:47], v[104:107], v[172:175], a[44:47]
    buffer_load_dwordx4 a[168:171], v209, s[8:11], s16 offen offset:0 sc1
    v_mfma_f32_16x16x32_bf16 a[48:51], v[108:111], v[160:163], a[48:51]
    ds_read_b64_tr_b16 v[188:189], v219 offset:12288
    v_mfma_f32_16x16x32_bf16 a[52:55], v[108:111], v[164:167], a[52:55]
    ds_read_b64_tr_b16 v[190:191], v219 offset:14336
    v_mfma_f32_16x16x32_bf16 a[56:59], v[108:111], v[168:171], a[56:59]
    v_mfma_f32_16x16x32_bf16 a[60:63], v[108:111], v[172:175], a[60:63]
    buffer_load_dwordx4 a[172:175], v209, s[8:11], s16 offen offset:256 sc1
    v_mfma_f32_16x16x32_bf16 a[64:67], v[112:115], v[160:163], a[64:67]
    v_mfma_f32_16x16x32_bf16 a[68:71], v[112:115], v[164:167], a[68:71]
    v_mfma_f32_16x16x32_bf16 a[72:75], v[112:115], v[168:171], a[72:75]
    v_mfma_f32_16x16x32_bf16 a[76:79], v[112:115], v[172:175], a[76:79]
    buffer_load_dwordx4 a[176:179], v210, s[8:11], s16 offen offset:0 sc1
    v_mfma_f32_16x16x32_bf16 a[80:83], v[116:119], v[160:163], a[80:83]
    v_mfma_f32_16x16x32_bf16 a[84:87], v[116:119], v[164:167], a[84:87]
    v_mfma_f32_16x16x32_bf16 a[88:91], v[116:119], v[168:171], a[88:91]
    v_mfma_f32_16x16x32_bf16 a[92:95], v[116:119], v[172:175], a[92:95]
    buffer_load_dwordx4 a[180:183], v210, s[8:11], s16 offen offset:256 sc1
    v_mfma_f32_16x16x32_bf16 a[96:99], v[120:123], v[160:163], a[96:99]
    v_mfma_f32_16x16x32_bf16 a[100:103], v[120:123], v[164:167], a[100:103]
    v_mfma_f32_16x16x32_bf16 a[104:107], v[120:123], v[168:171], a[104:107]
    v_mfma_f32_16x16x32_bf16 a[108:111], v[120:123], v[172:175], a[108:111]
    buffer_load_dwordx4 a[184:187], v211, s[8:11], s16 offen offset:0 sc1
    v_mfma_f32_16x16x32_bf16 a[112:115], v[124:127], v[160:163], a[112:115]
    v_mfma_f32_16x16x32_bf16 a[116:119], v[124:127], v[164:167], a[116:119]
    v_mfma_f32_16x16x32_bf16 a[120:123], v[124:127], v[168:171], a[120:123]
    v_mfma_f32_16x16x32_bf16 a[124:127], v[124:127], v[172:175], a[124:127]
    buffer_load_dwordx4 a[188:191], v211, s[8:11], s16 offen offset:256 sc1
    s_add_u32 s16, s16, 16384
    s_waitcnt vmcnt(16) lgkmcnt(0)
    v_mfma_f32_16x16x32_bf16 a[0:3], v[128:131], v[176:179], a[0:3]
    v_mfma_f32_16x16x32_bf16 a[4:7], v[128:131], v[180:183], a[4:7]
    v_mfma_f32_16x16x32_bf16 a[8:11], v[128:131], v[184:187], a[8:11]
    v_mfma_f32_16x16x32_bf16 a[12:15], v[128:131], v[188:191], a[12:15]
    buffer_load_dwordx4 a[192:195], v208, s[8:11], s16 offen offset:0 sc1
    v_mfma_f32_16x16x32_bf16 a[16:19], v[132:135], v[176:179], a[16:19]
    ds_read_b64_tr_b16 v[160:161], v216 offset:16384
    v_mfma_f32_16x16x32_bf16 a[20:23], v[132:135], v[180:183], a[20:23]
    ds_read_b64_tr_b16 v[162:163], v216 offset:18432
    v_mfma_f32_16x16x32_bf16 a[24:27], v[132:135], v[184:187], a[24:27]
    ds_read_b64_tr_b16 v[164:165], v217 offset:16384
    v_mfma_f32_16x16x32_bf16 a[28:31], v[132:135], v[188:191], a[28:31]
    buffer_load_dwordx4 a[196:199], v208, s[8:11], s16 offen offset:256 sc1
    v_mfma_f32_16x16x32_bf16 a[32:35], v[136:139], v[176:179], a[32:35]
    ds_read_b64_tr_b16 v[166:167], v217 offset:18432
    v_mfma_f32_16x16x32_bf16 a[36:39], v[136:139], v[180:183], a[36:39]
    ds_read_b64_tr_b16 v[168:169], v218 offset:16384
    v_mfma_f32_16x16x32_bf16 a[40:43], v[136:139], v[184:187], a[40:43]
    ds_read_b64_tr_b16 v[170:171], v218 offset:18432
    v_mfma_f32_16x16x32_bf16 a[44:47], v[136:139], v[188:191], a[44:47]
    buffer_load_dwordx4 a[200:203], v209, s[8:11], s16 offen offset:0 sc1
    v_mfma_f32_16x16x32_bf16 a[48:51], v[140:143], v[176:179], a[48:51]
    ds_read_b64_tr_b16 v[172:173], v219 offset:16384
    v_mfma_f32_16x16x32_bf16 a[52:55], v[140:143], v[180:183], a[52:55]
    ds_read_b64_tr_b16 v[174:175], v219 offset:18432
    v_mfma_f32_16x16x32_bf16 a[56:59], v[140:143], v[184:187], a[56:59]
    v_mfma_f32_16x16x32_bf16 a[60:63], v[140:143], v[188:191], a[60:63]
    buffer_load_dwordx4 a[204:207], v209, s[8:11], s16 offen offset:256 sc1
    v_mfma_f32_16x16x32_bf16 a[64:67], v[144:147], v[176:179], a[64:67]
    v_mfma_f32_16x16x32_bf16 a[68:71], v[144:147], v[180:183], a[68:71]
    v_mfma_f32_16x16x32_bf16 a[72:75], v[144:147], v[184:187], a[72:75]
    v_mfma_f32_16x16x32_bf16 a[76:79], v[144:147], v[188:191], a[76:79]
    buffer_load_dwordx4 a[208:211], v210, s[8:11], s16 offen offset:0 sc1
    v_mfma_f32_16x16x32_bf16 a[80:83], v[148:151], v[176:179], a[80:83]
    v_mfma_f32_16x16x32_bf16 a[84:87], v[148:151], v[180:183], a[84:87]
    v_mfma_f32_16x16x32_bf16 a[88:91], v[148:151], v[184:187], a[88:91]
    v_mfma_f32_16x16x32_bf16 a[92:95], v[148:151], v[188:191], a[92:95]
    buffer_load_dwordx4 a[212:215], v210, s[8:11], s16 offen offset:256 sc1
    v_mfma_f32_16x16x32_bf16 a[96:99], v[152:155], v[176:179], a[96:99]
    v_mfma_f32_16x16x32_bf16 a[100:103], v[152:155], v[180:183], a[100:103]
    v_mfma_f32_16x16x32_bf16 a[104:107], v[152:155], v[184:187], a[104:107]
    v_mfma_f32_16x16x32_bf16 a[108:111], v[152:155], v[188:191], a[108:111]
    buffer_load_dwordx4 a[216:219], v211, s[8:11], s16 offen offset:0 sc1
    v_mfma_f32_16x16x32_bf16 a[112:115], v[156:159], v[176:179], a[112:115]
    v_mfma_f32_16x16x32_bf16 a[116:119], v[156:159], v[180:183], a[116:119]
    v_mfma_f32_16x16x32_bf16 a[120:123], v[156:159], v[184:187], a[120:123]
    v_mfma_f32_16x16x32_bf16 a[124:127], v[156:159], v[188:191], a[124:127]
    buffer_load_dwordx4 a[220:223], v211, s[8:11], s16 offen offset:256 sc1
    s_add_u32 s16, s16, 16384
    s_waitcnt vmcnt(16) lgkmcnt(0)
    v_mfma_f32_16x16x32_bf16 a[0:3], a[128:131], v[160:163], a[0:3]
    v_mfma_f32_16x16x32_bf16 a[4:7], a[128:131], v[164:167], a[4:7]
    v_mfma_f32_16x16x32_bf16 a[8:11], a[128:131], v[168:171], a[8:11]
    v_mfma_f32_16x16x32_bf16 a[12:15], a[128:131], v[172:175], a[12:15]
    buffer_load_dwordx4 a[224:227], v208, s[8:11], s16 offen offset:0 sc1
    v_mfma_f32_16x16x32_bf16 a[16:19], a[132:135], v[160:163], a[16:19]
    ds_read_b64_tr_b16 v[176:177], v216 offset:20480
    v_mfma_f32_16x16x32_bf16 a[20:23], a[132:135], v[164:167], a[20:23]
    ds_read_b64_tr_b16 v[178:179], v216 offset:22528
    v_mfma_f32_16x16x32_bf16 a[24:27], a[132:135], v[168:171], a[24:27]
    ds_read_b64_tr_b16 v[180:181], v217 offset:20480
    v_mfma_f32_16x16x32_bf16 a[28:31], a[132:135], v[172:175], a[28:31]
    buffer_load_dwordx4 a[228:231], v208, s[8:11], s16 offen offset:256 sc1
    v_mfma_f32_16x16x32_bf16 a[32:35], a[136:139], v[160:163], a[32:35]
    ds_read_b64_tr_b16 v[182:183], v217 offset:22528
    v_mfma_f32_16x16x32_bf16 a[36:39], a[136:139], v[164:167], a[36:39]
    ds_read_b64_tr_b16 v[184:185], v218 offset:20480
    v_mfma_f32_16x16x32_bf16 a[40:43], a[136:139], v[168:171], a[40:43]
    ds_read_b64_tr_b16 v[186:187], v218 offset:22528
    v_mfma_f32_16x16x32_bf16 a[44:47], a[136:139], v[172:175], a[44:47]
    buffer_load_dwordx4 a[232:235], v209, s[8:11], s16 offen offset:0 sc1
    v_mfma_f32_16x16x32_bf16 a[48:51], a[140:143], v[160:163], a[48:51]
    ds_read_b64_tr_b16 v[188:189], v219 offset:20480
    v_mfma_f32_16x16x32_bf16 a[52:55], a[140:143], v[164:167], a[52:55]
    ds_read_b64_tr_b16 v[190:191], v219 offset:22528
    v_mfma_f32_16x16x32_bf16 a[56:59], a[140:143], v[168:171], a[56:59]
    v_mfma_f32_16x16x32_bf16 a[60:63], a[140:143], v[172:175], a[60:63]
    buffer_load_dwordx4 a[236:239], v209, s[8:11], s16 offen offset:256 sc1
    v_mfma_f32_16x16x32_bf16 a[64:67], a[144:147], v[160:163], a[64:67]
    v_mfma_f32_16x16x32_bf16 a[68:71], a[144:147], v[164:167], a[68:71]
    v_mfma_f32_16x16x32_bf16 a[72:75], a[144:147], v[168:171], a[72:75]
    v_mfma_f32_16x16x32_bf16 a[76:79], a[144:147], v[172:175], a[76:79]
    buffer_load_dwordx4 a[240:243], v210, s[8:11], s16 offen offset:0 sc1
    v_mfma_f32_16x16x32_bf16 a[80:83], a[148:151], v[160:163], a[80:83]
    v_mfma_f32_16x16x32_bf16 a[84:87], a[148:151], v[164:167], a[84:87]
    v_mfma_f32_16x16x32_bf16 a[88:91], a[148:151], v[168:171], a[88:91]
    v_mfma_f32_16x16x32_bf16 a[92:95], a[148:151], v[172:175], a[92:95]
    buffer_load_dwordx4 a[244:247], v210, s[8:11], s16 offen offset:256 sc1
    v_mfma_f32_16x16x32_bf16 a[96:99], a[152:155], v[160:163], a[96:99]
    v_mfma_f32_16x16x32_bf16 a[100:103], a[152:155], v[164:167], a[100:103]
    v_mfma_f32_16x16x32_bf16 a[104:107], a[152:155], v[168:171], a[104:107]
    v_mfma_f32_16x16x32_bf16 a[108:111], a[152:155], v[172:175], a[108:111]
    buffer_load_dwordx4 a[248:251], v211, s[8:11], s16 offen offset:0 sc1
    v_mfma_f32_16x16x32_bf16 a[112:115], a[156:159], v[160:163], a[112:115]
    v_mfma_f32_16x16x32_bf16 a[116:119], a[156:159], v[164:167], a[116:119]
    v_mfma_f32_16x16x32_bf16 a[120:123], a[156:159], v[168:171], a[120:123]
    v_mfma_f32_16x16x32_bf16 a[124:127], a[156:159], v[172:175], a[124:127]
    buffer_load_dwordx4 a[252:255], v211, s[8:11], s16 offen offset:256 sc1
    s_add_u32 s16, s16, 16384
    s_waitcnt vmcnt(16) lgkmcnt(0)
    v_mfma_f32_16x16x32_bf16 a[0:3], a[160:163], v[176:179], a[0:3]
    v_mfma_f32_16x16x32_bf16 a[4:7], a[160:163], v[180:183], a[4:7]
    v_mfma_f32_16x16x32_bf16 a[8:11], a[160:163], v[184:187], a[8:11]
    v_mfma_f32_16x16x32_bf16 a[12:15], a[160:163], v[188:191], a[12:15]
    v_mfma_f32_16x16x32_bf16 a[16:19], a[164:167], v[176:179], a[16:19]
    ds_read_b64_tr_b16 v[160:161], v216 offset:24576
    v_mfma_f32_16x16x32_bf16 a[20:23], a[164:167], v[180:183], a[20:23]
    ds_read_b64_tr_b16 v[162:163], v216 offset:26624
    v_mfma_f32_16x16x32_bf16 a[24:27], a[164:167], v[184:187], a[24:27]
    ds_read_b64_tr_b16 v[164:165], v217 offset:24576
    v_mfma_f32_16x16x32_bf16 a[28:31], a[164:167], v[188:191], a[28:31]
    v_mfma_f32_16x16x32_bf16 a[32:35], a[168:171], v[176:179], a[32:35]
    ds_read_b64_tr_b16 v[166:167], v217 offset:26624
    v_mfma_f32_16x16x32_bf16 a[36:39], a[168:171], v[180:183], a[36:39]
    ds_read_b64_tr_b16 v[168:169], v218 offset:24576
    v_mfma_f32_16x16x32_bf16 a[40:43], a[168:171], v[184:187], a[40:43]
    ds_read_b64_tr_b16 v[170:171], v218 offset:26624
    v_mfma_f32_16x16x32_bf16 a[44:47], a[168:171], v[188:191], a[44:47]
    v_mfma_f32_16x16x32_bf16 a[48:51], a[172:175], v[176:179], a[48:51]
    ds_read_b64_tr_b16 v[172:173], v219 offset:24576
    v_mfma_f32_16x16x32_bf16 a[52:55], a[172:175], v[180:183], a[52:55]
    ds_read_b64_tr_b16 v[174:175], v219 offset:26624
    v_mfma_f32_16x16x32_bf16 a[56:59], a[172:175], v[184:187], a[56:59]
    v_mfma_f32_16x16x32_bf16 a[60:63], a[172:175], v[188:191], a[60:63]
    v_mfma_f32_16x16x32_bf16 a[64:67], a[176:179], v[176:179], a[64:67]
    v_mfma_f32_16x16x32_bf16 a[68:71], a[176:179], v[180:183], a[68:71]
    v_mfma_f32_16x16x32_bf16 a[72:75], a[176:179], v[184:187], a[72:75]
    v_mfma_f32_16x16x32_bf16 a[76:79], a[176:179], v[188:191], a[76:79]
    v_mfma_f32_16x16x32_bf16 a[80:83], a[180:183], v[176:179], a[80:83]
    v_mfma_f32_16x16x32_bf16 a[84:87], a[180:183], v[180:183], a[84:87]
    v_mfma_f32_16x16x32_bf16 a[88:91], a[180:183], v[184:187], a[88:91]
    v_mfma_f32_16x16x32_bf16 a[92:95], a[180:183], v[188:191], a[92:95]
    v_mfma_f32_16x16x32_bf16 a[96:99], a[184:187], v[176:179], a[96:99]
    v_mfma_f32_16x16x32_bf16 a[100:103], a[184:187], v[180:183], a[100:103]
    v_mfma_f32_16x16x32_bf16 a[104:107], a[184:187], v[184:187], a[104:107]
    v_mfma_f32_16x16x32_bf16 a[108:111], a[184:187], v[188:191], a[108:111]
    v_mfma_f32_16x16x32_bf16 a[112:115], a[188:191], v[176:179], a[112:115]
    v_mfma_f32_16x16x32_bf16 a[116:119], a[188:191], v[180:183], a[116:119]
    v_mfma_f32_16x16x32_bf16 a[120:123], a[188:191], v[184:187], a[120:123]
    v_mfma_f32_16x16x32_bf16 a[124:127], a[188:191], v[188:191], a[124:127]
    s_waitcnt vmcnt(8) lgkmcnt(0)
    v_mfma_f32_16x16x32_bf16 a[0:3], a[192:195], v[160:163], a[0:3]
    v_mfma_f32_16x16x32_bf16 a[4:7], a[192:195], v[164:167], a[4:7]
    v_mfma_f32_16x16x32_bf16 a[8:11], a[192:195], v[168:171], a[8:11]
    v_mfma_f32_16x16x32_bf16 a[12:15], a[192:195], v[172:175], a[12:15]
    v_mfma_f32_16x16x32_bf16 a[16:19], a[196:199], v[160:163], a[16:19]
    ds_read_b64_tr_b16 v[176:177], v216 offset:28672
    v_mfma_f32_16x16x32_bf16 a[20:23], a[196:199], v[164:167], a[20:23]
    ds_read_b64_tr_b16 v[178:179], v216 offset:30720
    v_mfma_f32_16x16x32_bf16 a[24:27], a[196:199], v[168:171], a[24:27]
    ds_read_b64_tr_b16 v[180:181], v217 offset:28672
    v_mfma_f32_16x16x32_bf16 a[28:31], a[196:199], v[172:175], a[28:31]
    v_mfma_f32_16x16x32_bf16 a[32:35], a[200:203], v[160:163], a[32:35]
    ds_read_b64_tr_b16 v[182:183], v217 offset:30720
    v_mfma_f32_16x16x32_bf16 a[36:39], a[200:203], v[164:167], a[36:39]
    ds_read_b64_tr_b16 v[184:185], v218 offset:28672
    v_mfma_f32_16x16x32_bf16 a[40:43], a[200:203], v[168:171], a[40:43]
    ds_read_b64_tr_b16 v[186:187], v218 offset:30720
    v_mfma_f32_16x16x32_bf16 a[44:47], a[200:203], v[172:175], a[44:47]
    v_mfma_f32_16x16x32_bf16 a[48:51], a[204:207], v[160:163], a[48:51]
    ds_read_b64_tr_b16 v[188:189], v219 offset:28672
    v_mfma_f32_16x16x32_bf16 a[52:55], a[204:207], v[164:167], a[52:55]
    ds_read_b64_tr_b16 v[190:191], v219 offset:30720
    v_mfma_f32_16x16x32_bf16 a[56:59], a[204:207], v[168:171], a[56:59]
    v_mfma_f32_16x16x32_bf16 a[60:63], a[204:207], v[172:175], a[60:63]
    v_mfma_f32_16x16x32_bf16 a[64:67], a[208:211], v[160:163], a[64:67]
    v_mfma_f32_16x16x32_bf16 a[68:71], a[208:211], v[164:167], a[68:71]
    v_mfma_f32_16x16x32_bf16 a[72:75], a[208:211], v[168:171], a[72:75]
    v_mfma_f32_16x16x32_bf16 a[76:79], a[208:211], v[172:175], a[76:79]
    v_mfma_f32_16x16x32_bf16 a[80:83], a[212:215], v[160:163], a[80:83]
    v_mfma_f32_16x16x32_bf16 a[84:87], a[212:215], v[164:167], a[84:87]
    v_mfma_f32_16x16x32_bf16 a[88:91], a[212:215], v[168:171], a[88:91]
    v_mfma_f32_16x16x32_bf16 a[92:95], a[212:215], v[172:175], a[92:95]
    v_mfma_f32_16x16x32_bf16 a[96:99], a[216:219], v[160:163], a[96:99]
    v_mfma_f32_16x16x32_bf16 a[100:103], a[216:219], v[164:167], a[100:103]
    v_mfma_f32_16x16x32_bf16 a[104:107], a[216:219], v[168:171], a[104:107]
    v_mfma_f32_16x16x32_bf16 a[108:111], a[216:219], v[172:175], a[108:111]
    v_mfma_f32_16x16x32_bf16 a[112:115], a[220:223], v[160:163], a[112:115]
    v_mfma_f32_16x16x32_bf16 a[116:119], a[220:223], v[164:167], a[116:119]
    v_mfma_f32_16x16x32_bf16 a[120:123], a[220:223], v[168:171], a[120:123]
    v_mfma_f32_16x16x32_bf16 a[124:127], a[220:223], v[172:175], a[124:127]
    s_waitcnt vmcnt(0) lgkmcnt(0)
    v_mfma_f32_16x16x32_bf16 a[0:3], a[224:227], v[176:179], a[0:3]
    v_mfma_f32_16x16x32_bf16 a[4:7], a[224:227], v[180:183], a[4:7]
    v_mfma_f32_16x16x32_bf16 a[8:11], a[224:227], v[184:187], a[8:11]
    v_mfma_f32_16x16x32_bf16 a[12:15], a[224:227], v[188:191], a[12:15]
    v_mfma_f32_16x16x32_bf16 a[16:19], a[228:231], v[176:179], a[16:19]
    v_mfma_f32_16x16x32_bf16 a[20:23], a[228:231], v[180:183], a[20:23]
    v_mfma_f32_16x16x32_bf16 a[24:27], a[228:231], v[184:187], a[24:27]
    v_mfma_f32_16x16x32_bf16 a[28:31], a[228:231], v[188:191], a[28:31]
    v_mfma_f32_16x16x32_bf16 a[32:35], a[232:235], v[176:179], a[32:35]
    v_mfma_f32_16x16x32_bf16 a[36:39], a[232:235], v[180:183], a[36:39]
    v_mfma_f32_16x16x32_bf16 a[40:43], a[232:235], v[184:187], a[40:43]
    v_mfma_f32_16x16x32_bf16 a[44:47], a[232:235], v[188:191], a[44:47]
    v_mfma_f32_16x16x32_bf16 a[48:51], a[236:239], v[176:179], a[48:51]
    v_mfma_f32_16x16x32_bf16 a[52:55], a[236:239], v[180:183], a[52:55]
    v_mfma_f32_16x16x32_bf16 a[56:59], a[236:239], v[184:187], a[56:59]
    v_mfma_f32_16x16x32_bf16 a[60:63], a[236:239], v[188:191], a[60:63]
    v_mfma_f32_16x16x32_bf16 a[64:67], a[240:243], v[176:179], a[64:67]
    v_mfma_f32_16x16x32_bf16 a[68:71], a[240:243], v[180:183], a[68:71]
    v_mfma_f32_16x16x32_bf16 a[72:75], a[240:243], v[184:187], a[72:75]
    v_mfma_f32_16x16x32_bf16 a[76:79], a[240:243], v[188:191], a[76:79]
    v_mfma_f32_16x16x32_bf16 a[80:83], a[244:247], v[176:179], a[80:83]
    v_mfma_f32_16x16x32_bf16 a[84:87], a[244:247], v[180:183], a[84:87]
    v_mfma_f32_16x16x32_bf16 a[88:91], a[244:247], v[184:187], a[88:91]
    v_mfma_f32_16x16x32_bf16 a[92:95], a[244:247], v[188:191], a[92:95]
    v_mfma_f32_16x16x32_bf16 a[96:99], a[248:251], v[176:179], a[96:99]
    v_mfma_f32_16x16x32_bf16 a[100:103], a[248:251], v[180:183], a[100:103]
    v_mfma_f32_16x16x32_bf16 a[104:107], a[248:251], v[184:187], a[104:107]
    v_mfma_f32_16x16x32_bf16 a[108:111], a[248:251], v[188:191], a[108:111]
    v_mfma_f32_16x16x32_bf16 a[112:115], a[252:255], v[176:179], a[112:115]
    v_mfma_f32_16x16x32_bf16 a[116:119], a[252:255], v[180:183], a[116:119]
    v_mfma_f32_16x16x32_bf16 a[120:123], a[252:255], v[184:187], a[120:123]
    v_mfma_f32_16x16x32_bf16 a[124:127], a[252:255], v[188:191], a[124:127]
L_kv0Vr:
    v_mov_b32 v6, 176
    buffer_load_dword v7, v6, s[64:67], 0 offen sc1
    s_nop 7
    ds_write_b128 v220, a[32:35] offset:0
    ds_write_b128 v220, a[36:39] offset:1024
    ds_write_b128 v220, a[40:43] offset:2048
    ds_write_b128 v220, a[44:47] offset:3072
    ds_write_b128 v220, a[48:51] offset:4096
    ds_write_b128 v220, a[52:55] offset:5120
    ds_write_b128 v220, a[56:59] offset:6144
    ds_write_b128 v220, a[60:63] offset:7168
    ds_write_b128 v221, a[64:67] offset:0
    ds_write_b128 v221, a[68:71] offset:1024
    ds_write_b128 v221, a[72:75] offset:2048
    ds_write_b128 v221, a[76:79] offset:3072
    ds_write_b128 v221, a[80:83] offset:4096
    ds_write_b128 v221, a[84:87] offset:5120
    ds_write_b128 v221, a[88:91] offset:6144
    ds_write_b128 v221, a[92:95] offset:7168
    ds_write_b128 v222, a[96:99] offset:0
    ds_write_b128 v222, a[100:103] offset:1024
    ds_write_b128 v222, a[104:107] offset:2048
    ds_write_b128 v222, a[108:111] offset:3072
    ds_write_b128 v222, a[112:115] offset:4096
    ds_write_b128 v222, a[116:119] offset:5120
    ds_write_b128 v222, a[120:123] offset:6144
    ds_write_b128 v222, a[124:127] offset:7168
    v_accvgpr_read_b32 v160, a0
    v_accvgpr_read_b32 v161, a1
    v_accvgpr_read_b32 v162, a2
    v_accvgpr_read_b32 v163, a3
    v_accvgpr_read_b32 v164, a4
    v_accvgpr_read_b32 v165, a5
    v_accvgpr_read_b32 v166, a6
    v_accvgpr_read_b32 v167, a7
    v_accvgpr_read_b32 v168, a8
    v_accvgpr_read_b32 v169, a9
    v_accvgpr_read_b32 v170, a10
    v_accvgpr_read_b32 v171, a11
    v_accvgpr_read_b32 v172, a12
    v_accvgpr_read_b32 v173, a13
    v_accvgpr_read_b32 v174, a14
    v_accvgpr_read_b32 v175, a15
    v_accvgpr_read_b32 v176, a16
    v_accvgpr_read_b32 v177, a17
    v_accvgpr_read_b32 v178, a18
    v_accvgpr_read_b32 v179, a19
    v_accvgpr_read_b32 v180, a20
    v_accvgpr_read_b32 v181, a21
    v_accvgpr_read_b32 v182, a22
    v_accvgpr_read_b32 v183, a23
    v_accvgpr_read_b32 v184, a24
    v_accvgpr_read_b32 v185, a25
    v_accvgpr_read_b32 v186, a26
    v_accvgpr_read_b32 v187, a27
    v_accvgpr_read_b32 v188, a28
    v_accvgpr_read_b32 v189, a29
    v_accvgpr_read_b32 v190, a30
    v_accvgpr_read_b32 v191, a31
    s_waitcnt lgkmcnt(0)
    s_barrier
    ds_read_b128 v[192:195], v223 offset:0
    ds_read_b128 v[196:199], v223 offset:1024
    ds_read_b128 v[200:203], v223 offset:2048
    ds_read_b128 v[204:207], v223 offset:3072
    ds_read_b128 v[232:235], v223 offset:4096
    ds_read_b128 v[236:239], v223 offset:5120
    ds_read_b128 v[240:243], v223 offset:6144
    ds_read_b128 v[244:247], v223 offset:7168
    s_waitcnt lgkmcnt(4)
    v_pk_add_f32 v[160:161], v[160:161], v[192:193]
    v_pk_add_f32 v[162:163], v[162:163], v[194:195]
    v_pk_add_f32 v[164:165], v[164:165], v[196:197]
    v_pk_add_f32 v[166:167], v[166:167], v[198:199]
    v_pk_add_f32 v[168:169], v[168:169], v[200:201]
    v_pk_add_f32 v[170:171], v[170:171], v[202:203]
    v_pk_add_f32 v[172:173], v[172:173], v[204:205]
    v_pk_add_f32 v[174:175], v[174:175], v[206:207]
    ds_read_b128 v[192:195], v224 offset:0
    ds_read_b128 v[196:199], v224 offset:1024
    ds_read_b128 v[200:203], v224 offset:2048
    ds_read_b128 v[204:207], v224 offset:3072
    s_waitcnt lgkmcnt(4)
    v_pk_add_f32 v[176:177], v[176:177], v[232:233]
    v_pk_add_f32 v[178:179], v[178:179], v[234:235]
    v_pk_add_f32 v[180:181], v[180:181], v[236:237]
    v_pk_add_f32 v[182:183], v[182:183], v[238:239]
    v_pk_add_f32 v[184:185], v[184:185], v[240:241]
    v_pk_add_f32 v[186:187], v[186:187], v[242:243]
    v_pk_add_f32 v[188:189], v[188:189], v[244:245]
    v_pk_add_f32 v[190:191], v[190:191], v[246:247]
    ds_read_b128 v[232:235], v224 offset:4096
    ds_read_b128 v[236:239], v224 offset:5120
    ds_read_b128 v[240:243], v224 offset:6144
    ds_read_b128 v[244:247], v224 offset:7168
    s_waitcnt lgkmcnt(4)
    v_pk_add_f32 v[160:161], v[160:161], v[192:193]
    v_pk_add_f32 v[162:163], v[162:163], v[194:195]
    v_pk_add_f32 v[164:165], v[164:165], v[196:197]
    v_pk_add_f32 v[166:167], v[166:167], v[198:199]
    v_pk_add_f32 v[168:169], v[168:169], v[200:201]
    v_pk_add_f32 v[170:171], v[170:171], v[202:203]
    v_pk_add_f32 v[172:173], v[172:173], v[204:205]
    v_pk_add_f32 v[174:175], v[174:175], v[206:207]
    ds_read_b128 v[192:195], v225 offset:0
    ds_read_b128 v[196:199], v225 offset:1024
    ds_read_b128 v[200:203], v225 offset:2048
    ds_read_b128 v[204:207], v225 offset:3072
    s_waitcnt lgkmcnt(4)
    v_pk_add_f32 v[176:177], v[176:177], v[232:233]
    v_pk_add_f32 v[178:179], v[178:179], v[234:235]
    v_pk_add_f32 v[180:181], v[180:181], v[236:237]
    v_pk_add_f32 v[182:183], v[182:183], v[238:239]
    v_pk_add_f32 v[184:185], v[184:185], v[240:241]
    v_pk_add_f32 v[186:187], v[186:187], v[242:243]
    v_pk_add_f32 v[188:189], v[188:189], v[244:245]
    v_pk_add_f32 v[190:191], v[190:191], v[246:247]
    ds_read_b128 v[232:235], v225 offset:4096
    ds_read_b128 v[236:239], v225 offset:5120
    ds_read_b128 v[240:243], v225 offset:6144
    ds_read_b128 v[244:247], v225 offset:7168
    s_waitcnt lgkmcnt(4)
    v_pk_add_f32 v[160:161], v[160:161], v[192:193]
    v_pk_add_f32 v[162:163], v[162:163], v[194:195]
    v_pk_add_f32 v[164:165], v[164:165], v[196:197]
    v_pk_add_f32 v[166:167], v[166:167], v[198:199]
    v_pk_add_f32 v[168:169], v[168:169], v[200:201]
    v_pk_add_f32 v[170:171], v[170:171], v[202:203]
    v_pk_add_f32 v[172:173], v[172:173], v[204:205]
    v_pk_add_f32 v[174:175], v[174:175], v[206:207]
    s_waitcnt lgkmcnt(0)
    v_pk_add_f32 v[176:177], v[176:177], v[232:233]
    v_pk_add_f32 v[178:179], v[178:179], v[234:235]
    v_pk_add_f32 v[180:181], v[180:181], v[236:237]
    v_pk_add_f32 v[182:183], v[182:183], v[238:239]
    v_pk_add_f32 v[184:185], v[184:185], v[240:241]
    v_pk_add_f32 v[186:187], v[186:187], v[242:243]
    v_pk_add_f32 v[188:189], v[188:189], v[244:245]
    v_pk_add_f32 v[190:191], v[190:191], v[246:247]
Ll0_162:
    s_waitcnt vmcnt(0)
    v_cmp_le_u32 vcc, 16, v7
    s_cbranch_vccnz Ll0o_163
    s_sub_u32 s22, s22, 1
    s_cbranch_scc1 L_abort
    s_sleep 2
    buffer_load_dword v7, v6, s[64:67], 0 offen sc1
    s_branch Ll0_162
Ll0o_163:
    v_cvt_pk_bf16_f32 v192, v160, v161
    v_cvt_pk_bf16_f32 v193, v162, v163
    v_cvt_pk_bf16_f32 v194, v176, v177
    v_cvt_pk_bf16_f32 v195, v178, v179
    v_cvt_pk_bf16_f32 v196, v164, v165
    v_cvt_pk_bf16_f32 v197, v166, v167
    v_cvt_pk_bf16_f32 v198, v180, v181
    v_cvt_pk_bf16_f32 v199, v182, v183
    v_cvt_pk_bf16_f32 v200, v168, v169
    v_cvt_pk_bf16_f32 v201, v170, v171
    v_cvt_pk_bf16_f32 v202, v184, v185
    v_cvt_pk_bf16_f32 v203, v186, v187
    v_cvt_pk_bf16_f32 v204, v172, v173
    v_cvt_pk_bf16_f32 v205, v174, v175
    v_cvt_pk_bf16_f32 v206, v188, v189
    v_cvt_pk_bf16_f32 v207, v190, v191
    buffer_store_dwordx4 v[192:195], v230, s[8:11], s29 offen offset:0 sc1
    buffer_store_dwordx4 v[196:199], v230, s[8:11], s29 offen offset:256 sc1
    buffer_store_dwordx4 v[200:203], v230, s[8:11], s29 offen offset:512 sc1
    buffer_store_dwordx4 v[204:207], v230, s[8:11], s29 offen offset:768 sc1
L_kv0done:
    s_add_u32 s60, s60, 1
    s_cmp_ge_u32 s25, 16
    s_cbranch_scc1 L_kv0last
    s_cmp_ge_u32 s60, 3
    s_cbranch_scc1 L_kv0last
    s_mov_b32 s62, s40
    s_barrier
    s_lshl_b32 s4, s23, 5
    s_add_u32 s5, s4, s25
    s_mov_b32 s26, 0
    s_mov_b32 s40, 102773248
    s_cmp_eq_u32 s60, 0
    s_cbranch_scc1 Lk0_164
    s_add_u32 s5, s5, s25
    s_add_u32 s5, s5, s60
    s_sub_u32 s5, s5, 1
    s_mov_b32 s26, 1
    s_mov_b32 s40, 102760448
Lk0_164:
    s_and_b32 s27, s5, 63
    s_lshr_b32 s4, s23, 1
    s_lshl_b32 s4, s4, 3
    s_add_u32 s4, s4, 24
    s_load_dwordx2 s[12:13], s[0:1], s4
    s_mov_b32 s14, 8388608
    s_mov_b32 s15, 0x20000
    s_lshl_b32 s16, s3, 17
    s_lshl_b32 s4, s26, 11
    s_add_u32 s16, s16, s4
    s_add_u32 s16, s16, 0
    s_lshl_b32 s17, s3, 21
    s_lshl_b32 s4, s27, 7
    s_add_u32 s17, s17, s4
    s_lshl_b32 s41, s3, 15
    s_cmp_ge_u32 s23, 2
    s_cbranch_scc1 Lk0_165
    s_lshl_b32 s4, s27, 15
    s_lshl_b32 s5, s26, 11
    s_add_u32 s4, s4, s5
    s_lshl_b32 s5, s3, 9
    s_add_u32 s4, s4, s5
    s_add_u32 s29, s4, 4194304
    s_branch Lk0_166
Lk0_165:
    s_lshl_b32 s4, s26, 2
    s_add_u32 s4, s4, s3
    s_lshl_b32 s4, s4, 18
    s_lshl_b32 s5, s27, 10
    s_add_u32 s4, s4, s5
    s_add_u32 s29, s4, 20971520
Lk0_166:
    s_waitcnt lgkmcnt(0)
    s_add_u32 m0, s41, 0
    s_nop 0
    buffer_load_dwordx4 v212, s[12:15], s17 offen lds
    buffer_load_dwordx4 v213, s[12:15], s17 offen offset:1024 lds
    buffer_load_dwordx4 v214, s[12:15], s17 offen offset:2048 lds
    buffer_load_dwordx4 v215, s[12:15], s17 offen offset:3072 lds
    s_add_u32 s17, s17, 262144
    s_add_u32 m0, s41, 4096
    s_nop 0
    buffer_load_dwordx4 v212, s[12:15], s17 offen lds
    buffer_load_dwordx4 v213, s[12:15], s17 offen offset:1024 lds
    buffer_load_dwordx4 v214, s[12:15], s17 offen offset:2048 lds
    buffer_load_dwordx4 v215, s[12:15], s17 offen offset:3072 lds
    s_add_u32 s17, s17, 262144
    s_add_u32 m0, s41, 8192
    s_nop 0
    buffer_load_dwordx4 v212, s[12:15], s17 offen lds
    buffer_load_dwordx4 v213, s[12:15], s17 offen offset:1024 lds
    buffer_load_dwordx4 v214, s[12:15], s17 offen offset:2048 lds
    buffer_load_dwordx4 v215, s[12:15], s17 offen offset:3072 lds
    s_add_u32 s17, s17, 262144
    s_add_u32 m0, s41, 12288
    s_nop 0
    buffer_load_dwordx4 v212, s[12:15], s17 offen lds
    buffer_load_dwordx4 v213, s[12:15], s17 offen offset:1024 lds
    buffer_load_dwordx4 v214, s[12:15], s17 offen offset:2048 lds
    buffer_load_dwordx4 v215, s[12:15], s17 offen offset:3072 lds
    s_add_u32 s17, s17, 262144
    s_add_u32 m0, s41, 16384
    s_nop 0
    buffer_load_dwordx4 v212, s[12:15], s17 offen lds
    buffer_load_dwordx4 v213, s[12:15], s17 offen offset:1024 lds
    buffer_load_dwordx4 v214, s[12:15], s17 offen offset:2048 lds
    buffer_load_dwordx4 v215, s[12:15], s17 offen offset:3072 lds
    s_add_u32 s17, s17, 262144
    s_waitcnt vmcnt(20)
    s_barrier
    buffer_atomic_add v24, v23, s[8:11], s62 offen sc1
    s_add_u32 m0, s41, 20480
    s_nop 0
    buffer_load_dwordx4 v212, s[12:15], s17 offen lds
    buffer_load_dwordx4 v213, s[12:15], s17 offen offset:1024 lds
    buffer_load_dwordx4 v214, s[12:15], s17 offen offset:2048 lds
    buffer_load_dwordx4 v215, s[12:15], s17 offen offset:3072 lds
    s_add_u32 s17, s17, 262144
    s_add_u32 m0, s41, 24576
    s_nop 0
    buffer_load_dwordx4 v212, s[12:15], s17 offen lds
    buffer_load_dwordx4 v213, s[12:15], s17 offen offset:1024 lds
    buffer_load_dwordx4 v214, s[12:15], s17 offen offset:2048 lds
    buffer_load_dwordx4 v215, s[12:15], s17 offen offset:3072 lds
    s_add_u32 s17, s17, 262144
    s_add_u32 m0, s41, 28672
    s_nop 0
    buffer_load_dwordx4 v212, s[12:15], s17 offen lds
    buffer_load_dwordx4 v213, s[12:15], s17 offen offset:1024 lds
    buffer_load_dwordx4 v214, s[12:15], s17 offen offset:2048 lds
    buffer_load_dwordx4 v215, s[12:15], s17 offen offset:3072 lds
    s_add_u32 s17, s17, 262144
    s_branch L_kv0
L_kv0last:
    s_waitcnt vmcnt(0) lgkmcnt(0)
    s_barrier
    buffer_atomic_add v24, v23, s[8:11], s40 offen sc1
L_kv0end:
    s_cmp_lg_u32 s3, 0
    s_cbranch_scc1 Lwwo_168
    v_mov_b32 v1, 32
Lww_167:
    buffer_load_dword v2, v1, s[64:67], 0 offen sc1
    s_waitcnt vmcnt(0)
    v_cmp_le_u32 vcc, 128, v2
    s_cbranch_vccnz Lwwo_168
    s_sleep 8
    s_sub_u32 s22, s22, 1
    s_cbranch_scc0 Lww_167
    s_branch L_abort
Lwwo_168:
    s_barrier
L_e1start:
    s_lshr_b32 s6, s80, 8
    s_cmp_eq_u32 s6, 0
    s_cbranch_scc1 L_p2
    s_cmp_eq_u32 s6, 4
    s_cbranch_scc0 Lnd_169
    s_and_b32 s26, s80, 0xff
    s_mul_i32 s4, s26, 256
    s_add_u32 s4, s4, 102764544
    s_cmp_lg_u32 s3, 0
    s_cbranch_scc1 Lwwo_171
    v_mov_b32 v1, s4
Lww_170:
    buffer_load_dword v2, v1, s[8:11], 0 offen sc1
    s_waitcnt vmcnt(0)
    v_cmp_le_u32 vcc, 28, v2
    s_cbranch_vccnz Lwwo_171
    s_sleep 8
    s_sub_u32 s22, s22, 1
    s_cbranch_scc0 Lww_170
    s_branch L_abort
Lwwo_171:
    s_barrier
Lnd_169:
    s_lshr_b32 s6, s80, 8
    s_and_b32 s7, s80, 0xff
    s_mov_b32 s50, 268435456
    s_mov_b32 s63, 7
    s_cmp_eq_u32 s6, 2
    s_cbranch_scc1 Ldg_173
    s_cmp_eq_u32 s6, 4
    s_cbranch_scc1 Ldd_177
    s_cmp_eq_u32 s6, 3
    s_cbranch_scc1 Ldq_172
    s_lshr_b32 s30, s7, 3
    s_and_b32 s31, s7, 3
    s_lshl_b32 s4, s23, 2
    s_add_u32 s31, s31, s4
    s_add_u32 s4, s30, 0
    s_lshl_b32 s4, s4, 8
    s_add_u32 s43, s4, 102760448
    s_bitcmp1_b32 s7, 2
    s_cbranch_scc1 Ldv_174
    s_load_dwordx2 s[12:13], s[0:1], 24
    s_mov_b32 s61, 1
    s_lshl_b32 s4, s30, 21
    s_lshl_b32 s5, s31, 17
    s_add_u32 s4, s4, s5
    s_add_u32 s42, s4, 4194304
    s_branch Ldb_175
Ldv_174:
    s_load_dwordx2 s[12:13], s[0:1], 32
    s_mov_b32 s61, 2
    s_lshl_b32 s4, s30, 21
    s_lshl_b32 s5, s31, 12
    s_add_u32 s4, s4, s5
    s_add_u32 s42, s4, 20971520
    s_branch Ldb_175
Ldq_172:
    s_lshr_b32 s30, s7, 2
    s_and_b32 s31, s7, 3
    s_lshl_b32 s4, s23, 2
    s_add_u32 s31, s31, s4
    s_add_u32 s4, s30, 8
    s_lshl_b32 s4, s4, 8
    s_add_u32 s43, s4, 102760448
    s_load_dwordx2 s[12:13], s[0:1], 16
    s_mov_b32 s61, 3
    s_lshl_b32 s4, s30, 21
    s_lshl_b32 s5, s31, 17
    s_add_u32 s4, s4, s5
    s_add_u32 s42, s4, 37748736
Ldb_175:
    s_mov_b32 s14, 8388608
    s_mov_b32 s32, 8192
    s_lshl_b32 s17, s31, 9
    s_and_b32 s4, s3, 1
    s_lshl_b32 s4, s4, 8
    s_add_u32 s17, s17, s4
    s_lshl_b32 s16, s30, 19
    s_add_u32 s16, s16, 0
    s_branch Lde_176
Ldd_177:
    s_load_dwordx2 s[12:13], s[0:1], 80
    s_mov_b32 s14, 7340032
    s_mov_b32 s61, 5
    s_mov_b32 s63, 27
    s_add_u32 s4, s7, 24
    s_lshl_b32 s4, s4, 8
    s_add_u32 s43, s4, 102760448
    s_mov_b32 s32, 2048
    s_lshl_b32 s17, s23, 9
    s_and_b32 s4, s3, 1
    s_lshl_b32 s4, s4, 8
    s_add_u32 s17, s17, s4
    s_mul_i32 s16, s7, 1835008
    s_add_u32 s16, s16, 54525952
    s_lshl_b32 s4, s7, 19
    s_lshl_b32 s5, s23, 17
    s_add_u32 s4, s4, s5
    s_add_u32 s42, s4, 104857600
    s_branch Lde_176
Ldg_173:
    s_mul_i32 s5, s7, 9363
    s_lshr_b32 s30, s5, 16
    s_mul_i32 s5, s30, 7
    s_sub_u32 s4, s7, s5
    s_mul_i32 s31, s23, 7
    s_add_u32 s31, s31, s4
    s_add_u32 s4, s30, 16
    s_lshl_b32 s4, s4, 8
    s_add_u32 s43, s4, 102760448
    s_and_b32 s4, s3, 1
    s_lshl_b32 s4, s4, 3
    s_add_u32 s4, s4, 64
    s_load_dwordx2 s[12:13], s[0:1], s4
    s_mov_b32 s14, 7340032
    s_mov_b32 s61, 4
    s_mov_b32 s32, 7168
    s_lshl_b32 s17, s31, 8
    s_mul_i32 s4, s30, 1835008
    s_lshl_b32 s5, s31, 16
    s_add_u32 s4, s4, s5
    s_add_u32 s42, s4, 54525952
    s_lshl_b32 s16, s30, 19
    s_add_u32 s16, s16, 0
Lde_176:
    s_mov_b32 s15, 0x20000
    v_mul_u32_u24 v1, s32, v19
    s_lshl_b32 s4, s32, 2
    s_sub_u32 s4, s4, 1024
    v_add_u32 v204, v1, v20
    v_add3_u32 v205, v1, v21, s4
    s_lshl_b32 s5, s4, 1
    v_add3_u32 v206, v1, v20, s5
    s_add_u32 s5, s5, s4
    v_add3_u32 v207, v1, v21, s5
    s_lshl_b32 s18, s32, 5
    s_mov_b32 s80, s81
    s_mov_b32 s81, s82
    s_mov_b32 s82, s83
    s_mov_b32 s83, s84
    s_mov_b32 s84, s85
    s_mov_b32 s85, s86
    s_mov_b32 s86, s87
    s_mov_b32 s87, 0
    s_mov_b32 s40, 102772992
    s_waitcnt lgkmcnt(0)
    s_add_u32 m0, s19, 0
    s_nop 0
    buffer_load_dwordx4 v18, s[48:51], s16 offen sc1 lds
    buffer_load_dwordx4 v18, s[48:51], s16 offen offset:1024 sc1 lds
    buffer_load_dwordx4 v18, s[48:51], s16 offen offset:2048 sc1 lds
    buffer_load_dwordx4 v18, s[48:51], s16 offen offset:3072 sc1 lds
    s_add_u32 s16, s16, 16384
    s_add_u32 m0, s20, 0
    s_nop 0
    buffer_load_dwordx4 v204, s[12:15], s17 offen lds
    buffer_load_dwordx4 v205, s[12:15], s17 offen offset:1024 lds
    buffer_load_dwordx4 v206, s[12:15], s17 offen offset:2048 lds
    buffer_load_dwordx4 v207, s[12:15], s17 offen offset:3072 lds
    s_add_u32 s17, s17, s18
    s_add_u32 m0, s19, 32768
    s_nop 0
    buffer_load_dwordx4 v18, s[48:51], s16 offen sc1 lds
    buffer_load_dwordx4 v18, s[48:51], s16 offen offset:1024 sc1 lds
    buffer_load_dwordx4 v18, s[48:51], s16 offen offset:2048 sc1 lds
    buffer_load_dwordx4 v18, s[48:51], s16 offen offset:3072 sc1 lds
    s_add_u32 s16, s16, 16384
    s_add_u32 m0, s20, 32768
    s_nop 0
    buffer_load_dwordx4 v204, s[12:15], s17 offen lds
    buffer_load_dwordx4 v205, s[12:15], s17 offen offset:1024 lds
    buffer_load_dwordx4 v206, s[12:15], s17 offen offset:2048 lds
    buffer_load_dwordx4 v207, s[12:15], s17 offen offset:3072 lds
    s_add_u32 s17, s17, s18
    s_add_u32 m0, s19, 65536
    s_nop 0
    buffer_load_dwordx4 v18, s[48:51], s16 offen sc1 lds
    buffer_load_dwordx4 v18, s[48:51], s16 offen offset:1024 sc1 lds
    buffer_load_dwordx4 v18, s[48:51], s16 offen offset:2048 sc1 lds
    buffer_load_dwordx4 v18, s[48:51], s16 offen offset:3072 sc1 lds
    s_add_u32 s16, s16, 16384
    s_add_u32 m0, s20, 65536
    s_nop 0
    buffer_load_dwordx4 v204, s[12:15], s17 offen lds
    buffer_load_dwordx4 v205, s[12:15], s17 offen offset:1024 lds
    buffer_load_dwordx4 v206, s[12:15], s17 offen offset:2048 lds
    buffer_load_dwordx4 v207, s[12:15], s17 offen offset:3072 lds
    s_add_u32 s17, s17, s18
    s_add_u32 m0, s19, 98304
    s_nop 0
    buffer_load_dwordx4 v18, s[48:51], s16 offen sc1 lds
    buffer_load_dwordx4 v18, s[48:51], s16 offen offset:1024 sc1 lds
    buffer_load_dwordx4 v18, s[48:51], s16 offen offset:2048 sc1 lds
    buffer_load_dwordx4 v18, s[48:51], s16 offen offset:3072 sc1 lds
    s_add_u32 s16, s16, 16384
    s_add_u32 m0, s20, 98304
    s_nop 0
    buffer_load_dwordx4 v204, s[12:15], s17 offen lds
    buffer_load_dwordx4 v205, s[12:15], s17 offen offset:1024 lds
    buffer_load_dwordx4 v206, s[12:15], s17 offen offset:2048 lds
    buffer_load_dwordx4 v207, s[12:15], s17 offen offset:3072 lds
    s_add_u32 s17, s17, s18
    s_waitcnt vmcnt(24)
    s_barrier
    ds_read_b64_tr_b16 v[64:65], v10 offset:16384
    ds_read_b64_tr_b16 v[66:67], v10 offset:20480
    ds_read_b128 v[32:35], v8 offset:0
    ds_read_b128 v[36:39], v8 offset:256
    ds_read_b128 v[40:43], v8 offset:512
    ds_read_b128 v[44:47], v8 offset:768
    ds_read_b128 v[48:51], v8 offset:1024
    ds_read_b128 v[52:55], v8 offset:1280
    ds_read_b128 v[56:59], v8 offset:1536
    ds_read_b128 v[60:63], v8 offset:1792
    ds_read_b64_tr_b16 v[68:69], v11 offset:16384
    ds_read_b64_tr_b16 v[70:71], v11 offset:20480
    ds_read_b64_tr_b16 v[72:73], v12 offset:16384
    ds_read_b64_tr_b16 v[74:75], v12 offset:20480
    ds_read_b64_tr_b16 v[76:77], v13 offset:16384
    ds_read_b64_tr_b16 v[78:79], v13 offset:20480
    ds_read_b64_tr_b16 v[80:81], v10 offset:24576
    ds_read_b64_tr_b16 v[82:83], v10 offset:28672
    ds_read_b64_tr_b16 v[84:85], v11 offset:24576
    ds_read_b64_tr_b16 v[86:87], v11 offset:28672
    ds_read_b64_tr_b16 v[88:89], v12 offset:24576
    ds_read_b64_tr_b16 v[90:91], v12 offset:28672
    ds_read_b64_tr_b16 v[92:93], v13 offset:24576
    ds_read_b64_tr_b16 v[94:95], v13 offset:28672
    buffer_store_dword v24, v26, s[8:11], 0 offen
    buffer_store_dword v24, v26, s[8:11], 0 offen
    buffer_store_dword v24, v26, s[8:11], 0 offen
    buffer_store_dword v24, v26, s[8:11], 0 offen
    buffer_store_dword v24, v26, s[8:11], 0 offen
    buffer_store_dword v24, v26, s[8:11], 0 offen
    buffer_store_dword v24, v26, s[8:11], 0 offen
    buffer_store_dword v24, v26, s[8:11], 0 offen
    buffer_store_dword v24, v26, s[8:11], 0 offen
    buffer_store_dword v24, v26, s[8:11], 0 offen
    buffer_store_dword v24, v26, s[8:11], 0 offen
    buffer_store_dword v24, v26, s[8:11], 0 offen
    buffer_store_dword v24, v26, s[8:11], 0 offen
    buffer_store_dword v24, v26, s[8:11], 0 offen
    buffer_store_dword v24, v26, s[8:11], 0 offen
    buffer_store_dword v24, v26, s[8:11], 0 offen
    buffer_store_dword v24, v26, s[8:11], 0 offen
    buffer_store_dword v24, v26, s[8:11], 0 offen
    buffer_store_dword v24, v26, s[8:11], 0 offen
    buffer_store_dword v24, v26, s[8:11], 0 offen
    buffer_store_dword v24, v26, s[8:11], 0 offen
    buffer_store_dword v24, v26, s[8:11], 0 offen
    buffer_store_dword v24, v26, s[8:11], 0 offen
    buffer_store_dword v24, v26, s[8:11], 0 offen
    buffer_store_dword v24, v26, s[8:11], 0 offen
    buffer_store_dword v24, v26, s[8:11], 0 offen
    buffer_store_dword v24, v26, s[8:11], 0 offen
    buffer_store_dword v24, v26, s[8:11], 0 offen
    buffer_store_dword v24, v26, s[8:11], 0 offen
    buffer_store_dword v24, v26, s[8:11], 0 offen
    buffer_store_dword v24, v26, s[8:11], 0 offen
    buffer_store_dword v24, v26, s[8:11], 0 offen
    s_mov_b32 s62, 102772992
    s_mov_b32 s29, s42
    s_mov_b32 s40, s43
    s_mov_b32 s60, s61
    s_mov_b32 s21, s63
    s_cmp_eq_u32 s60, 2
    s_cbranch_scc1 L_f4S
    s_branch L_f4N
L_f4N:
    s_waitcnt vmcnt(48) lgkmcnt(0)
    s_barrier
    v_mfma_f32_16x16x32_bf16 a[0:3], v[64:67], v[32:35], 0
    ds_read_b64_tr_b16 v[128:129], v10 offset:49152
    v_mfma_f32_16x16x32_bf16 a[4:7], v[64:67], v[36:39], 0
    v_mfma_f32_16x16x32_bf16 a[8:11], v[64:67], v[40:43], 0
    ds_read_b64_tr_b16 v[130:131], v10 offset:53248
    v_mfma_f32_16x16x32_bf16 a[12:15], v[64:67], v[44:47], 0
    s_add_u32 m0, s19, 0
    s_nop 0
    buffer_load_dwordx4 v18, s[48:51], s16 offen sc1 lds
    v_mfma_f32_16x16x32_bf16 a[16:19], v[64:67], v[48:51], 0
    ds_read_b128 v[96:99], v8 offset:32768
    v_mfma_f32_16x16x32_bf16 a[20:23], v[64:67], v[52:55], 0
    v_mfma_f32_16x16x32_bf16 a[24:27], v[64:67], v[56:59], 0
    ds_read_b128 v[100:103], v8 offset:33024
    v_mfma_f32_16x16x32_bf16 a[28:31], v[64:67], v[60:63], 0
    v_mfma_f32_16x16x32_bf16 a[32:35], v[68:71], v[32:35], 0
    ds_read_b128 v[104:107], v8 offset:33280
    v_mfma_f32_16x16x32_bf16 a[36:39], v[68:71], v[36:39], 0
    v_mfma_f32_16x16x32_bf16 a[40:43], v[68:71], v[40:43], 0
    ds_read_b128 v[108:111], v8 offset:33536
    v_mfma_f32_16x16x32_bf16 a[44:47], v[68:71], v[44:47], 0
    buffer_load_dwordx4 v18, s[48:51], s16 offen offset:1024 sc1 lds
    v_mfma_f32_16x16x32_bf16 a[48:51], v[68:71], v[48:51], 0
    ds_read_b128 v[112:115], v8 offset:33792
    v_mfma_f32_16x16x32_bf16 a[52:55], v[68:71], v[52:55], 0
    v_mfma_f32_16x16x32_bf16 a[56:59], v[68:71], v[56:59], 0
    ds_read_b128 v[116:119], v8 offset:34048
    v_mfma_f32_16x16x32_bf16 a[60:63], v[68:71], v[60:63], 0
    v_mfma_f32_16x16x32_bf16 a[64:67], v[72:75], v[32:35], 0
    ds_read_b128 v[120:123], v8 offset:34304
    v_mfma_f32_16x16x32_bf16 a[68:71], v[72:75], v[36:39], 0
    v_mfma_f32_16x16x32_bf16 a[72:75], v[72:75], v[40:43], 0
    ds_read_b128 v[124:127], v8 offset:34560
    v_mfma_f32_16x16x32_bf16 a[76:79], v[72:75], v[44:47], 0
    buffer_load_dwordx4 v18, s[48:51], s16 offen offset:2048 sc1 lds
    v_mfma_f32_16x16x32_bf16 a[80:83], v[72:75], v[48:51], 0
    ds_read_b64_tr_b16 v[132:133], v11 offset:49152
    v_mfma_f32_16x16x32_bf16 a[84:87], v[72:75], v[52:55], 0
    v_mfma_f32_16x16x32_bf16 a[88:91], v[72:75], v[56:59], 0
    ds_read_b64_tr_b16 v[134:135], v11 offset:53248
    v_mfma_f32_16x16x32_bf16 a[92:95], v[72:75], v[60:63], 0
    v_mfma_f32_16x16x32_bf16 a[96:99], v[76:79], v[32:35], 0
    ds_read_b64_tr_b16 v[136:137], v12 offset:49152
    v_mfma_f32_16x16x32_bf16 a[100:103], v[76:79], v[36:39], 0
    v_mfma_f32_16x16x32_bf16 a[104:107], v[76:79], v[40:43], 0
    ds_read_b64_tr_b16 v[138:139], v12 offset:53248
    v_mfma_f32_16x16x32_bf16 a[108:111], v[76:79], v[44:47], 0
    buffer_load_dwordx4 v18, s[48:51], s16 offen offset:3072 sc1 lds
    s_add_u32 s16, s16, 16384
    v_mfma_f32_16x16x32_bf16 a[112:115], v[76:79], v[48:51], 0
    ds_read_b64_tr_b16 v[140:141], v13 offset:49152
    v_mfma_f32_16x16x32_bf16 a[116:119], v[76:79], v[52:55], 0
    v_mfma_f32_16x16x32_bf16 a[120:123], v[76:79], v[56:59], 0
    ds_read_b64_tr_b16 v[142:143], v13 offset:53248
    v_mfma_f32_16x16x32_bf16 a[124:127], v[76:79], v[60:63], 0
    v_mfma_f32_16x16x32_bf16 a[128:131], v[80:83], v[32:35], 0
    ds_read_b64_tr_b16 v[144:145], v10 offset:57344
    v_mfma_f32_16x16x32_bf16 a[132:135], v[80:83], v[36:39], 0
    v_mfma_f32_16x16x32_bf16 a[136:139], v[80:83], v[40:43], 0
    ds_read_b64_tr_b16 v[146:147], v10 offset:61440
    v_mfma_f32_16x16x32_bf16 a[140:143], v[80:83], v[44:47], 0
    s_add_u32 m0, s20, 0
    s_nop 0
    buffer_load_dwordx4 v204, s[12:15], s17 offen lds
    v_mfma_f32_16x16x32_bf16 a[144:147], v[80:83], v[48:51], 0
    ds_read_b64_tr_b16 v[148:149], v11 offset:57344
    v_mfma_f32_16x16x32_bf16 a[148:151], v[80:83], v[52:55], 0
    v_mfma_f32_16x16x32_bf16 a[152:155], v[80:83], v[56:59], 0
    ds_read_b64_tr_b16 v[150:151], v11 offset:61440
    v_mfma_f32_16x16x32_bf16 a[156:159], v[80:83], v[60:63], 0
    v_mfma_f32_16x16x32_bf16 a[160:163], v[84:87], v[32:35], 0
    ds_read_b64_tr_b16 v[152:153], v12 offset:57344
    v_mfma_f32_16x16x32_bf16 a[164:167], v[84:87], v[36:39], 0
    v_mfma_f32_16x16x32_bf16 a[168:171], v[84:87], v[40:43], 0
    ds_read_b64_tr_b16 v[154:155], v12 offset:61440
    v_mfma_f32_16x16x32_bf16 a[172:175], v[84:87], v[44:47], 0
    buffer_load_dwordx4 v205, s[12:15], s17 offen offset:1024 lds
    v_mfma_f32_16x16x32_bf16 a[176:179], v[84:87], v[48:51], 0
    ds_read_b64_tr_b16 v[156:157], v13 offset:57344
    v_mfma_f32_16x16x32_bf16 a[180:183], v[84:87], v[52:55], 0
    v_mfma_f32_16x16x32_bf16 a[184:187], v[84:87], v[56:59], 0
    ds_read_b64_tr_b16 v[158:159], v13 offset:61440
    v_mfma_f32_16x16x32_bf16 a[188:191], v[84:87], v[60:63], 0
    v_mfma_f32_16x16x32_bf16 a[192:195], v[88:91], v[32:35], 0
    v_mfma_f32_16x16x32_bf16 a[196:199], v[88:91], v[36:39], 0
    v_mfma_f32_16x16x32_bf16 a[200:203], v[88:91], v[40:43], 0
    v_mfma_f32_16x16x32_bf16 a[204:207], v[88:91], v[44:47], 0
    buffer_load_dwordx4 v206, s[12:15], s17 offen offset:2048 lds
    v_mfma_f32_16x16x32_bf16 a[208:211], v[88:91], v[48:51], 0
    v_mfma_f32_16x16x32_bf16 a[212:215], v[88:91], v[52:55], 0
    v_mfma_f32_16x16x32_bf16 a[216:219], v[88:91], v[56:59], 0
    v_mfma_f32_16x16x32_bf16 a[220:223], v[88:91], v[60:63], 0
    v_mfma_f32_16x16x32_bf16 a[224:227], v[92:95], v[32:35], 0
    v_mfma_f32_16x16x32_bf16 a[228:231], v[92:95], v[36:39], 0
    v_mfma_f32_16x16x32_bf16 a[232:235], v[92:95], v[40:43], 0
    v_mfma_f32_16x16x32_bf16 a[236:239], v[92:95], v[44:47], 0
    buffer_load_dwordx4 v207, s[12:15], s17 offen offset:3072 lds
    s_add_u32 s17, s17, s18
    v_mfma_f32_16x16x32_bf16 a[240:243], v[92:95], v[48:51], 0
    v_mfma_f32_16x16x32_bf16 a[244:247], v[92:95], v[52:55], 0
    v_mfma_f32_16x16x32_bf16 a[248:251], v[92:95], v[56:59], 0
    v_mfma_f32_16x16x32_bf16 a[252:255], v[92:95], v[60:63], 0
    s_waitcnt vmcnt(48) lgkmcnt(0)
    s_barrier
    v_mfma_f32_16x16x32_bf16 a[0:3], v[128:131], v[96:99], a[0:3]
    ds_read_b64_tr_b16 v[64:65], v14 offset:16384
    v_mfma_f32_16x16x32_bf16 a[4:7], v[128:131], v[100:103], a[4:7]
    v_mfma_f32_16x16x32_bf16 a[8:11], v[128:131], v[104:107], a[8:11]
    ds_read_b64_tr_b16 v[66:67], v14 offset:20480
    v_mfma_f32_16x16x32_bf16 a[12:15], v[128:131], v[108:111], a[12:15]
    s_add_u32 m0, s19, 32768
    s_nop 0
    buffer_load_dwordx4 v18, s[48:51], s16 offen sc1 lds
    v_mfma_f32_16x16x32_bf16 a[16:19], v[128:131], v[112:115], a[16:19]
    ds_read_b128 v[32:35], v9 offset:0
    v_mfma_f32_16x16x32_bf16 a[20:23], v[128:131], v[116:119], a[20:23]
    v_mfma_f32_16x16x32_bf16 a[24:27], v[128:131], v[120:123], a[24:27]
    ds_read_b128 v[36:39], v9 offset:256
    v_mfma_f32_16x16x32_bf16 a[28:31], v[128:131], v[124:127], a[28:31]
    v_mfma_f32_16x16x32_bf16 a[32:35], v[132:135], v[96:99], a[32:35]
    ds_read_b128 v[40:43], v9 offset:512
    v_mfma_f32_16x16x32_bf16 a[36:39], v[132:135], v[100:103], a[36:39]
    v_mfma_f32_16x16x32_bf16 a[40:43], v[132:135], v[104:107], a[40:43]
    ds_read_b128 v[44:47], v9 offset:768
    v_mfma_f32_16x16x32_bf16 a[44:47], v[132:135], v[108:111], a[44:47]
    buffer_load_dwordx4 v18, s[48:51], s16 offen offset:1024 sc1 lds
    v_mfma_f32_16x16x32_bf16 a[48:51], v[132:135], v[112:115], a[48:51]
    ds_read_b128 v[48:51], v9 offset:1024
    v_mfma_f32_16x16x32_bf16 a[52:55], v[132:135], v[116:119], a[52:55]
    v_mfma_f32_16x16x32_bf16 a[56:59], v[132:135], v[120:123], a[56:59]
    ds_read_b128 v[52:55], v9 offset:1280
    v_mfma_f32_16x16x32_bf16 a[60:63], v[132:135], v[124:127], a[60:63]
    v_mfma_f32_16x16x32_bf16 a[64:67], v[136:139], v[96:99], a[64:67]
    ds_read_b128 v[56:59], v9 offset:1536
    v_mfma_f32_16x16x32_bf16 a[68:71], v[136:139], v[100:103], a[68:71]
    v_mfma_f32_16x16x32_bf16 a[72:75], v[136:139], v[104:107], a[72:75]
    ds_read_b128 v[60:63], v9 offset:1792
    v_mfma_f32_16x16x32_bf16 a[76:79], v[136:139], v[108:111], a[76:79]
    buffer_load_dwordx4 v18, s[48:51], s16 offen offset:2048 sc1 lds
    v_mfma_f32_16x16x32_bf16 a[80:83], v[136:139], v[112:115], a[80:83]
    ds_read_b64_tr_b16 v[68:69], v15 offset:16384
    v_mfma_f32_16x16x32_bf16 a[84:87], v[136:139], v[116:119], a[84:87]
    v_mfma_f32_16x16x32_bf16 a[88:91], v[136:139], v[120:123], a[88:91]
    ds_read_b64_tr_b16 v[70:71], v15 offset:20480
    v_mfma_f32_16x16x32_bf16 a[92:95], v[136:139], v[124:127], a[92:95]
    v_mfma_f32_16x16x32_bf16 a[96:99], v[140:143], v[96:99], a[96:99]
    ds_read_b64_tr_b16 v[72:73], v16 offset:16384
    v_mfma_f32_16x16x32_bf16 a[100:103], v[140:143], v[100:103], a[100:103]
    v_mfma_f32_16x16x32_bf16 a[104:107], v[140:143], v[104:107], a[104:107]
    ds_read_b64_tr_b16 v[74:75], v16 offset:20480
    v_mfma_f32_16x16x32_bf16 a[108:111], v[140:143], v[108:111], a[108:111]
    buffer_load_dwordx4 v18, s[48:51], s16 offen offset:3072 sc1 lds
    s_add_u32 s16, s16, 16384
    v_mfma_f32_16x16x32_bf16 a[112:115], v[140:143], v[112:115], a[112:115]
    ds_read_b64_tr_b16 v[76:77], v17 offset:16384
    v_mfma_f32_16x16x32_bf16 a[116:119], v[140:143], v[116:119], a[116:119]
    v_mfma_f32_16x16x32_bf16 a[120:123], v[140:143], v[120:123], a[120:123]
    ds_read_b64_tr_b16 v[78:79], v17 offset:20480
    v_mfma_f32_16x16x32_bf16 a[124:127], v[140:143], v[124:127], a[124:127]
    v_mfma_f32_16x16x32_bf16 a[128:131], v[144:147], v[96:99], a[128:131]
    ds_read_b64_tr_b16 v[80:81], v14 offset:24576
    v_mfma_f32_16x16x32_bf16 a[132:135], v[144:147], v[100:103], a[132:135]
    v_mfma_f32_16x16x32_bf16 a[136:139], v[144:147], v[104:107], a[136:139]
    ds_read_b64_tr_b16 v[82:83], v14 offset:28672
    v_mfma_f32_16x16x32_bf16 a[140:143], v[144:147], v[108:111], a[140:143]
    s_add_u32 m0, s20, 32768
    s_nop 0
    buffer_load_dwordx4 v204, s[12:15], s17 offen lds
    v_mfma_f32_16x16x32_bf16 a[144:147], v[144:147], v[112:115], a[144:147]
    ds_read_b64_tr_b16 v[84:85], v15 offset:24576
    v_mfma_f32_16x16x32_bf16 a[148:151], v[144:147], v[116:119], a[148:151]
    v_mfma_f32_16x16x32_bf16 a[152:155], v[144:147], v[120:123], a[152:155]
    ds_read_b64_tr_b16 v[86:87], v15 offset:28672
    v_mfma_f32_16x16x32_bf16 a[156:159], v[144:147], v[124:127], a[156:159]
    v_mfma_f32_16x16x32_bf16 a[160:163], v[148:151], v[96:99], a[160:163]
    ds_read_b64_tr_b16 v[88:89], v16 offset:24576
    v_mfma_f32_16x16x32_bf16 a[164:167], v[148:151], v[100:103], a[164:167]
    v_mfma_f32_16x16x32_bf16 a[168:171], v[148:151], v[104:107], a[168:171]
    ds_read_b64_tr_b16 v[90:91], v16 offset:28672
    v_mfma_f32_16x16x32_bf16 a[172:175], v[148:151], v[108:111], a[172:175]
    buffer_load_dwordx4 v205, s[12:15], s17 offen offset:1024 lds
    v_mfma_f32_16x16x32_bf16 a[176:179], v[148:151], v[112:115], a[176:179]
    ds_read_b64_tr_b16 v[92:93], v17 offset:24576
    v_mfma_f32_16x16x32_bf16 a[180:183], v[148:151], v[116:119], a[180:183]
    v_mfma_f32_16x16x32_bf16 a[184:187], v[148:151], v[120:123], a[184:187]
    ds_read_b64_tr_b16 v[94:95], v17 offset:28672
    v_mfma_f32_16x16x32_bf16 a[188:191], v[148:151], v[124:127], a[188:191]
    v_mfma_f32_16x16x32_bf16 a[192:195], v[152:155], v[96:99], a[192:195]
    v_mfma_f32_16x16x32_bf16 a[196:199], v[152:155], v[100:103], a[196:199]
    v_mfma_f32_16x16x32_bf16 a[200:203], v[152:155], v[104:107], a[200:203]
    v_mfma_f32_16x16x32_bf16 a[204:207], v[152:155], v[108:111], a[204:207]
    buffer_load_dwordx4 v206, s[12:15], s17 offen offset:2048 lds
    v_mfma_f32_16x16x32_bf16 a[208:211], v[152:155], v[112:115], a[208:211]
    v_mfma_f32_16x16x32_bf16 a[212:215], v[152:155], v[116:119], a[212:215]
    v_mfma_f32_16x16x32_bf16 a[216:219], v[152:155], v[120:123], a[216:219]
    v_mfma_f32_16x16x32_bf16 a[220:223], v[152:155], v[124:127], a[220:223]
    v_mfma_f32_16x16x32_bf16 a[224:227], v[156:159], v[96:99], a[224:227]
    v_mfma_f32_16x16x32_bf16 a[228:231], v[156:159], v[100:103], a[228:231]
    v_mfma_f32_16x16x32_bf16 a[232:235], v[156:159], v[104:107], a[232:235]
    v_mfma_f32_16x16x32_bf16 a[236:239], v[156:159], v[108:111], a[236:239]
    buffer_load_dwordx4 v207, s[12:15], s17 offen offset:3072 lds
    s_add_u32 s17, s17, s18
    v_mfma_f32_16x16x32_bf16 a[240:243], v[156:159], v[112:115], a[240:243]
    v_mfma_f32_16x16x32_bf16 a[244:247], v[156:159], v[116:119], a[244:247]
    v_mfma_f32_16x16x32_bf16 a[248:251], v[156:159], v[120:123], a[248:251]
    v_mfma_f32_16x16x32_bf16 a[252:255], v[156:159], v[124:127], a[252:255]
    s_waitcnt vmcnt(48) lgkmcnt(0)
    s_barrier
    v_mfma_f32_16x16x32_bf16 a[0:3], v[64:67], v[32:35], a[0:3]
    ds_read_b64_tr_b16 v[128:129], v14 offset:49152
    v_mfma_f32_16x16x32_bf16 a[4:7], v[64:67], v[36:39], a[4:7]
    v_mfma_f32_16x16x32_bf16 a[8:11], v[64:67], v[40:43], a[8:11]
    ds_read_b64_tr_b16 v[130:131], v14 offset:53248
    v_mfma_f32_16x16x32_bf16 a[12:15], v[64:67], v[44:47], a[12:15]
    s_add_u32 m0, s19, 65536
    s_nop 0
    buffer_load_dwordx4 v18, s[48:51], s16 offen sc1 lds
    v_mfma_f32_16x16x32_bf16 a[16:19], v[64:67], v[48:51], a[16:19]
    ds_read_b128 v[96:99], v9 offset:32768
    v_mfma_f32_16x16x32_bf16 a[20:23], v[64:67], v[52:55], a[20:23]
    v_mfma_f32_16x16x32_bf16 a[24:27], v[64:67], v[56:59], a[24:27]
    ds_read_b128 v[100:103], v9 offset:33024
    v_mfma_f32_16x16x32_bf16 a[28:31], v[64:67], v[60:63], a[28:31]
    v_mfma_f32_16x16x32_bf16 a[32:35], v[68:71], v[32:35], a[32:35]
    ds_read_b128 v[104:107], v9 offset:33280
    v_mfma_f32_16x16x32_bf16 a[36:39], v[68:71], v[36:39], a[36:39]
    v_mfma_f32_16x16x32_bf16 a[40:43], v[68:71], v[40:43], a[40:43]
    ds_read_b128 v[108:111], v9 offset:33536
    v_mfma_f32_16x16x32_bf16 a[44:47], v[68:71], v[44:47], a[44:47]
    buffer_load_dwordx4 v18, s[48:51], s16 offen offset:1024 sc1 lds
    v_mfma_f32_16x16x32_bf16 a[48:51], v[68:71], v[48:51], a[48:51]
    ds_read_b128 v[112:115], v9 offset:33792
    v_mfma_f32_16x16x32_bf16 a[52:55], v[68:71], v[52:55], a[52:55]
    v_mfma_f32_16x16x32_bf16 a[56:59], v[68:71], v[56:59], a[56:59]
    ds_read_b128 v[116:119], v9 offset:34048
    v_mfma_f32_16x16x32_bf16 a[60:63], v[68:71], v[60:63], a[60:63]
    v_mfma_f32_16x16x32_bf16 a[64:67], v[72:75], v[32:35], a[64:67]
    ds_read_b128 v[120:123], v9 offset:34304
    v_mfma_f32_16x16x32_bf16 a[68:71], v[72:75], v[36:39], a[68:71]
    v_mfma_f32_16x16x32_bf16 a[72:75], v[72:75], v[40:43], a[72:75]
    ds_read_b128 v[124:127], v9 offset:34560
    v_mfma_f32_16x16x32_bf16 a[76:79], v[72:75], v[44:47], a[76:79]
    buffer_load_dwordx4 v18, s[48:51], s16 offen offset:2048 sc1 lds
    v_mfma_f32_16x16x32_bf16 a[80:83], v[72:75], v[48:51], a[80:83]
    ds_read_b64_tr_b16 v[132:133], v15 offset:49152
    v_mfma_f32_16x16x32_bf16 a[84:87], v[72:75], v[52:55], a[84:87]
    v_mfma_f32_16x16x32_bf16 a[88:91], v[72:75], v[56:59], a[88:91]
    ds_read_b64_tr_b16 v[134:135], v15 offset:53248
    v_mfma_f32_16x16x32_bf16 a[92:95], v[72:75], v[60:63], a[92:95]
    v_mfma_f32_16x16x32_bf16 a[96:99], v[76:79], v[32:35], a[96:99]
    ds_read_b64_tr_b16 v[136:137], v16 offset:49152
    v_mfma_f32_16x16x32_bf16 a[100:103], v[76:79], v[36:39], a[100:103]
    v_mfma_f32_16x16x32_bf16 a[104:107], v[76:79], v[40:43], a[104:107]
    ds_read_b64_tr_b16 v[138:139], v16 offset:53248
    v_mfma_f32_16x16x32_bf16 a[108:111], v[76:79], v[44:47], a[108:111]
    buffer_load_dwordx4 v18, s[48:51], s16 offen offset:3072 sc1 lds
    s_add_u32 s16, s16, 16384
    v_mfma_f32_16x16x32_bf16 a[112:115], v[76:79], v[48:51], a[112:115]
    ds_read_b64_tr_b16 v[140:141], v17 offset:49152
    v_mfma_f32_16x16x32_bf16 a[116:119], v[76:79], v[52:55], a[116:119]
    v_mfma_f32_16x16x32_bf16 a[120:123], v[76:79], v[56:59], a[120:123]
    ds_read_b64_tr_b16 v[142:143], v17 offset:53248
    v_mfma_f32_16x16x32_bf16 a[124:127], v[76:79], v[60:63], a[124:127]
    v_mfma_f32_16x16x32_bf16 a[128:131], v[80:83], v[32:35], a[128:131]
    ds_read_b64_tr_b16 v[144:145], v14 offset:57344
    v_mfma_f32_16x16x32_bf16 a[132:135], v[80:83], v[36:39], a[132:135]
    v_mfma_f32_16x16x32_bf16 a[136:139], v[80:83], v[40:43], a[136:139]
    ds_read_b64_tr_b16 v[146:147], v14 offset:61440
    v_mfma_f32_16x16x32_bf16 a[140:143], v[80:83], v[44:47], a[140:143]
    s_add_u32 m0, s20, 65536
    s_nop 0
    buffer_load_dwordx4 v204, s[12:15], s17 offen lds
    v_mfma_f32_16x16x32_bf16 a[144:147], v[80:83], v[48:51], a[144:147]
    ds_read_b64_tr_b16 v[148:149], v15 offset:57344
    v_mfma_f32_16x16x32_bf16 a[148:151], v[80:83], v[52:55], a[148:151]
    v_mfma_f32_16x16x32_bf16 a[152:155], v[80:83], v[56:59], a[152:155]
    ds_read_b64_tr_b16 v[150:151], v15 offset:61440
    v_mfma_f32_16x16x32_bf16 a[156:159], v[80:83], v[60:63], a[156:159]
    v_mfma_f32_16x16x32_bf16 a[160:163], v[84:87], v[32:35], a[160:163]
    ds_read_b64_tr_b16 v[152:153], v16 offset:57344
    v_mfma_f32_16x16x32_bf16 a[164:167], v[84:87], v[36:39], a[164:167]
    v_mfma_f32_16x16x32_bf16 a[168:171], v[84:87], v[40:43], a[168:171]
    ds_read_b64_tr_b16 v[154:155], v16 offset:61440
    v_mfma_f32_16x16x32_bf16 a[172:175], v[84:87], v[44:47], a[172:175]
    buffer_load_dwordx4 v205, s[12:15], s17 offen offset:1024 lds
    v_mfma_f32_16x16x32_bf16 a[176:179], v[84:87], v[48:51], a[176:179]
    ds_read_b64_tr_b16 v[156:157], v17 offset:57344
    v_mfma_f32_16x16x32_bf16 a[180:183], v[84:87], v[52:55], a[180:183]
    v_mfma_f32_16x16x32_bf16 a[184:187], v[84:87], v[56:59], a[184:187]
    ds_read_b64_tr_b16 v[158:159], v17 offset:61440
    v_mfma_f32_16x16x32_bf16 a[188:191], v[84:87], v[60:63], a[188:191]
    v_mfma_f32_16x16x32_bf16 a[192:195], v[88:91], v[32:35], a[192:195]
    v_mfma_f32_16x16x32_bf16 a[196:199], v[88:91], v[36:39], a[196:199]
    v_mfma_f32_16x16x32_bf16 a[200:203], v[88:91], v[40:43], a[200:203]
    v_mfma_f32_16x16x32_bf16 a[204:207], v[88:91], v[44:47], a[204:207]
    buffer_load_dwordx4 v206, s[12:15], s17 offen offset:2048 lds
    v_mfma_f32_16x16x32_bf16 a[208:211], v[88:91], v[48:51], a[208:211]
    v_mfma_f32_16x16x32_bf16 a[212:215], v[88:91], v[52:55], a[212:215]
    v_mfma_f32_16x16x32_bf16 a[216:219], v[88:91], v[56:59], a[216:219]
    v_mfma_f32_16x16x32_bf16 a[220:223], v[88:91], v[60:63], a[220:223]
    v_mfma_f32_16x16x32_bf16 a[224:227], v[92:95], v[32:35], a[224:227]
    v_mfma_f32_16x16x32_bf16 a[228:231], v[92:95], v[36:39], a[228:231]
    v_mfma_f32_16x16x32_bf16 a[232:235], v[92:95], v[40:43], a[232:235]
    v_mfma_f32_16x16x32_bf16 a[236:239], v[92:95], v[44:47], a[236:239]
    buffer_load_dwordx4 v207, s[12:15], s17 offen offset:3072 lds
    s_add_u32 s17, s17, s18
    v_mfma_f32_16x16x32_bf16 a[240:243], v[92:95], v[48:51], a[240:243]
    v_mfma_f32_16x16x32_bf16 a[244:247], v[92:95], v[52:55], a[244:247]
    v_mfma_f32_16x16x32_bf16 a[248:251], v[92:95], v[56:59], a[248:251]
    v_mfma_f32_16x16x32_bf16 a[252:255], v[92:95], v[60:63], a[252:255]
    s_waitcnt vmcnt(16) lgkmcnt(0)
    s_barrier
    v_mfma_f32_16x16x32_bf16 a[0:3], v[128:131], v[96:99], a[0:3]
    ds_read_b64_tr_b16 v[64:65], v10 offset:16384
    v_mfma_f32_16x16x32_bf16 a[4:7], v[128:131], v[100:103], a[4:7]
    buffer_atomic_add v24, v23, s[8:11], s62 offen sc1
    v_mfma_f32_16x16x32_bf16 a[8:11], v[128:131], v[104:107], a[8:11]
    ds_read_b64_tr_b16 v[66:67], v10 offset:20480
    v_mfma_f32_16x16x32_bf16 a[12:15], v[128:131], v[108:111], a[12:15]
    s_add_u32 m0, s19, 98304
    s_nop 0
    buffer_load_dwordx4 v18, s[48:51], s16 offen sc1 lds
    v_mfma_f32_16x16x32_bf16 a[16:19], v[128:131], v[112:115], a[16:19]
    ds_read_b128 v[32:35], v8 offset:0
    v_mfma_f32_16x16x32_bf16 a[20:23], v[128:131], v[116:119], a[20:23]
    v_mfma_f32_16x16x32_bf16 a[24:27], v[128:131], v[120:123], a[24:27]
    ds_read_b128 v[36:39], v8 offset:256
    v_mfma_f32_16x16x32_bf16 a[28:31], v[128:131], v[124:127], a[28:31]
    v_mfma_f32_16x16x32_bf16 a[32:35], v[132:135], v[96:99], a[32:35]
    ds_read_b128 v[40:43], v8 offset:512
    v_mfma_f32_16x16x32_bf16 a[36:39], v[132:135], v[100:103], a[36:39]
    v_mfma_f32_16x16x32_bf16 a[40:43], v[132:135], v[104:107], a[40:43]
    ds_read_b128 v[44:47], v8 offset:768
    v_mfma_f32_16x16x32_bf16 a[44:47], v[132:135], v[108:111], a[44:47]
    buffer_load_dwordx4 v18, s[48:51], s16 offen offset:1024 sc1 lds
    v_mfma_f32_16x16x32_bf16 a[48:51], v[132:135], v[112:115], a[48:51]
    ds_read_b128 v[48:51], v8 offset:1024
    v_mfma_f32_16x16x32_bf16 a[52:55], v[132:135], v[116:119], a[52:55]
    v_mfma_f32_16x16x32_bf16 a[56:59], v[132:135], v[120:123], a[56:59]
    ds_read_b128 v[52:55], v8 offset:1280
    v_mfma_f32_16x16x32_bf16 a[60:63], v[132:135], v[124:127], a[60:63]
    v_mfma_f32_16x16x32_bf16 a[64:67], v[136:139], v[96:99], a[64:67]
    ds_read_b128 v[56:59], v8 offset:1536
    v_mfma_f32_16x16x32_bf16 a[68:71], v[136:139], v[100:103], a[68:71]
    v_mfma_f32_16x16x32_bf16 a[72:75], v[136:139], v[104:107], a[72:75]
    ds_read_b128 v[60:63], v8 offset:1792
    v_mfma_f32_16x16x32_bf16 a[76:79], v[136:139], v[108:111], a[76:79]
    buffer_load_dwordx4 v18, s[48:51], s16 offen offset:2048 sc1 lds
    v_mfma_f32_16x16x32_bf16 a[80:83], v[136:139], v[112:115], a[80:83]
    ds_read_b64_tr_b16 v[68:69], v11 offset:16384
    v_mfma_f32_16x16x32_bf16 a[84:87], v[136:139], v[116:119], a[84:87]
    v_mfma_f32_16x16x32_bf16 a[88:91], v[136:139], v[120:123], a[88:91]
    ds_read_b64_tr_b16 v[70:71], v11 offset:20480
    v_mfma_f32_16x16x32_bf16 a[92:95], v[136:139], v[124:127], a[92:95]
    v_mfma_f32_16x16x32_bf16 a[96:99], v[140:143], v[96:99], a[96:99]
    ds_read_b64_tr_b16 v[72:73], v12 offset:16384
    v_mfma_f32_16x16x32_bf16 a[100:103], v[140:143], v[100:103], a[100:103]
    v_mfma_f32_16x16x32_bf16 a[104:107], v[140:143], v[104:107], a[104:107]
    ds_read_b64_tr_b16 v[74:75], v12 offset:20480
    v_mfma_f32_16x16x32_bf16 a[108:111], v[140:143], v[108:111], a[108:111]
    buffer_load_dwordx4 v18, s[48:51], s16 offen offset:3072 sc1 lds
    s_add_u32 s16, s16, 16384
    v_mfma_f32_16x16x32_bf16 a[112:115], v[140:143], v[112:115], a[112:115]
    ds_read_b64_tr_b16 v[76:77], v13 offset:16384
    v_mfma_f32_16x16x32_bf16 a[116:119], v[140:143], v[116:119], a[116:119]
    v_mfma_f32_16x16x32_bf16 a[120:123], v[140:143], v[120:123], a[120:123]
    ds_read_b64_tr_b16 v[78:79], v13 offset:20480
    v_mfma_f32_16x16x32_bf16 a[124:127], v[140:143], v[124:127], a[124:127]
    v_mfma_f32_16x16x32_bf16 a[128:131], v[144:147], v[96:99], a[128:131]
    ds_read_b64_tr_b16 v[80:81], v10 offset:24576
    v_mfma_f32_16x16x32_bf16 a[132:135], v[144:147], v[100:103], a[132:135]
    v_mfma_f32_16x16x32_bf16 a[136:139], v[144:147], v[104:107], a[136:139]
    ds_read_b64_tr_b16 v[82:83], v10 offset:28672
    v_mfma_f32_16x16x32_bf16 a[140:143], v[144:147], v[108:111], a[140:143]
    s_add_u32 m0, s20, 98304
    s_nop 0
    buffer_load_dwordx4 v204, s[12:15], s17 offen lds
    v_mfma_f32_16x16x32_bf16 a[144:147], v[144:147], v[112:115], a[144:147]
    ds_read_b64_tr_b16 v[84:85], v11 offset:24576
    v_mfma_f32_16x16x32_bf16 a[148:151], v[144:147], v[116:119], a[148:151]
    v_mfma_f32_16x16x32_bf16 a[152:155], v[144:147], v[120:123], a[152:155]
    ds_read_b64_tr_b16 v[86:87], v11 offset:28672
    v_mfma_f32_16x16x32_bf16 a[156:159], v[144:147], v[124:127], a[156:159]
    v_mfma_f32_16x16x32_bf16 a[160:163], v[148:151], v[96:99], a[160:163]
    ds_read_b64_tr_b16 v[88:89], v12 offset:24576
    v_mfma_f32_16x16x32_bf16 a[164:167], v[148:151], v[100:103], a[164:167]
    v_mfma_f32_16x16x32_bf16 a[168:171], v[148:151], v[104:107], a[168:171]
    ds_read_b64_tr_b16 v[90:91], v12 offset:28672
    v_mfma_f32_16x16x32_bf16 a[172:175], v[148:151], v[108:111], a[172:175]
    buffer_load_dwordx4 v205, s[12:15], s17 offen offset:1024 lds
    v_mfma_f32_16x16x32_bf16 a[176:179], v[148:151], v[112:115], a[176:179]
    ds_read_b64_tr_b16 v[92:93], v13 offset:24576
    v_mfma_f32_16x16x32_bf16 a[180:183], v[148:151], v[116:119], a[180:183]
    v_mfma_f32_16x16x32_bf16 a[184:187], v[148:151], v[120:123], a[184:187]
    ds_read_b64_tr_b16 v[94:95], v13 offset:28672
    v_mfma_f32_16x16x32_bf16 a[188:191], v[148:151], v[124:127], a[188:191]
    v_mfma_f32_16x16x32_bf16 a[192:195], v[152:155], v[96:99], a[192:195]
    v_mfma_f32_16x16x32_bf16 a[196:199], v[152:155], v[100:103], a[196:199]
    v_mfma_f32_16x16x32_bf16 a[200:203], v[152:155], v[104:107], a[200:203]
    v_mfma_f32_16x16x32_bf16 a[204:207], v[152:155], v[108:111], a[204:207]
    buffer_load_dwordx4 v206, s[12:15], s17 offen offset:2048 lds
    v_mfma_f32_16x16x32_bf16 a[208:211], v[152:155], v[112:115], a[208:211]
    v_mfma_f32_16x16x32_bf16 a[212:215], v[152:155], v[116:119], a[212:215]
    v_mfma_f32_16x16x32_bf16 a[216:219], v[152:155], v[120:123], a[216:219]
    v_mfma_f32_16x16x32_bf16 a[220:223], v[152:155], v[124:127], a[220:223]
    v_mfma_f32_16x16x32_bf16 a[224:227], v[156:159], v[96:99], a[224:227]
    v_mfma_f32_16x16x32_bf16 a[228:231], v[156:159], v[100:103], a[228:231]
    v_mfma_f32_16x16x32_bf16 a[232:235], v[156:159], v[104:107], a[232:235]
    v_mfma_f32_16x16x32_bf16 a[236:239], v[156:159], v[108:111], a[236:239]
    buffer_load_dwordx4 v207, s[12:15], s17 offen offset:3072 lds
    s_add_u32 s17, s17, s18
    v_mfma_f32_16x16x32_bf16 a[240:243], v[156:159], v[112:115], a[240:243]
    v_mfma_f32_16x16x32_bf16 a[244:247], v[156:159], v[116:119], a[244:247]
    v_mfma_f32_16x16x32_bf16 a[248:251], v[156:159], v[120:123], a[248:251]
    v_mfma_f32_16x16x32_bf16 a[252:255], v[156:159], v[124:127], a[252:255]
Lmid_178:
    s_cmp_eq_u32 s21, 1
    s_cbranch_scc1 Lsw_179
Lswb_180:
    s_waitcnt vmcnt(16) lgkmcnt(0)
    s_barrier
    v_mfma_f32_16x16x32_bf16 a[0:3], v[64:67], v[32:35], a[0:3]
    ds_read_b64_tr_b16 v[128:129], v10 offset:49152
    v_mfma_f32_16x16x32_bf16 a[4:7], v[64:67], v[36:39], a[4:7]
    v_mfma_f32_16x16x32_bf16 a[8:11], v[64:67], v[40:43], a[8:11]
    ds_read_b64_tr_b16 v[130:131], v10 offset:53248
    v_mfma_f32_16x16x32_bf16 a[12:15], v[64:67], v[44:47], a[12:15]
    s_add_u32 m0, s19, 0
    s_nop 0
    buffer_load_dwordx4 v18, s[48:51], s16 offen sc1 lds
    v_mfma_f32_16x16x32_bf16 a[16:19], v[64:67], v[48:51], a[16:19]
    ds_read_b128 v[96:99], v8 offset:32768
    v_mfma_f32_16x16x32_bf16 a[20:23], v[64:67], v[52:55], a[20:23]
    v_mfma_f32_16x16x32_bf16 a[24:27], v[64:67], v[56:59], a[24:27]
    ds_read_b128 v[100:103], v8 offset:33024
    v_mfma_f32_16x16x32_bf16 a[28:31], v[64:67], v[60:63], a[28:31]
    v_mfma_f32_16x16x32_bf16 a[32:35], v[68:71], v[32:35], a[32:35]
    ds_read_b128 v[104:107], v8 offset:33280
    v_mfma_f32_16x16x32_bf16 a[36:39], v[68:71], v[36:39], a[36:39]
    v_mfma_f32_16x16x32_bf16 a[40:43], v[68:71], v[40:43], a[40:43]
    ds_read_b128 v[108:111], v8 offset:33536
    v_mfma_f32_16x16x32_bf16 a[44:47], v[68:71], v[44:47], a[44:47]
    buffer_load_dwordx4 v18, s[48:51], s16 offen offset:1024 sc1 lds
    v_mfma_f32_16x16x32_bf16 a[48:51], v[68:71], v[48:51], a[48:51]
    ds_read_b128 v[112:115], v8 offset:33792
    v_mfma_f32_16x16x32_bf16 a[52:55], v[68:71], v[52:55], a[52:55]
    v_mfma_f32_16x16x32_bf16 a[56:59], v[68:71], v[56:59], a[56:59]
    ds_read_b128 v[116:119], v8 offset:34048
    v_mfma_f32_16x16x32_bf16 a[60:63], v[68:71], v[60:63], a[60:63]
    v_mfma_f32_16x16x32_bf16 a[64:67], v[72:75], v[32:35], a[64:67]
    ds_read_b128 v[120:123], v8 offset:34304
    v_mfma_f32_16x16x32_bf16 a[68:71], v[72:75], v[36:39], a[68:71]
    v_mfma_f32_16x16x32_bf16 a[72:75], v[72:75], v[40:43], a[72:75]
    ds_read_b128 v[124:127], v8 offset:34560
    v_mfma_f32_16x16x32_bf16 a[76:79], v[72:75], v[44:47], a[76:79]
    buffer_load_dwordx4 v18, s[48:51], s16 offen offset:2048 sc1 lds
    v_mfma_f32_16x16x32_bf16 a[80:83], v[72:75], v[48:51], a[80:83]
    ds_read_b64_tr_b16 v[132:133], v11 offset:49152
    v_mfma_f32_16x16x32_bf16 a[84:87], v[72:75], v[52:55], a[84:87]
    v_mfma_f32_16x16x32_bf16 a[88:91], v[72:75], v[56:59], a[88:91]
    ds_read_b64_tr_b16 v[134:135], v11 offset:53248
    v_mfma_f32_16x16x32_bf16 a[92:95], v[72:75], v[60:63], a[92:95]
    v_mfma_f32_16x16x32_bf16 a[96:99], v[76:79], v[32:35], a[96:99]
    ds_read_b64_tr_b16 v[136:137], v12 offset:49152
    v_mfma_f32_16x16x32_bf16 a[100:103], v[76:79], v[36:39], a[100:103]
    v_mfma_f32_16x16x32_bf16 a[104:107], v[76:79], v[40:43], a[104:107]
    ds_read_b64_tr_b16 v[138:139], v12 offset:53248
    v_mfma_f32_16x16x32_bf16 a[108:111], v[76:79], v[44:47], a[108:111]
    buffer_load_dwordx4 v18, s[48:51], s16 offen offset:3072 sc1 lds
    s_add_u32 s16, s16, 16384
    v_mfma_f32_16x16x32_bf16 a[112:115], v[76:79], v[48:51], a[112:115]
    ds_read_b64_tr_b16 v[140:141], v13 offset:49152
    v_mfma_f32_16x16x32_bf16 a[116:119], v[76:79], v[52:55], a[116:119]
    v_mfma_f32_16x16x32_bf16 a[120:123], v[76:79], v[56:59], a[120:123]
    ds_read_b64_tr_b16 v[142:143], v13 offset:53248
    v_mfma_f32_16x16x32_bf16 a[124:127], v[76:79], v[60:63], a[124:127]
    v_mfma_f32_16x16x32_bf16 a[128:131], v[80:83], v[32:35], a[128:131]
    ds_read_b64_tr_b16 v[144:145], v10 offset:57344
    v_mfma_f32_16x16x32_bf16 a[132:135], v[80:83], v[36:39], a[132:135]
    v_mfma_f32_16x16x32_bf16 a[136:139], v[80:83], v[40:43], a[136:139]
    ds_read_b64_tr_b16 v[146:147], v10 offset:61440
    v_mfma_f32_16x16x32_bf16 a[140:143], v[80:83], v[44:47], a[140:143]
    s_add_u32 m0, s20, 0
    s_nop 0
    buffer_load_dwordx4 v204, s[12:15], s17 offen lds
    v_mfma_f32_16x16x32_bf16 a[144:147], v[80:83], v[48:51], a[144:147]
    ds_read_b64_tr_b16 v[148:149], v11 offset:57344
    v_mfma_f32_16x16x32_bf16 a[148:151], v[80:83], v[52:55], a[148:151]
    v_mfma_f32_16x16x32_bf16 a[152:155], v[80:83], v[56:59], a[152:155]
    ds_read_b64_tr_b16 v[150:151], v11 offset:61440
    v_mfma_f32_16x16x32_bf16 a[156:159], v[80:83], v[60:63], a[156:159]
    v_mfma_f32_16x16x32_bf16 a[160:163], v[84:87], v[32:35], a[160:163]
    ds_read_b64_tr_b16 v[152:153], v12 offset:57344
    v_mfma_f32_16x16x32_bf16 a[164:167], v[84:87], v[36:39], a[164:167]
    v_mfma_f32_16x16x32_bf16 a[168:171], v[84:87], v[40:43], a[168:171]
    ds_read_b64_tr_b16 v[154:155], v12 offset:61440
    v_mfma_f32_16x16x32_bf16 a[172:175], v[84:87], v[44:47], a[172:175]
    buffer_load_dwordx4 v205, s[12:15], s17 offen offset:1024 lds
    v_mfma_f32_16x16x32_bf16 a[176:179], v[84:87], v[48:51], a[176:179]
    ds_read_b64_tr_b16 v[156:157], v13 offset:57344
    v_mfma_f32_16x16x32_bf16 a[180:183], v[84:87], v[52:55], a[180:183]
    v_mfma_f32_16x16x32_bf16 a[184:187], v[84:87], v[56:59], a[184:187]
    ds_read_b64_tr_b16 v[158:159], v13 offset:61440
    v_mfma_f32_16x16x32_bf16 a[188:191], v[84:87], v[60:63], a[188:191]
    v_mfma_f32_16x16x32_bf16 a[192:195], v[88:91], v[32:35], a[192:195]
    v_mfma_f32_16x16x32_bf16 a[196:199], v[88:91], v[36:39], a[196:199]
    v_mfma_f32_16x16x32_bf16 a[200:203], v[88:91], v[40:43], a[200:203]
    v_mfma_f32_16x16x32_bf16 a[204:207], v[88:91], v[44:47], a[204:207]
    buffer_load_dwordx4 v206, s[12:15], s17 offen offset:2048 lds
    v_mfma_f32_16x16x32_bf16 a[208:211], v[88:91], v[48:51], a[208:211]
    v_mfma_f32_16x16x32_bf16 a[212:215], v[88:91], v[52:55], a[212:215]
    v_mfma_f32_16x16x32_bf16 a[216:219], v[88:91], v[56:59], a[216:219]
    v_mfma_f32_16x16x32_bf16 a[220:223], v[88:91], v[60:63], a[220:223]
    v_mfma_f32_16x16x32_bf16 a[224:227], v[92:95], v[32:35], a[224:227]
    v_mfma_f32_16x16x32_bf16 a[228:231], v[92:95], v[36:39], a[228:231]
    v_mfma_f32_16x16x32_bf16 a[232:235], v[92:95], v[40:43], a[232:235]
    v_mfma_f32_16x16x32_bf16 a[236:239], v[92:95], v[44:47], a[236:239]
    buffer_load_dwordx4 v207, s[12:15], s17 offen offset:3072 lds
    s_add_u32 s17, s17, s18
    v_mfma_f32_16x16x32_bf16 a[240:243], v[92:95], v[48:51], a[240:243]
    v_mfma_f32_16x16x32_bf16 a[244:247], v[92:95], v[52:55], a[244:247]
    v_mfma_f32_16x16x32_bf16 a[248:251], v[92:95], v[56:59], a[248:251]
    v_mfma_f32_16x16x32_bf16 a[252:255], v[92:95], v[60:63], a[252:255]
    s_waitcnt vmcnt(16) lgkmcnt(0)
    s_barrier
    v_mfma_f32_16x16x32_bf16 a[0:3], v[128:131], v[96:99], a[0:3]
    ds_read_b64_tr_b16 v[64:65], v14 offset:16384
    v_mfma_f32_16x16x32_bf16 a[4:7], v[128:131], v[100:103], a[4:7]
    v_mfma_f32_16x16x32_bf16 a[8:11], v[128:131], v[104:107], a[8:11]
    ds_read_b64_tr_b16 v[66:67], v14 offset:20480
    v_mfma_f32_16x16x32_bf16 a[12:15], v[128:131], v[108:111], a[12:15]
    s_add_u32 m0, s19, 32768
    s_nop 0
    buffer_load_dwordx4 v18, s[48:51], s16 offen sc1 lds
    v_mfma_f32_16x16x32_bf16 a[16:19], v[128:131], v[112:115], a[16:19]
    ds_read_b128 v[32:35], v9 offset:0
    v_mfma_f32_16x16x32_bf16 a[20:23], v[128:131], v[116:119], a[20:23]
    v_mfma_f32_16x16x32_bf16 a[24:27], v[128:131], v[120:123], a[24:27]
    ds_read_b128 v[36:39], v9 offset:256
    v_mfma_f32_16x16x32_bf16 a[28:31], v[128:131], v[124:127], a[28:31]
    v_mfma_f32_16x16x32_bf16 a[32:35], v[132:135], v[96:99], a[32:35]
    ds_read_b128 v[40:43], v9 offset:512
    v_mfma_f32_16x16x32_bf16 a[36:39], v[132:135], v[100:103], a[36:39]
    v_mfma_f32_16x16x32_bf16 a[40:43], v[132:135], v[104:107], a[40:43]
    ds_read_b128 v[44:47], v9 offset:768
    v_mfma_f32_16x16x32_bf16 a[44:47], v[132:135], v[108:111], a[44:47]
    buffer_load_dwordx4 v18, s[48:51], s16 offen offset:1024 sc1 lds
    v_mfma_f32_16x16x32_bf16 a[48:51], v[132:135], v[112:115], a[48:51]
    ds_read_b128 v[48:51], v9 offset:1024
    v_mfma_f32_16x16x32_bf16 a[52:55], v[132:135], v[116:119], a[52:55]
    v_mfma_f32_16x16x32_bf16 a[56:59], v[132:135], v[120:123], a[56:59]
    ds_read_b128 v[52:55], v9 offset:1280
    v_mfma_f32_16x16x32_bf16 a[60:63], v[132:135], v[124:127], a[60:63]
    v_mfma_f32_16x16x32_bf16 a[64:67], v[136:139], v[96:99], a[64:67]
    ds_read_b128 v[56:59], v9 offset:1536
    v_mfma_f32_16x16x32_bf16 a[68:71], v[136:139], v[100:103], a[68:71]
    v_mfma_f32_16x16x32_bf16 a[72:75], v[136:139], v[104:107], a[72:75]
    ds_read_b128 v[60:63], v9 offset:1792
    v_mfma_f32_16x16x32_bf16 a[76:79], v[136:139], v[108:111], a[76:79]
    buffer_load_dwordx4 v18, s[48:51], s16 offen offset:2048 sc1 lds
    v_mfma_f32_16x16x32_bf16 a[80:83], v[136:139], v[112:115], a[80:83]
    ds_read_b64_tr_b16 v[68:69], v15 offset:16384
    v_mfma_f32_16x16x32_bf16 a[84:87], v[136:139], v[116:119], a[84:87]
    v_mfma_f32_16x16x32_bf16 a[88:91], v[136:139], v[120:123], a[88:91]
    ds_read_b64_tr_b16 v[70:71], v15 offset:20480
    v_mfma_f32_16x16x32_bf16 a[92:95], v[136:139], v[124:127], a[92:95]
    v_mfma_f32_16x16x32_bf16 a[96:99], v[140:143], v[96:99], a[96:99]
    ds_read_b64_tr_b16 v[72:73], v16 offset:16384
    v_mfma_f32_16x16x32_bf16 a[100:103], v[140:143], v[100:103], a[100:103]
    v_mfma_f32_16x16x32_bf16 a[104:107], v[140:143], v[104:107], a[104:107]
    ds_read_b64_tr_b16 v[74:75], v16 offset:20480
    v_mfma_f32_16x16x32_bf16 a[108:111], v[140:143], v[108:111], a[108:111]
    buffer_load_dwordx4 v18, s[48:51], s16 offen offset:3072 sc1 lds
    s_add_u32 s16, s16, 16384
    v_mfma_f32_16x16x32_bf16 a[112:115], v[140:143], v[112:115], a[112:115]
    ds_read_b64_tr_b16 v[76:77], v17 offset:16384
    v_mfma_f32_16x16x32_bf16 a[116:119], v[140:143], v[116:119], a[116:119]
    v_mfma_f32_16x16x32_bf16 a[120:123], v[140:143], v[120:123], a[120:123]
    ds_read_b64_tr_b16 v[78:79], v17 offset:20480
    v_mfma_f32_16x16x32_bf16 a[124:127], v[140:143], v[124:127], a[124:127]
    v_mfma_f32_16x16x32_bf16 a[128:131], v[144:147], v[96:99], a[128:131]
    ds_read_b64_tr_b16 v[80:81], v14 offset:24576
    v_mfma_f32_16x16x32_bf16 a[132:135], v[144:147], v[100:103], a[132:135]
    v_mfma_f32_16x16x32_bf16 a[136:139], v[144:147], v[104:107], a[136:139]
    ds_read_b64_tr_b16 v[82:83], v14 offset:28672
    v_mfma_f32_16x16x32_bf16 a[140:143], v[144:147], v[108:111], a[140:143]
    s_add_u32 m0, s20, 32768
    s_nop 0
    buffer_load_dwordx4 v204, s[12:15], s17 offen lds
    v_mfma_f32_16x16x32_bf16 a[144:147], v[144:147], v[112:115], a[144:147]
    ds_read_b64_tr_b16 v[84:85], v15 offset:24576
    v_mfma_f32_16x16x32_bf16 a[148:151], v[144:147], v[116:119], a[148:151]
    v_mfma_f32_16x16x32_bf16 a[152:155], v[144:147], v[120:123], a[152:155]
    ds_read_b64_tr_b16 v[86:87], v15 offset:28672
    v_mfma_f32_16x16x32_bf16 a[156:159], v[144:147], v[124:127], a[156:159]
    v_mfma_f32_16x16x32_bf16 a[160:163], v[148:151], v[96:99], a[160:163]
    ds_read_b64_tr_b16 v[88:89], v16 offset:24576
    v_mfma_f32_16x16x32_bf16 a[164:167], v[148:151], v[100:103], a[164:167]
    v_mfma_f32_16x16x32_bf16 a[168:171], v[148:151], v[104:107], a[168:171]
    ds_read_b64_tr_b16 v[90:91], v16 offset:28672
    v_mfma_f32_16x16x32_bf16 a[172:175], v[148:151], v[108:111], a[172:175]
    buffer_load_dwordx4 v205, s[12:15], s17 offen offset:1024 lds
    v_mfma_f32_16x16x32_bf16 a[176:179], v[148:151], v[112:115], a[176:179]
    ds_read_b64_tr_b16 v[92:93], v17 offset:24576
    v_mfma_f32_16x16x32_bf16 a[180:183], v[148:151], v[116:119], a[180:183]
    v_mfma_f32_16x16x32_bf16 a[184:187], v[148:151], v[120:123], a[184:187]
    ds_read_b64_tr_b16 v[94:95], v17 offset:28672
    v_mfma_f32_16x16x32_bf16 a[188:191], v[148:151], v[124:127], a[188:191]
    v_mfma_f32_16x16x32_bf16 a[192:195], v[152:155], v[96:99], a[192:195]
    v_mfma_f32_16x16x32_bf16 a[196:199], v[152:155], v[100:103], a[196:199]
    v_mfma_f32_16x16x32_bf16 a[200:203], v[152:155], v[104:107], a[200:203]
    v_mfma_f32_16x16x32_bf16 a[204:207], v[152:155], v[108:111], a[204:207]
    buffer_load_dwordx4 v206, s[12:15], s17 offen offset:2048 lds
    v_mfma_f32_16x16x32_bf16 a[208:211], v[152:155], v[112:115], a[208:211]
    v_mfma_f32_16x16x32_bf16 a[212:215], v[152:155], v[116:119], a[212:215]
    v_mfma_f32_16x16x32_bf16 a[216:219], v[152:155], v[120:123], a[216:219]
    v_mfma_f32_16x16x32_bf16 a[220:223], v[152:155], v[124:127], a[220:223]
    v_mfma_f32_16x16x32_bf16 a[224:227], v[156:159], v[96:99], a[224:227]
    v_mfma_f32_16x16x32_bf16 a[228:231], v[156:159], v[100:103], a[228:231]
    v_mfma_f32_16x16x32_bf16 a[232:235], v[156:159], v[104:107], a[232:235]
    v_mfma_f32_16x16x32_bf16 a[236:239], v[156:159], v[108:111], a[236:239]
    buffer_load_dwordx4 v207, s[12:15], s17 offen offset:3072 lds
    s_add_u32 s17, s17, s18
    v_mfma_f32_16x16x32_bf16 a[240:243], v[156:159], v[112:115], a[240:243]
    v_mfma_f32_16x16x32_bf16 a[244:247], v[156:159], v[116:119], a[244:247]
    v_mfma_f32_16x16x32_bf16 a[248:251], v[156:159], v[120:123], a[248:251]
    v_mfma_f32_16x16x32_bf16 a[252:255], v[156:159], v[124:127], a[252:255]
    s_waitcnt vmcnt(16) lgkmcnt(0)
    s_barrier
    v_mfma_f32_16x16x32_bf16 a[0:3], v[64:67], v[32:35], a[0:3]
    ds_read_b64_tr_b16 v[128:129], v14 offset:49152
    v_mfma_f32_16x16x32_bf16 a[4:7], v[64:67], v[36:39], a[4:7]
    v_mfma_f32_16x16x32_bf16 a[8:11], v[64:67], v[40:43], a[8:11]
    ds_read_b64_tr_b16 v[130:131], v14 offset:53248
    v_mfma_f32_16x16x32_bf16 a[12:15], v[64:67], v[44:47], a[12:15]
    s_add_u32 m0, s19, 65536
    s_nop 0
    buffer_load_dwordx4 v18, s[48:51], s16 offen sc1 lds
    v_mfma_f32_16x16x32_bf16 a[16:19], v[64:67], v[48:51], a[16:19]
    ds_read_b128 v[96:99], v9 offset:32768
    v_mfma_f32_16x16x32_bf16 a[20:23], v[64:67], v[52:55], a[20:23]
    v_mfma_f32_16x16x32_bf16 a[24:27], v[64:67], v[56:59], a[24:27]
    ds_read_b128 v[100:103], v9 offset:33024
    v_mfma_f32_16x16x32_bf16 a[28:31], v[64:67], v[60:63], a[28:31]
    v_mfma_f32_16x16x32_bf16 a[32:35], v[68:71], v[32:35], a[32:35]
    ds_read_b128 v[104:107], v9 offset:33280
    v_mfma_f32_16x16x32_bf16 a[36:39], v[68:71], v[36:39], a[36:39]
    v_mfma_f32_16x16x32_bf16 a[40:43], v[68:71], v[40:43], a[40:43]
    ds_read_b128 v[108:111], v9 offset:33536
    v_mfma_f32_16x16x32_bf16 a[44:47], v[68:71], v[44:47], a[44:47]
    buffer_load_dwordx4 v18, s[48:51], s16 offen offset:1024 sc1 lds
    v_mfma_f32_16x16x32_bf16 a[48:51], v[68:71], v[48:51], a[48:51]
    ds_read_b128 v[112:115], v9 offset:33792
    v_mfma_f32_16x16x32_bf16 a[52:55], v[68:71], v[52:55], a[52:55]
    v_mfma_f32_16x16x32_bf16 a[56:59], v[68:71], v[56:59], a[56:59]
    ds_read_b128 v[116:119], v9 offset:34048
    v_mfma_f32_16x16x32_bf16 a[60:63], v[68:71], v[60:63], a[60:63]
    v_mfma_f32_16x16x32_bf16 a[64:67], v[72:75], v[32:35], a[64:67]
    ds_read_b128 v[120:123], v9 offset:34304
    v_mfma_f32_16x16x32_bf16 a[68:71], v[72:75], v[36:39], a[68:71]
    v_mfma_f32_16x16x32_bf16 a[72:75], v[72:75], v[40:43], a[72:75]
    ds_read_b128 v[124:127], v9 offset:34560
    v_mfma_f32_16x16x32_bf16 a[76:79], v[72:75], v[44:47], a[76:79]
    buffer_load_dwordx4 v18, s[48:51], s16 offen offset:2048 sc1 lds
    v_mfma_f32_16x16x32_bf16 a[80:83], v[72:75], v[48:51], a[80:83]
    ds_read_b64_tr_b16 v[132:133], v15 offset:49152
    v_mfma_f32_16x16x32_bf16 a[84:87], v[72:75], v[52:55], a[84:87]
    v_mfma_f32_16x16x32_bf16 a[88:91], v[72:75], v[56:59], a[88:91]
    ds_read_b64_tr_b16 v[134:135], v15 offset:53248
    v_mfma_f32_16x16x32_bf16 a[92:95], v[72:75], v[60:63], a[92:95]
    v_mfma_f32_16x16x32_bf16 a[96:99], v[76:79], v[32:35], a[96:99]
    ds_read_b64_tr_b16 v[136:137], v16 offset:49152
    v_mfma_f32_16x16x32_bf16 a[100:103], v[76:79], v[36:39], a[100:103]
    v_mfma_f32_16x16x32_bf16 a[104:107], v[76:79], v[40:43], a[104:107]
    ds_read_b64_tr_b16 v[138:139], v16 offset:53248
    v_mfma_f32_16x16x32_bf16 a[108:111], v[76:79], v[44:47], a[108:111]
    buffer_load_dwordx4 v18, s[48:51], s16 offen offset:3072 sc1 lds
    s_add_u32 s16, s16, 16384
    v_mfma_f32_16x16x32_bf16 a[112:115], v[76:79], v[48:51], a[112:115]
    ds_read_b64_tr_b16 v[140:141], v17 offset:49152
    v_mfma_f32_16x16x32_bf16 a[116:119], v[76:79], v[52:55], a[116:119]
    v_mfma_f32_16x16x32_bf16 a[120:123], v[76:79], v[56:59], a[120:123]
    ds_read_b64_tr_b16 v[142:143], v17 offset:53248
    v_mfma_f32_16x16x32_bf16 a[124:127], v[76:79], v[60:63], a[124:127]
    v_mfma_f32_16x16x32_bf16 a[128:131], v[80:83], v[32:35], a[128:131]
    ds_read_b64_tr_b16 v[144:145], v14 offset:57344
    v_mfma_f32_16x16x32_bf16 a[132:135], v[80:83], v[36:39], a[132:135]
    v_mfma_f32_16x16x32_bf16 a[136:139], v[80:83], v[40:43], a[136:139]
    ds_read_b64_tr_b16 v[146:147], v14 offset:61440
    v_mfma_f32_16x16x32_bf16 a[140:143], v[80:83], v[44:47], a[140:143]
    s_add_u32 m0, s20, 65536
    s_nop 0
    buffer_load_dwordx4 v204, s[12:15], s17 offen lds
    v_mfma_f32_16x16x32_bf16 a[144:147], v[80:83], v[48:51], a[144:147]
    ds_read_b64_tr_b16 v[148:149], v15 offset:57344
    v_mfma_f32_16x16x32_bf16 a[148:151], v[80:83], v[52:55], a[148:151]
    v_mfma_f32_16x16x32_bf16 a[152:155], v[80:83], v[56:59], a[152:155]
    ds_read_b64_tr_b16 v[150:151], v15 offset:61440
    v_mfma_f32_16x16x32_bf16 a[156:159], v[80:83], v[60:63], a[156:159]
    v_mfma_f32_16x16x32_bf16 a[160:163], v[84:87], v[32:35], a[160:163]
    ds_read_b64_tr_b16 v[152:153], v16 offset:57344
    v_mfma_f32_16x16x32_bf16 a[164:167], v[84:87], v[36:39], a[164:167]
    v_mfma_f32_16x16x32_bf16 a[168:171], v[84:87], v[40:43], a[168:171]
    ds_read_b64_tr_b16 v[154:155], v16 offset:61440
    v_mfma_f32_16x16x32_bf16 a[172:175], v[84:87], v[44:47], a[172:175]
    buffer_load_dwordx4 v205, s[12:15], s17 offen offset:1024 lds
    v_mfma_f32_16x16x32_bf16 a[176:179], v[84:87], v[48:51], a[176:179]
    ds_read_b64_tr_b16 v[156:157], v17 offset:57344
    v_mfma_f32_16x16x32_bf16 a[180:183], v[84:87], v[52:55], a[180:183]
    v_mfma_f32_16x16x32_bf16 a[184:187], v[84:87], v[56:59], a[184:187]
    ds_read_b64_tr_b16 v[158:159], v17 offset:61440
    v_mfma_f32_16x16x32_bf16 a[188:191], v[84:87], v[60:63], a[188:191]
    v_mfma_f32_16x16x32_bf16 a[192:195], v[88:91], v[32:35], a[192:195]
    v_mfma_f32_16x16x32_bf16 a[196:199], v[88:91], v[36:39], a[196:199]
    v_mfma_f32_16x16x32_bf16 a[200:203], v[88:91], v[40:43], a[200:203]
    v_mfma_f32_16x16x32_bf16 a[204:207], v[88:91], v[44:47], a[204:207]
    buffer_load_dwordx4 v206, s[12:15], s17 offen offset:2048 lds
    v_mfma_f32_16x16x32_bf16 a[208:211], v[88:91], v[48:51], a[208:211]
    v_mfma_f32_16x16x32_bf16 a[212:215], v[88:91], v[52:55], a[212:215]
    v_mfma_f32_16x16x32_bf16 a[216:219], v[88:91], v[56:59], a[216:219]
    v_mfma_f32_16x16x32_bf16 a[220:223], v[88:91], v[60:63], a[220:223]
    v_mfma_f32_16x16x32_bf16 a[224:227], v[92:95], v[32:35], a[224:227]
    v_mfma_f32_16x16x32_bf16 a[228:231], v[92:95], v[36:39], a[228:231]
    v_mfma_f32_16x16x32_bf16 a[232:235], v[92:95], v[40:43], a[232:235]
    v_mfma_f32_16x16x32_bf16 a[236:239], v[92:95], v[44:47], a[236:239]
    buffer_load_dwordx4 v207, s[12:15], s17 offen offset:3072 lds
    s_add_u32 s17, s17, s18
    v_mfma_f32_16x16x32_bf16 a[240:243], v[92:95], v[48:51], a[240:243]
    v_mfma_f32_16x16x32_bf16 a[244:247], v[92:95], v[52:55], a[244:247]
    v_mfma_f32_16x16x32_bf16 a[248:251], v[92:95], v[56:59], a[248:251]
    v_mfma_f32_16x16x32_bf16 a[252:255], v[92:95], v[60:63], a[252:255]
    s_waitcnt vmcnt(16) lgkmcnt(0)
    s_barrier
    v_mfma_f32_16x16x32_bf16 a[0:3], v[128:131], v[96:99], a[0:3]
    ds_read_b64_tr_b16 v[64:65], v10 offset:16384
    v_mfma_f32_16x16x32_bf16 a[4:7], v[128:131], v[100:103], a[4:7]
    v_mfma_f32_16x16x32_bf16 a[8:11], v[128:131], v[104:107], a[8:11]
    ds_read_b64_tr_b16 v[66:67], v10 offset:20480
    v_mfma_f32_16x16x32_bf16 a[12:15], v[128:131], v[108:111], a[12:15]
    s_add_u32 m0, s19, 98304
    s_nop 0
    buffer_load_dwordx4 v18, s[48:51], s16 offen sc1 lds
    v_mfma_f32_16x16x32_bf16 a[16:19], v[128:131], v[112:115], a[16:19]
    ds_read_b128 v[32:35], v8 offset:0
    v_mfma_f32_16x16x32_bf16 a[20:23], v[128:131], v[116:119], a[20:23]
    v_mfma_f32_16x16x32_bf16 a[24:27], v[128:131], v[120:123], a[24:27]
    ds_read_b128 v[36:39], v8 offset:256
    v_mfma_f32_16x16x32_bf16 a[28:31], v[128:131], v[124:127], a[28:31]
    v_mfma_f32_16x16x32_bf16 a[32:35], v[132:135], v[96:99], a[32:35]
    ds_read_b128 v[40:43], v8 offset:512
    v_mfma_f32_16x16x32_bf16 a[36:39], v[132:135], v[100:103], a[36:39]
    v_mfma_f32_16x16x32_bf16 a[40:43], v[132:135], v[104:107], a[40:43]
    ds_read_b128 v[44:47], v8 offset:768
    v_mfma_f32_16x16x32_bf16 a[44:47], v[132:135], v[108:111], a[44:47]
    buffer_load_dwordx4 v18, s[48:51], s16 offen offset:1024 sc1 lds
    v_mfma_f32_16x16x32_bf16 a[48:51], v[132:135], v[112:115], a[48:51]
    ds_read_b128 v[48:51], v8 offset:1024
    v_mfma_f32_16x16x32_bf16 a[52:55], v[132:135], v[116:119], a[52:55]
    v_mfma_f32_16x16x32_bf16 a[56:59], v[132:135], v[120:123], a[56:59]
    ds_read_b128 v[52:55], v8 offset:1280
    v_mfma_f32_16x16x32_bf16 a[60:63], v[132:135], v[124:127], a[60:63]
    v_mfma_f32_16x16x32_bf16 a[64:67], v[136:139], v[96:99], a[64:67]
    ds_read_b128 v[56:59], v8 offset:1536
    v_mfma_f32_16x16x32_bf16 a[68:71], v[136:139], v[100:103], a[68:71]
    v_mfma_f32_16x16x32_bf16 a[72:75], v[136:139], v[104:107], a[72:75]
    ds_read_b128 v[60:63], v8 offset:1792
    v_mfma_f32_16x16x32_bf16 a[76:79], v[136:139], v[108:111], a[76:79]
    buffer_load_dwordx4 v18, s[48:51], s16 offen offset:2048 sc1 lds
    v_mfma_f32_16x16x32_bf16 a[80:83], v[136:139], v[112:115], a[80:83]
    ds_read_b64_tr_b16 v[68:69], v11 offset:16384
    v_mfma_f32_16x16x32_bf16 a[84:87], v[136:139], v[116:119], a[84:87]
    v_mfma_f32_16x16x32_bf16 a[88:91], v[136:139], v[120:123], a[88:91]
    ds_read_b64_tr_b16 v[70:71], v11 offset:20480
    v_mfma_f32_16x16x32_bf16 a[92:95], v[136:139], v[124:127], a[92:95]
    v_mfma_f32_16x16x32_bf16 a[96:99], v[140:143], v[96:99], a[96:99]
    ds_read_b64_tr_b16 v[72:73], v12 offset:16384
    v_mfma_f32_16x16x32_bf16 a[100:103], v[140:143], v[100:103], a[100:103]
    v_mfma_f32_16x16x32_bf16 a[104:107], v[140:143], v[104:107], a[104:107]
    ds_read_b64_tr_b16 v[74:75], v12 offset:20480
    v_mfma_f32_16x16x32_bf16 a[108:111], v[140:143], v[108:111], a[108:111]
    buffer_load_dwordx4 v18, s[48:51], s16 offen offset:3072 sc1 lds
    s_add_u32 s16, s16, 16384
    v_mfma_f32_16x16x32_bf16 a[112:115], v[140:143], v[112:115], a[112:115]
    ds_read_b64_tr_b16 v[76:77], v13 offset:16384
    v_mfma_f32_16x16x32_bf16 a[116:119], v[140:143], v[116:119], a[116:119]
    v_mfma_f32_16x16x32_bf16 a[120:123], v[140:143], v[120:123], a[120:123]
    ds_read_b64_tr_b16 v[78:79], v13 offset:20480
    v_mfma_f32_16x16x32_bf16 a[124:127], v[140:143], v[124:127], a[124:127]
    v_mfma_f32_16x16x32_bf16 a[128:131], v[144:147], v[96:99], a[128:131]
    ds_read_b64_tr_b16 v[80:81], v10 offset:24576
    v_mfma_f32_16x16x32_bf16 a[132:135], v[144:147], v[100:103], a[132:135]
    v_mfma_f32_16x16x32_bf16 a[136:139], v[144:147], v[104:107], a[136:139]
    ds_read_b64_tr_b16 v[82:83], v10 offset:28672
    v_mfma_f32_16x16x32_bf16 a[140:143], v[144:147], v[108:111], a[140:143]
    s_add_u32 m0, s20, 98304
    s_nop 0
    buffer_load_dwordx4 v204, s[12:15], s17 offen lds
    v_mfma_f32_16x16x32_bf16 a[144:147], v[144:147], v[112:115], a[144:147]
    ds_read_b64_tr_b16 v[84:85], v11 offset:24576
    v_mfma_f32_16x16x32_bf16 a[148:151], v[144:147], v[116:119], a[148:151]
    v_mfma_f32_16x16x32_bf16 a[152:155], v[144:147], v[120:123], a[152:155]
    ds_read_b64_tr_b16 v[86:87], v11 offset:28672
    v_mfma_f32_16x16x32_bf16 a[156:159], v[144:147], v[124:127], a[156:159]
    v_mfma_f32_16x16x32_bf16 a[160:163], v[148:151], v[96:99], a[160:163]
    ds_read_b64_tr_b16 v[88:89], v12 offset:24576
    v_mfma_f32_16x16x32_bf16 a[164:167], v[148:151], v[100:103], a[164:167]
    v_mfma_f32_16x16x32_bf16 a[168:171], v[148:151], v[104:107], a[168:171]
    ds_read_b64_tr_b16 v[90:91], v12 offset:28672
    v_mfma_f32_16x16x32_bf16 a[172:175], v[148:151], v[108:111], a[172:175]
    buffer_load_dwordx4 v205, s[12:15], s17 offen offset:1024 lds
    v_mfma_f32_16x16x32_bf16 a[176:179], v[148:151], v[112:115], a[176:179]
    ds_read_b64_tr_b16 v[92:93], v13 offset:24576
    v_mfma_f32_16x16x32_bf16 a[180:183], v[148:151], v[116:119], a[180:183]
    v_mfma_f32_16x16x32_bf16 a[184:187], v[148:151], v[120:123], a[184:187]
    ds_read_b64_tr_b16 v[94:95], v13 offset:28672
    v_mfma_f32_16x16x32_bf16 a[188:191], v[148:151], v[124:127], a[188:191]
    v_mfma_f32_16x16x32_bf16 a[192:195], v[152:155], v[96:99], a[192:195]
    v_mfma_f32_16x16x32_bf16 a[196:199], v[152:155], v[100:103], a[196:199]
    v_mfma_f32_16x16x32_bf16 a[200:203], v[152:155], v[104:107], a[200:203]
    v_mfma_f32_16x16x32_bf16 a[204:207], v[152:155], v[108:111], a[204:207]
    buffer_load_dwordx4 v206, s[12:15], s17 offen offset:2048 lds
    v_mfma_f32_16x16x32_bf16 a[208:211], v[152:155], v[112:115], a[208:211]
    v_mfma_f32_16x16x32_bf16 a[212:215], v[152:155], v[116:119], a[212:215]
    v_mfma_f32_16x16x32_bf16 a[216:219], v[152:155], v[120:123], a[216:219]
    v_mfma_f32_16x16x32_bf16 a[220:223], v[152:155], v[124:127], a[220:223]
    v_mfma_f32_16x16x32_bf16 a[224:227], v[156:159], v[96:99], a[224:227]
    v_mfma_f32_16x16x32_bf16 a[228:231], v[156:159], v[100:103], a[228:231]
    v_mfma_f32_16x16x32_bf16 a[232:235], v[156:159], v[104:107], a[232:235]
    v_mfma_f32_16x16x32_bf16 a[236:239], v[156:159], v[108:111], a[236:239]
    buffer_load_dwordx4 v207, s[12:15], s17 offen offset:3072 lds
    s_add_u32 s17, s17, s18
    v_mfma_f32_16x16x32_bf16 a[240:243], v[156:159], v[112:115], a[240:243]
    v_mfma_f32_16x16x32_bf16 a[244:247], v[156:159], v[116:119], a[244:247]
    v_mfma_f32_16x16x32_bf16 a[248:251], v[156:159], v[120:123], a[248:251]
    v_mfma_f32_16x16x32_bf16 a[252:255], v[156:159], v[124:127], a[252:255]
    s_sub_u32 s21, s21, 1
    s_cmp_lg_u32 s21, 0
    s_cbranch_scc1 Lmid_178
    s_branch L_e1ep
Lsw_179:
    s_lshr_b32 s6, s80, 8
    s_cmp_eq_u32 s6, 0
    s_cbranch_scc1 Lnul_181
    s_cmp_eq_u32 s6, 4
    s_cbranch_scc1 Lnul_181
    s_lshr_b32 s6, s80, 8
    s_and_b32 s7, s80, 0xff
    s_mov_b32 s50, 268435456
    s_mov_b32 s63, 7
    s_cmp_eq_u32 s6, 2
    s_cbranch_scc1 Ldg_183
    s_cmp_eq_u32 s6, 3
    s_cbranch_scc1 Ldq_182
    s_lshr_b32 s30, s7, 3
    s_and_b32 s31, s7, 3
    s_lshl_b32 s4, s23, 2
    s_add_u32 s31, s31, s4
    s_add_u32 s4, s30, 0
    s_lshl_b32 s4, s4, 8
    s_add_u32 s43, s4, 102760448
    s_bitcmp1_b32 s7, 2
    s_cbranch_scc1 Ldv_184
    s_load_dwordx2 s[12:13], s[0:1], 24
    s_mov_b32 s61, 1
    s_lshl_b32 s4, s30, 21
    s_lshl_b32 s5, s31, 17
    s_add_u32 s4, s4, s5
    s_add_u32 s42, s4, 4194304
    s_branch Ldb_185
Ldv_184:
    s_load_dwordx2 s[12:13], s[0:1], 32
    s_mov_b32 s61, 2
    s_lshl_b32 s4, s30, 21
    s_lshl_b32 s5, s31, 12
    s_add_u32 s4, s4, s5
    s_add_u32 s42, s4, 20971520
    s_branch Ldb_185
Ldq_182:
    s_lshr_b32 s30, s7, 2
    s_and_b32 s31, s7, 3
    s_lshl_b32 s4, s23, 2
    s_add_u32 s31, s31, s4
    s_add_u32 s4, s30, 8
    s_lshl_b32 s4, s4, 8
    s_add_u32 s43, s4, 102760448
    s_load_dwordx2 s[12:13], s[0:1], 16
    s_mov_b32 s61, 3
    s_lshl_b32 s4, s30, 21
    s_lshl_b32 s5, s31, 17
    s_add_u32 s4, s4, s5
    s_add_u32 s42, s4, 37748736
Ldb_185:
    s_mov_b32 s14, 8388608
    s_mov_b32 s32, 8192
    s_lshl_b32 s17, s31, 9
    s_and_b32 s4, s3, 1
    s_lshl_b32 s4, s4, 8
    s_add_u32 s17, s17, s4
    s_lshl_b32 s16, s30, 19
    s_add_u32 s16, s16, 0
    s_branch Lde_186
Ldg_183:
    s_mul_i32 s5, s7, 9363
    s_lshr_b32 s30, s5, 16
    s_mul_i32 s5, s30, 7
    s_sub_u32 s4, s7, s5
    s_mul_i32 s31, s23, 7
    s_add_u32 s31, s31, s4
    s_add_u32 s4, s30, 16
    s_lshl_b32 s4, s4, 8
    s_add_u32 s43, s4, 102760448
    s_and_b32 s4, s3, 1
    s_lshl_b32 s4, s4, 3
    s_add_u32 s4, s4, 64
    s_load_dwordx2 s[12:13], s[0:1], s4
    s_mov_b32 s14, 7340032
    s_mov_b32 s61, 4
    s_mov_b32 s32, 7168
    s_lshl_b32 s17, s31, 8
    s_mul_i32 s4, s30, 1835008
    s_lshl_b32 s5, s31, 16
    s_add_u32 s4, s4, s5
    s_add_u32 s42, s4, 54525952
    s_lshl_b32 s16, s30, 19
    s_add_u32 s16, s16, 0
Lde_186:
    s_mov_b32 s15, 0x20000
    v_mul_u32_u24 v1, s32, v19
    s_lshl_b32 s4, s32, 2
    s_sub_u32 s4, s4, 1024
    v_add_u32 v204, v1, v20
    v_add3_u32 v205, v1, v21, s4
    s_lshl_b32 s5, s4, 1
    v_add3_u32 v206, v1, v20, s5
    s_add_u32 s5, s5, s4
    v_add3_u32 v207, v1, v21, s5
    s_lshl_b32 s18, s32, 5
    s_mov_b32 s80, s81
    s_mov_b32 s81, s82
    s_mov_b32 s82, s83
    s_mov_b32 s83, s84
    s_mov_b32 s84, s85
    s_mov_b32 s85, s86
    s_mov_b32 s86, s87
    s_mov_b32 s87, 0
    s_branch Lswb_180
Lnul_181:
    s_mov_b32 s61, 0
    s_mov_b32 s50, 0
    s_mov_b32 s14, 0
    s_branch Lswb_180
L_f4S:
    s_waitcnt vmcnt(48) lgkmcnt(0)
    s_barrier
    v_mfma_f32_16x16x32_bf16 a[0:3], v[32:35], v[64:67], 0
    ds_read_b64_tr_b16 v[128:129], v10 offset:49152
    v_mfma_f32_16x16x32_bf16 a[4:7], v[36:39], v[64:67], 0
    v_mfma_f32_16x16x32_bf16 a[8:11], v[40:43], v[64:67], 0
    ds_read_b64_tr_b16 v[130:131], v10 offset:53248
    v_mfma_f32_16x16x32_bf16 a[12:15], v[44:47], v[64:67], 0
    s_add_u32 m0, s19, 0
    s_nop 0
    buffer_load_dwordx4 v18, s[48:51], s16 offen sc1 lds
    v_mfma_f32_16x16x32_bf16 a[16:19], v[48:51], v[64:67], 0
    ds_read_b128 v[96:99], v8 offset:32768
    v_mfma_f32_16x16x32_bf16 a[20:23], v[52:55], v[64:67], 0
    v_mfma_f32_16x16x32_bf16 a[24:27], v[56:59], v[64:67], 0
    ds_read_b128 v[100:103], v8 offset:33024
    v_mfma_f32_16x16x32_bf16 a[28:31], v[60:63], v[64:67], 0
    v_mfma_f32_16x16x32_bf16 a[32:35], v[32:35], v[68:71], 0
    ds_read_b128 v[104:107], v8 offset:33280
    v_mfma_f32_16x16x32_bf16 a[36:39], v[36:39], v[68:71], 0
    v_mfma_f32_16x16x32_bf16 a[40:43], v[40:43], v[68:71], 0
    ds_read_b128 v[108:111], v8 offset:33536
    v_mfma_f32_16x16x32_bf16 a[44:47], v[44:47], v[68:71], 0
    buffer_load_dwordx4 v18, s[48:51], s16 offen offset:1024 sc1 lds
    v_mfma_f32_16x16x32_bf16 a[48:51], v[48:51], v[68:71], 0
    ds_read_b128 v[112:115], v8 offset:33792
    v_mfma_f32_16x16x32_bf16 a[52:55], v[52:55], v[68:71], 0
    v_mfma_f32_16x16x32_bf16 a[56:59], v[56:59], v[68:71], 0
    ds_read_b128 v[116:119], v8 offset:34048
    v_mfma_f32_16x16x32_bf16 a[60:63], v[60:63], v[68:71], 0
    v_mfma_f32_16x16x32_bf16 a[64:67], v[32:35], v[72:75], 0
    ds_read_b128 v[120:123], v8 offset:34304
    v_mfma_f32_16x16x32_bf16 a[68:71], v[36:39], v[72:75], 0
    v_mfma_f32_16x16x32_bf16 a[72:75], v[40:43], v[72:75], 0
    ds_read_b128 v[124:127], v8 offset:34560
    v_mfma_f32_16x16x32_bf16 a[76:79], v[44:47], v[72:75], 0
    buffer_load_dwordx4 v18, s[48:51], s16 offen offset:2048 sc1 lds
    v_mfma_f32_16x16x32_bf16 a[80:83], v[48:51], v[72:75], 0
    ds_read_b64_tr_b16 v[132:133], v11 offset:49152
    v_mfma_f32_16x16x32_bf16 a[84:87], v[52:55], v[72:75], 0
    v_mfma_f32_16x16x32_bf16 a[88:91], v[56:59], v[72:75], 0
    ds_read_b64_tr_b16 v[134:135], v11 offset:53248
    v_mfma_f32_16x16x32_bf16 a[92:95], v[60:63], v[72:75], 0
    v_mfma_f32_16x16x32_bf16 a[96:99], v[32:35], v[76:79], 0
    ds_read_b64_tr_b16 v[136:137], v12 offset:49152
    v_mfma_f32_16x16x32_bf16 a[100:103], v[36:39], v[76:79], 0
    v_mfma_f32_16x16x32_bf16 a[104:107], v[40:43], v[76:79], 0
    ds_read_b64_tr_b16 v[138:139], v12 offset:53248
    v_mfma_f32_16x16x32_bf16 a[108:111], v[44:47], v[76:79], 0
    buffer_load_dwordx4 v18, s[48:51], s16 offen offset:3072 sc1 lds
    s_add_u32 s16, s16, 16384
    v_mfma_f32_16x16x32_bf16 a[112:115], v[48:51], v[76:79], 0
    ds_read_b64_tr_b16 v[140:141], v13 offset:49152
    v_mfma_f32_16x16x32_bf16 a[116:119], v[52:55], v[76:79], 0
    v_mfma_f32_16x16x32_bf16 a[120:123], v[56:59], v[76:79], 0
    ds_read_b64_tr_b16 v[142:143], v13 offset:53248
    v_mfma_f32_16x16x32_bf16 a[124:127], v[60:63], v[76:79], 0
    v_mfma_f32_16x16x32_bf16 a[128:131], v[32:35], v[80:83], 0
    ds_read_b64_tr_b16 v[144:145], v10 offset:57344
    v_mfma_f32_16x16x32_bf16 a[132:135], v[36:39], v[80:83], 0
    v_mfma_f32_16x16x32_bf16 a[136:139], v[40:43], v[80:83], 0
    ds_read_b64_tr_b16 v[146:147], v10 offset:61440
    v_mfma_f32_16x16x32_bf16 a[140:143], v[44:47], v[80:83], 0
    s_add_u32 m0, s20, 0
    s_nop 0
    buffer_load_dwordx4 v204, s[12:15], s17 offen lds
    v_mfma_f32_16x16x32_bf16 a[144:147], v[48:51], v[80:83], 0
    ds_read_b64_tr_b16 v[148:149], v11 offset:57344
    v_mfma_f32_16x16x32_bf16 a[148:151], v[52:55], v[80:83], 0
    v_mfma_f32_16x16x32_bf16 a[152:155], v[56:59], v[80:83], 0
    ds_read_b64_tr_b16 v[150:151], v11 offset:61440
    v_mfma_f32_16x16x32_bf16 a[156:159], v[60:63], v[80:83], 0
    v_mfma_f32_16x16x32_bf16 a[160:163], v[32:35], v[84:87], 0
    ds_read_b64_tr_b16 v[152:153], v12 offset:57344
    v_mfma_f32_16x16x32_bf16 a[164:167], v[36:39], v[84:87], 0
    v_mfma_f32_16x16x32_bf16 a[168:171], v[40:43], v[84:87], 0
    ds_read_b64_tr_b16 v[154:155], v12 offset:61440
    v_mfma_f32_16x16x32_bf16 a[172:175], v[44:47], v[84:87], 0
    buffer_load_dwordx4 v205, s[12:15], s17 offen offset:1024 lds
    v_mfma_f32_16x16x32_bf16 a[176:179], v[48:51], v[84:87], 0
    ds_read_b64_tr_b16 v[156:157], v13 offset:57344
    v_mfma_f32_16x16x32_bf16 a[180:183], v[52:55], v[84:87], 0
    v_mfma_f32_16x16x32_bf16 a[184:187], v[56:59], v[84:87], 0
    ds_read_b64_tr_b16 v[158:159], v13 offset:61440
    v_mfma_f32_16x16x32_bf16 a[188:191], v[60:63], v[84:87], 0
    v_mfma_f32_16x16x32_bf16 a[192:195], v[32:35], v[88:91], 0
    v_mfma_f32_16x16x32_bf16 a[196:199], v[36:39], v[88:91], 0
    v_mfma_f32_16x16x32_bf16 a[200:203], v[40:43], v[88:91], 0
    v_mfma_f32_16x16x32_bf16 a[204:207], v[44:47], v[88:91], 0
    buffer_load_dwordx4 v206, s[12:15], s17 offen offset:2048 lds
    v_mfma_f32_16x16x32_bf16 a[208:211], v[48:51], v[88:91], 0
    v_mfma_f32_16x16x32_bf16 a[212:215], v[52:55], v[88:91], 0
    v_mfma_f32_16x16x32_bf16 a[216:219], v[56:59], v[88:91], 0
    v_mfma_f32_16x16x32_bf16 a[220:223], v[60:63], v[88:91], 0
    v_mfma_f32_16x16x32_bf16 a[224:227], v[32:35], v[92:95], 0
    v_mfma_f32_16x16x32_bf16 a[228:231], v[36:39], v[92:95], 0
    v_mfma_f32_16x16x32_bf16 a[232:235], v[40:43], v[92:95], 0
    v_mfma_f32_16x16x32_bf16 a[236:239], v[44:47], v[92:95], 0
    buffer_load_dwordx4 v207, s[12:15], s17 offen offset:3072 lds
    s_add_u32 s17, s17, s18
    v_mfma_f32_16x16x32_bf16 a[240:243], v[48:51], v[92:95], 0
    v_mfma_f32_16x16x32_bf16 a[244:247], v[52:55], v[92:95], 0
    v_mfma_f32_16x16x32_bf16 a[248:251], v[56:59], v[92:95], 0
    v_mfma_f32_16x16x32_bf16 a[252:255], v[60:63], v[92:95], 0
    s_waitcnt vmcnt(48) lgkmcnt(0)
    s_barrier
    v_mfma_f32_16x16x32_bf16 a[0:3], v[96:99], v[128:131], a[0:3]
    ds_read_b64_tr_b16 v[64:65], v14 offset:16384
    v_mfma_f32_16x16x32_bf16 a[4:7], v[100:103], v[128:131], a[4:7]
    v_mfma_f32_16x16x32_bf16 a[8:11], v[104:107], v[128:131], a[8:11]
    ds_read_b64_tr_b16 v[66:67], v14 offset:20480
    v_mfma_f32_16x16x32_bf16 a[12:15], v[108:111], v[128:131], a[12:15]
    s_add_u32 m0, s19, 32768
    s_nop 0
    buffer_load_dwordx4 v18, s[48:51], s16 offen sc1 lds
    v_mfma_f32_16x16x32_bf16 a[16:19], v[112:115], v[128:131], a[16:19]
    ds_read_b128 v[32:35], v9 offset:0
    v_mfma_f32_16x16x32_bf16 a[20:23], v[116:119], v[128:131], a[20:23]
    v_mfma_f32_16x16x32_bf16 a[24:27], v[120:123], v[128:131], a[24:27]
    ds_read_b128 v[36:39], v9 offset:256
    v_mfma_f32_16x16x32_bf16 a[28:31], v[124:127], v[128:131], a[28:31]
    v_mfma_f32_16x16x32_bf16 a[32:35], v[96:99], v[132:135], a[32:35]
    ds_read_b128 v[40:43], v9 offset:512
    v_mfma_f32_16x16x32_bf16 a[36:39], v[100:103], v[132:135], a[36:39]
    v_mfma_f32_16x16x32_bf16 a[40:43], v[104:107], v[132:135], a[40:43]
    ds_read_b128 v[44:47], v9 offset:768
    v_mfma_f32_16x16x32_bf16 a[44:47], v[108:111], v[132:135], a[44:47]
    buffer_load_dwordx4 v18, s[48:51], s16 offen offset:1024 sc1 lds
    v_mfma_f32_16x16x32_bf16 a[48:51], v[112:115], v[132:135], a[48:51]
    ds_read_b128 v[48:51], v9 offset:1024
    v_mfma_f32_16x16x32_bf16 a[52:55], v[116:119], v[132:135], a[52:55]
    v_mfma_f32_16x16x32_bf16 a[56:59], v[120:123], v[132:135], a[56:59]
    ds_read_b128 v[52:55], v9 offset:1280
    v_mfma_f32_16x16x32_bf16 a[60:63], v[124:127], v[132:135], a[60:63]
    v_mfma_f32_16x16x32_bf16 a[64:67], v[96:99], v[136:139], a[64:67]
    ds_read_b128 v[56:59], v9 offset:1536
    v_mfma_f32_16x16x32_bf16 a[68:71], v[100:103], v[136:139], a[68:71]
    v_mfma_f32_16x16x32_bf16 a[72:75], v[104:107], v[136:139], a[72:75]
    ds_read_b128 v[60:63], v9 offset:1792
    v_mfma_f32_16x16x32_bf16 a[76:79], v[108:111], v[136:139], a[76:79]
    buffer_load_dwordx4 v18, s[48:51], s16 offen offset:2048 sc1 lds
    v_mfma_f32_16x16x32_bf16 a[80:83], v[112:115], v[136:139], a[80:83]
    ds_read_b64_tr_b16 v[68:69], v15 offset:16384
    v_mfma_f32_16x16x32_bf16 a[84:87], v[116:119], v[136:139], a[84:87]
    v_mfma_f32_16x16x32_bf16 a[88:91], v[120:123], v[136:139], a[88:91]
    ds_read_b64_tr_b16 v[70:71], v15 offset:20480
    v_mfma_f32_16x16x32_bf16 a[92:95], v[124:127], v[136:139], a[92:95]
    v_mfma_f32_16x16x32_bf16 a[96:99], v[96:99], v[140:143], a[96:99]
    ds_read_b64_tr_b16 v[72:73], v16 offset:16384
    v_mfma_f32_16x16x32_bf16 a[100:103], v[100:103], v[140:143], a[100:103]
    v_mfma_f32_16x16x32_bf16 a[104:107], v[104:107], v[140:143], a[104:107]
    ds_read_b64_tr_b16 v[74:75], v16 offset:20480
    v_mfma_f32_16x16x32_bf16 a[108:111], v[108:111], v[140:143], a[108:111]
    buffer_load_dwordx4 v18, s[48:51], s16 offen offset:3072 sc1 lds
    s_add_u32 s16, s16, 16384
    v_mfma_f32_16x16x32_bf16 a[112:115], v[112:115], v[140:143], a[112:115]
    ds_read_b64_tr_b16 v[76:77], v17 offset:16384
    v_mfma_f32_16x16x32_bf16 a[116:119], v[116:119], v[140:143], a[116:119]
    v_mfma_f32_16x16x32_bf16 a[120:123], v[120:123], v[140:143], a[120:123]
    ds_read_b64_tr_b16 v[78:79], v17 offset:20480
    v_mfma_f32_16x16x32_bf16 a[124:127], v[124:127], v[140:143], a[124:127]
    v_mfma_f32_16x16x32_bf16 a[128:131], v[96:99], v[144:147], a[128:131]
    ds_read_b64_tr_b16 v[80:81], v14 offset:24576
    v_mfma_f32_16x16x32_bf16 a[132:135], v[100:103], v[144:147], a[132:135]
    v_mfma_f32_16x16x32_bf16 a[136:139], v[104:107], v[144:147], a[136:139]
    ds_read_b64_tr_b16 v[82:83], v14 offset:28672
    v_mfma_f32_16x16x32_bf16 a[140:143], v[108:111], v[144:147], a[140:143]
    s_add_u32 m0, s20, 32768
    s_nop 0
    buffer_load_dwordx4 v204, s[12:15], s17 offen lds
    v_mfma_f32_16x16x32_bf16 a[144:147], v[112:115], v[144:147], a[144:147]
    ds_read_b64_tr_b16 v[84:85], v15 offset:24576
    v_mfma_f32_16x16x32_bf16 a[148:151], v[116:119], v[144:147], a[148:151]
    v_mfma_f32_16x16x32_bf16 a[152:155], v[120:123], v[144:147], a[152:155]
    ds_read_b64_tr_b16 v[86:87], v15 offset:28672
    v_mfma_f32_16x16x32_bf16 a[156:159], v[124:127], v[144:147], a[156:159]
    v_mfma_f32_16x16x32_bf16 a[160:163], v[96:99], v[148:151], a[160:163]
    ds_read_b64_tr_b16 v[88:89], v16 offset:24576
    v_mfma_f32_16x16x32_bf16 a[164:167], v[100:103], v[148:151], a[164:167]
    v_mfma_f32_16x16x32_bf16 a[168:171], v[104:107], v[148:151], a[168:171]
    ds_read_b64_tr_b16 v[90:91], v16 offset:28672
    v_mfma_f32_16x16x32_bf16 a[172:175], v[108:111], v[148:151], a[172:175]
    buffer_load_dwordx4 v205, s[12:15], s17 offen offset:1024 lds
    v_mfma_f32_16x16x32_bf16 a[176:179], v[112:115], v[148:151], a[176:179]
    ds_read_b64_tr_b16 v[92:93], v17 offset:24576
    v_mfma_f32_16x16x32_bf16 a[180:183], v[116:119], v[148:151], a[180:183]
    v_mfma_f32_16x16x32_bf16 a[184:187], v[120:123], v[148:151], a[184:187]
    ds_read_b64_tr_b16 v[94:95], v17 offset:28672
    v_mfma_f32_16x16x32_bf16 a[188:191], v[124:127], v[148:151], a[188:191]
    v_mfma_f32_16x16x32_bf16 a[192:195], v[96:99], v[152:155], a[192:195]
    v_mfma_f32_16x16x32_bf16 a[196:199], v[100:103], v[152:155], a[196:199]
    v_mfma_f32_16x16x32_bf16 a[200:203], v[104:107], v[152:155], a[200:203]
    v_mfma_f32_16x16x32_bf16 a[204:207], v[108:111], v[152:155], a[204:207]
    buffer_load_dwordx4 v206, s[12:15], s17 offen offset:2048 lds
    v_mfma_f32_16x16x32_bf16 a[208:211], v[112:115], v[152:155], a[208:211]
    v_mfma_f32_16x16x32_bf16 a[212:215], v[116:119], v[152:155], a[212:215]
    v_mfma_f32_16x16x32_bf16 a[216:219], v[120:123], v[152:155], a[216:219]
    v_mfma_f32_16x16x32_bf16 a[220:223], v[124:127], v[152:155], a[220:223]
    v_mfma_f32_16x16x32_bf16 a[224:227], v[96:99], v[156:159], a[224:227]
    v_mfma_f32_16x16x32_bf16 a[228:231], v[100:103], v[156:159], a[228:231]
    v_mfma_f32_16x16x32_bf16 a[232:235], v[104:107], v[156:159], a[232:235]
    v_mfma_f32_16x16x32_bf16 a[236:239], v[108:111], v[156:159], a[236:239]
    buffer_load_dwordx4 v207, s[12:15], s17 offen offset:3072 lds
    s_add_u32 s17, s17, s18
    v_mfma_f32_16x16x32_bf16 a[240:243], v[112:115], v[156:159], a[240:243]
    v_mfma_f32_16x16x32_bf16 a[244:247], v[116:119], v[156:159], a[244:247]
    v_mfma_f32_16x16x32_bf16 a[248:251], v[120:123], v[156:159], a[248:251]
    v_mfma_f32_16x16x32_bf16 a[252:255], v[124:127], v[156:159], a[252:255]
    s_waitcnt vmcnt(48) lgkmcnt(0)
    s_barrier
    v_mfma_f32_16x16x32_bf16 a[0:3], v[32:35], v[64:67], a[0:3]
    ds_read_b64_tr_b16 v[128:129], v14 offset:49152
    v_mfma_f32_16x16x32_bf16 a[4:7], v[36:39], v[64:67], a[4:7]
    v_mfma_f32_16x16x32_bf16 a[8:11], v[40:43], v[64:67], a[8:11]
    ds_read_b64_tr_b16 v[130:131], v14 offset:53248
    v_mfma_f32_16x16x32_bf16 a[12:15], v[44:47], v[64:67], a[12:15]
    s_add_u32 m0, s19, 65536
    s_nop 0
    buffer_load_dwordx4 v18, s[48:51], s16 offen sc1 lds
    v_mfma_f32_16x16x32_bf16 a[16:19], v[48:51], v[64:67], a[16:19]
    ds_read_b128 v[96:99], v9 offset:32768
    v_mfma_f32_16x16x32_bf16 a[20:23], v[52:55], v[64:67], a[20:23]
    v_mfma_f32_16x16x32_bf16 a[24:27], v[56:59], v[64:67], a[24:27]
    ds_read_b128 v[100:103], v9 offset:33024
    v_mfma_f32_16x16x32_bf16 a[28:31], v[60:63], v[64:67], a[28:31]
    v_mfma_f32_16x16x32_bf16 a[32:35], v[32:35], v[68:71], a[32:35]
    ds_read_b128 v[104:107], v9 offset:33280
    v_mfma_f32_16x16x32_bf16 a[36:39], v[36:39], v[68:71], a[36:39]
    v_mfma_f32_16x16x32_bf16 a[40:43], v[40:43], v[68:71], a[40:43]
    ds_read_b128 v[108:111], v9 offset:33536
    v_mfma_f32_16x16x32_bf16 a[44:47], v[44:47], v[68:71], a[44:47]
    buffer_load_dwordx4 v18, s[48:51], s16 offen offset:1024 sc1 lds
    v_mfma_f32_16x16x32_bf16 a[48:51], v[48:51], v[68:71], a[48:51]
    ds_read_b128 v[112:115], v9 offset:33792
    v_mfma_f32_16x16x32_bf16 a[52:55], v[52:55], v[68:71], a[52:55]
    v_mfma_f32_16x16x32_bf16 a[56:59], v[56:59], v[68:71], a[56:59]
    ds_read_b128 v[116:119], v9 offset:34048
    v_mfma_f32_16x16x32_bf16 a[60:63], v[60:63], v[68:71], a[60:63]
    v_mfma_f32_16x16x32_bf16 a[64:67], v[32:35], v[72:75], a[64:67]
    ds_read_b128 v[120:123], v9 offset:34304
    v_mfma_f32_16x16x32_bf16 a[68:71], v[36:39], v[72:75], a[68:71]
    v_mfma_f32_16x16x32_bf16 a[72:75], v[40:43], v[72:75], a[72:75]
    ds_read_b128 v[124:127], v9 offset:34560
    v_mfma_f32_16x16x32_bf16 a[76:79], v[44:47], v[72:75], a[76:79]
    buffer_load_dwordx4 v18, s[48:51], s16 offen offset:2048 sc1 lds
    v_mfma_f32_16x16x32_bf16 a[80:83], v[48:51], v[72:75], a[80:83]
    ds_read_b64_tr_b16 v[132:133], v15 offset:49152
    v_mfma_f32_16x16x32_bf16 a[84:87], v[52:55], v[72:75], a[84:87]
    v_mfma_f32_16x16x32_bf16 a[88:91], v[56:59], v[72:75], a[88:91]
    ds_read_b64_tr_b16 v[134:135], v15 offset:53248
    v_mfma_f32_16x16x32_bf16 a[92:95], v[60:63], v[72:75], a[92:95]
    v_mfma_f32_16x16x32_bf16 a[96:99], v[32:35], v[76:79], a[96:99]
    ds_read_b64_tr_b16 v[136:137], v16 offset:49152
    v_mfma_f32_16x16x32_bf16 a[100:103], v[36:39], v[76:79], a[100:103]
    v_mfma_f32_16x16x32_bf16 a[104:107], v[40:43], v[76:79], a[104:107]
    ds_read_b64_tr_b16 v[138:139], v16 offset:53248
    v_mfma_f32_16x16x32_bf16 a[108:111], v[44:47], v[76:79], a[108:111]
    buffer_load_dwordx4 v18, s[48:51], s16 offen offset:3072 sc1 lds
    s_add_u32 s16, s16, 16384
    v_mfma_f32_16x16x32_bf16 a[112:115], v[48:51], v[76:79], a[112:115]
    ds_read_b64_tr_b16 v[140:141], v17 offset:49152
    v_mfma_f32_16x16x32_bf16 a[116:119], v[52:55], v[76:79], a[116:119]
    v_mfma_f32_16x16x32_bf16 a[120:123], v[56:59], v[76:79], a[120:123]
    ds_read_b64_tr_b16 v[142:143], v17 offset:53248
    v_mfma_f32_16x16x32_bf16 a[124:127], v[60:63], v[76:79], a[124:127]
    v_mfma_f32_16x16x32_bf16 a[128:131], v[32:35], v[80:83], a[128:131]
    ds_read_b64_tr_b16 v[144:145], v14 offset:57344
    v_mfma_f32_16x16x32_bf16 a[132:135], v[36:39], v[80:83], a[132:135]
    v_mfma_f32_16x16x32_bf16 a[136:139], v[40:43], v[80:83], a[136:139]
    ds_read_b64_tr_b16 v[146:147], v14 offset:61440
    v_mfma_f32_16x16x32_bf16 a[140:143], v[44:47], v[80:83], a[140:143]
    s_add_u32 m0, s20, 65536
    s_nop 0
    buffer_load_dwordx4 v204, s[12:15], s17 offen lds
    v_mfma_f32_16x16x32_bf16 a[144:147], v[48:51], v[80:83], a[144:147]
    ds_read_b64_tr_b16 v[148:149], v15 offset:57344
    v_mfma_f32_16x16x32_bf16 a[148:151], v[52:55], v[80:83], a[148:151]
    v_mfma_f32_16x16x32_bf16 a[152:155], v[56:59], v[80:83], a[152:155]
    ds_read_b64_tr_b16 v[150:151], v15 offset:61440
    v_mfma_f32_16x16x32_bf16 a[156:159], v[60:63], v[80:83], a[156:159]
    v_mfma_f32_16x16x32_bf16 a[160:163], v[32:35], v[84:87], a[160:163]
    ds_read_b64_tr_b16 v[152:153], v16 offset:57344
    v_mfma_f32_16x16x32_bf16 a[164:167], v[36:39], v[84:87], a[164:167]
    v_mfma_f32_16x16x32_bf16 a[168:171], v[40:43], v[84:87], a[168:171]
    ds_read_b64_tr_b16 v[154:155], v16 offset:61440
    v_mfma_f32_16x16x32_bf16 a[172:175], v[44:47], v[84:87], a[172:175]
    buffer_load_dwordx4 v205, s[12:15], s17 offen offset:1024 lds
    v_mfma_f32_16x16x32_bf16 a[176:179], v[48:51], v[84:87], a[176:179]
    ds_read_b64_tr_b16 v[156:157], v17 offset:57344
    v_mfma_f32_16x16x32_bf16 a[180:183], v[52:55], v[84:87], a[180:183]
    v_mfma_f32_16x16x32_bf16 a[184:187], v[56:59], v[84:87], a[184:187]
    ds_read_b64_tr_b16 v[158:159], v17 offset:61440
    v_mfma_f32_16x16x32_bf16 a[188:191], v[60:63], v[84:87], a[188:191]
    v_mfma_f32_16x16x32_bf16 a[192:195], v[32:35], v[88:91], a[192:195]
    v_mfma_f32_16x16x32_bf16 a[196:199], v[36:39], v[88:91], a[196:199]
    v_mfma_f32_16x16x32_bf16 a[200:203], v[40:43], v[88:91], a[200:203]
    v_mfma_f32_16x16x32_bf16 a[204:207], v[44:47], v[88:91], a[204:207]
    buffer_load_dwordx4 v206, s[12:15], s17 offen offset:2048 lds
    v_mfma_f32_16x16x32_bf16 a[208:211], v[48:51], v[88:91], a[208:211]
    v_mfma_f32_16x16x32_bf16 a[212:215], v[52:55], v[88:91], a[212:215]
    v_mfma_f32_16x16x32_bf16 a[216:219], v[56:59], v[88:91], a[216:219]
    v_mfma_f32_16x16x32_bf16 a[220:223], v[60:63], v[88:91], a[220:223]
    v_mfma_f32_16x16x32_bf16 a[224:227], v[32:35], v[92:95], a[224:227]
    v_mfma_f32_16x16x32_bf16 a[228:231], v[36:39], v[92:95], a[228:231]
    v_mfma_f32_16x16x32_bf16 a[232:235], v[40:43], v[92:95], a[232:235]
    v_mfma_f32_16x16x32_bf16 a[236:239], v[44:47], v[92:95], a[236:239]
    buffer_load_dwordx4 v207, s[12:15], s17 offen offset:3072 lds
    s_add_u32 s17, s17, s18
    v_mfma_f32_16x16x32_bf16 a[240:243], v[48:51], v[92:95], a[240:243]
    v_mfma_f32_16x16x32_bf16 a[244:247], v[52:55], v[92:95], a[244:247]
    v_mfma_f32_16x16x32_bf16 a[248:251], v[56:59], v[92:95], a[248:251]
    v_mfma_f32_16x16x32_bf16 a[252:255], v[60:63], v[92:95], a[252:255]
    s_waitcnt vmcnt(16) lgkmcnt(0)
    s_barrier
    v_mfma_f32_16x16x32_bf16 a[0:3], v[96:99], v[128:131], a[0:3]
    ds_read_b64_tr_b16 v[64:65], v10 offset:16384
    v_mfma_f32_16x16x32_bf16 a[4:7], v[100:103], v[128:131], a[4:7]
    buffer_atomic_add v24, v23, s[8:11], s62 offen sc1
    v_mfma_f32_16x16x32_bf16 a[8:11], v[104:107], v[128:131], a[8:11]
    ds_read_b64_tr_b16 v[66:67], v10 offset:20480
    v_mfma_f32_16x16x32_bf16 a[12:15], v[108:111], v[128:131], a[12:15]
    s_add_u32 m0, s19, 98304
    s_nop 0
    buffer_load_dwordx4 v18, s[48:51], s16 offen sc1 lds
    v_mfma_f32_16x16x32_bf16 a[16:19], v[112:115], v[128:131], a[16:19]
    ds_read_b128 v[32:35], v8 offset:0
    v_mfma_f32_16x16x32_bf16 a[20:23], v[116:119], v[128:131], a[20:23]
    v_mfma_f32_16x16x32_bf16 a[24:27], v[120:123], v[128:131], a[24:27]
    ds_read_b128 v[36:39], v8 offset:256
    v_mfma_f32_16x16x32_bf16 a[28:31], v[124:127], v[128:131], a[28:31]
    v_mfma_f32_16x16x32_bf16 a[32:35], v[96:99], v[132:135], a[32:35]
    ds_read_b128 v[40:43], v8 offset:512
    v_mfma_f32_16x16x32_bf16 a[36:39], v[100:103], v[132:135], a[36:39]
    v_mfma_f32_16x16x32_bf16 a[40:43], v[104:107], v[132:135], a[40:43]
    ds_read_b128 v[44:47], v8 offset:768
    v_mfma_f32_16x16x32_bf16 a[44:47], v[108:111], v[132:135], a[44:47]
    buffer_load_dwordx4 v18, s[48:51], s16 offen offset:1024 sc1 lds
    v_mfma_f32_16x16x32_bf16 a[48:51], v[112:115], v[132:135], a[48:51]
    ds_read_b128 v[48:51], v8 offset:1024
    v_mfma_f32_16x16x32_bf16 a[52:55], v[116:119], v[132:135], a[52:55]
    v_mfma_f32_16x16x32_bf16 a[56:59], v[120:123], v[132:135], a[56:59]
    ds_read_b128 v[52:55], v8 offset:1280
    v_mfma_f32_16x16x32_bf16 a[60:63], v[124:127], v[132:135], a[60:63]
    v_mfma_f32_16x16x32_bf16 a[64:67], v[96:99], v[136:139], a[64:67]
    ds_read_b128 v[56:59], v8 offset:1536
    v_mfma_f32_16x16x32_bf16 a[68:71], v[100:103], v[136:139], a[68:71]
    v_mfma_f32_16x16x32_bf16 a[72:75], v[104:107], v[136:139], a[72:75]
    ds_read_b128 v[60:63], v8 offset:1792
    v_mfma_f32_16x16x32_bf16 a[76:79], v[108:111], v[136:139], a[76:79]
    buffer_load_dwordx4 v18, s[48:51], s16 offen offset:2048 sc1 lds
    v_mfma_f32_16x16x32_bf16 a[80:83], v[112:115], v[136:139], a[80:83]
    ds_read_b64_tr_b16 v[68:69], v11 offset:16384
    v_mfma_f32_16x16x32_bf16 a[84:87], v[116:119], v[136:139], a[84:87]
    v_mfma_f32_16x16x32_bf16 a[88:91], v[120:123], v[136:139], a[88:91]
    ds_read_b64_tr_b16 v[70:71], v11 offset:20480
    v_mfma_f32_16x16x32_bf16 a[92:95], v[124:127], v[136:139], a[92:95]
    v_mfma_f32_16x16x32_bf16 a[96:99], v[96:99], v[140:143], a[96:99]
    ds_read_b64_tr_b16 v[72:73], v12 offset:16384
    v_mfma_f32_16x16x32_bf16 a[100:103], v[100:103], v[140:143], a[100:103]
    v_mfma_f32_16x16x32_bf16 a[104:107], v[104:107], v[140:143], a[104:107]
    ds_read_b64_tr_b16 v[74:75], v12 offset:20480
    v_mfma_f32_16x16x32_bf16 a[108:111], v[108:111], v[140:143], a[108:111]
    buffer_load_dwordx4 v18, s[48:51], s16 offen offset:3072 sc1 lds
    s_add_u32 s16, s16, 16384
    v_mfma_f32_16x16x32_bf16 a[112:115], v[112:115], v[140:143], a[112:115]
    ds_read_b64_tr_b16 v[76:77], v13 offset:16384
    v_mfma_f32_16x16x32_bf16 a[116:119], v[116:119], v[140:143], a[116:119]
    v_mfma_f32_16x16x32_bf16 a[120:123], v[120:123], v[140:143], a[120:123]
    ds_read_b64_tr_b16 v[78:79], v13 offset:20480
    v_mfma_f32_16x16x32_bf16 a[124:127], v[124:127], v[140:143], a[124:127]
    v_mfma_f32_16x16x32_bf16 a[128:131], v[96:99], v[144:147], a[128:131]
    ds_read_b64_tr_b16 v[80:81], v10 offset:24576
    v_mfma_f32_16x16x32_bf16 a[132:135], v[100:103], v[144:147], a[132:135]
    v_mfma_f32_16x16x32_bf16 a[136:139], v[104:107], v[144:147], a[136:139]
    ds_read_b64_tr_b16 v[82:83], v10 offset:28672
    v_mfma_f32_16x16x32_bf16 a[140:143], v[108:111], v[144:147], a[140:143]
    s_add_u32 m0, s20, 98304
    s_nop 0
    buffer_load_dwordx4 v204, s[12:15], s17 offen lds
    v_mfma_f32_16x16x32_bf16 a[144:147], v[112:115], v[144:147], a[144:147]
    ds_read_b64_tr_b16 v[84:85], v11 offset:24576
    v_mfma_f32_16x16x32_bf16 a[148:151], v[116:119], v[144:147], a[148:151]
    v_mfma_f32_16x16x32_bf16 a[152:155], v[120:123], v[144:147], a[152:155]
    ds_read_b64_tr_b16 v[86:87], v11 offset:28672
    v_mfma_f32_16x16x32_bf16 a[156:159], v[124:127], v[144:147], a[156:159]
    v_mfma_f32_16x16x32_bf16 a[160:163], v[96:99], v[148:151], a[160:163]
    ds_read_b64_tr_b16 v[88:89], v12 offset:24576
    v_mfma_f32_16x16x32_bf16 a[164:167], v[100:103], v[148:151], a[164:167]
    v_mfma_f32_16x16x32_bf16 a[168:171], v[104:107], v[148:151], a[168:171]
    ds_read_b64_tr_b16 v[90:91], v12 offset:28672
    v_mfma_f32_16x16x32_bf16 a[172:175], v[108:111], v[148:151], a[172:175]
    buffer_load_dwordx4 v205, s[12:15], s17 offen offset:1024 lds
    v_mfma_f32_16x16x32_bf16 a[176:179], v[112:115], v[148:151], a[176:179]
    ds_read_b64_tr_b16 v[92:93], v13 offset:24576
    v_mfma_f32_16x16x32_bf16 a[180:183], v[116:119], v[148:151], a[180:183]
    v_mfma_f32_16x16x32_bf16 a[184:187], v[120:123], v[148:151], a[184:187]
    ds_read_b64_tr_b16 v[94:95], v13 offset:28672
    v_mfma_f32_16x16x32_bf16 a[188:191], v[124:127], v[148:151], a[188:191]
    v_mfma_f32_16x16x32_bf16 a[192:195], v[96:99], v[152:155], a[192:195]
    v_mfma_f32_16x16x32_bf16 a[196:199], v[100:103], v[152:155], a[196:199]
    v_mfma_f32_16x16x32_bf16 a[200:203], v[104:107], v[152:155], a[200:203]
    v_mfma_f32_16x16x32_bf16 a[204:207], v[108:111], v[152:155], a[204:207]
    buffer_load_dwordx4 v206, s[12:15], s17 offen offset:2048 lds
    v_mfma_f32_16x16x32_bf16 a[208:211], v[112:115], v[152:155], a[208:211]
    v_mfma_f32_16x16x32_bf16 a[212:215], v[116:119], v[152:155], a[212:215]
    v_mfma_f32_16x16x32_bf16 a[216:219], v[120:123], v[152:155], a[216:219]
    v_mfma_f32_16x16x32_bf16 a[220:223], v[124:127], v[152:155], a[220:223]
    v_mfma_f32_16x16x32_bf16 a[224:227], v[96:99], v[156:159], a[224:227]
    v_mfma_f32_16x16x32_bf16 a[228:231], v[100:103], v[156:159], a[228:231]
    v_mfma_f32_16x16x32_bf16 a[232:235], v[104:107], v[156:159], a[232:235]
    v_mfma_f32_16x16x32_bf16 a[236:239], v[108:111], v[156:159], a[236:239]
    buffer_load_dwordx4 v207, s[12:15], s17 offen offset:3072 lds
    s_add_u32 s17, s17, s18
    v_mfma_f32_16x16x32_bf16 a[240:243], v[112:115], v[156:159], a[240:243]
    v_mfma_f32_16x16x32_bf16 a[244:247], v[116:119], v[156:159], a[244:247]
    v_mfma_f32_16x16x32_bf16 a[248:251], v[120:123], v[156:159], a[248:251]
    v_mfma_f32_16x16x32_bf16 a[252:255], v[124:127], v[156:159], a[252:255]
Lmid_188:
    s_cmp_eq_u32 s21, 1
    s_cbranch_scc1 Lsw_189
Lswb_190:
    s_waitcnt vmcnt(16) lgkmcnt(0)
    s_barrier
    v_mfma_f32_16x16x32_bf16 a[0:3], v[32:35], v[64:67], a[0:3]
    ds_read_b64_tr_b16 v[128:129], v10 offset:49152
    v_mfma_f32_16x16x32_bf16 a[4:7], v[36:39], v[64:67], a[4:7]
    v_mfma_f32_16x16x32_bf16 a[8:11], v[40:43], v[64:67], a[8:11]
    ds_read_b64_tr_b16 v[130:131], v10 offset:53248
    v_mfma_f32_16x16x32_bf16 a[12:15], v[44:47], v[64:67], a[12:15]
    s_add_u32 m0, s19, 0
    s_nop 0
    buffer_load_dwordx4 v18, s[48:51], s16 offen sc1 lds
    v_mfma_f32_16x16x32_bf16 a[16:19], v[48:51], v[64:67], a[16:19]
    ds_read_b128 v[96:99], v8 offset:32768
    v_mfma_f32_16x16x32_bf16 a[20:23], v[52:55], v[64:67], a[20:23]
    v_mfma_f32_16x16x32_bf16 a[24:27], v[56:59], v[64:67], a[24:27]
    ds_read_b128 v[100:103], v8 offset:33024
    v_mfma_f32_16x16x32_bf16 a[28:31], v[60:63], v[64:67], a[28:31]
    v_mfma_f32_16x16x32_bf16 a[32:35], v[32:35], v[68:71], a[32:35]
    ds_read_b128 v[104:107], v8 offset:33280
    v_mfma_f32_16x16x32_bf16 a[36:39], v[36:39], v[68:71], a[36:39]
    v_mfma_f32_16x16x32_bf16 a[40:43], v[40:43], v[68:71], a[40:43]
    ds_read_b128 v[108:111], v8 offset:33536
    v_mfma_f32_16x16x32_bf16 a[44:47], v[44:47], v[68:71], a[44:47]
    buffer_load_dwordx4 v18, s[48:51], s16 offen offset:1024 sc1 lds
    v_mfma_f32_16x16x32_bf16 a[48:51], v[48:51], v[68:71], a[48:51]
    ds_read_b128 v[112:115], v8 offset:33792
    v_mfma_f32_16x16x32_bf16 a[52:55], v[52:55], v[68:71], a[52:55]
    v_mfma_f32_16x16x32_bf16 a[56:59], v[56:59], v[68:71], a[56:59]
    ds_read_b128 v[116:119], v8 offset:34048
    v_mfma_f32_16x16x32_bf16 a[60:63], v[60:63], v[68:71], a[60:63]
    v_mfma_f32_16x16x32_bf16 a[64:67], v[32:35], v[72:75], a[64:67]
    ds_read_b128 v[120:123], v8 offset:34304
    v_mfma_f32_16x16x32_bf16 a[68:71], v[36:39], v[72:75], a[68:71]
    v_mfma_f32_16x16x32_bf16 a[72:75], v[40:43], v[72:75], a[72:75]
    ds_read_b128 v[124:127], v8 offset:34560
    v_mfma_f32_16x16x32_bf16 a[76:79], v[44:47], v[72:75], a[76:79]
    buffer_load_dwordx4 v18, s[48:51], s16 offen offset:2048 sc1 lds
    v_mfma_f32_16x16x32_bf16 a[80:83], v[48:51], v[72:75], a[80:83]
    ds_read_b64_tr_b16 v[132:133], v11 offset:49152
    v_mfma_f32_16x16x32_bf16 a[84:87], v[52:55], v[72:75], a[84:87]
    v_mfma_f32_16x16x32_bf16 a[88:91], v[56:59], v[72:75], a[88:91]
    ds_read_b64_tr_b16 v[134:135], v11 offset:53248
    v_mfma_f32_16x16x32_bf16 a[92:95], v[60:63], v[72:75], a[92:95]
    v_mfma_f32_16x16x32_bf16 a[96:99], v[32:35], v[76:79], a[96:99]
    ds_read_b64_tr_b16 v[136:137], v12 offset:49152
    v_mfma_f32_16x16x32_bf16 a[100:103], v[36:39], v[76:79], a[100:103]
    v_mfma_f32_16x16x32_bf16 a[104:107], v[40:43], v[76:79], a[104:107]
    ds_read_b64_tr_b16 v[138:139], v12 offset:53248
    v_mfma_f32_16x16x32_bf16 a[108:111], v[44:47], v[76:79], a[108:111]
    buffer_load_dwordx4 v18, s[48:51], s16 offen offset:3072 sc1 lds
    s_add_u32 s16, s16, 16384
    v_mfma_f32_16x16x32_bf16 a[112:115], v[48:51], v[76:79], a[112:115]
    ds_read_b64_tr_b16 v[140:141], v13 offset:49152
    v_mfma_f32_16x16x32_bf16 a[116:119], v[52:55], v[76:79], a[116:119]
    v_mfma_f32_16x16x32_bf16 a[120:123], v[56:59], v[76:79], a[120:123]
    ds_read_b64_tr_b16 v[142:143], v13 offset:53248
    v_mfma_f32_16x16x32_bf16 a[124:127], v[60:63], v[76:79], a[124:127]
    v_mfma_f32_16x16x32_bf16 a[128:131], v[32:35], v[80:83], a[128:131]
    ds_read_b64_tr_b16 v[144:145], v10 offset:57344
    v_mfma_f32_16x16x32_bf16 a[132:135], v[36:39], v[80:83], a[132:135]
    v_mfma_f32_16x16x32_bf16 a[136:139], v[40:43], v[80:83], a[136:139]
    ds_read_b64_tr_b16 v[146:147], v10 offset:61440
    v_mfma_f32_16x16x32_bf16 a[140:143], v[44:47], v[80:83], a[140:143]
    s_add_u32 m0, s20, 0
    s_nop 0
    buffer_load_dwordx4 v204, s[12:15], s17 offen lds
    v_mfma_f32_16x16x32_bf16 a[144:147], v[48:51], v[80:83], a[144:147]
    ds_read_b64_tr_b16 v[148:149], v11 offset:57344
    v_mfma_f32_16x16x32_bf16 a[148:151], v[52:55], v[80:83], a[148:151]
    v_mfma_f32_16x16x32_bf16 a[152:155], v[56:59], v[80:83], a[152:155]
    ds_read_b64_tr_b16 v[150:151], v11 offset:61440
    v_mfma_f32_16x16x32_bf16 a[156:159], v[60:63], v[80:83], a[156:159]
    v_mfma_f32_16x16x32_bf16 a[160:163], v[32:35], v[84:87], a[160:163]
    ds_read_b64_tr_b16 v[152:153], v12 offset:57344
    v_mfma_f32_16x16x32_bf16 a[164:167], v[36:39], v[84:87], a[164:167]
    v_mfma_f32_16x16x32_bf16 a[168:171], v[40:43], v[84:87], a[168:171]
    ds_read_b64_tr_b16 v[154:155], v12 offset:61440
    v_mfma_f32_16x16x32_bf16 a[172:175], v[44:47], v[84:87], a[172:175]
    buffer_load_dwordx4 v205, s[12:15], s17 offen offset:1024 lds
    v_mfma_f32_16x16x32_bf16 a[176:179], v[48:51], v[84:87], a[176:179]
    ds_read_b64_tr_b16 v[156:157], v13 offset:57344
    v_mfma_f32_16x16x32_bf16 a[180:183], v[52:55], v[84:87], a[180:183]
    v_mfma_f32_16x16x32_bf16 a[184:187], v[56:59], v[84:87], a[184:187]
    ds_read_b64_tr_b16 v[158:159], v13 offset:61440
    v_mfma_f32_16x16x32_bf16 a[188:191], v[60:63], v[84:87], a[188:191]
    v_mfma_f32_16x16x32_bf16 a[192:195], v[32:35], v[88:91], a[192:195]
    v_mfma_f32_16x16x32_bf16 a[196:199], v[36:39], v[88:91], a[196:199]
    v_mfma_f32_16x16x32_bf16 a[200:203], v[40:43], v[88:91], a[200:203]
    v_mfma_f32_16x16x32_bf16 a[204:207], v[44:47], v[88:91], a[204:207]
    buffer_load_dwordx4 v206, s[12:15], s17 offen offset:2048 lds
    v_mfma_f32_16x16x32_bf16 a[208:211], v[48:51], v[88:91], a[208:211]
    v_mfma_f32_16x16x32_bf16 a[212:215], v[52:55], v[88:91], a[212:215]
    v_mfma_f32_16x16x32_bf16 a[216:219], v[56:59], v[88:91], a[216:219]
    v_mfma_f32_16x16x32_bf16 a[220:223], v[60:63], v[88:91], a[220:223]
    v_mfma_f32_16x16x32_bf16 a[224:227], v[32:35], v[92:95], a[224:227]
    v_mfma_f32_16x16x32_bf16 a[228:231], v[36:39], v[92:95], a[228:231]
    v_mfma_f32_16x16x32_bf16 a[232:235], v[40:43], v[92:95], a[232:235]
    v_mfma_f32_16x16x32_bf16 a[236:239], v[44:47], v[92:95], a[236:239]
    buffer_load_dwordx4 v207, s[12:15], s17 offen offset:3072 lds
    s_add_u32 s17, s17, s18
    v_mfma_f32_16x16x32_bf16 a[240:243], v[48:51], v[92:95], a[240:243]
    v_mfma_f32_16x16x32_bf16 a[244:247], v[52:55], v[92:95], a[244:247]
    v_mfma_f32_16x16x32_bf16 a[248:251], v[56:59], v[92:95], a[248:251]
    v_mfma_f32_16x16x32_bf16 a[252:255], v[60:63], v[92:95], a[252:255]
    s_waitcnt vmcnt(16) lgkmcnt(0)
    s_barrier
    v_mfma_f32_16x16x32_bf16 a[0:3], v[96:99], v[128:131], a[0:3]
    ds_read_b64_tr_b16 v[64:65], v14 offset:16384
    v_mfma_f32_16x16x32_bf16 a[4:7], v[100:103], v[128:131], a[4:7]
    v_mfma_f32_16x16x32_bf16 a[8:11], v[104:107], v[128:131], a[8:11]
    ds_read_b64_tr_b16 v[66:67], v14 offset:20480
    v_mfma_f32_16x16x32_bf16 a[12:15], v[108:111], v[128:131], a[12:15]
    s_add_u32 m0, s19, 32768
    s_nop 0
    buffer_load_dwordx4 v18, s[48:51], s16 offen sc1 lds
    v_mfma_f32_16x16x32_bf16 a[16:19], v[112:115], v[128:131], a[16:19]
    ds_read_b128 v[32:35], v9 offset:0
    v_mfma_f32_16x16x32_bf16 a[20:23], v[116:119], v[128:131], a[20:23]
    v_mfma_f32_16x16x32_bf16 a[24:27], v[120:123], v[128:131], a[24:27]
    ds_read_b128 v[36:39], v9 offset:256
    v_mfma_f32_16x16x32_bf16 a[28:31], v[124:127], v[128:131], a[28:31]
    v_mfma_f32_16x16x32_bf16 a[32:35], v[96:99], v[132:135], a[32:35]
    ds_read_b128 v[40:43], v9 offset:512
    v_mfma_f32_16x16x32_bf16 a[36:39], v[100:103], v[132:135], a[36:39]
    v_mfma_f32_16x16x32_bf16 a[40:43], v[104:107], v[132:135], a[40:43]
    ds_read_b128 v[44:47], v9 offset:768
    v_mfma_f32_16x16x32_bf16 a[44:47], v[108:111], v[132:135], a[44:47]
    buffer_load_dwordx4 v18, s[48:51], s16 offen offset:1024 sc1 lds
    v_mfma_f32_16x16x32_bf16 a[48:51], v[112:115], v[132:135], a[48:51]
    ds_read_b128 v[48:51], v9 offset:1024
    v_mfma_f32_16x16x32_bf16 a[52:55], v[116:119], v[132:135], a[52:55]
    v_mfma_f32_16x16x32_bf16 a[56:59], v[120:123], v[132:135], a[56:59]
    ds_read_b128 v[52:55], v9 offset:1280
    v_mfma_f32_16x16x32_bf16 a[60:63], v[124:127], v[132:135], a[60:63]
    v_mfma_f32_16x16x32_bf16 a[64:67], v[96:99], v[136:139], a[64:67]
    ds_read_b128 v[56:59], v9 offset:1536
    v_mfma_f32_16x16x32_bf16 a[68:71], v[100:103], v[136:139], a[68:71]
    v_mfma_f32_16x16x32_bf16 a[72:75], v[104:107], v[136:139], a[72:75]
    ds_read_b128 v[60:63], v9 offset:1792
    v_mfma_f32_16x16x32_bf16 a[76:79], v[108:111], v[136:139], a[76:79]
    buffer_load_dwordx4 v18, s[48:51], s16 offen offset:2048 sc1 lds
    v_mfma_f32_16x16x32_bf16 a[80:83], v[112:115], v[136:139], a[80:83]
    ds_read_b64_tr_b16 v[68:69], v15 offset:16384
    v_mfma_f32_16x16x32_bf16 a[84:87], v[116:119], v[136:139], a[84:87]
    v_mfma_f32_16x16x32_bf16 a[88:91], v[120:123], v[136:139], a[88:91]
    ds_read_b64_tr_b16 v[70:71], v15 offset:20480
    v_mfma_f32_16x16x32_bf16 a[92:95], v[124:127], v[136:139], a[92:95]
    v_mfma_f32_16x16x32_bf16 a[96:99], v[96:99], v[140:143], a[96:99]
    ds_read_b64_tr_b16 v[72:73], v16 offset:16384
    v_mfma_f32_16x16x32_bf16 a[100:103], v[100:103], v[140:143], a[100:103]
    v_mfma_f32_16x16x32_bf16 a[104:107], v[104:107], v[140:143], a[104:107]
    ds_read_b64_tr_b16 v[74:75], v16 offset:20480
    v_mfma_f32_16x16x32_bf16 a[108:111], v[108:111], v[140:143], a[108:111]
    buffer_load_dwordx4 v18, s[48:51], s16 offen offset:3072 sc1 lds
    s_add_u32 s16, s16, 16384
    v_mfma_f32_16x16x32_bf16 a[112:115], v[112:115], v[140:143], a[112:115]
    ds_read_b64_tr_b16 v[76:77], v17 offset:16384
    v_mfma_f32_16x16x32_bf16 a[116:119], v[116:119], v[140:143], a[116:119]
    v_mfma_f32_16x16x32_bf16 a[120:123], v[120:123], v[140:143], a[120:123]
    ds_read_b64_tr_b16 v[78:79], v17 offset:20480
    v_mfma_f32_16x16x32_bf16 a[124:127], v[124:127], v[140:143], a[124:127]
    v_mfma_f32_16x16x32_bf16 a[128:131], v[96:99], v[144:147], a[128:131]
    ds_read_b64_tr_b16 v[80:81], v14 offset:24576
    v_mfma_f32_16x16x32_bf16 a[132:135], v[100:103], v[144:147], a[132:135]
    v_mfma_f32_16x16x32_bf16 a[136:139], v[104:107], v[144:147], a[136:139]
    ds_read_b64_tr_b16 v[82:83], v14 offset:28672
    v_mfma_f32_16x16x32_bf16 a[140:143], v[108:111], v[144:147], a[140:143]
    s_add_u32 m0, s20, 32768
    s_nop 0
    buffer_load_dwordx4 v204, s[12:15], s17 offen lds
    v_mfma_f32_16x16x32_bf16 a[144:147], v[112:115], v[144:147], a[144:147]
    ds_read_b64_tr_b16 v[84:85], v15 offset:24576
    v_mfma_f32_16x16x32_bf16 a[148:151], v[116:119], v[144:147], a[148:151]
    v_mfma_f32_16x16x32_bf16 a[152:155], v[120:123], v[144:147], a[152:155]
    ds_read_b64_tr_b16 v[86:87], v15 offset:28672
    v_mfma_f32_16x16x32_bf16 a[156:159], v[124:127], v[144:147], a[156:159]
    v_mfma_f32_16x16x32_bf16 a[160:163], v[96:99], v[148:151], a[160:163]
    ds_read_b64_tr_b16 v[88:89], v16 offset:24576
    v_mfma_f32_16x16x32_bf16 a[164:167], v[100:103], v[148:151], a[164:167]
    v_mfma_f32_16x16x32_bf16 a[168:171], v[104:107], v[148:151], a[168:171]
    ds_read_b64_tr_b16 v[90:91], v16 offset:28672
    v_mfma_f32_16x16x32_bf16 a[172:175], v[108:111], v[148:151], a[172:175]
    buffer_load_dwordx4 v205, s[12:15], s17 offen offset:1024 lds
    v_mfma_f32_16x16x32_bf16 a[176:179], v[112:115], v[148:151], a[176:179]
    ds_read_b64_tr_b16 v[92:93], v17 offset:24576
    v_mfma_f32_16x16x32_bf16 a[180:183], v[116:119], v[148:151], a[180:183]
    v_mfma_f32_16x16x32_bf16 a[184:187], v[120:123], v[148:151], a[184:187]
    ds_read_b64_tr_b16 v[94:95], v17 offset:28672
    v_mfma_f32_16x16x32_bf16 a[188:191], v[124:127], v[148:151], a[188:191]
    v_mfma_f32_16x16x32_bf16 a[192:195], v[96:99], v[152:155], a[192:195]
    v_mfma_f32_16x16x32_bf16 a[196:199], v[100:103], v[152:155], a[196:199]
    v_mfma_f32_16x16x32_bf16 a[200:203], v[104:107], v[152:155], a[200:203]
    v_mfma_f32_16x16x32_bf16 a[204:207], v[108:111], v[152:155], a[204:207]
    buffer_load_dwordx4 v206, s[12:15], s17 offen offset:2048 lds
    v_mfma_f32_16x16x32_bf16 a[208:211], v[112:115], v[152:155], a[208:211]
    v_mfma_f32_16x16x32_bf16 a[212:215], v[116:119], v[152:155], a[212:215]
    v_mfma_f32_16x16x32_bf16 a[216:219], v[120:123], v[152:155], a[216:219]
    v_mfma_f32_16x16x32_bf16 a[220:223], v[124:127], v[152:155], a[220:223]
    v_mfma_f32_16x16x32_bf16 a[224:227], v[96:99], v[156:159], a[224:227]
    v_mfma_f32_16x16x32_bf16 a[228:231], v[100:103], v[156:159], a[228:231]
    v_mfma_f32_16x16x32_bf16 a[232:235], v[104:107], v[156:159], a[232:235]
    v_mfma_f32_16x16x32_bf16 a[236:239], v[108:111], v[156:159], a[236:239]
    buffer_load_dwordx4 v207, s[12:15], s17 offen offset:3072 lds
    s_add_u32 s17, s17, s18
    v_mfma_f32_16x16x32_bf16 a[240:243], v[112:115], v[156:159], a[240:243]
    v_mfma_f32_16x16x32_bf16 a[244:247], v[116:119], v[156:159], a[244:247]
    v_mfma_f32_16x16x32_bf16 a[248:251], v[120:123], v[156:159], a[248:251]
    v_mfma_f32_16x16x32_bf16 a[252:255], v[124:127], v[156:159], a[252:255]
    s_waitcnt vmcnt(16) lgkmcnt(0)
    s_barrier
    v_mfma_f32_16x16x32_bf16 a[0:3], v[32:35], v[64:67], a[0:3]
    ds_read_b64_tr_b16 v[128:129], v14 offset:49152
    v_mfma_f32_16x16x32_bf16 a[4:7], v[36:39], v[64:67], a[4:7]
    v_mfma_f32_16x16x32_bf16 a[8:11], v[40:43], v[64:67], a[8:11]
    ds_read_b64_tr_b16 v[130:131], v14 offset:53248
    v_mfma_f32_16x16x32_bf16 a[12:15], v[44:47], v[64:67], a[12:15]
    s_add_u32 m0, s19, 65536
    s_nop 0
    buffer_load_dwordx4 v18, s[48:51], s16 offen sc1 lds
    v_mfma_f32_16x16x32_bf16 a[16:19], v[48:51], v[64:67], a[16:19]
    ds_read_b128 v[96:99], v9 offset:32768
    v_mfma_f32_16x16x32_bf16 a[20:23], v[52:55], v[64:67], a[20:23]
    v_mfma_f32_16x16x32_bf16 a[24:27], v[56:59], v[64:67], a[24:27]
    ds_read_b128 v[100:103], v9 offset:33024
    v_mfma_f32_16x16x32_bf16 a[28:31], v[60:63], v[64:67], a[28:31]
    v_mfma_f32_16x16x32_bf16 a[32:35], v[32:35], v[68:71], a[32:35]
    ds_read_b128 v[104:107], v9 offset:33280
    v_mfma_f32_16x16x32_bf16 a[36:39], v[36:39], v[68:71], a[36:39]
    v_mfma_f32_16x16x32_bf16 a[40:43], v[40:43], v[68:71], a[40:43]
    ds_read_b128 v[108:111], v9 offset:33536
    v_mfma_f32_16x16x32_bf16 a[44:47], v[44:47], v[68:71], a[44:47]
    buffer_load_dwordx4 v18, s[48:51], s16 offen offset:1024 sc1 lds
    v_mfma_f32_16x16x32_bf16 a[48:51], v[48:51], v[68:71], a[48:51]
    ds_read_b128 v[112:115], v9 offset:33792
    v_mfma_f32_16x16x32_bf16 a[52:55], v[52:55], v[68:71], a[52:55]
    v_mfma_f32_16x16x32_bf16 a[56:59], v[56:59], v[68:71], a[56:59]
    ds_read_b128 v[116:119], v9 offset:34048
    v_mfma_f32_16x16x32_bf16 a[60:63], v[60:63], v[68:71], a[60:63]
    v_mfma_f32_16x16x32_bf16 a[64:67], v[32:35], v[72:75], a[64:67]
    ds_read_b128 v[120:123], v9 offset:34304
    v_mfma_f32_16x16x32_bf16 a[68:71], v[36:39], v[72:75], a[68:71]
    v_mfma_f32_16x16x32_bf16 a[72:75], v[40:43], v[72:75], a[72:75]
    ds_read_b128 v[124:127], v9 offset:34560
    v_mfma_f32_16x16x32_bf16 a[76:79], v[44:47], v[72:75], a[76:79]
    buffer_load_dwordx4 v18, s[48:51], s16 offen offset:2048 sc1 lds
    v_mfma_f32_16x16x32_bf16 a[80:83], v[48:51], v[72:75], a[80:83]
    ds_read_b64_tr_b16 v[132:133], v15 offset:49152
    v_mfma_f32_16x16x32_bf16 a[84:87], v[52:55], v[72:75], a[84:87]
    v_mfma_f32_16x16x32_bf16 a[88:91], v[56:59], v[72:75], a[88:91]
    ds_read_b64_tr_b16 v[134:135], v15 offset:53248
    v_mfma_f32_16x16x32_bf16 a[92:95], v[60:63], v[72:75], a[92:95]
    v_mfma_f32_16x16x32_bf16 a[96:99], v[32:35], v[76:79], a[96:99]
    ds_read_b64_tr_b16 v[136:137], v16 offset:49152
    v_mfma_f32_16x16x32_bf16 a[100:103], v[36:39], v[76:79], a[100:103]
    v_mfma_f32_16x16x32_bf16 a[104:107], v[40:43], v[76:79], a[104:107]
    ds_read_b64_tr_b16 v[138:139], v16 offset:53248
    v_mfma_f32_16x16x32_bf16 a[108:111], v[44:47], v[76:79], a[108:111]
    buffer_load_dwordx4 v18, s[48:51], s16 offen offset:3072 sc1 lds
    s_add_u32 s16, s16, 16384
    v_mfma_f32_16x16x32_bf16 a[112:115], v[48:51], v[76:79], a[112:115]
    ds_read_b64_tr_b16 v[140:141], v17 offset:49152
    v_mfma_f32_16x16x32_bf16 a[116:119], v[52:55], v[76:79], a[116:119]
    v_mfma_f32_16x16x32_bf16 a[120:123], v[56:59], v[76:79], a[120:123]
    ds_read_b64_tr_b16 v[142:143], v17 offset:53248
    v_mfma_f32_16x16x32_bf16 a[124:127], v[60:63], v[76:79], a[124:127]
    v_mfma_f32_16x16x32_bf16 a[128:131], v[32:35], v[80:83], a[128:131]
    ds_read_b64_tr_b16 v[144:145], v14 offset:57344
    v_mfma_f32_16x16x32_bf16 a[132:135], v[36:39], v[80:83], a[132:135]
    v_mfma_f32_16x16x32_bf16 a[136:139], v[40:43], v[80:83], a[136:139]
    ds_read_b64_tr_b16 v[146:147], v14 offset:61440
    v_mfma_f32_16x16x32_bf16 a[140:143], v[44:47], v[80:83], a[140:143]
    s_add_u32 m0, s20, 65536
    s_nop 0
    buffer_load_dwordx4 v204, s[12:15], s17 offen lds
    v_mfma_f32_16x16x32_bf16 a[144:147], v[48:51], v[80:83], a[144:147]
    ds_read_b64_tr_b16 v[148:149], v15 offset:57344
    v_mfma_f32_16x16x32_bf16 a[148:151], v[52:55], v[80:83], a[148:151]
    v_mfma_f32_16x16x32_bf16 a[152:155], v[56:59], v[80:83], a[152:155]
    ds_read_b64_tr_b16 v[150:151], v15 offset:61440
    v_mfma_f32_16x16x32_bf16 a[156:159], v[60:63], v[80:83], a[156:159]
    v_mfma_f32_16x16x32_bf16 a[160:163], v[32:35], v[84:87], a[160:163]
    ds_read_b64_tr_b16 v[152:153], v16 offset:57344
    v_mfma_f32_16x16x32_bf16 a[164:167], v[36:39], v[84:87], a[164:167]
    v_mfma_f32_16x16x32_bf16 a[168:171], v[40:43], v[84:87], a[168:171]
    ds_read_b64_tr_b16 v[154:155], v16 offset:61440
    v_mfma_f32_16x16x32_bf16 a[172:175], v[44:47], v[84:87], a[172:175]
    buffer_load_dwordx4 v205, s[12:15], s17 offen offset:1024 lds
    v_mfma_f32_16x16x32_bf16 a[176:179], v[48:51], v[84:87], a[176:179]
    ds_read_b64_tr_b16 v[156:157], v17 offset:57344
    v_mfma_f32_16x16x32_bf16 a[180:183], v[52:55], v[84:87], a[180:183]
    v_mfma_f32_16x16x32_bf16 a[184:187], v[56:59], v[84:87], a[184:187]
    ds_read_b64_tr_b16 v[158:159], v17 offset:61440
    v_mfma_f32_16x16x32_bf16 a[188:191], v[60:63], v[84:87], a[188:191]
    v_mfma_f32_16x16x32_bf16 a[192:195], v[32:35], v[88:91], a[192:195]
    v_mfma_f32_16x16x32_bf16 a[196:199], v[36:39], v[88:91], a[196:199]
    v_mfma_f32_16x16x32_bf16 a[200:203], v[40:43], v[88:91], a[200:203]
    v_mfma_f32_16x16x32_bf16 a[204:207], v[44:47], v[88:91], a[204:207]
    buffer_load_dwordx4 v206, s[12:15], s17 offen offset:2048 lds
    v_mfma_f32_16x16x32_bf16 a[208:211], v[48:51], v[88:91], a[208:211]
    v_mfma_f32_16x16x32_bf16 a[212:215], v[52:55], v[88:91], a[212:215]
    v_mfma_f32_16x16x32_bf16 a[216:219], v[56:59], v[88:91], a[216:219]
    v_mfma_f32_16x16x32_bf16 a[220:223], v[60:63], v[88:91], a[220:223]
    v_mfma_f32_16x16x32_bf16 a[224:227], v[32:35], v[92:95], a[224:227]
    v_mfma_f32_16x16x32_bf16 a[228:231], v[36:39], v[92:95], a[228:231]
    v_mfma_f32_16x16x32_bf16 a[232:235], v[40:43], v[92:95], a[232:235]
    v_mfma_f32_16x16x32_bf16 a[236:239], v[44:47], v[92:95], a[236:239]
    buffer_load_dwordx4 v207, s[12:15], s17 offen offset:3072 lds
    s_add_u32 s17, s17, s18
    v_mfma_f32_16x16x32_bf16 a[240:243], v[48:51], v[92:95], a[240:243]
    v_mfma_f32_16x16x32_bf16 a[244:247], v[52:55], v[92:95], a[244:247]
    v_mfma_f32_16x16x32_bf16 a[248:251], v[56:59], v[92:95], a[248:251]
    v_mfma_f32_16x16x32_bf16 a[252:255], v[60:63], v[92:95], a[252:255]
    s_waitcnt vmcnt(16) lgkmcnt(0)
    s_barrier
    v_mfma_f32_16x16x32_bf16 a[0:3], v[96:99], v[128:131], a[0:3]
    ds_read_b64_tr_b16 v[64:65], v10 offset:16384
    v_mfma_f32_16x16x32_bf16 a[4:7], v[100:103], v[128:131], a[4:7]
    v_mfma_f32_16x16x32_bf16 a[8:11], v[104:107], v[128:131], a[8:11]
    ds_read_b64_tr_b16 v[66:67], v10 offset:20480
    v_mfma_f32_16x16x32_bf16 a[12:15], v[108:111], v[128:131], a[12:15]
    s_add_u32 m0, s19, 98304
    s_nop 0
    buffer_load_dwordx4 v18, s[48:51], s16 offen sc1 lds
    v_mfma_f32_16x16x32_bf16 a[16:19], v[112:115], v[128:131], a[16:19]
    ds_read_b128 v[32:35], v8 offset:0
    v_mfma_f32_16x16x32_bf16 a[20:23], v[116:119], v[128:131], a[20:23]
    v_mfma_f32_16x16x32_bf16 a[24:27], v[120:123], v[128:131], a[24:27]
    ds_read_b128 v[36:39], v8 offset:256
    v_mfma_f32_16x16x32_bf16 a[28:31], v[124:127], v[128:131], a[28:31]
    v_mfma_f32_16x16x32_bf16 a[32:35], v[96:99], v[132:135], a[32:35]
    ds_read_b128 v[40:43], v8 offset:512
    v_mfma_f32_16x16x32_bf16 a[36:39], v[100:103], v[132:135], a[36:39]
    v_mfma_f32_16x16x32_bf16 a[40:43], v[104:107], v[132:135], a[40:43]
    ds_read_b128 v[44:47], v8 offset:768
    v_mfma_f32_16x16x32_bf16 a[44:47], v[108:111], v[132:135], a[44:47]
    buffer_load_dwordx4 v18, s[48:51], s16 offen offset:1024 sc1 lds
    v_mfma_f32_16x16x32_bf16 a[48:51], v[112:115], v[132:135], a[48:51]
    ds_read_b128 v[48:51], v8 offset:1024
    v_mfma_f32_16x16x32_bf16 a[52:55], v[116:119], v[132:135], a[52:55]
    v_mfma_f32_16x16x32_bf16 a[56:59], v[120:123], v[132:135], a[56:59]
    ds_read_b128 v[52:55], v8 offset:1280
    v_mfma_f32_16x16x32_bf16 a[60:63], v[124:127], v[132:135], a[60:63]
    v_mfma_f32_16x16x32_bf16 a[64:67], v[96:99], v[136:139], a[64:67]
    ds_read_b128 v[56:59], v8 offset:1536
    v_mfma_f32_16x16x32_bf16 a[68:71], v[100:103], v[136:139], a[68:71]
    v_mfma_f32_16x16x32_bf16 a[72:75], v[104:107], v[136:139], a[72:75]
    ds_read_b128 v[60:63], v8 offset:1792
    v_mfma_f32_16x16x32_bf16 a[76:79], v[108:111], v[136:139], a[76:79]
    buffer_load_dwordx4 v18, s[48:51], s16 offen offset:2048 sc1 lds
    v_mfma_f32_16x16x32_bf16 a[80:83], v[112:115], v[136:139], a[80:83]
    ds_read_b64_tr_b16 v[68:69], v11 offset:16384
    v_mfma_f32_16x16x32_bf16 a[84:87], v[116:119], v[136:139], a[84:87]
    v_mfma_f32_16x16x32_bf16 a[88:91], v[120:123], v[136:139], a[88:91]
    ds_read_b64_tr_b16 v[70:71], v11 offset:20480
    v_mfma_f32_16x16x32_bf16 a[92:95], v[124:127], v[136:139], a[92:95]
    v_mfma_f32_16x16x32_bf16 a[96:99], v[96:99], v[140:143], a[96:99]
    ds_read_b64_tr_b16 v[72:73], v12 offset:16384
    v_mfma_f32_16x16x32_bf16 a[100:103], v[100:103], v[140:143], a[100:103]
    v_mfma_f32_16x16x32_bf16 a[104:107], v[104:107], v[140:143], a[104:107]
    ds_read_b64_tr_b16 v[74:75], v12 offset:20480
    v_mfma_f32_16x16x32_bf16 a[108:111], v[108:111], v[140:143], a[108:111]
    buffer_load_dwordx4 v18, s[48:51], s16 offen offset:3072 sc1 lds
    s_add_u32 s16, s16, 16384
    v_mfma_f32_16x16x32_bf16 a[112:115], v[112:115], v[140:143], a[112:115]
    ds_read_b64_tr_b16 v[76:77], v13 offset:16384
    v_mfma_f32_16x16x32_bf16 a[116:119], v[116:119], v[140:143], a[116:119]
    v_mfma_f32_16x16x32_bf16 a[120:123], v[120:123], v[140:143], a[120:123]
    ds_read_b64_tr_b16 v[78:79], v13 offset:20480
    v_mfma_f32_16x16x32_bf16 a[124:127], v[124:127], v[140:143], a[124:127]
    v_mfma_f32_16x16x32_bf16 a[128:131], v[96:99], v[144:147], a[128:131]
    ds_read_b64_tr_b16 v[80:81], v10 offset:24576
    v_mfma_f32_16x16x32_bf16 a[132:135], v[100:103], v[144:147], a[132:135]
    v_mfma_f32_16x16x32_bf16 a[136:139], v[104:107], v[144:147], a[136:139]
    ds_read_b64_tr_b16 v[82:83], v10 offset:28672
    v_mfma_f32_16x16x32_bf16 a[140:143], v[108:111], v[144:147], a[140:143]
    s_add_u32 m0, s20, 98304
    s_nop 0
    buffer_load_dwordx4 v204, s[12:15], s17 offen lds
    v_mfma_f32_16x16x32_bf16 a[144:147], v[112:115], v[144:147], a[144:147]
    ds_read_b64_tr_b16 v[84:85], v11 offset:24576
    v_mfma_f32_16x16x32_bf16 a[148:151], v[116:119], v[144:147], a[148:151]
    v_mfma_f32_16x16x32_bf16 a[152:155], v[120:123], v[144:147], a[152:155]
    ds_read_b64_tr_b16 v[86:87], v11 offset:28672
    v_mfma_f32_16x16x32_bf16 a[156:159], v[124:127], v[144:147], a[156:159]
    v_mfma_f32_16x16x32_bf16 a[160:163], v[96:99], v[148:151], a[160:163]
    ds_read_b64_tr_b16 v[88:89], v12 offset:24576
    v_mfma_f32_16x16x32_bf16 a[164:167], v[100:103], v[148:151], a[164:167]
    v_mfma_f32_16x16x32_bf16 a[168:171], v[104:107], v[148:151], a[168:171]
    ds_read_b64_tr_b16 v[90:91], v12 offset:28672
    v_mfma_f32_16x16x32_bf16 a[172:175], v[108:111], v[148:151], a[172:175]
    buffer_load_dwordx4 v205, s[12:15], s17 offen offset:1024 lds
    v_mfma_f32_16x16x32_bf16 a[176:179], v[112:115], v[148:151], a[176:179]
    ds_read_b64_tr_b16 v[92:93], v13 offset:24576
    v_mfma_f32_16x16x32_bf16 a[180:183], v[116:119], v[148:151], a[180:183]
    v_mfma_f32_16x16x32_bf16 a[184:187], v[120:123], v[148:151], a[184:187]
    ds_read_b64_tr_b16 v[94:95], v13 offset:28672
    v_mfma_f32_16x16x32_bf16 a[188:191], v[124:127], v[148:151], a[188:191]
    v_mfma_f32_16x16x32_bf16 a[192:195], v[96:99], v[152:155], a[192:195]
    v_mfma_f32_16x16x32_bf16 a[196:199], v[100:103], v[152:155], a[196:199]
    v_mfma_f32_16x16x32_bf16 a[200:203], v[104:107], v[152:155], a[200:203]
    v_mfma_f32_16x16x32_bf16 a[204:207], v[108:111], v[152:155], a[204:207]
    buffer_load_dwordx4 v206, s[12:15], s17 offen offset:2048 lds
    v_mfma_f32_16x16x32_bf16 a[208:211], v[112:115], v[152:155], a[208:211]
    v_mfma_f32_16x16x32_bf16 a[212:215], v[116:119], v[152:155], a[212:215]
    v_mfma_f32_16x16x32_bf16 a[216:219], v[120:123], v[152:155], a[216:219]
    v_mfma_f32_16x16x32_bf16 a[220:223], v[124:127], v[152:155], a[220:223]
    v_mfma_f32_16x16x32_bf16 a[224:227], v[96:99], v[156:159], a[224:227]
    v_mfma_f32_16x16x32_bf16 a[228:231], v[100:103], v[156:159], a[228:231]
    v_mfma_f32_16x16x32_bf16 a[232:235], v[104:107], v[156:159], a[232:235]
    v_mfma_f32_16x16x32_bf16 a[236:239], v[108:111], v[156:159], a[236:239]
    buffer_load_dwordx4 v207, s[12:15], s17 offen offset:3072 lds
    s_add_u32 s17, s17, s18
    v_mfma_f32_16x16x32_bf16 a[240:243], v[112:115], v[156:159], a[240:243]
    v_mfma_f32_16x16x32_bf16 a[244:247], v[116:119], v[156:159], a[244:247]
    v_mfma_f32_16x16x32_bf16 a[248:251], v[120:123], v[156:159], a[248:251]
    v_mfma_f32_16x16x32_bf16 a[252:255], v[124:127], v[156:159], a[252:255]
    s_sub_u32 s21, s21, 1
    s_cmp_lg_u32 s21, 0
    s_cbranch_scc1 Lmid_188
    s_branch L_e1ep
Lsw_189:
    s_lshr_b32 s6, s80, 8
    s_cmp_eq_u32 s6, 0
    s_cbranch_scc1 Lnul_191
    s_cmp_eq_u32 s6, 4
    s_cbranch_scc1 Lnul_191
    s_lshr_b32 s6, s80, 8
    s_and_b32 s7, s80, 0xff
    s_mov_b32 s50, 268435456
    s_mov_b32 s63, 7
    s_cmp_eq_u32 s6, 2
    s_cbranch_scc1 Ldg_193
    s_cmp_eq_u32 s6, 3
    s_cbranch_scc1 Ldq_192
    s_lshr_b32 s30, s7, 3
    s_and_b32 s31, s7, 3
    s_lshl_b32 s4, s23, 2
    s_add_u32 s31, s31, s4
    s_add_u32 s4, s30, 0
    s_lshl_b32 s4, s4, 8
    s_add_u32 s43, s4, 102760448
    s_bitcmp1_b32 s7, 2
    s_cbranch_scc1 Ldv_194
    s_load_dwordx2 s[12:13], s[0:1], 24
    s_mov_b32 s61, 1
    s_lshl_b32 s4, s30, 21
    s_lshl_b32 s5, s31, 17
    s_add_u32 s4, s4, s5
    s_add_u32 s42, s4, 4194304
    s_branch Ldb_195
Ldv_194:
    s_load_dwordx2 s[12:13], s[0:1], 32
    s_mov_b32 s61, 2
    s_lshl_b32 s4, s30, 21
    s_lshl_b32 s5, s31, 12
    s_add_u32 s4, s4, s5
    s_add_u32 s42, s4, 20971520
    s_branch Ldb_195
Ldq_192:
    s_lshr_b32 s30, s7, 2
    s_and_b32 s31, s7, 3
    s_lshl_b32 s4, s23, 2
    s_add_u32 s31, s31, s4
    s_add_u32 s4, s30, 8
    s_lshl_b32 s4, s4, 8
    s_add_u32 s43, s4, 102760448
    s_load_dwordx2 s[12:13], s[0:1], 16
    s_mov_b32 s61, 3
    s_lshl_b32 s4, s30, 21
    s_lshl_b32 s5, s31, 17
    s_add_u32 s4, s4, s5
    s_add_u32 s42, s4, 37748736
Ldb_195:
    s_mov_b32 s14, 8388608
    s_mov_b32 s32, 8192
    s_lshl_b32 s17, s31, 9
    s_and_b32 s4, s3, 1
    s_lshl_b32 s4, s4, 8
    s_add_u32 s17, s17, s4
    s_lshl_b32 s16, s30, 19
    s_add_u32 s16, s16, 0
    s_branch Lde_196
Ldg_193:
    s_mul_i32 s5, s7, 9363
    s_lshr_b32 s30, s5, 16
    s_mul_i32 s5, s30, 7
    s_sub_u32 s4, s7, s5
    s_mul_i32 s31, s23, 7
    s_add_u32 s31, s31, s4
    s_add_u32 s4, s30, 16
    s_lshl_b32 s4, s4, 8
    s_add_u32 s43, s4, 102760448
    s_and_b32 s4, s3, 1
    s_lshl_b32 s4, s4, 3
    s_add_u32 s4, s4, 64
    s_load_dwordx2 s[12:13], s[0:1], s4
    s_mov_b32 s14, 7340032
    s_mov_b32 s61, 4
    s_mov_b32 s32, 7168
    s_lshl_b32 s17, s31, 8
    s_mul_i32 s4, s30, 1835008
    s_lshl_b32 s5, s31, 16
    s_add_u32 s4, s4, s5
    s_add_u32 s42, s4, 54525952
    s_lshl_b32 s16, s30, 19
    s_add_u32 s16, s16, 0
Lde_196:
    s_mov_b32 s15, 0x20000
    v_mul_u32_u24 v1, s32, v19
    s_lshl_b32 s4, s32, 2
    s_sub_u32 s4, s4, 1024
    v_add_u32 v204, v1, v20
    v_add3_u32 v205, v1, v21, s4
    s_lshl_b32 s5, s4, 1
    v_add3_u32 v206, v1, v20, s5
    s_add_u32 s5, s5, s4
    v_add3_u32 v207, v1, v21, s5
    s_lshl_b32 s18, s32, 5
    s_mov_b32 s80, s81
    s_mov_b32 s81, s82
    s_mov_b32 s82, s83
    s_mov_b32 s83, s84
    s_mov_b32 s84, s85
    s_mov_b32 s85, s86
    s_mov_b32 s86, s87
    s_mov_b32 s87, 0
    s_branch Lswb_190
Lnul_191:
    s_mov_b32 s61, 0
    s_mov_b32 s50, 0
    s_mov_b32 s14, 0
    s_branch Lswb_190
L_e1ep:
    s_cmp_eq_u32 s60, 2
    s_cbranch_scc1 L_epV
    s_cmp_eq_u32 s60, 4
    s_cbranch_scc1 L_epGU
    s_cmp_eq_u32 s60, 5
    s_cbranch_scc1 L_epDN
    s_and_b32 s5, s3, 1
    s_lshl_b32 s5, s5, 15
    s_add_u32 s7, s29, s5
    s_nop 4
    s_add_u32 s6, s7, 0
    v_accvgpr_read_b32 v160, a0
    v_accvgpr_read_b32 v161, a1
    v_accvgpr_read_b32 v162, a2
    v_accvgpr_read_b32 v163, a3
    v_accvgpr_read_b32 v164, a32
    v_accvgpr_read_b32 v165, a33
    v_accvgpr_read_b32 v166, a34
    v_accvgpr_read_b32 v167, a35
    v_cvt_pk_bf16_f32 v168, v160, v161
    v_cvt_pk_bf16_f32 v169, v162, v163
    v_cvt_pk_bf16_f32 v170, v164, v165
    v_cvt_pk_bf16_f32 v171, v166, v167
    buffer_store_dwordx4 v[168:171], v30, s[8:11], s6 offen offset:0 sc1
    v_accvgpr_read_b32 v172, a4
    v_accvgpr_read_b32 v173, a5
    v_accvgpr_read_b32 v174, a6
    v_accvgpr_read_b32 v175, a7
    v_accvgpr_read_b32 v176, a36
    v_accvgpr_read_b32 v177, a37
    v_accvgpr_read_b32 v178, a38
    v_accvgpr_read_b32 v179, a39
    v_cvt_pk_bf16_f32 v180, v172, v173
    v_cvt_pk_bf16_f32 v181, v174, v175
    v_cvt_pk_bf16_f32 v182, v176, v177
    v_cvt_pk_bf16_f32 v183, v178, v179
    buffer_store_dwordx4 v[180:183], v30, s[8:11], s6 offen offset:256 sc1
    v_accvgpr_read_b32 v184, a8
    v_accvgpr_read_b32 v185, a9
    v_accvgpr_read_b32 v186, a10
    v_accvgpr_read_b32 v187, a11
    v_accvgpr_read_b32 v188, a40
    v_accvgpr_read_b32 v189, a41
    v_accvgpr_read_b32 v190, a42
    v_accvgpr_read_b32 v191, a43
    v_cvt_pk_bf16_f32 v192, v184, v185
    v_cvt_pk_bf16_f32 v193, v186, v187
    v_cvt_pk_bf16_f32 v194, v188, v189
    v_cvt_pk_bf16_f32 v195, v190, v191
    buffer_store_dwordx4 v[192:195], v30, s[8:11], s6 offen offset:512 sc1
    v_accvgpr_read_b32 v160, a12
    v_accvgpr_read_b32 v161, a13
    v_accvgpr_read_b32 v162, a14
    v_accvgpr_read_b32 v163, a15
    v_accvgpr_read_b32 v164, a44
    v_accvgpr_read_b32 v165, a45
    v_accvgpr_read_b32 v166, a46
    v_accvgpr_read_b32 v167, a47
    v_cvt_pk_bf16_f32 v168, v160, v161
    v_cvt_pk_bf16_f32 v169, v162, v163
    v_cvt_pk_bf16_f32 v170, v164, v165
    v_cvt_pk_bf16_f32 v171, v166, v167
    buffer_store_dwordx4 v[168:171], v30, s[8:11], s6 offen offset:768 sc1
    v_accvgpr_read_b32 v172, a16
    v_accvgpr_read_b32 v173, a17
    v_accvgpr_read_b32 v174, a18
    v_accvgpr_read_b32 v175, a19
    v_accvgpr_read_b32 v176, a48
    v_accvgpr_read_b32 v177, a49
    v_accvgpr_read_b32 v178, a50
    v_accvgpr_read_b32 v179, a51
    v_cvt_pk_bf16_f32 v180, v172, v173
    v_cvt_pk_bf16_f32 v181, v174, v175
    v_cvt_pk_bf16_f32 v182, v176, v177
    v_cvt_pk_bf16_f32 v183, v178, v179
    buffer_store_dwordx4 v[180:183], v30, s[8:11], s6 offen offset:1024 sc1
    v_accvgpr_read_b32 v184, a20
    v_accvgpr_read_b32 v185, a21
    v_accvgpr_read_b32 v186, a22
    v_accvgpr_read_b32 v187, a23
    v_accvgpr_read_b32 v188, a52
    v_accvgpr_read_b32 v189, a53
    v_accvgpr_read_b32 v190, a54
    v_accvgpr_read_b32 v191, a55
    v_cvt_pk_bf16_f32 v192, v184, v185
    v_cvt_pk_bf16_f32 v193, v186, v187
    v_cvt_pk_bf16_f32 v194, v188, v189
    v_cvt_pk_bf16_f32 v195, v190, v191
    buffer_store_dwordx4 v[192:195], v30, s[8:11], s6 offen offset:1280 sc1
    v_accvgpr_read_b32 v160, a24
    v_accvgpr_read_b32 v161, a25
    v_accvgpr_read_b32 v162, a26
    v_accvgpr_read_b32 v163, a27
    v_accvgpr_read_b32 v164, a56
    v_accvgpr_read_b32 v165, a57
    v_accvgpr_read_b32 v166, a58
    v_accvgpr_read_b32 v167, a59
    v_cvt_pk_bf16_f32 v168, v160, v161
    v_cvt_pk_bf16_f32 v169, v162, v163
    v_cvt_pk_bf16_f32 v170, v164, v165
    v_cvt_pk_bf16_f32 v171, v166, v167
    buffer_store_dwordx4 v[168:171], v30, s[8:11], s6 offen offset:1536 sc1
    v_accvgpr_read_b32 v172, a28
    v_accvgpr_read_b32 v173, a29
    v_accvgpr_read_b32 v174, a30
    v_accvgpr_read_b32 v175, a31
    v_accvgpr_read_b32 v176, a60
    v_accvgpr_read_b32 v177, a61
    v_accvgpr_read_b32 v178, a62
    v_accvgpr_read_b32 v179, a63
    v_cvt_pk_bf16_f32 v180, v172, v173
    v_cvt_pk_bf16_f32 v181, v174, v175
    v_cvt_pk_bf16_f32 v182, v176, v177
    v_cvt_pk_bf16_f32 v183, v178, v179
    buffer_store_dwordx4 v[180:183], v30, s[8:11], s6 offen offset:1792 sc1
    s_add_u32 s6, s7, 16384
    v_accvgpr_read_b32 v184, a64
    v_accvgpr_read_b32 v185, a65
    v_accvgpr_read_b32 v186, a66
    v_accvgpr_read_b32 v187, a67
    v_accvgpr_read_b32 v188, a96
    v_accvgpr_read_b32 v189, a97
    v_accvgpr_read_b32 v190, a98
    v_accvgpr_read_b32 v191, a99
    v_cvt_pk_bf16_f32 v192, v184, v185
    v_cvt_pk_bf16_f32 v193, v186, v187
    v_cvt_pk_bf16_f32 v194, v188, v189
    v_cvt_pk_bf16_f32 v195, v190, v191
    buffer_store_dwordx4 v[192:195], v30, s[8:11], s6 offen offset:0 sc1
    v_accvgpr_read_b32 v160, a68
    v_accvgpr_read_b32 v161, a69
    v_accvgpr_read_b32 v162, a70
    v_accvgpr_read_b32 v163, a71
    v_accvgpr_read_b32 v164, a100
    v_accvgpr_read_b32 v165, a101
    v_accvgpr_read_b32 v166, a102
    v_accvgpr_read_b32 v167, a103
    v_cvt_pk_bf16_f32 v168, v160, v161
    v_cvt_pk_bf16_f32 v169, v162, v163
    v_cvt_pk_bf16_f32 v170, v164, v165
    v_cvt_pk_bf16_f32 v171, v166, v167
    buffer_store_dwordx4 v[168:171], v30, s[8:11], s6 offen offset:256 sc1
    v_accvgpr_read_b32 v172, a72
    v_accvgpr_read_b32 v173, a73
    v_accvgpr_read_b32 v174, a74
    v_accvgpr_read_b32 v175, a75
    v_accvgpr_read_b32 v176, a104
    v_accvgpr_read_b32 v177, a105
    v_accvgpr_read_b32 v178, a106
    v_accvgpr_read_b32 v179, a107
    v_cvt_pk_bf16_f32 v180, v172, v173
    v_cvt_pk_bf16_f32 v181, v174, v175
    v_cvt_pk_bf16_f32 v182, v176, v177
    v_cvt_pk_bf16_f32 v183, v178, v179
    buffer_store_dwordx4 v[180:183], v30, s[8:11], s6 offen offset:512 sc1
    v_accvgpr_read_b32 v184, a76
    v_accvgpr_read_b32 v185, a77
    v_accvgpr_read_b32 v186, a78
    v_accvgpr_read_b32 v187, a79
    v_accvgpr_read_b32 v188, a108
    v_accvgpr_read_b32 v189, a109
    v_accvgpr_read_b32 v190, a110
    v_accvgpr_read_b32 v191, a111
    v_cvt_pk_bf16_f32 v192, v184, v185
    v_cvt_pk_bf16_f32 v193, v186, v187
    v_cvt_pk_bf16_f32 v194, v188, v189
    v_cvt_pk_bf16_f32 v195, v190, v191
    buffer_store_dwordx4 v[192:195], v30, s[8:11], s6 offen offset:768 sc1
    v_accvgpr_read_b32 v160, a80
    v_accvgpr_read_b32 v161, a81
    v_accvgpr_read_b32 v162, a82
    v_accvgpr_read_b32 v163, a83
    v_accvgpr_read_b32 v164, a112
    v_accvgpr_read_b32 v165, a113
    v_accvgpr_read_b32 v166, a114
    v_accvgpr_read_b32 v167, a115
    v_cvt_pk_bf16_f32 v168, v160, v161
    v_cvt_pk_bf16_f32 v169, v162, v163
    v_cvt_pk_bf16_f32 v170, v164, v165
    v_cvt_pk_bf16_f32 v171, v166, v167
    buffer_store_dwordx4 v[168:171], v30, s[8:11], s6 offen offset:1024 sc1
    v_accvgpr_read_b32 v172, a84
    v_accvgpr_read_b32 v173, a85
    v_accvgpr_read_b32 v174, a86
    v_accvgpr_read_b32 v175, a87
    v_accvgpr_read_b32 v176, a116
    v_accvgpr_read_b32 v177, a117
    v_accvgpr_read_b32 v178, a118
    v_accvgpr_read_b32 v179, a119
    v_cvt_pk_bf16_f32 v180, v172, v173
    v_cvt_pk_bf16_f32 v181, v174, v175
    v_cvt_pk_bf16_f32 v182, v176, v177
    v_cvt_pk_bf16_f32 v183, v178, v179
    buffer_store_dwordx4 v[180:183], v30, s[8:11], s6 offen offset:1280 sc1
    v_accvgpr_read_b32 v184, a88
    v_accvgpr_read_b32 v185, a89
    v_accvgpr_read_b32 v186, a90
    v_accvgpr_read_b32 v187, a91
    v_accvgpr_read_b32 v188, a120
    v_accvgpr_read_b32 v189, a121
    v_accvgpr_read_b32 v190, a122
    v_accvgpr_read_b32 v191, a123
    v_cvt_pk_bf16_f32 v192, v184, v185
    v_cvt_pk_bf16_f32 v193, v186, v187
    v_cvt_pk_bf16_f32 v194, v188, v189
    v_cvt_pk_bf16_f32 v195, v190, v191
    buffer_store_dwordx4 v[192:195], v30, s[8:11], s6 offen offset:1536 sc1
    v_accvgpr_read_b32 v160, a92
    v_accvgpr_read_b32 v161, a93
    v_accvgpr_read_b32 v162, a94
    v_accvgpr_read_b32 v163, a95
    v_accvgpr_read_b32 v164, a124
    v_accvgpr_read_b32 v165, a125
    v_accvgpr_read_b32 v166, a126
    v_accvgpr_read_b32 v167, a127
    v_cvt_pk_bf16_f32 v168, v160, v161
    v_cvt_pk_bf16_f32 v169, v162, v163
    v_cvt_pk_bf16_f32 v170, v164, v165
    v_cvt_pk_bf16_f32 v171, v166, v167
    buffer_store_dwordx4 v[168:171], v30, s[8:11], s6 offen offset:1792 sc1
    s_add_u32 s6, s7, 65536
    v_accvgpr_read_b32 v172, a128
    v_accvgpr_read_b32 v173, a129
    v_accvgpr_read_b32 v174, a130
    v_accvgpr_read_b32 v175, a131
    v_accvgpr_read_b32 v176, a160
    v_accvgpr_read_b32 v177, a161
    v_accvgpr_read_b32 v178, a162
    v_accvgpr_read_b32 v179, a163
    v_cvt_pk_bf16_f32 v180, v172, v173
    v_cvt_pk_bf16_f32 v181, v174, v175
    v_cvt_pk_bf16_f32 v182, v176, v177
    v_cvt_pk_bf16_f32 v183, v178, v179
    buffer_store_dwordx4 v[180:183], v30, s[8:11], s6 offen offset:0 sc1
    v_accvgpr_read_b32 v184, a132
    v_accvgpr_read_b32 v185, a133
    v_accvgpr_read_b32 v186, a134
    v_accvgpr_read_b32 v187, a135
    v_accvgpr_read_b32 v188, a164
    v_accvgpr_read_b32 v189, a165
    v_accvgpr_read_b32 v190, a166
    v_accvgpr_read_b32 v191, a167
    v_cvt_pk_bf16_f32 v192, v184, v185
    v_cvt_pk_bf16_f32 v193, v186, v187
    v_cvt_pk_bf16_f32 v194, v188, v189
    v_cvt_pk_bf16_f32 v195, v190, v191
    buffer_store_dwordx4 v[192:195], v30, s[8:11], s6 offen offset:256 sc1
    v_accvgpr_read_b32 v160, a136
    v_accvgpr_read_b32 v161, a137
    v_accvgpr_read_b32 v162, a138
    v_accvgpr_read_b32 v163, a139
    v_accvgpr_read_b32 v164, a168
    v_accvgpr_read_b32 v165, a169
    v_accvgpr_read_b32 v166, a170
    v_accvgpr_read_b32 v167, a171
    v_cvt_pk_bf16_f32 v168, v160, v161
    v_cvt_pk_bf16_f32 v169, v162, v163
    v_cvt_pk_bf16_f32 v170, v164, v165
    v_cvt_pk_bf16_f32 v171, v166, v167
    buffer_store_dwordx4 v[168:171], v30, s[8:11], s6 offen offset:512 sc1
    v_accvgpr_read_b32 v172, a140
    v_accvgpr_read_b32 v173, a141
    v_accvgpr_read_b32 v174, a142
    v_accvgpr_read_b32 v175, a143
    v_accvgpr_read_b32 v176, a172
    v_accvgpr_read_b32 v177, a173
    v_accvgpr_read_b32 v178, a174
    v_accvgpr_read_b32 v179, a175
    v_cvt_pk_bf16_f32 v180, v172, v173
    v_cvt_pk_bf16_f32 v181, v174, v175
    v_cvt_pk_bf16_f32 v182, v176, v177
    v_cvt_pk_bf16_f32 v183, v178, v179
    buffer_store_dwordx4 v[180:183], v30, s[8:11], s6 offen offset:768 sc1
    v_accvgpr_read_b32 v184, a144
    v_accvgpr_read_b32 v185, a145
    v_accvgpr_read_b32 v186, a146
    v_accvgpr_read_b32 v187, a147
    v_accvgpr_read_b32 v188, a176
    v_accvgpr_read_b32 v189, a177
    v_accvgpr_read_b32 v190, a178
    v_accvgpr_read_b32 v191, a179
    v_cvt_pk_bf16_f32 v192, v184, v185
    v_cvt_pk_bf16_f32 v193, v186, v187
    v_cvt_pk_bf16_f32 v194, v188, v189
    v_cvt_pk_bf16_f32 v195, v190, v191
    buffer_store_dwordx4 v[192:195], v30, s[8:11], s6 offen offset:1024 sc1
    v_accvgpr_read_b32 v160, a148
    v_accvgpr_read_b32 v161, a149
    v_accvgpr_read_b32 v162, a150
    v_accvgpr_read_b32 v163, a151
    v_accvgpr_read_b32 v164, a180
    v_accvgpr_read_b32 v165, a181
    v_accvgpr_read_b32 v166, a182
    v_accvgpr_read_b32 v167, a183
    v_cvt_pk_bf16_f32 v168, v160, v161
    v_cvt_pk_bf16_f32 v169, v162, v163
    v_cvt_pk_bf16_f32 v170, v164, v165
    v_cvt_pk_bf16_f32 v171, v166, v167
    buffer_store_dwordx4 v[168:171], v30, s[8:11], s6 offen offset:1280 sc1
    v_accvgpr_read_b32 v172, a152
    v_accvgpr_read_b32 v173, a153
    v_accvgpr_read_b32 v174, a154
    v_accvgpr_read_b32 v175, a155
    v_accvgpr_read_b32 v176, a184
    v_accvgpr_read_b32 v177, a185
    v_accvgpr_read_b32 v178, a186
    v_accvgpr_read_b32 v179, a187
    v_cvt_pk_bf16_f32 v180, v172, v173
    v_cvt_pk_bf16_f32 v181, v174, v175
    v_cvt_pk_bf16_f32 v182, v176, v177
    v_cvt_pk_bf16_f32 v183, v178, v179
    buffer_store_dwordx4 v[180:183], v30, s[8:11], s6 offen offset:1536 sc1
    v_accvgpr_read_b32 v184, a156
    v_accvgpr_read_b32 v185, a157
    v_accvgpr_read_b32 v186, a158
    v_accvgpr_read_b32 v187, a159
    v_accvgpr_read_b32 v188, a188
    v_accvgpr_read_b32 v189, a189
    v_accvgpr_read_b32 v190, a190
    v_accvgpr_read_b32 v191, a191
    v_cvt_pk_bf16_f32 v192, v184, v185
    v_cvt_pk_bf16_f32 v193, v186, v187
    v_cvt_pk_bf16_f32 v194, v188, v189
    v_cvt_pk_bf16_f32 v195, v190, v191
    buffer_store_dwordx4 v[192:195], v30, s[8:11], s6 offen offset:1792 sc1
    s_add_u32 s6, s7, 81920
    v_accvgpr_read_b32 v160, a192
    v_accvgpr_read_b32 v161, a193
    v_accvgpr_read_b32 v162, a194
    v_accvgpr_read_b32 v163, a195
    v_accvgpr_read_b32 v164, a224
    v_accvgpr_read_b32 v165, a225
    v_accvgpr_read_b32 v166, a226
    v_accvgpr_read_b32 v167, a227
    v_cvt_pk_bf16_f32 v168, v160, v161
    v_cvt_pk_bf16_f32 v169, v162, v163
    v_cvt_pk_bf16_f32 v170, v164, v165
    v_cvt_pk_bf16_f32 v171, v166, v167
    buffer_store_dwordx4 v[168:171], v30, s[8:11], s6 offen offset:0 sc1
    v_accvgpr_read_b32 v172, a196
    v_accvgpr_read_b32 v173, a197
    v_accvgpr_read_b32 v174, a198
    v_accvgpr_read_b32 v175, a199
    v_accvgpr_read_b32 v176, a228
    v_accvgpr_read_b32 v177, a229
    v_accvgpr_read_b32 v178, a230
    v_accvgpr_read_b32 v179, a231
    v_cvt_pk_bf16_f32 v180, v172, v173
    v_cvt_pk_bf16_f32 v181, v174, v175
    v_cvt_pk_bf16_f32 v182, v176, v177
    v_cvt_pk_bf16_f32 v183, v178, v179
    buffer_store_dwordx4 v[180:183], v30, s[8:11], s6 offen offset:256 sc1
    v_accvgpr_read_b32 v184, a200
    v_accvgpr_read_b32 v185, a201
    v_accvgpr_read_b32 v186, a202
    v_accvgpr_read_b32 v187, a203
    v_accvgpr_read_b32 v188, a232
    v_accvgpr_read_b32 v189, a233
    v_accvgpr_read_b32 v190, a234
    v_accvgpr_read_b32 v191, a235
    v_cvt_pk_bf16_f32 v192, v184, v185
    v_cvt_pk_bf16_f32 v193, v186, v187
    v_cvt_pk_bf16_f32 v194, v188, v189
    v_cvt_pk_bf16_f32 v195, v190, v191
    buffer_store_dwordx4 v[192:195], v30, s[8:11], s6 offen offset:512 sc1
    v_accvgpr_read_b32 v160, a204
    v_accvgpr_read_b32 v161, a205
    v_accvgpr_read_b32 v162, a206
    v_accvgpr_read_b32 v163, a207
    v_accvgpr_read_b32 v164, a236
    v_accvgpr_read_b32 v165, a237
    v_accvgpr_read_b32 v166, a238
    v_accvgpr_read_b32 v167, a239
    v_cvt_pk_bf16_f32 v168, v160, v161
    v_cvt_pk_bf16_f32 v169, v162, v163
    v_cvt_pk_bf16_f32 v170, v164, v165
    v_cvt_pk_bf16_f32 v171, v166, v167
    buffer_store_dwordx4 v[168:171], v30, s[8:11], s6 offen offset:768 sc1
    v_accvgpr_read_b32 v172, a208
    v_accvgpr_read_b32 v173, a209
    v_accvgpr_read_b32 v174, a210
    v_accvgpr_read_b32 v175, a211
    v_accvgpr_read_b32 v176, a240
    v_accvgpr_read_b32 v177, a241
    v_accvgpr_read_b32 v178, a242
    v_accvgpr_read_b32 v179, a243
    v_cvt_pk_bf16_f32 v180, v172, v173
    v_cvt_pk_bf16_f32 v181, v174, v175
    v_cvt_pk_bf16_f32 v182, v176, v177
    v_cvt_pk_bf16_f32 v183, v178, v179
    buffer_store_dwordx4 v[180:183], v30, s[8:11], s6 offen offset:1024 sc1
    v_accvgpr_read_b32 v184, a212
    v_accvgpr_read_b32 v185, a213
    v_accvgpr_read_b32 v186, a214
    v_accvgpr_read_b32 v187, a215
    v_accvgpr_read_b32 v188, a244
    v_accvgpr_read_b32 v189, a245
    v_accvgpr_read_b32 v190, a246
    v_accvgpr_read_b32 v191, a247
    v_cvt_pk_bf16_f32 v192, v184, v185
    v_cvt_pk_bf16_f32 v193, v186, v187
    v_cvt_pk_bf16_f32 v194, v188, v189
    v_cvt_pk_bf16_f32 v195, v190, v191
    buffer_store_dwordx4 v[192:195], v30, s[8:11], s6 offen offset:1280 sc1
    v_accvgpr_read_b32 v160, a216
    v_accvgpr_read_b32 v161, a217
    v_accvgpr_read_b32 v162, a218
    v_accvgpr_read_b32 v163, a219
    v_accvgpr_read_b32 v164, a248
    v_accvgpr_read_b32 v165, a249
    v_accvgpr_read_b32 v166, a250
    v_accvgpr_read_b32 v167, a251
    v_cvt_pk_bf16_f32 v168, v160, v161
    v_cvt_pk_bf16_f32 v169, v162, v163
    v_cvt_pk_bf16_f32 v170, v164, v165
    v_cvt_pk_bf16_f32 v171, v166, v167
    buffer_store_dwordx4 v[168:171], v30, s[8:11], s6 offen offset:1536 sc1
    v_accvgpr_read_b32 v172, a220
    v_accvgpr_read_b32 v173, a221
    v_accvgpr_read_b32 v174, a222
    v_accvgpr_read_b32 v175, a223
    v_accvgpr_read_b32 v176, a252
    v_accvgpr_read_b32 v177, a253
    v_accvgpr_read_b32 v178, a254
    v_accvgpr_read_b32 v179, a255
    v_cvt_pk_bf16_f32 v180, v172, v173
    v_cvt_pk_bf16_f32 v181, v174, v175
    v_cvt_pk_bf16_f32 v182, v176, v177
    v_cvt_pk_bf16_f32 v183, v178, v179
    buffer_store_dwordx4 v[180:183], v30, s[8:11], s6 offen offset:1792 sc1
    s_branch L_e1done
L_epV:
    s_lshr_b32 s5, s3, 1
    s_lshl_b32 s5, s5, 20
    s_add_u32 s7, s29, s5
    s_and_b32 s5, s3, 1
    s_lshl_b32 s5, s5, 10
    s_add_u32 s7, s7, s5
    s_nop 4
    s_add_u32 s6, s7, 0
    v_accvgpr_read_b32 v160, a0
    v_accvgpr_read_b32 v161, a1
    v_accvgpr_read_b32 v162, a2
    v_accvgpr_read_b32 v163, a3
    v_accvgpr_read_b32 v164, a4
    v_accvgpr_read_b32 v165, a5
    v_accvgpr_read_b32 v166, a6
    v_accvgpr_read_b32 v167, a7
    v_cvt_pk_bf16_f32 v168, v160, v161
    v_cvt_pk_bf16_f32 v169, v162, v163
    v_cvt_pk_bf16_f32 v170, v164, v165
    v_cvt_pk_bf16_f32 v171, v166, v167
    buffer_store_dwordx4 v[168:171], v230, s[8:11], s6 offen offset:0 sc1
    v_accvgpr_read_b32 v172, a32
    v_accvgpr_read_b32 v173, a33
    v_accvgpr_read_b32 v174, a34
    v_accvgpr_read_b32 v175, a35
    v_accvgpr_read_b32 v176, a36
    v_accvgpr_read_b32 v177, a37
    v_accvgpr_read_b32 v178, a38
    v_accvgpr_read_b32 v179, a39
    v_cvt_pk_bf16_f32 v180, v172, v173
    v_cvt_pk_bf16_f32 v181, v174, v175
    v_cvt_pk_bf16_f32 v182, v176, v177
    v_cvt_pk_bf16_f32 v183, v178, v179
    buffer_store_dwordx4 v[180:183], v230, s[8:11], s6 offen offset:256 sc1
    v_accvgpr_read_b32 v184, a64
    v_accvgpr_read_b32 v185, a65
    v_accvgpr_read_b32 v186, a66
    v_accvgpr_read_b32 v187, a67
    v_accvgpr_read_b32 v188, a68
    v_accvgpr_read_b32 v189, a69
    v_accvgpr_read_b32 v190, a70
    v_accvgpr_read_b32 v191, a71
    v_cvt_pk_bf16_f32 v192, v184, v185
    v_cvt_pk_bf16_f32 v193, v186, v187
    v_cvt_pk_bf16_f32 v194, v188, v189
    v_cvt_pk_bf16_f32 v195, v190, v191
    buffer_store_dwordx4 v[192:195], v230, s[8:11], s6 offen offset:512 sc1
    v_accvgpr_read_b32 v160, a96
    v_accvgpr_read_b32 v161, a97
    v_accvgpr_read_b32 v162, a98
    v_accvgpr_read_b32 v163, a99
    v_accvgpr_read_b32 v164, a100
    v_accvgpr_read_b32 v165, a101
    v_accvgpr_read_b32 v166, a102
    v_accvgpr_read_b32 v167, a103
    v_cvt_pk_bf16_f32 v168, v160, v161
    v_cvt_pk_bf16_f32 v169, v162, v163
    v_cvt_pk_bf16_f32 v170, v164, v165
    v_cvt_pk_bf16_f32 v171, v166, v167
    buffer_store_dwordx4 v[168:171], v230, s[8:11], s6 offen offset:768 sc1
    v_accvgpr_read_b32 v172, a128
    v_accvgpr_read_b32 v173, a129
    v_accvgpr_read_b32 v174, a130
    v_accvgpr_read_b32 v175, a131
    v_accvgpr_read_b32 v176, a132
    v_accvgpr_read_b32 v177, a133
    v_accvgpr_read_b32 v178, a134
    v_accvgpr_read_b32 v179, a135
    v_cvt_pk_bf16_f32 v180, v172, v173
    v_cvt_pk_bf16_f32 v181, v174, v175
    v_cvt_pk_bf16_f32 v182, v176, v177
    v_cvt_pk_bf16_f32 v183, v178, v179
    buffer_store_dwordx4 v[180:183], v230, s[8:11], s6 offen offset:2048 sc1
    v_accvgpr_read_b32 v184, a160
    v_accvgpr_read_b32 v185, a161
    v_accvgpr_read_b32 v186, a162
    v_accvgpr_read_b32 v187, a163
    v_accvgpr_read_b32 v188, a164
    v_accvgpr_read_b32 v189, a165
    v_accvgpr_read_b32 v190, a166
    v_accvgpr_read_b32 v191, a167
    v_cvt_pk_bf16_f32 v192, v184, v185
    v_cvt_pk_bf16_f32 v193, v186, v187
    v_cvt_pk_bf16_f32 v194, v188, v189
    v_cvt_pk_bf16_f32 v195, v190, v191
    buffer_store_dwordx4 v[192:195], v230, s[8:11], s6 offen offset:2304 sc1
    v_accvgpr_read_b32 v160, a192
    v_accvgpr_read_b32 v161, a193
    v_accvgpr_read_b32 v162, a194
    v_accvgpr_read_b32 v163, a195
    v_accvgpr_read_b32 v164, a196
    v_accvgpr_read_b32 v165, a197
    v_accvgpr_read_b32 v166, a198
    v_accvgpr_read_b32 v167, a199
    v_cvt_pk_bf16_f32 v168, v160, v161
    v_cvt_pk_bf16_f32 v169, v162, v163
    v_cvt_pk_bf16_f32 v170, v164, v165
    v_cvt_pk_bf16_f32 v171, v166, v167
    buffer_store_dwordx4 v[168:171], v230, s[8:11], s6 offen offset:2560 sc1
    v_accvgpr_read_b32 v172, a224
    v_accvgpr_read_b32 v173, a225
    v_accvgpr_read_b32 v174, a226
    v_accvgpr_read_b32 v175, a227
    v_accvgpr_read_b32 v176, a228
    v_accvgpr_read_b32 v177, a229
    v_accvgpr_read_b32 v178, a230
    v_accvgpr_read_b32 v179, a231
    v_cvt_pk_bf16_f32 v180, v172, v173
    v_cvt_pk_bf16_f32 v181, v174, v175
    v_cvt_pk_bf16_f32 v182, v176, v177
    v_cvt_pk_bf16_f32 v183, v178, v179
    buffer_store_dwordx4 v[180:183], v230, s[8:11], s6 offen offset:2816 sc1
    s_add_u32 s6, s7, 262144
    v_accvgpr_read_b32 v184, a8
    v_accvgpr_read_b32 v185, a9
    v_accvgpr_read_b32 v186, a10
    v_accvgpr_read_b32 v187, a11
    v_accvgpr_read_b32 v188, a12
    v_accvgpr_read_b32 v189, a13
    v_accvgpr_read_b32 v190, a14
    v_accvgpr_read_b32 v191, a15
    v_cvt_pk_bf16_f32 v192, v184, v185
    v_cvt_pk_bf16_f32 v193, v186, v187
    v_cvt_pk_bf16_f32 v194, v188, v189
    v_cvt_pk_bf16_f32 v195, v190, v191
    buffer_store_dwordx4 v[192:195], v230, s[8:11], s6 offen offset:0 sc1
    v_accvgpr_read_b32 v160, a40
    v_accvgpr_read_b32 v161, a41
    v_accvgpr_read_b32 v162, a42
    v_accvgpr_read_b32 v163, a43
    v_accvgpr_read_b32 v164, a44
    v_accvgpr_read_b32 v165, a45
    v_accvgpr_read_b32 v166, a46
    v_accvgpr_read_b32 v167, a47
    v_cvt_pk_bf16_f32 v168, v160, v161
    v_cvt_pk_bf16_f32 v169, v162, v163
    v_cvt_pk_bf16_f32 v170, v164, v165
    v_cvt_pk_bf16_f32 v171, v166, v167
    buffer_store_dwordx4 v[168:171], v230, s[8:11], s6 offen offset:256 sc1
    v_accvgpr_read_b32 v172, a72
    v_accvgpr_read_b32 v173, a73
    v_accvgpr_read_b32 v174, a74
    v_accvgpr_read_b32 v175, a75
    v_accvgpr_read_b32 v176, a76
    v_accvgpr_read_b32 v177, a77
    v_accvgpr_read_b32 v178, a78
    v_accvgpr_read_b32 v179, a79
    v_cvt_pk_bf16_f32 v180, v172, v173
    v_cvt_pk_bf16_f32 v181, v174, v175
    v_cvt_pk_bf16_f32 v182, v176, v177
    v_cvt_pk_bf16_f32 v183, v178, v179
    buffer_store_dwordx4 v[180:183], v230, s[8:11], s6 offen offset:512 sc1
    v_accvgpr_read_b32 v184, a104
    v_accvgpr_read_b32 v185, a105
    v_accvgpr_read_b32 v186, a106
    v_accvgpr_read_b32 v187, a107
    v_accvgpr_read_b32 v188, a108
    v_accvgpr_read_b32 v189, a109
    v_accvgpr_read_b32 v190, a110
    v_accvgpr_read_b32 v191, a111
    v_cvt_pk_bf16_f32 v192, v184, v185
    v_cvt_pk_bf16_f32 v193, v186, v187
    v_cvt_pk_bf16_f32 v194, v188, v189
    v_cvt_pk_bf16_f32 v195, v190, v191
    buffer_store_dwordx4 v[192:195], v230, s[8:11], s6 offen offset:768 sc1
    v_accvgpr_read_b32 v160, a136
    v_accvgpr_read_b32 v161, a137
    v_accvgpr_read_b32 v162, a138
    v_accvgpr_read_b32 v163, a139
    v_accvgpr_read_b32 v164, a140
    v_accvgpr_read_b32 v165, a141
    v_accvgpr_read_b32 v166, a142
    v_accvgpr_read_b32 v167, a143
    v_cvt_pk_bf16_f32 v168, v160, v161
    v_cvt_pk_bf16_f32 v169, v162, v163
    v_cvt_pk_bf16_f32 v170, v164, v165
    v_cvt_pk_bf16_f32 v171, v166, v167
    buffer_store_dwordx4 v[168:171], v230, s[8:11], s6 offen offset:2048 sc1
    v_accvgpr_read_b32 v172, a168
    v_accvgpr_read_b32 v173, a169
    v_accvgpr_read_b32 v174, a170
    v_accvgpr_read_b32 v175, a171
    v_accvgpr_read_b32 v176, a172
    v_accvgpr_read_b32 v177, a173
    v_accvgpr_read_b32 v178, a174
    v_accvgpr_read_b32 v179, a175
    v_cvt_pk_bf16_f32 v180, v172, v173
    v_cvt_pk_bf16_f32 v181, v174, v175
    v_cvt_pk_bf16_f32 v182, v176, v177
    v_cvt_pk_bf16_f32 v183, v178, v179
    buffer_store_dwordx4 v[180:183], v230, s[8:11], s6 offen offset:2304 sc1
    v_accvgpr_read_b32 v184, a200
    v_accvgpr_read_b32 v185, a201
    v_accvgpr_read_b32 v186, a202
    v_accvgpr_read_b32 v187, a203
    v_accvgpr_read_b32 v188, a204
    v_accvgpr_read_b32 v189, a205
    v_accvgpr_read_b32 v190, a206
    v_accvgpr_read_b32 v191, a207
    v_cvt_pk_bf16_f32 v192, v184, v185
    v_cvt_pk_bf16_f32 v193, v186, v187
    v_cvt_pk_bf16_f32 v194, v188, v189
    v_cvt_pk_bf16_f32 v195, v190, v191
    buffer_store_dwordx4 v[192:195], v230, s[8:11], s6 offen offset:2560 sc1
    v_accvgpr_read_b32 v160, a232
    v_accvgpr_read_b32 v161, a233
    v_accvgpr_read_b32 v162, a234
    v_accvgpr_read_b32 v163, a235
    v_accvgpr_read_b32 v164, a236
    v_accvgpr_read_b32 v165, a237
    v_accvgpr_read_b32 v166, a238
    v_accvgpr_read_b32 v167, a239
    v_cvt_pk_bf16_f32 v168, v160, v161
    v_cvt_pk_bf16_f32 v169, v162, v163
    v_cvt_pk_bf16_f32 v170, v164, v165
    v_cvt_pk_bf16_f32 v171, v166, v167
    buffer_store_dwordx4 v[168:171], v230, s[8:11], s6 offen offset:2816 sc1
    s_add_u32 s6, s7, 524288
    v_accvgpr_read_b32 v172, a16
    v_accvgpr_read_b32 v173, a17
    v_accvgpr_read_b32 v174, a18
    v_accvgpr_read_b32 v175, a19
    v_accvgpr_read_b32 v176, a20
    v_accvgpr_read_b32 v177, a21
    v_accvgpr_read_b32 v178, a22
    v_accvgpr_read_b32 v179, a23
    v_cvt_pk_bf16_f32 v180, v172, v173
    v_cvt_pk_bf16_f32 v181, v174, v175
    v_cvt_pk_bf16_f32 v182, v176, v177
    v_cvt_pk_bf16_f32 v183, v178, v179
    buffer_store_dwordx4 v[180:183], v230, s[8:11], s6 offen offset:0 sc1
    v_accvgpr_read_b32 v184, a48
    v_accvgpr_read_b32 v185, a49
    v_accvgpr_read_b32 v186, a50
    v_accvgpr_read_b32 v187, a51
    v_accvgpr_read_b32 v188, a52
    v_accvgpr_read_b32 v189, a53
    v_accvgpr_read_b32 v190, a54
    v_accvgpr_read_b32 v191, a55
    v_cvt_pk_bf16_f32 v192, v184, v185
    v_cvt_pk_bf16_f32 v193, v186, v187
    v_cvt_pk_bf16_f32 v194, v188, v189
    v_cvt_pk_bf16_f32 v195, v190, v191
    buffer_store_dwordx4 v[192:195], v230, s[8:11], s6 offen offset:256 sc1
    v_accvgpr_read_b32 v160, a80
    v_accvgpr_read_b32 v161, a81
    v_accvgpr_read_b32 v162, a82
    v_accvgpr_read_b32 v163, a83
    v_accvgpr_read_b32 v164, a84
    v_accvgpr_read_b32 v165, a85
    v_accvgpr_read_b32 v166, a86
    v_accvgpr_read_b32 v167, a87
    v_cvt_pk_bf16_f32 v168, v160, v161
    v_cvt_pk_bf16_f32 v169, v162, v163
    v_cvt_pk_bf16_f32 v170, v164, v165
    v_cvt_pk_bf16_f32 v171, v166, v167
    buffer_store_dwordx4 v[168:171], v230, s[8:11], s6 offen offset:512 sc1
    v_accvgpr_read_b32 v172, a112
    v_accvgpr_read_b32 v173, a113
    v_accvgpr_read_b32 v174, a114
    v_accvgpr_read_b32 v175, a115
    v_accvgpr_read_b32 v176, a116
    v_accvgpr_read_b32 v177, a117
    v_accvgpr_read_b32 v178, a118
    v_accvgpr_read_b32 v179, a119
    v_cvt_pk_bf16_f32 v180, v172, v173
    v_cvt_pk_bf16_f32 v181, v174, v175
    v_cvt_pk_bf16_f32 v182, v176, v177
    v_cvt_pk_bf16_f32 v183, v178, v179
    buffer_store_dwordx4 v[180:183], v230, s[8:11], s6 offen offset:768 sc1
    v_accvgpr_read_b32 v184, a144
    v_accvgpr_read_b32 v185, a145
    v_accvgpr_read_b32 v186, a146
    v_accvgpr_read_b32 v187, a147
    v_accvgpr_read_b32 v188, a148
    v_accvgpr_read_b32 v189, a149
    v_accvgpr_read_b32 v190, a150
    v_accvgpr_read_b32 v191, a151
    v_cvt_pk_bf16_f32 v192, v184, v185
    v_cvt_pk_bf16_f32 v193, v186, v187
    v_cvt_pk_bf16_f32 v194, v188, v189
    v_cvt_pk_bf16_f32 v195, v190, v191
    buffer_store_dwordx4 v[192:195], v230, s[8:11], s6 offen offset:2048 sc1
    v_accvgpr_read_b32 v160, a176
    v_accvgpr_read_b32 v161, a177
    v_accvgpr_read_b32 v162, a178
    v_accvgpr_read_b32 v163, a179
    v_accvgpr_read_b32 v164, a180
    v_accvgpr_read_b32 v165, a181
    v_accvgpr_read_b32 v166, a182
    v_accvgpr_read_b32 v167, a183
    v_cvt_pk_bf16_f32 v168, v160, v161
    v_cvt_pk_bf16_f32 v169, v162, v163
    v_cvt_pk_bf16_f32 v170, v164, v165
    v_cvt_pk_bf16_f32 v171, v166, v167
    buffer_store_dwordx4 v[168:171], v230, s[8:11], s6 offen offset:2304 sc1
    v_accvgpr_read_b32 v172, a208
    v_accvgpr_read_b32 v173, a209
    v_accvgpr_read_b32 v174, a210
    v_accvgpr_read_b32 v175, a211
    v_accvgpr_read_b32 v176, a212
    v_accvgpr_read_b32 v177, a213
    v_accvgpr_read_b32 v178, a214
    v_accvgpr_read_b32 v179, a215
    v_cvt_pk_bf16_f32 v180, v172, v173
    v_cvt_pk_bf16_f32 v181, v174, v175
    v_cvt_pk_bf16_f32 v182, v176, v177
    v_cvt_pk_bf16_f32 v183, v178, v179
    buffer_store_dwordx4 v[180:183], v230, s[8:11], s6 offen offset:2560 sc1
    v_accvgpr_read_b32 v184, a240
    v_accvgpr_read_b32 v185, a241
    v_accvgpr_read_b32 v186, a242
    v_accvgpr_read_b32 v187, a243
    v_accvgpr_read_b32 v188, a244
    v_accvgpr_read_b32 v189, a245
    v_accvgpr_read_b32 v190, a246
    v_accvgpr_read_b32 v191, a247
    v_cvt_pk_bf16_f32 v192, v184, v185
    v_cvt_pk_bf16_f32 v193, v186, v187
    v_cvt_pk_bf16_f32 v194, v188, v189
    v_cvt_pk_bf16_f32 v195, v190, v191
    buffer_store_dwordx4 v[192:195], v230, s[8:11], s6 offen offset:2816 sc1
    s_add_u32 s6, s7, 786432
    v_accvgpr_read_b32 v160, a24
    v_accvgpr_read_b32 v161, a25
    v_accvgpr_read_b32 v162, a26
    v_accvgpr_read_b32 v163, a27
    v_accvgpr_read_b32 v164, a28
    v_accvgpr_read_b32 v165, a29
    v_accvgpr_read_b32 v166, a30
    v_accvgpr_read_b32 v167, a31
    v_cvt_pk_bf16_f32 v168, v160, v161
    v_cvt_pk_bf16_f32 v169, v162, v163
    v_cvt_pk_bf16_f32 v170, v164, v165
    v_cvt_pk_bf16_f32 v171, v166, v167
    buffer_store_dwordx4 v[168:171], v230, s[8:11], s6 offen offset:0 sc1
    v_accvgpr_read_b32 v172, a56
    v_accvgpr_read_b32 v173, a57
    v_accvgpr_read_b32 v174, a58
    v_accvgpr_read_b32 v175, a59
    v_accvgpr_read_b32 v176, a60
    v_accvgpr_read_b32 v177, a61
    v_accvgpr_read_b32 v178, a62
    v_accvgpr_read_b32 v179, a63
    v_cvt_pk_bf16_f32 v180, v172, v173
    v_cvt_pk_bf16_f32 v181, v174, v175
    v_cvt_pk_bf16_f32 v182, v176, v177
    v_cvt_pk_bf16_f32 v183, v178, v179
    buffer_store_dwordx4 v[180:183], v230, s[8:11], s6 offen offset:256 sc1
    v_accvgpr_read_b32 v184, a88
    v_accvgpr_read_b32 v185, a89
    v_accvgpr_read_b32 v186, a90
    v_accvgpr_read_b32 v187, a91
    v_accvgpr_read_b32 v188, a92
    v_accvgpr_read_b32 v189, a93
    v_accvgpr_read_b32 v190, a94
    v_accvgpr_read_b32 v191, a95
    v_cvt_pk_bf16_f32 v192, v184, v185
    v_cvt_pk_bf16_f32 v193, v186, v187
    v_cvt_pk_bf16_f32 v194, v188, v189
    v_cvt_pk_bf16_f32 v195, v190, v191
    buffer_store_dwordx4 v[192:195], v230, s[8:11], s6 offen offset:512 sc1
    v_accvgpr_read_b32 v160, a120
    v_accvgpr_read_b32 v161, a121
    v_accvgpr_read_b32 v162, a122
    v_accvgpr_read_b32 v163, a123
    v_accvgpr_read_b32 v164, a124
    v_accvgpr_read_b32 v165, a125
    v_accvgpr_read_b32 v166, a126
    v_accvgpr_read_b32 v167, a127
    v_cvt_pk_bf16_f32 v168, v160, v161
    v_cvt_pk_bf16_f32 v169, v162, v163
    v_cvt_pk_bf16_f32 v170, v164, v165
    v_cvt_pk_bf16_f32 v171, v166, v167
    buffer_store_dwordx4 v[168:171], v230, s[8:11], s6 offen offset:768 sc1
    v_accvgpr_read_b32 v172, a152
    v_accvgpr_read_b32 v173, a153
    v_accvgpr_read_b32 v174, a154
    v_accvgpr_read_b32 v175, a155
    v_accvgpr_read_b32 v176, a156
    v_accvgpr_read_b32 v177, a157
    v_accvgpr_read_b32 v178, a158
    v_accvgpr_read_b32 v179, a159
    v_cvt_pk_bf16_f32 v180, v172, v173
    v_cvt_pk_bf16_f32 v181, v174, v175
    v_cvt_pk_bf16_f32 v182, v176, v177
    v_cvt_pk_bf16_f32 v183, v178, v179
    buffer_store_dwordx4 v[180:183], v230, s[8:11], s6 offen offset:2048 sc1
    v_accvgpr_read_b32 v184, a184
    v_accvgpr_read_b32 v185, a185
    v_accvgpr_read_b32 v186, a186
    v_accvgpr_read_b32 v187, a187
    v_accvgpr_read_b32 v188, a188
    v_accvgpr_read_b32 v189, a189
    v_accvgpr_read_b32 v190, a190
    v_accvgpr_read_b32 v191, a191
    v_cvt_pk_bf16_f32 v192, v184, v185
    v_cvt_pk_bf16_f32 v193, v186, v187
    v_cvt_pk_bf16_f32 v194, v188, v189
    v_cvt_pk_bf16_f32 v195, v190, v191
    buffer_store_dwordx4 v[192:195], v230, s[8:11], s6 offen offset:2304 sc1
    v_accvgpr_read_b32 v160, a216
    v_accvgpr_read_b32 v161, a217
    v_accvgpr_read_b32 v162, a218
    v_accvgpr_read_b32 v163, a219
    v_accvgpr_read_b32 v164, a220
    v_accvgpr_read_b32 v165, a221
    v_accvgpr_read_b32 v166, a222
    v_accvgpr_read_b32 v167, a223
    v_cvt_pk_bf16_f32 v168, v160, v161
    v_cvt_pk_bf16_f32 v169, v162, v163
    v_cvt_pk_bf16_f32 v170, v164, v165
    v_cvt_pk_bf16_f32 v171, v166, v167
    buffer_store_dwordx4 v[168:171], v230, s[8:11], s6 offen offset:2560 sc1
    v_accvgpr_read_b32 v172, a248
    v_accvgpr_read_b32 v173, a249
    v_accvgpr_read_b32 v174, a250
    v_accvgpr_read_b32 v175, a251
    v_accvgpr_read_b32 v176, a252
    v_accvgpr_read_b32 v177, a253
    v_accvgpr_read_b32 v178, a254
    v_accvgpr_read_b32 v179, a255
    v_cvt_pk_bf16_f32 v180, v172, v173
    v_cvt_pk_bf16_f32 v181, v174, v175
    v_cvt_pk_bf16_f32 v182, v176, v177
    v_cvt_pk_bf16_f32 v183, v178, v179
    buffer_store_dwordx4 v[180:183], v230, s[8:11], s6 offen offset:2816 sc1
    s_branch L_e1done
L_epGU:
    s_and_b32 s5, s3, 1
    s_lshl_b32 s5, s5, 15
    s_add_u32 s7, s29, s5
    s_nop 4
    s_add_u32 s6, s7, 0
    v_accvgpr_read_b32 v160, a0
    v_accvgpr_read_b32 v168, a128
    v_accvgpr_read_b32 v161, a1
    v_accvgpr_read_b32 v169, a129
    v_accvgpr_read_b32 v162, a2
    v_accvgpr_read_b32 v170, a130
    v_accvgpr_read_b32 v163, a3
    v_accvgpr_read_b32 v171, a131
    v_accvgpr_read_b32 v164, a32
    v_accvgpr_read_b32 v172, a160
    v_accvgpr_read_b32 v165, a33
    v_accvgpr_read_b32 v173, a161
    v_accvgpr_read_b32 v166, a34
    v_accvgpr_read_b32 v174, a162
    v_accvgpr_read_b32 v167, a35
    v_accvgpr_read_b32 v175, a163
    v_max_f32 v160, 0, v160
    v_max_f32 v161, 0, v161
    v_max_f32 v162, 0, v162
    v_max_f32 v163, 0, v163
    v_max_f32 v164, 0, v164
    v_max_f32 v165, 0, v165
    v_max_f32 v166, 0, v166
    v_max_f32 v167, 0, v167
    v_pk_mul_f32 v[160:161], v[160:161], v[168:169]
    v_pk_mul_f32 v[162:163], v[162:163], v[170:171]
    v_pk_mul_f32 v[164:165], v[164:165], v[172:173]
    v_pk_mul_f32 v[166:167], v[166:167], v[174:175]
    v_cvt_pk_bf16_f32 v176, v160, v161
    v_cvt_pk_bf16_f32 v177, v162, v163
    v_cvt_pk_bf16_f32 v178, v164, v165
    v_cvt_pk_bf16_f32 v179, v166, v167
    buffer_store_dwordx4 v[176:179], v30, s[8:11], s6 offen offset:0 sc1
    v_accvgpr_read_b32 v180, a4
    v_accvgpr_read_b32 v188, a132
    v_accvgpr_read_b32 v181, a5
    v_accvgpr_read_b32 v189, a133
    v_accvgpr_read_b32 v182, a6
    v_accvgpr_read_b32 v190, a134
    v_accvgpr_read_b32 v183, a7
    v_accvgpr_read_b32 v191, a135
    v_accvgpr_read_b32 v184, a36
    v_accvgpr_read_b32 v192, a164
    v_accvgpr_read_b32 v185, a37
    v_accvgpr_read_b32 v193, a165
    v_accvgpr_read_b32 v186, a38
    v_accvgpr_read_b32 v194, a166
    v_accvgpr_read_b32 v187, a39
    v_accvgpr_read_b32 v195, a167
    v_max_f32 v180, 0, v180
    v_max_f32 v181, 0, v181
    v_max_f32 v182, 0, v182
    v_max_f32 v183, 0, v183
    v_max_f32 v184, 0, v184
    v_max_f32 v185, 0, v185
    v_max_f32 v186, 0, v186
    v_max_f32 v187, 0, v187
    v_pk_mul_f32 v[180:181], v[180:181], v[188:189]
    v_pk_mul_f32 v[182:183], v[182:183], v[190:191]
    v_pk_mul_f32 v[184:185], v[184:185], v[192:193]
    v_pk_mul_f32 v[186:187], v[186:187], v[194:195]
    v_cvt_pk_bf16_f32 v196, v180, v181
    v_cvt_pk_bf16_f32 v197, v182, v183
    v_cvt_pk_bf16_f32 v198, v184, v185
    v_cvt_pk_bf16_f32 v199, v186, v187
    buffer_store_dwordx4 v[196:199], v30, s[8:11], s6 offen offset:256 sc1
    v_accvgpr_read_b32 v160, a8
    v_accvgpr_read_b32 v168, a136
    v_accvgpr_read_b32 v161, a9
    v_accvgpr_read_b32 v169, a137
    v_accvgpr_read_b32 v162, a10
    v_accvgpr_read_b32 v170, a138
    v_accvgpr_read_b32 v163, a11
    v_accvgpr_read_b32 v171, a139
    v_accvgpr_read_b32 v164, a40
    v_accvgpr_read_b32 v172, a168
    v_accvgpr_read_b32 v165, a41
    v_accvgpr_read_b32 v173, a169
    v_accvgpr_read_b32 v166, a42
    v_accvgpr_read_b32 v174, a170
    v_accvgpr_read_b32 v167, a43
    v_accvgpr_read_b32 v175, a171
    v_max_f32 v160, 0, v160
    v_max_f32 v161, 0, v161
    v_max_f32 v162, 0, v162
    v_max_f32 v163, 0, v163
    v_max_f32 v164, 0, v164
    v_max_f32 v165, 0, v165
    v_max_f32 v166, 0, v166
    v_max_f32 v167, 0, v167
    v_pk_mul_f32 v[160:161], v[160:161], v[168:169]
    v_pk_mul_f32 v[162:163], v[162:163], v[170:171]
    v_pk_mul_f32 v[164:165], v[164:165], v[172:173]
    v_pk_mul_f32 v[166:167], v[166:167], v[174:175]
    v_cvt_pk_bf16_f32 v176, v160, v161
    v_cvt_pk_bf16_f32 v177, v162, v163
    v_cvt_pk_bf16_f32 v178, v164, v165
    v_cvt_pk_bf16_f32 v179, v166, v167
    buffer_store_dwordx4 v[176:179], v30, s[8:11], s6 offen offset:512 sc1
    v_accvgpr_read_b32 v180, a12
    v_accvgpr_read_b32 v188, a140
    v_accvgpr_read_b32 v181, a13
    v_accvgpr_read_b32 v189, a141
    v_accvgpr_read_b32 v182, a14
    v_accvgpr_read_b32 v190, a142
    v_accvgpr_read_b32 v183, a15
    v_accvgpr_read_b32 v191, a143
    v_accvgpr_read_b32 v184, a44
    v_accvgpr_read_b32 v192, a172
    v_accvgpr_read_b32 v185, a45
    v_accvgpr_read_b32 v193, a173
    v_accvgpr_read_b32 v186, a46
    v_accvgpr_read_b32 v194, a174
    v_accvgpr_read_b32 v187, a47
    v_accvgpr_read_b32 v195, a175
    v_max_f32 v180, 0, v180
    v_max_f32 v181, 0, v181
    v_max_f32 v182, 0, v182
    v_max_f32 v183, 0, v183
    v_max_f32 v184, 0, v184
    v_max_f32 v185, 0, v185
    v_max_f32 v186, 0, v186
    v_max_f32 v187, 0, v187
    v_pk_mul_f32 v[180:181], v[180:181], v[188:189]
    v_pk_mul_f32 v[182:183], v[182:183], v[190:191]
    v_pk_mul_f32 v[184:185], v[184:185], v[192:193]
    v_pk_mul_f32 v[186:187], v[186:187], v[194:195]
    v_cvt_pk_bf16_f32 v196, v180, v181
    v_cvt_pk_bf16_f32 v197, v182, v183
    v_cvt_pk_bf16_f32 v198, v184, v185
    v_cvt_pk_bf16_f32 v199, v186, v187
    buffer_store_dwordx4 v[196:199], v30, s[8:11], s6 offen offset:768 sc1
    v_accvgpr_read_b32 v160, a16
    v_accvgpr_read_b32 v168, a144
    v_accvgpr_read_b32 v161, a17
    v_accvgpr_read_b32 v169, a145
    v_accvgpr_read_b32 v162, a18
    v_accvgpr_read_b32 v170, a146
    v_accvgpr_read_b32 v163, a19
    v_accvgpr_read_b32 v171, a147
    v_accvgpr_read_b32 v164, a48
    v_accvgpr_read_b32 v172, a176
    v_accvgpr_read_b32 v165, a49
    v_accvgpr_read_b32 v173, a177
    v_accvgpr_read_b32 v166, a50
    v_accvgpr_read_b32 v174, a178
    v_accvgpr_read_b32 v167, a51
    v_accvgpr_read_b32 v175, a179
    v_max_f32 v160, 0, v160
    v_max_f32 v161, 0, v161
    v_max_f32 v162, 0, v162
    v_max_f32 v163, 0, v163
    v_max_f32 v164, 0, v164
    v_max_f32 v165, 0, v165
    v_max_f32 v166, 0, v166
    v_max_f32 v167, 0, v167
    v_pk_mul_f32 v[160:161], v[160:161], v[168:169]
    v_pk_mul_f32 v[162:163], v[162:163], v[170:171]
    v_pk_mul_f32 v[164:165], v[164:165], v[172:173]
    v_pk_mul_f32 v[166:167], v[166:167], v[174:175]
    v_cvt_pk_bf16_f32 v176, v160, v161
    v_cvt_pk_bf16_f32 v177, v162, v163
    v_cvt_pk_bf16_f32 v178, v164, v165
    v_cvt_pk_bf16_f32 v179, v166, v167
    buffer_store_dwordx4 v[176:179], v30, s[8:11], s6 offen offset:1024 sc1
    v_accvgpr_read_b32 v180, a20
    v_accvgpr_read_b32 v188, a148
    v_accvgpr_read_b32 v181, a21
    v_accvgpr_read_b32 v189, a149
    v_accvgpr_read_b32 v182, a22
    v_accvgpr_read_b32 v190, a150
    v_accvgpr_read_b32 v183, a23
    v_accvgpr_read_b32 v191, a151
    v_accvgpr_read_b32 v184, a52
    v_accvgpr_read_b32 v192, a180
    v_accvgpr_read_b32 v185, a53
    v_accvgpr_read_b32 v193, a181
    v_accvgpr_read_b32 v186, a54
    v_accvgpr_read_b32 v194, a182
    v_accvgpr_read_b32 v187, a55
    v_accvgpr_read_b32 v195, a183
    v_max_f32 v180, 0, v180
    v_max_f32 v181, 0, v181
    v_max_f32 v182, 0, v182
    v_max_f32 v183, 0, v183
    v_max_f32 v184, 0, v184
    v_max_f32 v185, 0, v185
    v_max_f32 v186, 0, v186
    v_max_f32 v187, 0, v187
    v_pk_mul_f32 v[180:181], v[180:181], v[188:189]
    v_pk_mul_f32 v[182:183], v[182:183], v[190:191]
    v_pk_mul_f32 v[184:185], v[184:185], v[192:193]
    v_pk_mul_f32 v[186:187], v[186:187], v[194:195]
    v_cvt_pk_bf16_f32 v196, v180, v181
    v_cvt_pk_bf16_f32 v197, v182, v183
    v_cvt_pk_bf16_f32 v198, v184, v185
    v_cvt_pk_bf16_f32 v199, v186, v187
    buffer_store_dwordx4 v[196:199], v30, s[8:11], s6 offen offset:1280 sc1
    v_accvgpr_read_b32 v160, a24
    v_accvgpr_read_b32 v168, a152
    v_accvgpr_read_b32 v161, a25
    v_accvgpr_read_b32 v169, a153
    v_accvgpr_read_b32 v162, a26
    v_accvgpr_read_b32 v170, a154
    v_accvgpr_read_b32 v163, a27
    v_accvgpr_read_b32 v171, a155
    v_accvgpr_read_b32 v164, a56
    v_accvgpr_read_b32 v172, a184
    v_accvgpr_read_b32 v165, a57
    v_accvgpr_read_b32 v173, a185
    v_accvgpr_read_b32 v166, a58
    v_accvgpr_read_b32 v174, a186
    v_accvgpr_read_b32 v167, a59
    v_accvgpr_read_b32 v175, a187
    v_max_f32 v160, 0, v160
    v_max_f32 v161, 0, v161
    v_max_f32 v162, 0, v162
    v_max_f32 v163, 0, v163
    v_max_f32 v164, 0, v164
    v_max_f32 v165, 0, v165
    v_max_f32 v166, 0, v166
    v_max_f32 v167, 0, v167
    v_pk_mul_f32 v[160:161], v[160:161], v[168:169]
    v_pk_mul_f32 v[162:163], v[162:163], v[170:171]
    v_pk_mul_f32 v[164:165], v[164:165], v[172:173]
    v_pk_mul_f32 v[166:167], v[166:167], v[174:175]
    v_cvt_pk_bf16_f32 v176, v160, v161
    v_cvt_pk_bf16_f32 v177, v162, v163
    v_cvt_pk_bf16_f32 v178, v164, v165
    v_cvt_pk_bf16_f32 v179, v166, v167
    buffer_store_dwordx4 v[176:179], v30, s[8:11], s6 offen offset:1536 sc1
    v_accvgpr_read_b32 v180, a28
    v_accvgpr_read_b32 v188, a156
    v_accvgpr_read_b32 v181, a29
    v_accvgpr_read_b32 v189, a157
    v_accvgpr_read_b32 v182, a30
    v_accvgpr_read_b32 v190, a158
    v_accvgpr_read_b32 v183, a31
    v_accvgpr_read_b32 v191, a159
    v_accvgpr_read_b32 v184, a60
    v_accvgpr_read_b32 v192, a188
    v_accvgpr_read_b32 v185, a61
    v_accvgpr_read_b32 v193, a189
    v_accvgpr_read_b32 v186, a62
    v_accvgpr_read_b32 v194, a190
    v_accvgpr_read_b32 v187, a63
    v_accvgpr_read_b32 v195, a191
    v_max_f32 v180, 0, v180
    v_max_f32 v181, 0, v181
    v_max_f32 v182, 0, v182
    v_max_f32 v183, 0, v183
    v_max_f32 v184, 0, v184
    v_max_f32 v185, 0, v185
    v_max_f32 v186, 0, v186
    v_max_f32 v187, 0, v187
    v_pk_mul_f32 v[180:181], v[180:181], v[188:189]
    v_pk_mul_f32 v[182:183], v[182:183], v[190:191]
    v_pk_mul_f32 v[184:185], v[184:185], v[192:193]
    v_pk_mul_f32 v[186:187], v[186:187], v[194:195]
    v_cvt_pk_bf16_f32 v196, v180, v181
    v_cvt_pk_bf16_f32 v197, v182, v183
    v_cvt_pk_bf16_f32 v198, v184, v185
    v_cvt_pk_bf16_f32 v199, v186, v187
    buffer_store_dwordx4 v[196:199], v30, s[8:11], s6 offen offset:1792 sc1
    s_add_u32 s6, s7, 16384
    v_accvgpr_read_b32 v160, a64
    v_accvgpr_read_b32 v168, a192
    v_accvgpr_read_b32 v161, a65
    v_accvgpr_read_b32 v169, a193
    v_accvgpr_read_b32 v162, a66
    v_accvgpr_read_b32 v170, a194
    v_accvgpr_read_b32 v163, a67
    v_accvgpr_read_b32 v171, a195
    v_accvgpr_read_b32 v164, a96
    v_accvgpr_read_b32 v172, a224
    v_accvgpr_read_b32 v165, a97
    v_accvgpr_read_b32 v173, a225
    v_accvgpr_read_b32 v166, a98
    v_accvgpr_read_b32 v174, a226
    v_accvgpr_read_b32 v167, a99
    v_accvgpr_read_b32 v175, a227
    v_max_f32 v160, 0, v160
    v_max_f32 v161, 0, v161
    v_max_f32 v162, 0, v162
    v_max_f32 v163, 0, v163
    v_max_f32 v164, 0, v164
    v_max_f32 v165, 0, v165
    v_max_f32 v166, 0, v166
    v_max_f32 v167, 0, v167
    v_pk_mul_f32 v[160:161], v[160:161], v[168:169]
    v_pk_mul_f32 v[162:163], v[162:163], v[170:171]
    v_pk_mul_f32 v[164:165], v[164:165], v[172:173]
    v_pk_mul_f32 v[166:167], v[166:167], v[174:175]
    v_cvt_pk_bf16_f32 v176, v160, v161
    v_cvt_pk_bf16_f32 v177, v162, v163
    v_cvt_pk_bf16_f32 v178, v164, v165
    v_cvt_pk_bf16_f32 v179, v166, v167
    buffer_store_dwordx4 v[176:179], v30, s[8:11], s6 offen offset:0 sc1
    v_accvgpr_read_b32 v180, a68
    v_accvgpr_read_b32 v188, a196
    v_accvgpr_read_b32 v181, a69
    v_accvgpr_read_b32 v189, a197
    v_accvgpr_read_b32 v182, a70
    v_accvgpr_read_b32 v190, a198
    v_accvgpr_read_b32 v183, a71
    v_accvgpr_read_b32 v191, a199
    v_accvgpr_read_b32 v184, a100
    v_accvgpr_read_b32 v192, a228
    v_accvgpr_read_b32 v185, a101
    v_accvgpr_read_b32 v193, a229
    v_accvgpr_read_b32 v186, a102
    v_accvgpr_read_b32 v194, a230
    v_accvgpr_read_b32 v187, a103
    v_accvgpr_read_b32 v195, a231
    v_max_f32 v180, 0, v180
    v_max_f32 v181, 0, v181
    v_max_f32 v182, 0, v182
    v_max_f32 v183, 0, v183
    v_max_f32 v184, 0, v184
    v_max_f32 v185, 0, v185
    v_max_f32 v186, 0, v186
    v_max_f32 v187, 0, v187
    v_pk_mul_f32 v[180:181], v[180:181], v[188:189]
    v_pk_mul_f32 v[182:183], v[182:183], v[190:191]
    v_pk_mul_f32 v[184:185], v[184:185], v[192:193]
    v_pk_mul_f32 v[186:187], v[186:187], v[194:195]
    v_cvt_pk_bf16_f32 v196, v180, v181
    v_cvt_pk_bf16_f32 v197, v182, v183
    v_cvt_pk_bf16_f32 v198, v184, v185
    v_cvt_pk_bf16_f32 v199, v186, v187
    buffer_store_dwordx4 v[196:199], v30, s[8:11], s6 offen offset:256 sc1
    v_accvgpr_read_b32 v160, a72
    v_accvgpr_read_b32 v168, a200
    v_accvgpr_read_b32 v161, a73
    v_accvgpr_read_b32 v169, a201
    v_accvgpr_read_b32 v162, a74
    v_accvgpr_read_b32 v170, a202
    v_accvgpr_read_b32 v163, a75
    v_accvgpr_read_b32 v171, a203
    v_accvgpr_read_b32 v164, a104
    v_accvgpr_read_b32 v172, a232
    v_accvgpr_read_b32 v165, a105
    v_accvgpr_read_b32 v173, a233
    v_accvgpr_read_b32 v166, a106
    v_accvgpr_read_b32 v174, a234
    v_accvgpr_read_b32 v167, a107
    v_accvgpr_read_b32 v175, a235
    v_max_f32 v160, 0, v160
    v_max_f32 v161, 0, v161
    v_max_f32 v162, 0, v162
    v_max_f32 v163, 0, v163
    v_max_f32 v164, 0, v164
    v_max_f32 v165, 0, v165
    v_max_f32 v166, 0, v166
    v_max_f32 v167, 0, v167
    v_pk_mul_f32 v[160:161], v[160:161], v[168:169]
    v_pk_mul_f32 v[162:163], v[162:163], v[170:171]
    v_pk_mul_f32 v[164:165], v[164:165], v[172:173]
    v_pk_mul_f32 v[166:167], v[166:167], v[174:175]
    v_cvt_pk_bf16_f32 v176, v160, v161
    v_cvt_pk_bf16_f32 v177, v162, v163
    v_cvt_pk_bf16_f32 v178, v164, v165
    v_cvt_pk_bf16_f32 v179, v166, v167
    buffer_store_dwordx4 v[176:179], v30, s[8:11], s6 offen offset:512 sc1
    v_accvgpr_read_b32 v180, a76
    v_accvgpr_read_b32 v188, a204
    v_accvgpr_read_b32 v181, a77
    v_accvgpr_read_b32 v189, a205
    v_accvgpr_read_b32 v182, a78
    v_accvgpr_read_b32 v190, a206
    v_accvgpr_read_b32 v183, a79
    v_accvgpr_read_b32 v191, a207
    v_accvgpr_read_b32 v184, a108
    v_accvgpr_read_b32 v192, a236
    v_accvgpr_read_b32 v185, a109
    v_accvgpr_read_b32 v193, a237
    v_accvgpr_read_b32 v186, a110
    v_accvgpr_read_b32 v194, a238
    v_accvgpr_read_b32 v187, a111
    v_accvgpr_read_b32 v195, a239
    v_max_f32 v180, 0, v180
    v_max_f32 v181, 0, v181
    v_max_f32 v182, 0, v182
    v_max_f32 v183, 0, v183
    v_max_f32 v184, 0, v184
    v_max_f32 v185, 0, v185
    v_max_f32 v186, 0, v186
    v_max_f32 v187, 0, v187
    v_pk_mul_f32 v[180:181], v[180:181], v[188:189]
    v_pk_mul_f32 v[182:183], v[182:183], v[190:191]
    v_pk_mul_f32 v[184:185], v[184:185], v[192:193]
    v_pk_mul_f32 v[186:187], v[186:187], v[194:195]
    v_cvt_pk_bf16_f32 v196, v180, v181
    v_cvt_pk_bf16_f32 v197, v182, v183
    v_cvt_pk_bf16_f32 v198, v184, v185
    v_cvt_pk_bf16_f32 v199, v186, v187
    buffer_store_dwordx4 v[196:199], v30, s[8:11], s6 offen offset:768 sc1
    v_accvgpr_read_b32 v160, a80
    v_accvgpr_read_b32 v168, a208
    v_accvgpr_read_b32 v161, a81
    v_accvgpr_read_b32 v169, a209
    v_accvgpr_read_b32 v162, a82
    v_accvgpr_read_b32 v170, a210
    v_accvgpr_read_b32 v163, a83
    v_accvgpr_read_b32 v171, a211
    v_accvgpr_read_b32 v164, a112
    v_accvgpr_read_b32 v172, a240
    v_accvgpr_read_b32 v165, a113
    v_accvgpr_read_b32 v173, a241
    v_accvgpr_read_b32 v166, a114
    v_accvgpr_read_b32 v174, a242
    v_accvgpr_read_b32 v167, a115
    v_accvgpr_read_b32 v175, a243
    v_max_f32 v160, 0, v160
    v_max_f32 v161, 0, v161
    v_max_f32 v162, 0, v162
    v_max_f32 v163, 0, v163
    v_max_f32 v164, 0, v164
    v_max_f32 v165, 0, v165
    v_max_f32 v166, 0, v166
    v_max_f32 v167, 0, v167
    v_pk_mul_f32 v[160:161], v[160:161], v[168:169]
    v_pk_mul_f32 v[162:163], v[162:163], v[170:171]
    v_pk_mul_f32 v[164:165], v[164:165], v[172:173]
    v_pk_mul_f32 v[166:167], v[166:167], v[174:175]
    v_cvt_pk_bf16_f32 v176, v160, v161
    v_cvt_pk_bf16_f32 v177, v162, v163
    v_cvt_pk_bf16_f32 v178, v164, v165
    v_cvt_pk_bf16_f32 v179, v166, v167
    buffer_store_dwordx4 v[176:179], v30, s[8:11], s6 offen offset:1024 sc1
    v_accvgpr_read_b32 v180, a84
    v_accvgpr_read_b32 v188, a212
    v_accvgpr_read_b32 v181, a85
    v_accvgpr_read_b32 v189, a213
    v_accvgpr_read_b32 v182, a86
    v_accvgpr_read_b32 v190, a214
    v_accvgpr_read_b32 v183, a87
    v_accvgpr_read_b32 v191, a215
    v_accvgpr_read_b32 v184, a116
    v_accvgpr_read_b32 v192, a244
    v_accvgpr_read_b32 v185, a117
    v_accvgpr_read_b32 v193, a245
    v_accvgpr_read_b32 v186, a118
    v_accvgpr_read_b32 v194, a246
    v_accvgpr_read_b32 v187, a119
    v_accvgpr_read_b32 v195, a247
    v_max_f32 v180, 0, v180
    v_max_f32 v181, 0, v181
    v_max_f32 v182, 0, v182
    v_max_f32 v183, 0, v183
    v_max_f32 v184, 0, v184
    v_max_f32 v185, 0, v185
    v_max_f32 v186, 0, v186
    v_max_f32 v187, 0, v187
    v_pk_mul_f32 v[180:181], v[180:181], v[188:189]
    v_pk_mul_f32 v[182:183], v[182:183], v[190:191]
    v_pk_mul_f32 v[184:185], v[184:185], v[192:193]
    v_pk_mul_f32 v[186:187], v[186:187], v[194:195]
    v_cvt_pk_bf16_f32 v196, v180, v181
    v_cvt_pk_bf16_f32 v197, v182, v183
    v_cvt_pk_bf16_f32 v198, v184, v185
    v_cvt_pk_bf16_f32 v199, v186, v187
    buffer_store_dwordx4 v[196:199], v30, s[8:11], s6 offen offset:1280 sc1
    v_accvgpr_read_b32 v160, a88
    v_accvgpr_read_b32 v168, a216
    v_accvgpr_read_b32 v161, a89
    v_accvgpr_read_b32 v169, a217
    v_accvgpr_read_b32 v162, a90
    v_accvgpr_read_b32 v170, a218
    v_accvgpr_read_b32 v163, a91
    v_accvgpr_read_b32 v171, a219
    v_accvgpr_read_b32 v164, a120
    v_accvgpr_read_b32 v172, a248
    v_accvgpr_read_b32 v165, a121
    v_accvgpr_read_b32 v173, a249
    v_accvgpr_read_b32 v166, a122
    v_accvgpr_read_b32 v174, a250
    v_accvgpr_read_b32 v167, a123
    v_accvgpr_read_b32 v175, a251
    v_max_f32 v160, 0, v160
    v_max_f32 v161, 0, v161
    v_max_f32 v162, 0, v162
    v_max_f32 v163, 0, v163
    v_max_f32 v164, 0, v164
    v_max_f32 v165, 0, v165
    v_max_f32 v166, 0, v166
    v_max_f32 v167, 0, v167
    v_pk_mul_f32 v[160:161], v[160:161], v[168:169]
    v_pk_mul_f32 v[162:163], v[162:163], v[170:171]
    v_pk_mul_f32 v[164:165], v[164:165], v[172:173]
    v_pk_mul_f32 v[166:167], v[166:167], v[174:175]
    v_cvt_pk_bf16_f32 v176, v160, v161
    v_cvt_pk_bf16_f32 v177, v162, v163
    v_cvt_pk_bf16_f32 v178, v164, v165
    v_cvt_pk_bf16_f32 v179, v166, v167
    buffer_store_dwordx4 v[176:179], v30, s[8:11], s6 offen offset:1536 sc1
    v_accvgpr_read_b32 v180, a92
    v_accvgpr_read_b32 v188, a220
    v_accvgpr_read_b32 v181, a93
    v_accvgpr_read_b32 v189, a221
    v_accvgpr_read_b32 v182, a94
    v_accvgpr_read_b32 v190, a222
    v_accvgpr_read_b32 v183, a95
    v_accvgpr_read_b32 v191, a223
    v_accvgpr_read_b32 v184, a124
    v_accvgpr_read_b32 v192, a252
    v_accvgpr_read_b32 v185, a125
    v_accvgpr_read_b32 v193, a253
    v_accvgpr_read_b32 v186, a126
    v_accvgpr_read_b32 v194, a254
    v_accvgpr_read_b32 v187, a127
    v_accvgpr_read_b32 v195, a255
    v_max_f32 v180, 0, v180
    v_max_f32 v181, 0, v181
    v_max_f32 v182, 0, v182
    v_max_f32 v183, 0, v183
    v_max_f32 v184, 0, v184
    v_max_f32 v185, 0, v185
    v_max_f32 v186, 0, v186
    v_max_f32 v187, 0, v187
    v_pk_mul_f32 v[180:181], v[180:181], v[188:189]
    v_pk_mul_f32 v[182:183], v[182:183], v[190:191]
    v_pk_mul_f32 v[184:185], v[184:185], v[192:193]
    v_pk_mul_f32 v[186:187], v[186:187], v[194:195]
    v_cvt_pk_bf16_f32 v196, v180, v181
    v_cvt_pk_bf16_f32 v197, v182, v183
    v_cvt_pk_bf16_f32 v198, v184, v185
    v_cvt_pk_bf16_f32 v199, v186, v187
    buffer_store_dwordx4 v[196:199], v30, s[8:11], s6 offen offset:1792 sc1
    buffer_store_dword v24, v26, s[8:11], 0 offen
    buffer_store_dword v24, v26, s[8:11], 0 offen
    buffer_store_dword v24, v26, s[8:11], 0 offen
    buffer_store_dword v24, v26, s[8:11], 0 offen
    buffer_store_dword v24, v26, s[8:11], 0 offen
    buffer_store_dword v24, v26, s[8:11], 0 offen
    buffer_store_dword v24, v26, s[8:11], 0 offen
    buffer_store_dword v24, v26, s[8:11], 0 offen
    buffer_store_dword v24, v26, s[8:11], 0 offen
    buffer_store_dword v24, v26, s[8:11], 0 offen
    buffer_store_dword v24, v26, s[8:11], 0 offen
    buffer_store_dword v24, v26, s[8:11], 0 offen
    buffer_store_dword v24, v26, s[8:11], 0 offen
    buffer_store_dword v24, v26, s[8:11], 0 offen
    buffer_store_dword v24, v26, s[8:11], 0 offen
    buffer_store_dword v24, v26, s[8:11], 0 offen
    s_branch L_e1done
L_epDN:
    s_and_b32 s5, s3, 1
    s_lshl_b32 s5, s5, 15
    s_add_u32 s7, s29, s5
    s_mov_b32 s4, 0xbfb8aa3b
    s_nop 4
    s_add_u32 s6, s7, 0
    v_accvgpr_read_b32 v160, a0
    v_accvgpr_read_b32 v161, a1
    v_accvgpr_read_b32 v162, a2
    v_accvgpr_read_b32 v163, a3
    v_accvgpr_read_b32 v164, a32
    v_accvgpr_read_b32 v165, a33
    v_accvgpr_read_b32 v166, a34
    v_accvgpr_read_b32 v167, a35
    v_mul_f32 v168, s4, v160
    v_mul_f32 v169, s4, v161
    v_mul_f32 v170, s4, v162
    v_mul_f32 v171, s4, v163
    v_mul_f32 v172, s4, v164
    v_mul_f32 v173, s4, v165
    v_mul_f32 v174, s4, v166
    v_mul_f32 v175, s4, v167
    v_exp_f32 v168, v168
    v_exp_f32 v169, v169
    v_exp_f32 v170, v170
    v_exp_f32 v171, v171
    v_exp_f32 v172, v172
    v_exp_f32 v173, v173
    v_exp_f32 v174, v174
    v_exp_f32 v175, v175
    v_add_f32 v168, 1.0, v168
    v_add_f32 v169, 1.0, v169
    v_add_f32 v170, 1.0, v170
    v_add_f32 v171, 1.0, v171
    v_add_f32 v172, 1.0, v172
    v_add_f32 v173, 1.0, v173
    v_add_f32 v174, 1.0, v174
    v_add_f32 v175, 1.0, v175
    v_rcp_f32 v168, v168
    v_rcp_f32 v169, v169
    v_rcp_f32 v170, v170
    v_rcp_f32 v171, v171
    v_rcp_f32 v172, v172
    v_rcp_f32 v173, v173
    v_rcp_f32 v174, v174
    v_rcp_f32 v175, v175
    v_mul_f32 v160, v160, v168
    v_mul_f32 v161, v161, v169
    v_mul_f32 v162, v162, v170
    v_mul_f32 v163, v163, v171
    v_mul_f32 v164, v164, v172
    v_mul_f32 v165, v165, v173
    v_mul_f32 v166, v166, v174
    v_mul_f32 v167, v167, v175
    v_cvt_pk_bf16_f32 v176, v160, v161
    v_cvt_pk_bf16_f32 v177, v162, v163
    v_cvt_pk_bf16_f32 v178, v164, v165
    v_cvt_pk_bf16_f32 v179, v166, v167
    buffer_store_dwordx4 v[176:179], v30, s[8:11], s6 offen offset:0 sc1
    v_accvgpr_read_b32 v180, a4
    v_accvgpr_read_b32 v181, a5
    v_accvgpr_read_b32 v182, a6
    v_accvgpr_read_b32 v183, a7
    v_accvgpr_read_b32 v184, a36
    v_accvgpr_read_b32 v185, a37
    v_accvgpr_read_b32 v186, a38
    v_accvgpr_read_b32 v187, a39
    v_mul_f32 v188, s4, v180
    v_mul_f32 v189, s4, v181
    v_mul_f32 v190, s4, v182
    v_mul_f32 v191, s4, v183
    v_mul_f32 v192, s4, v184
    v_mul_f32 v193, s4, v185
    v_mul_f32 v194, s4, v186
    v_mul_f32 v195, s4, v187
    v_exp_f32 v188, v188
    v_exp_f32 v189, v189
    v_exp_f32 v190, v190
    v_exp_f32 v191, v191
    v_exp_f32 v192, v192
    v_exp_f32 v193, v193
    v_exp_f32 v194, v194
    v_exp_f32 v195, v195
    v_add_f32 v188, 1.0, v188
    v_add_f32 v189, 1.0, v189
    v_add_f32 v190, 1.0, v190
    v_add_f32 v191, 1.0, v191
    v_add_f32 v192, 1.0, v192
    v_add_f32 v193, 1.0, v193
    v_add_f32 v194, 1.0, v194
    v_add_f32 v195, 1.0, v195
    v_rcp_f32 v188, v188
    v_rcp_f32 v189, v189
    v_rcp_f32 v190, v190
    v_rcp_f32 v191, v191
    v_rcp_f32 v192, v192
    v_rcp_f32 v193, v193
    v_rcp_f32 v194, v194
    v_rcp_f32 v195, v195
    v_mul_f32 v180, v180, v188
    v_mul_f32 v181, v181, v189
    v_mul_f32 v182, v182, v190
    v_mul_f32 v183, v183, v191
    v_mul_f32 v184, v184, v192
    v_mul_f32 v185, v185, v193
    v_mul_f32 v186, v186, v194
    v_mul_f32 v187, v187, v195
    v_cvt_pk_bf16_f32 v196, v180, v181
    v_cvt_pk_bf16_f32 v197, v182, v183
    v_cvt_pk_bf16_f32 v198, v184, v185
    v_cvt_pk_bf16_f32 v199, v186, v187
    buffer_store_dwordx4 v[196:199], v30, s[8:11], s6 offen offset:256 sc1
    v_accvgpr_read_b32 v160, a8
    v_accvgpr_read_b32 v161, a9
    v_accvgpr_read_b32 v162, a10
    v_accvgpr_read_b32 v163, a11
    v_accvgpr_read_b32 v164, a40
    v_accvgpr_read_b32 v165, a41
    v_accvgpr_read_b32 v166, a42
    v_accvgpr_read_b32 v167, a43
    v_mul_f32 v168, s4, v160
    v_mul_f32 v169, s4, v161
    v_mul_f32 v170, s4, v162
    v_mul_f32 v171, s4, v163
    v_mul_f32 v172, s4, v164
    v_mul_f32 v173, s4, v165
    v_mul_f32 v174, s4, v166
    v_mul_f32 v175, s4, v167
    v_exp_f32 v168, v168
    v_exp_f32 v169, v169
    v_exp_f32 v170, v170
    v_exp_f32 v171, v171
    v_exp_f32 v172, v172
    v_exp_f32 v173, v173
    v_exp_f32 v174, v174
    v_exp_f32 v175, v175
    v_add_f32 v168, 1.0, v168
    v_add_f32 v169, 1.0, v169
    v_add_f32 v170, 1.0, v170
    v_add_f32 v171, 1.0, v171
    v_add_f32 v172, 1.0, v172
    v_add_f32 v173, 1.0, v173
    v_add_f32 v174, 1.0, v174
    v_add_f32 v175, 1.0, v175
    v_rcp_f32 v168, v168
    v_rcp_f32 v169, v169
    v_rcp_f32 v170, v170
    v_rcp_f32 v171, v171
    v_rcp_f32 v172, v172
    v_rcp_f32 v173, v173
    v_rcp_f32 v174, v174
    v_rcp_f32 v175, v175
    v_mul_f32 v160, v160, v168
    v_mul_f32 v161, v161, v169
    v_mul_f32 v162, v162, v170
    v_mul_f32 v163, v163, v171
    v_mul_f32 v164, v164, v172
    v_mul_f32 v165, v165, v173
    v_mul_f32 v166, v166, v174
    v_mul_f32 v167, v167, v175
    v_cvt_pk_bf16_f32 v176, v160, v161
    v_cvt_pk_bf16_f32 v177, v162, v163
    v_cvt_pk_bf16_f32 v178, v164, v165
    v_cvt_pk_bf16_f32 v179, v166, v167
    buffer_store_dwordx4 v[176:179], v30, s[8:11], s6 offen offset:512 sc1
    v_accvgpr_read_b32 v180, a12
    v_accvgpr_read_b32 v181, a13
    v_accvgpr_read_b32 v182, a14
    v_accvgpr_read_b32 v183, a15
    v_accvgpr_read_b32 v184, a44
    v_accvgpr_read_b32 v185, a45
    v_accvgpr_read_b32 v186, a46
    v_accvgpr_read_b32 v187, a47
    v_mul_f32 v188, s4, v180
    v_mul_f32 v189, s4, v181
    v_mul_f32 v190, s4, v182
    v_mul_f32 v191, s4, v183
    v_mul_f32 v192, s4, v184
    v_mul_f32 v193, s4, v185
    v_mul_f32 v194, s4, v186
    v_mul_f32 v195, s4, v187
    v_exp_f32 v188, v188
    v_exp_f32 v189, v189
    v_exp_f32 v190, v190
    v_exp_f32 v191, v191
    v_exp_f32 v192, v192
    v_exp_f32 v193, v193
    v_exp_f32 v194, v194
    v_exp_f32 v195, v195
    v_add_f32 v188, 1.0, v188
    v_add_f32 v189, 1.0, v189
    v_add_f32 v190, 1.0, v190
    v_add_f32 v191, 1.0, v191
    v_add_f32 v192, 1.0, v192
    v_add_f32 v193, 1.0, v193
    v_add_f32 v194, 1.0, v194
    v_add_f32 v195, 1.0, v195
    v_rcp_f32 v188, v188
    v_rcp_f32 v189, v189
    v_rcp_f32 v190, v190
    v_rcp_f32 v191, v191
    v_rcp_f32 v192, v192
    v_rcp_f32 v193, v193
    v_rcp_f32 v194, v194
    v_rcp_f32 v195, v195
    v_mul_f32 v180, v180, v188
    v_mul_f32 v181, v181, v189
    v_mul_f32 v182, v182, v190
    v_mul_f32 v183, v183, v191
    v_mul_f32 v184, v184, v192
    v_mul_f32 v185, v185, v193
    v_mul_f32 v186, v186, v194
    v_mul_f32 v187, v187, v195
    v_cvt_pk_bf16_f32 v196, v180, v181
    v_cvt_pk_bf16_f32 v197, v182, v183
    v_cvt_pk_bf16_f32 v198, v184, v185
    v_cvt_pk_bf16_f32 v199, v186, v187
    buffer_store_dwordx4 v[196:199], v30, s[8:11], s6 offen offset:768 sc1
    v_accvgpr_read_b32 v160, a16
    v_accvgpr_read_b32 v161, a17
    v_accvgpr_read_b32 v162, a18
    v_accvgpr_read_b32 v163, a19
    v_accvgpr_read_b32 v164, a48
    v_accvgpr_read_b32 v165, a49
    v_accvgpr_read_b32 v166, a50
    v_accvgpr_read_b32 v167, a51
    v_mul_f32 v168, s4, v160
    v_mul_f32 v169, s4, v161
    v_mul_f32 v170, s4, v162
    v_mul_f32 v171, s4, v163
    v_mul_f32 v172, s4, v164
    v_mul_f32 v173, s4, v165
    v_mul_f32 v174, s4, v166
    v_mul_f32 v175, s4, v167
    v_exp_f32 v168, v168
    v_exp_f32 v169, v169
    v_exp_f32 v170, v170
    v_exp_f32 v171, v171
    v_exp_f32 v172, v172
    v_exp_f32 v173, v173
    v_exp_f32 v174, v174
    v_exp_f32 v175, v175
    v_add_f32 v168, 1.0, v168
    v_add_f32 v169, 1.0, v169
    v_add_f32 v170, 1.0, v170
    v_add_f32 v171, 1.0, v171
    v_add_f32 v172, 1.0, v172
    v_add_f32 v173, 1.0, v173
    v_add_f32 v174, 1.0, v174
    v_add_f32 v175, 1.0, v175
    v_rcp_f32 v168, v168
    v_rcp_f32 v169, v169
    v_rcp_f32 v170, v170
    v_rcp_f32 v171, v171
    v_rcp_f32 v172, v172
    v_rcp_f32 v173, v173
    v_rcp_f32 v174, v174
    v_rcp_f32 v175, v175
    v_mul_f32 v160, v160, v168
    v_mul_f32 v161, v161, v169
    v_mul_f32 v162, v162, v170
    v_mul_f32 v163, v163, v171
    v_mul_f32 v164, v164, v172
    v_mul_f32 v165, v165, v173
    v_mul_f32 v166, v166, v174
    v_mul_f32 v167, v167, v175
    v_cvt_pk_bf16_f32 v176, v160, v161
    v_cvt_pk_bf16_f32 v177, v162, v163
    v_cvt_pk_bf16_f32 v178, v164, v165
    v_cvt_pk_bf16_f32 v179, v166, v167
    buffer_store_dwordx4 v[176:179], v30, s[8:11], s6 offen offset:1024 sc1
    v_accvgpr_read_b32 v180, a20
    v_accvgpr_read_b32 v181, a21
    v_accvgpr_read_b32 v182, a22
    v_accvgpr_read_b32 v183, a23
    v_accvgpr_read_b32 v184, a52
    v_accvgpr_read_b32 v185, a53
    v_accvgpr_read_b32 v186, a54
    v_accvgpr_read_b32 v187, a55
    v_mul_f32 v188, s4, v180
    v_mul_f32 v189, s4, v181
    v_mul_f32 v190, s4, v182
    v_mul_f32 v191, s4, v183
    v_mul_f32 v192, s4, v184
    v_mul_f32 v193, s4, v185
    v_mul_f32 v194, s4, v186
    v_mul_f32 v195, s4, v187
    v_exp_f32 v188, v188
    v_exp_f32 v189, v189
    v_exp_f32 v190, v190
    v_exp_f32 v191, v191
    v_exp_f32 v192, v192
    v_exp_f32 v193, v193
    v_exp_f32 v194, v194
    v_exp_f32 v195, v195
    v_add_f32 v188, 1.0, v188
    v_add_f32 v189, 1.0, v189
    v_add_f32 v190, 1.0, v190
    v_add_f32 v191, 1.0, v191
    v_add_f32 v192, 1.0, v192
    v_add_f32 v193, 1.0, v193
    v_add_f32 v194, 1.0, v194
    v_add_f32 v195, 1.0, v195
    v_rcp_f32 v188, v188
    v_rcp_f32 v189, v189
    v_rcp_f32 v190, v190
    v_rcp_f32 v191, v191
    v_rcp_f32 v192, v192
    v_rcp_f32 v193, v193
    v_rcp_f32 v194, v194
    v_rcp_f32 v195, v195
    v_mul_f32 v180, v180, v188
    v_mul_f32 v181, v181, v189
    v_mul_f32 v182, v182, v190
    v_mul_f32 v183, v183, v191
    v_mul_f32 v184, v184, v192
    v_mul_f32 v185, v185, v193
    v_mul_f32 v186, v186, v194
    v_mul_f32 v187, v187, v195
    v_cvt_pk_bf16_f32 v196, v180, v181
    v_cvt_pk_bf16_f32 v197, v182, v183
    v_cvt_pk_bf16_f32 v198, v184, v185
    v_cvt_pk_bf16_f32 v199, v186, v187
    buffer_store_dwordx4 v[196:199], v30, s[8:11], s6 offen offset:1280 sc1
    v_accvgpr_read_b32 v160, a24
    v_accvgpr_read_b32 v161, a25
    v_accvgpr_read_b32 v162, a26
    v_accvgpr_read_b32 v163, a27
    v_accvgpr_read_b32 v164, a56
    v_accvgpr_read_b32 v165, a57
    v_accvgpr_read_b32 v166, a58
    v_accvgpr_read_b32 v167, a59
    v_mul_f32 v168, s4, v160
    v_mul_f32 v169, s4, v161
    v_mul_f32 v170, s4, v162
    v_mul_f32 v171, s4, v163
    v_mul_f32 v172, s4, v164
    v_mul_f32 v173, s4, v165
    v_mul_f32 v174, s4, v166
    v_mul_f32 v175, s4, v167
    v_exp_f32 v168, v168
    v_exp_f32 v169, v169
    v_exp_f32 v170, v170
    v_exp_f32 v171, v171
    v_exp_f32 v172, v172
    v_exp_f32 v173, v173
    v_exp_f32 v174, v174
    v_exp_f32 v175, v175
    v_add_f32 v168, 1.0, v168
    v_add_f32 v169, 1.0, v169
    v_add_f32 v170, 1.0, v170
    v_add_f32 v171, 1.0, v171
    v_add_f32 v172, 1.0, v172
    v_add_f32 v173, 1.0, v173
    v_add_f32 v174, 1.0, v174
    v_add_f32 v175, 1.0, v175
    v_rcp_f32 v168, v168
    v_rcp_f32 v169, v169
    v_rcp_f32 v170, v170
    v_rcp_f32 v171, v171
    v_rcp_f32 v172, v172
    v_rcp_f32 v173, v173
    v_rcp_f32 v174, v174
    v_rcp_f32 v175, v175
    v_mul_f32 v160, v160, v168
    v_mul_f32 v161, v161, v169
    v_mul_f32 v162, v162, v170
    v_mul_f32 v163, v163, v171
    v_mul_f32 v164, v164, v172
    v_mul_f32 v165, v165, v173
    v_mul_f32 v166, v166, v174
    v_mul_f32 v167, v167, v175
    v_cvt_pk_bf16_f32 v176, v160, v161
    v_cvt_pk_bf16_f32 v177, v162, v163
    v_cvt_pk_bf16_f32 v178, v164, v165
    v_cvt_pk_bf16_f32 v179, v166, v167
    buffer_store_dwordx4 v[176:179], v30, s[8:11], s6 offen offset:1536 sc1
    v_accvgpr_read_b32 v180, a28
    v_accvgpr_read_b32 v181, a29
    v_accvgpr_read_b32 v182, a30
    v_accvgpr_read_b32 v183, a31
    v_accvgpr_read_b32 v184, a60
    v_accvgpr_read_b32 v185, a61
    v_accvgpr_read_b32 v186, a62
    v_accvgpr_read_b32 v187, a63
    v_mul_f32 v188, s4, v180
    v_mul_f32 v189, s4, v181
    v_mul_f32 v190, s4, v182
    v_mul_f32 v191, s4, v183
    v_mul_f32 v192, s4, v184
    v_mul_f32 v193, s4, v185
    v_mul_f32 v194, s4, v186
    v_mul_f32 v195, s4, v187
    v_exp_f32 v188, v188
    v_exp_f32 v189, v189
    v_exp_f32 v190, v190
    v_exp_f32 v191, v191
    v_exp_f32 v192, v192
    v_exp_f32 v193, v193
    v_exp_f32 v194, v194
    v_exp_f32 v195, v195
    v_add_f32 v188, 1.0, v188
    v_add_f32 v189, 1.0, v189
    v_add_f32 v190, 1.0, v190
    v_add_f32 v191, 1.0, v191
    v_add_f32 v192, 1.0, v192
    v_add_f32 v193, 1.0, v193
    v_add_f32 v194, 1.0, v194
    v_add_f32 v195, 1.0, v195
    v_rcp_f32 v188, v188
    v_rcp_f32 v189, v189
    v_rcp_f32 v190, v190
    v_rcp_f32 v191, v191
    v_rcp_f32 v192, v192
    v_rcp_f32 v193, v193
    v_rcp_f32 v194, v194
    v_rcp_f32 v195, v195
    v_mul_f32 v180, v180, v188
    v_mul_f32 v181, v181, v189
    v_mul_f32 v182, v182, v190
    v_mul_f32 v183, v183, v191
    v_mul_f32 v184, v184, v192
    v_mul_f32 v185, v185, v193
    v_mul_f32 v186, v186, v194
    v_mul_f32 v187, v187, v195
    v_cvt_pk_bf16_f32 v196, v180, v181
    v_cvt_pk_bf16_f32 v197, v182, v183
    v_cvt_pk_bf16_f32 v198, v184, v185
    v_cvt_pk_bf16_f32 v199, v186, v187
    buffer_store_dwordx4 v[196:199], v30, s[8:11], s6 offen offset:1792 sc1
    s_add_u32 s6, s7, 16384
    v_accvgpr_read_b32 v160, a64
    v_accvgpr_read_b32 v161, a65
    v_accvgpr_read_b32 v162, a66
    v_accvgpr_read_b32 v163, a67
    v_accvgpr_read_b32 v164, a96
    v_accvgpr_read_b32 v165, a97
    v_accvgpr_read_b32 v166, a98
    v_accvgpr_read_b32 v167, a99
    v_mul_f32 v168, s4, v160
    v_mul_f32 v169, s4, v161
    v_mul_f32 v170, s4, v162
    v_mul_f32 v171, s4, v163
    v_mul_f32 v172, s4, v164
    v_mul_f32 v173, s4, v165
    v_mul_f32 v174, s4, v166
    v_mul_f32 v175, s4, v167
    v_exp_f32 v168, v168
    v_exp_f32 v169, v169
    v_exp_f32 v170, v170
    v_exp_f32 v171, v171
    v_exp_f32 v172, v172
    v_exp_f32 v173, v173
    v_exp_f32 v174, v174
    v_exp_f32 v175, v175
    v_add_f32 v168, 1.0, v168
    v_add_f32 v169, 1.0, v169
    v_add_f32 v170, 1.0, v170
    v_add_f32 v171, 1.0, v171
    v_add_f32 v172, 1.0, v172
    v_add_f32 v173, 1.0, v173
    v_add_f32 v174, 1.0, v174
    v_add_f32 v175, 1.0, v175
    v_rcp_f32 v168, v168
    v_rcp_f32 v169, v169
    v_rcp_f32 v170, v170
    v_rcp_f32 v171, v171
    v_rcp_f32 v172, v172
    v_rcp_f32 v173, v173
    v_rcp_f32 v174, v174
    v_rcp_f32 v175, v175
    v_mul_f32 v160, v160, v168
    v_mul_f32 v161, v161, v169
    v_mul_f32 v162, v162, v170
    v_mul_f32 v163, v163, v171
    v_mul_f32 v164, v164, v172
    v_mul_f32 v165, v165, v173
    v_mul_f32 v166, v166, v174
    v_mul_f32 v167, v167, v175
    v_cvt_pk_bf16_f32 v176, v160, v161
    v_cvt_pk_bf16_f32 v177, v162, v163
    v_cvt_pk_bf16_f32 v178, v164, v165
    v_cvt_pk_bf16_f32 v179, v166, v167
    buffer_store_dwordx4 v[176:179], v30, s[8:11], s6 offen offset:0 sc1
    v_accvgpr_read_b32 v180, a68
    v_accvgpr_read_b32 v181, a69
    v_accvgpr_read_b32 v182, a70
    v_accvgpr_read_b32 v183, a71
    v_accvgpr_read_b32 v184, a100
    v_accvgpr_read_b32 v185, a101
    v_accvgpr_read_b32 v186, a102
    v_accvgpr_read_b32 v187, a103
    v_mul_f32 v188, s4, v180
    v_mul_f32 v189, s4, v181
    v_mul_f32 v190, s4, v182
    v_mul_f32 v191, s4, v183
    v_mul_f32 v192, s4, v184
    v_mul_f32 v193, s4, v185
    v_mul_f32 v194, s4, v186
    v_mul_f32 v195, s4, v187
    v_exp_f32 v188, v188
    v_exp_f32 v189, v189
    v_exp_f32 v190, v190
    v_exp_f32 v191, v191
    v_exp_f32 v192, v192
    v_exp_f32 v193, v193
    v_exp_f32 v194, v194
    v_exp_f32 v195, v195
    v_add_f32 v188, 1.0, v188
    v_add_f32 v189, 1.0, v189
    v_add_f32 v190, 1.0, v190
    v_add_f32 v191, 1.0, v191
    v_add_f32 v192, 1.0, v192
    v_add_f32 v193, 1.0, v193
    v_add_f32 v194, 1.0, v194
    v_add_f32 v195, 1.0, v195
    v_rcp_f32 v188, v188
    v_rcp_f32 v189, v189
    v_rcp_f32 v190, v190
    v_rcp_f32 v191, v191
    v_rcp_f32 v192, v192
    v_rcp_f32 v193, v193
    v_rcp_f32 v194, v194
    v_rcp_f32 v195, v195
    v_mul_f32 v180, v180, v188
    v_mul_f32 v181, v181, v189
    v_mul_f32 v182, v182, v190
    v_mul_f32 v183, v183, v191
    v_mul_f32 v184, v184, v192
    v_mul_f32 v185, v185, v193
    v_mul_f32 v186, v186, v194
    v_mul_f32 v187, v187, v195
    v_cvt_pk_bf16_f32 v196, v180, v181
    v_cvt_pk_bf16_f32 v197, v182, v183
    v_cvt_pk_bf16_f32 v198, v184, v185
    v_cvt_pk_bf16_f32 v199, v186, v187
    buffer_store_dwordx4 v[196:199], v30, s[8:11], s6 offen offset:256 sc1
    v_accvgpr_read_b32 v160, a72
    v_accvgpr_read_b32 v161, a73
    v_accvgpr_read_b32 v162, a74
    v_accvgpr_read_b32 v163, a75
    v_accvgpr_read_b32 v164, a104
    v_accvgpr_read_b32 v165, a105
    v_accvgpr_read_b32 v166, a106
    v_accvgpr_read_b32 v167, a107
    v_mul_f32 v168, s4, v160
    v_mul_f32 v169, s4, v161
    v_mul_f32 v170, s4, v162
    v_mul_f32 v171, s4, v163
    v_mul_f32 v172, s4, v164
    v_mul_f32 v173, s4, v165
    v_mul_f32 v174, s4, v166
    v_mul_f32 v175, s4, v167
    v_exp_f32 v168, v168
    v_exp_f32 v169, v169
    v_exp_f32 v170, v170
    v_exp_f32 v171, v171
    v_exp_f32 v172, v172
    v_exp_f32 v173, v173
    v_exp_f32 v174, v174
    v_exp_f32 v175, v175
    v_add_f32 v168, 1.0, v168
    v_add_f32 v169, 1.0, v169
    v_add_f32 v170, 1.0, v170
    v_add_f32 v171, 1.0, v171
    v_add_f32 v172, 1.0, v172
    v_add_f32 v173, 1.0, v173
    v_add_f32 v174, 1.0, v174
    v_add_f32 v175, 1.0, v175
    v_rcp_f32 v168, v168
    v_rcp_f32 v169, v169
    v_rcp_f32 v170, v170
    v_rcp_f32 v171, v171
    v_rcp_f32 v172, v172
    v_rcp_f32 v173, v173
    v_rcp_f32 v174, v174
    v_rcp_f32 v175, v175
    v_mul_f32 v160, v160, v168
    v_mul_f32 v161, v161, v169
    v_mul_f32 v162, v162, v170
    v_mul_f32 v163, v163, v171
    v_mul_f32 v164, v164, v172
    v_mul_f32 v165, v165, v173
    v_mul_f32 v166, v166, v174
    v_mul_f32 v167, v167, v175
    v_cvt_pk_bf16_f32 v176, v160, v161
    v_cvt_pk_bf16_f32 v177, v162, v163
    v_cvt_pk_bf16_f32 v178, v164, v165
    v_cvt_pk_bf16_f32 v179, v166, v167
    buffer_store_dwordx4 v[176:179], v30, s[8:11], s6 offen offset:512 sc1
    v_accvgpr_read_b32 v180, a76
    v_accvgpr_read_b32 v181, a77
    v_accvgpr_read_b32 v182, a78
    v_accvgpr_read_b32 v183, a79
    v_accvgpr_read_b32 v184, a108
    v_accvgpr_read_b32 v185, a109
    v_accvgpr_read_b32 v186, a110
    v_accvgpr_read_b32 v187, a111
    v_mul_f32 v188, s4, v180
    v_mul_f32 v189, s4, v181
    v_mul_f32 v190, s4, v182
    v_mul_f32 v191, s4, v183
    v_mul_f32 v192, s4, v184
    v_mul_f32 v193, s4, v185
    v_mul_f32 v194, s4, v186
    v_mul_f32 v195, s4, v187
    v_exp_f32 v188, v188
    v_exp_f32 v189, v189
    v_exp_f32 v190, v190
    v_exp_f32 v191, v191
    v_exp_f32 v192, v192
    v_exp_f32 v193, v193
    v_exp_f32 v194, v194
    v_exp_f32 v195, v195
    v_add_f32 v188, 1.0, v188
    v_add_f32 v189, 1.0, v189
    v_add_f32 v190, 1.0, v190
    v_add_f32 v191, 1.0, v191
    v_add_f32 v192, 1.0, v192
    v_add_f32 v193, 1.0, v193
    v_add_f32 v194, 1.0, v194
    v_add_f32 v195, 1.0, v195
    v_rcp_f32 v188, v188
    v_rcp_f32 v189, v189
    v_rcp_f32 v190, v190
    v_rcp_f32 v191, v191
    v_rcp_f32 v192, v192
    v_rcp_f32 v193, v193
    v_rcp_f32 v194, v194
    v_rcp_f32 v195, v195
    v_mul_f32 v180, v180, v188
    v_mul_f32 v181, v181, v189
    v_mul_f32 v182, v182, v190
    v_mul_f32 v183, v183, v191
    v_mul_f32 v184, v184, v192
    v_mul_f32 v185, v185, v193
    v_mul_f32 v186, v186, v194
    v_mul_f32 v187, v187, v195
    v_cvt_pk_bf16_f32 v196, v180, v181
    v_cvt_pk_bf16_f32 v197, v182, v183
    v_cvt_pk_bf16_f32 v198, v184, v185
    v_cvt_pk_bf16_f32 v199, v186, v187
    buffer_store_dwordx4 v[196:199], v30, s[8:11], s6 offen offset:768 sc1
    v_accvgpr_read_b32 v160, a80
    v_accvgpr_read_b32 v161, a81
    v_accvgpr_read_b32 v162, a82
    v_accvgpr_read_b32 v163, a83
    v_accvgpr_read_b32 v164, a112
    v_accvgpr_read_b32 v165, a113
    v_accvgpr_read_b32 v166, a114
    v_accvgpr_read_b32 v167, a115
    v_mul_f32 v168, s4, v160
    v_mul_f32 v169, s4, v161
    v_mul_f32 v170, s4, v162
    v_mul_f32 v171, s4, v163
    v_mul_f32 v172, s4, v164
    v_mul_f32 v173, s4, v165
    v_mul_f32 v174, s4, v166
    v_mul_f32 v175, s4, v167
    v_exp_f32 v168, v168
    v_exp_f32 v169, v169
    v_exp_f32 v170, v170
    v_exp_f32 v171, v171
    v_exp_f32 v172, v172
    v_exp_f32 v173, v173
    v_exp_f32 v174, v174
    v_exp_f32 v175, v175
    v_add_f32 v168, 1.0, v168
    v_add_f32 v169, 1.0, v169
    v_add_f32 v170, 1.0, v170
    v_add_f32 v171, 1.0, v171
    v_add_f32 v172, 1.0, v172
    v_add_f32 v173, 1.0, v173
    v_add_f32 v174, 1.0, v174
    v_add_f32 v175, 1.0, v175
    v_rcp_f32 v168, v168
    v_rcp_f32 v169, v169
    v_rcp_f32 v170, v170
    v_rcp_f32 v171, v171
    v_rcp_f32 v172, v172
    v_rcp_f32 v173, v173
    v_rcp_f32 v174, v174
    v_rcp_f32 v175, v175
    v_mul_f32 v160, v160, v168
    v_mul_f32 v161, v161, v169
    v_mul_f32 v162, v162, v170
    v_mul_f32 v163, v163, v171
    v_mul_f32 v164, v164, v172
    v_mul_f32 v165, v165, v173
    v_mul_f32 v166, v166, v174
    v_mul_f32 v167, v167, v175
    v_cvt_pk_bf16_f32 v176, v160, v161
    v_cvt_pk_bf16_f32 v177, v162, v163
    v_cvt_pk_bf16_f32 v178, v164, v165
    v_cvt_pk_bf16_f32 v179, v166, v167
    buffer_store_dwordx4 v[176:179], v30, s[8:11], s6 offen offset:1024 sc1
    v_accvgpr_read_b32 v180, a84
    v_accvgpr_read_b32 v181, a85
    v_accvgpr_read_b32 v182, a86
    v_accvgpr_read_b32 v183, a87
    v_accvgpr_read_b32 v184, a116
    v_accvgpr_read_b32 v185, a117
    v_accvgpr_read_b32 v186, a118
    v_accvgpr_read_b32 v187, a119
    v_mul_f32 v188, s4, v180
    v_mul_f32 v189, s4, v181
    v_mul_f32 v190, s4, v182
    v_mul_f32 v191, s4, v183
    v_mul_f32 v192, s4, v184
    v_mul_f32 v193, s4, v185
    v_mul_f32 v194, s4, v186
    v_mul_f32 v195, s4, v187
    v_exp_f32 v188, v188
    v_exp_f32 v189, v189
    v_exp_f32 v190, v190
    v_exp_f32 v191, v191
    v_exp_f32 v192, v192
    v_exp_f32 v193, v193
    v_exp_f32 v194, v194
    v_exp_f32 v195, v195
    v_add_f32 v188, 1.0, v188
    v_add_f32 v189, 1.0, v189
    v_add_f32 v190, 1.0, v190
    v_add_f32 v191, 1.0, v191
    v_add_f32 v192, 1.0, v192
    v_add_f32 v193, 1.0, v193
    v_add_f32 v194, 1.0, v194
    v_add_f32 v195, 1.0, v195
    v_rcp_f32 v188, v188
    v_rcp_f32 v189, v189
    v_rcp_f32 v190, v190
    v_rcp_f32 v191, v191
    v_rcp_f32 v192, v192
    v_rcp_f32 v193, v193
    v_rcp_f32 v194, v194
    v_rcp_f32 v195, v195
    v_mul_f32 v180, v180, v188
    v_mul_f32 v181, v181, v189
    v_mul_f32 v182, v182, v190
    v_mul_f32 v183, v183, v191
    v_mul_f32 v184, v184, v192
    v_mul_f32 v185, v185, v193
    v_mul_f32 v186, v186, v194
    v_mul_f32 v187, v187, v195
    v_cvt_pk_bf16_f32 v196, v180, v181
    v_cvt_pk_bf16_f32 v197, v182, v183
    v_cvt_pk_bf16_f32 v198, v184, v185
    v_cvt_pk_bf16_f32 v199, v186, v187
    buffer_store_dwordx4 v[196:199], v30, s[8:11], s6 offen offset:1280 sc1
    v_accvgpr_read_b32 v160, a88
    v_accvgpr_read_b32 v161, a89
    v_accvgpr_read_b32 v162, a90
    v_accvgpr_read_b32 v163, a91
    v_accvgpr_read_b32 v164, a120
    v_accvgpr_read_b32 v165, a121
    v_accvgpr_read_b32 v166, a122
    v_accvgpr_read_b32 v167, a123
    v_mul_f32 v168, s4, v160
    v_mul_f32 v169, s4, v161
    v_mul_f32 v170, s4, v162
    v_mul_f32 v171, s4, v163
    v_mul_f32 v172, s4, v164
    v_mul_f32 v173, s4, v165
    v_mul_f32 v174, s4, v166
    v_mul_f32 v175, s4, v167
    v_exp_f32 v168, v168
    v_exp_f32 v169, v169
    v_exp_f32 v170, v170
    v_exp_f32 v171, v171
    v_exp_f32 v172, v172
    v_exp_f32 v173, v173
    v_exp_f32 v174, v174
    v_exp_f32 v175, v175
    v_add_f32 v168, 1.0, v168
    v_add_f32 v169, 1.0, v169
    v_add_f32 v170, 1.0, v170
    v_add_f32 v171, 1.0, v171
    v_add_f32 v172, 1.0, v172
    v_add_f32 v173, 1.0, v173
    v_add_f32 v174, 1.0, v174
    v_add_f32 v175, 1.0, v175
    v_rcp_f32 v168, v168
    v_rcp_f32 v169, v169
    v_rcp_f32 v170, v170
    v_rcp_f32 v171, v171
    v_rcp_f32 v172, v172
    v_rcp_f32 v173, v173
    v_rcp_f32 v174, v174
    v_rcp_f32 v175, v175
    v_mul_f32 v160, v160, v168
    v_mul_f32 v161, v161, v169
    v_mul_f32 v162, v162, v170
    v_mul_f32 v163, v163, v171
    v_mul_f32 v164, v164, v172
    v_mul_f32 v165, v165, v173
    v_mul_f32 v166, v166, v174
    v_mul_f32 v167, v167, v175
    v_cvt_pk_bf16_f32 v176, v160, v161
    v_cvt_pk_bf16_f32 v177, v162, v163
    v_cvt_pk_bf16_f32 v178, v164, v165
    v_cvt_pk_bf16_f32 v179, v166, v167
    buffer_store_dwordx4 v[176:179], v30, s[8:11], s6 offen offset:1536 sc1
    v_accvgpr_read_b32 v180, a92
    v_accvgpr_read_b32 v181, a93
    v_accvgpr_read_b32 v182, a94
    v_accvgpr_read_b32 v183, a95
    v_accvgpr_read_b32 v184, a124
    v_accvgpr_read_b32 v185, a125
    v_accvgpr_read_b32 v186, a126
    v_accvgpr_read_b32 v187, a127
    v_mul_f32 v188, s4, v180
    v_mul_f32 v189, s4, v181
    v_mul_f32 v190, s4, v182
    v_mul_f32 v191, s4, v183
    v_mul_f32 v192, s4, v184
    v_mul_f32 v193, s4, v185
    v_mul_f32 v194, s4, v186
    v_mul_f32 v195, s4, v187
    v_exp_f32 v188, v188
    v_exp_f32 v189, v189
    v_exp_f32 v190, v190
    v_exp_f32 v191, v191
    v_exp_f32 v192, v192
    v_exp_f32 v193, v193
    v_exp_f32 v194, v194
    v_exp_f32 v195, v195
    v_add_f32 v188, 1.0, v188
    v_add_f32 v189, 1.0, v189
    v_add_f32 v190, 1.0, v190
    v_add_f32 v191, 1.0, v191
    v_add_f32 v192, 1.0, v192
    v_add_f32 v193, 1.0, v193
    v_add_f32 v194, 1.0, v194
    v_add_f32 v195, 1.0, v195
    v_rcp_f32 v188, v188
    v_rcp_f32 v189, v189
    v_rcp_f32 v190, v190
    v_rcp_f32 v191, v191
    v_rcp_f32 v192, v192
    v_rcp_f32 v193, v193
    v_rcp_f32 v194, v194
    v_rcp_f32 v195, v195
    v_mul_f32 v180, v180, v188
    v_mul_f32 v181, v181, v189
    v_mul_f32 v182, v182, v190
    v_mul_f32 v183, v183, v191
    v_mul_f32 v184, v184, v192
    v_mul_f32 v185, v185, v193
    v_mul_f32 v186, v186, v194
    v_mul_f32 v187, v187, v195
    v_cvt_pk_bf16_f32 v196, v180, v181
    v_cvt_pk_bf16_f32 v197, v182, v183
    v_cvt_pk_bf16_f32 v198, v184, v185
    v_cvt_pk_bf16_f32 v199, v186, v187
    buffer_store_dwordx4 v[196:199], v30, s[8:11], s6 offen offset:1792 sc1
    s_add_u32 s6, s7, 65536
    v_accvgpr_read_b32 v160, a128
    v_accvgpr_read_b32 v161, a129
    v_accvgpr_read_b32 v162, a130
    v_accvgpr_read_b32 v163, a131
    v_accvgpr_read_b32 v164, a160
    v_accvgpr_read_b32 v165, a161
    v_accvgpr_read_b32 v166, a162
    v_accvgpr_read_b32 v167, a163
    v_mul_f32 v168, s4, v160
    v_mul_f32 v169, s4, v161
    v_mul_f32 v170, s4, v162
    v_mul_f32 v171, s4, v163
    v_mul_f32 v172, s4, v164
    v_mul_f32 v173, s4, v165
    v_mul_f32 v174, s4, v166
    v_mul_f32 v175, s4, v167
    v_exp_f32 v168, v168
    v_exp_f32 v169, v169
    v_exp_f32 v170, v170
    v_exp_f32 v171, v171
    v_exp_f32 v172, v172
    v_exp_f32 v173, v173
    v_exp_f32 v174, v174
    v_exp_f32 v175, v175
    v_add_f32 v168, 1.0, v168
    v_add_f32 v169, 1.0, v169
    v_add_f32 v170, 1.0, v170
    v_add_f32 v171, 1.0, v171
    v_add_f32 v172, 1.0, v172
    v_add_f32 v173, 1.0, v173
    v_add_f32 v174, 1.0, v174
    v_add_f32 v175, 1.0, v175
    v_rcp_f32 v168, v168
    v_rcp_f32 v169, v169
    v_rcp_f32 v170, v170
    v_rcp_f32 v171, v171
    v_rcp_f32 v172, v172
    v_rcp_f32 v173, v173
    v_rcp_f32 v174, v174
    v_rcp_f32 v175, v175
    v_mul_f32 v160, v160, v168
    v_mul_f32 v161, v161, v169
    v_mul_f32 v162, v162, v170
    v_mul_f32 v163, v163, v171
    v_mul_f32 v164, v164, v172
    v_mul_f32 v165, v165, v173
    v_mul_f32 v166, v166, v174
    v_mul_f32 v167, v167, v175
    v_cvt_pk_bf16_f32 v176, v160, v161
    v_cvt_pk_bf16_f32 v177, v162, v163
    v_cvt_pk_bf16_f32 v178, v164, v165
    v_cvt_pk_bf16_f32 v179, v166, v167
    buffer_store_dwordx4 v[176:179], v30, s[8:11], s6 offen offset:0 sc1
    v_accvgpr_read_b32 v180, a132
    v_accvgpr_read_b32 v181, a133
    v_accvgpr_read_b32 v182, a134
    v_accvgpr_read_b32 v183, a135
    v_accvgpr_read_b32 v184, a164
    v_accvgpr_read_b32 v185, a165
    v_accvgpr_read_b32 v186, a166
    v_accvgpr_read_b32 v187, a167
    v_mul_f32 v188, s4, v180
    v_mul_f32 v189, s4, v181
    v_mul_f32 v190, s4, v182
    v_mul_f32 v191, s4, v183
    v_mul_f32 v192, s4, v184
    v_mul_f32 v193, s4, v185
    v_mul_f32 v194, s4, v186
    v_mul_f32 v195, s4, v187
    v_exp_f32 v188, v188
    v_exp_f32 v189, v189
    v_exp_f32 v190, v190
    v_exp_f32 v191, v191
    v_exp_f32 v192, v192
    v_exp_f32 v193, v193
    v_exp_f32 v194, v194
    v_exp_f32 v195, v195
    v_add_f32 v188, 1.0, v188
    v_add_f32 v189, 1.0, v189
    v_add_f32 v190, 1.0, v190
    v_add_f32 v191, 1.0, v191
    v_add_f32 v192, 1.0, v192
    v_add_f32 v193, 1.0, v193
    v_add_f32 v194, 1.0, v194
    v_add_f32 v195, 1.0, v195
    v_rcp_f32 v188, v188
    v_rcp_f32 v189, v189
    v_rcp_f32 v190, v190
    v_rcp_f32 v191, v191
    v_rcp_f32 v192, v192
    v_rcp_f32 v193, v193
    v_rcp_f32 v194, v194
    v_rcp_f32 v195, v195
    v_mul_f32 v180, v180, v188
    v_mul_f32 v181, v181, v189
    v_mul_f32 v182, v182, v190
    v_mul_f32 v183, v183, v191
    v_mul_f32 v184, v184, v192
    v_mul_f32 v185, v185, v193
    v_mul_f32 v186, v186, v194
    v_mul_f32 v187, v187, v195
    v_cvt_pk_bf16_f32 v196, v180, v181
    v_cvt_pk_bf16_f32 v197, v182, v183
    v_cvt_pk_bf16_f32 v198, v184, v185
    v_cvt_pk_bf16_f32 v199, v186, v187
    buffer_store_dwordx4 v[196:199], v30, s[8:11], s6 offen offset:256 sc1
    v_accvgpr_read_b32 v160, a136
    v_accvgpr_read_b32 v161, a137
    v_accvgpr_read_b32 v162, a138
    v_accvgpr_read_b32 v163, a139
    v_accvgpr_read_b32 v164, a168
    v_accvgpr_read_b32 v165, a169
    v_accvgpr_read_b32 v166, a170
    v_accvgpr_read_b32 v167, a171
    v_mul_f32 v168, s4, v160
    v_mul_f32 v169, s4, v161
    v_mul_f32 v170, s4, v162
    v_mul_f32 v171, s4, v163
    v_mul_f32 v172, s4, v164
    v_mul_f32 v173, s4, v165
    v_mul_f32 v174, s4, v166
    v_mul_f32 v175, s4, v167
    v_exp_f32 v168, v168
    v_exp_f32 v169, v169
    v_exp_f32 v170, v170
    v_exp_f32 v171, v171
    v_exp_f32 v172, v172
    v_exp_f32 v173, v173
    v_exp_f32 v174, v174
    v_exp_f32 v175, v175
    v_add_f32 v168, 1.0, v168
    v_add_f32 v169, 1.0, v169
    v_add_f32 v170, 1.0, v170
    v_add_f32 v171, 1.0, v171
    v_add_f32 v172, 1.0, v172
    v_add_f32 v173, 1.0, v173
    v_add_f32 v174, 1.0, v174
    v_add_f32 v175, 1.0, v175
    v_rcp_f32 v168, v168
    v_rcp_f32 v169, v169
    v_rcp_f32 v170, v170
    v_rcp_f32 v171, v171
    v_rcp_f32 v172, v172
    v_rcp_f32 v173, v173
    v_rcp_f32 v174, v174
    v_rcp_f32 v175, v175
    v_mul_f32 v160, v160, v168
    v_mul_f32 v161, v161, v169
    v_mul_f32 v162, v162, v170
    v_mul_f32 v163, v163, v171
    v_mul_f32 v164, v164, v172
    v_mul_f32 v165, v165, v173
    v_mul_f32 v166, v166, v174
    v_mul_f32 v167, v167, v175
    v_cvt_pk_bf16_f32 v176, v160, v161
    v_cvt_pk_bf16_f32 v177, v162, v163
    v_cvt_pk_bf16_f32 v178, v164, v165
    v_cvt_pk_bf16_f32 v179, v166, v167
    buffer_store_dwordx4 v[176:179], v30, s[8:11], s6 offen offset:512 sc1
    v_accvgpr_read_b32 v180, a140
    v_accvgpr_read_b32 v181, a141
    v_accvgpr_read_b32 v182, a142
    v_accvgpr_read_b32 v183, a143
    v_accvgpr_read_b32 v184, a172
    v_accvgpr_read_b32 v185, a173
    v_accvgpr_read_b32 v186, a174
    v_accvgpr_read_b32 v187, a175
    v_mul_f32 v188, s4, v180
    v_mul_f32 v189, s4, v181
    v_mul_f32 v190, s4, v182
    v_mul_f32 v191, s4, v183
    v_mul_f32 v192, s4, v184
    v_mul_f32 v193, s4, v185
    v_mul_f32 v194, s4, v186
    v_mul_f32 v195, s4, v187
    v_exp_f32 v188, v188
    v_exp_f32 v189, v189
    v_exp_f32 v190, v190
    v_exp_f32 v191, v191
    v_exp_f32 v192, v192
    v_exp_f32 v193, v193
    v_exp_f32 v194, v194
    v_exp_f32 v195, v195
    v_add_f32 v188, 1.0, v188
    v_add_f32 v189, 1.0, v189
    v_add_f32 v190, 1.0, v190
    v_add_f32 v191, 1.0, v191
    v_add_f32 v192, 1.0, v192
    v_add_f32 v193, 1.0, v193
    v_add_f32 v194, 1.0, v194
    v_add_f32 v195, 1.0, v195
    v_rcp_f32 v188, v188
    v_rcp_f32 v189, v189
    v_rcp_f32 v190, v190
    v_rcp_f32 v191, v191
    v_rcp_f32 v192, v192
    v_rcp_f32 v193, v193
    v_rcp_f32 v194, v194
    v_rcp_f32 v195, v195
    v_mul_f32 v180, v180, v188
    v_mul_f32 v181, v181, v189
    v_mul_f32 v182, v182, v190
    v_mul_f32 v183, v183, v191
    v_mul_f32 v184, v184, v192
    v_mul_f32 v185, v185, v193
    v_mul_f32 v186, v186, v194
    v_mul_f32 v187, v187, v195
    v_cvt_pk_bf16_f32 v196, v180, v181
    v_cvt_pk_bf16_f32 v197, v182, v183
    v_cvt_pk_bf16_f32 v198, v184, v185
    v_cvt_pk_bf16_f32 v199, v186, v187
    buffer_store_dwordx4 v[196:199], v30, s[8:11], s6 offen offset:768 sc1
    v_accvgpr_read_b32 v160, a144
    v_accvgpr_read_b32 v161, a145
    v_accvgpr_read_b32 v162, a146
    v_accvgpr_read_b32 v163, a147
    v_accvgpr_read_b32 v164, a176
    v_accvgpr_read_b32 v165, a177
    v_accvgpr_read_b32 v166, a178
    v_accvgpr_read_b32 v167, a179
    v_mul_f32 v168, s4, v160
    v_mul_f32 v169, s4, v161
    v_mul_f32 v170, s4, v162
    v_mul_f32 v171, s4, v163
    v_mul_f32 v172, s4, v164
    v_mul_f32 v173, s4, v165
    v_mul_f32 v174, s4, v166
    v_mul_f32 v175, s4, v167
    v_exp_f32 v168, v168
    v_exp_f32 v169, v169
    v_exp_f32 v170, v170
    v_exp_f32 v171, v171
    v_exp_f32 v172, v172
    v_exp_f32 v173, v173
    v_exp_f32 v174, v174
    v_exp_f32 v175, v175
    v_add_f32 v168, 1.0, v168
    v_add_f32 v169, 1.0, v169
    v_add_f32 v170, 1.0, v170
    v_add_f32 v171, 1.0, v171
    v_add_f32 v172, 1.0, v172
    v_add_f32 v173, 1.0, v173
    v_add_f32 v174, 1.0, v174
    v_add_f32 v175, 1.0, v175
    v_rcp_f32 v168, v168
    v_rcp_f32 v169, v169
    v_rcp_f32 v170, v170
    v_rcp_f32 v171, v171
    v_rcp_f32 v172, v172
    v_rcp_f32 v173, v173
    v_rcp_f32 v174, v174
    v_rcp_f32 v175, v175
    v_mul_f32 v160, v160, v168
    v_mul_f32 v161, v161, v169
    v_mul_f32 v162, v162, v170
    v_mul_f32 v163, v163, v171
    v_mul_f32 v164, v164, v172
    v_mul_f32 v165, v165, v173
    v_mul_f32 v166, v166, v174
    v_mul_f32 v167, v167, v175
    v_cvt_pk_bf16_f32 v176, v160, v161
    v_cvt_pk_bf16_f32 v177, v162, v163
    v_cvt_pk_bf16_f32 v178, v164, v165
    v_cvt_pk_bf16_f32 v179, v166, v167
    buffer_store_dwordx4 v[176:179], v30, s[8:11], s6 offen offset:1024 sc1
    v_accvgpr_read_b32 v180, a148
    v_accvgpr_read_b32 v181, a149
    v_accvgpr_read_b32 v182, a150
    v_accvgpr_read_b32 v183, a151
    v_accvgpr_read_b32 v184, a180
    v_accvgpr_read_b32 v185, a181
    v_accvgpr_read_b32 v186, a182
    v_accvgpr_read_b32 v187, a183
    v_mul_f32 v188, s4, v180
    v_mul_f32 v189, s4, v181
    v_mul_f32 v190, s4, v182
    v_mul_f32 v191, s4, v183
    v_mul_f32 v192, s4, v184
    v_mul_f32 v193, s4, v185
    v_mul_f32 v194, s4, v186
    v_mul_f32 v195, s4, v187
    v_exp_f32 v188, v188
    v_exp_f32 v189, v189
    v_exp_f32 v190, v190
    v_exp_f32 v191, v191
    v_exp_f32 v192, v192
    v_exp_f32 v193, v193
    v_exp_f32 v194, v194
    v_exp_f32 v195, v195
    v_add_f32 v188, 1.0, v188
    v_add_f32 v189, 1.0, v189
    v_add_f32 v190, 1.0, v190
    v_add_f32 v191, 1.0, v191
    v_add_f32 v192, 1.0, v192
    v_add_f32 v193, 1.0, v193
    v_add_f32 v194, 1.0, v194
    v_add_f32 v195, 1.0, v195
    v_rcp_f32 v188, v188
    v_rcp_f32 v189, v189
    v_rcp_f32 v190, v190
    v_rcp_f32 v191, v191
    v_rcp_f32 v192, v192
    v_rcp_f32 v193, v193
    v_rcp_f32 v194, v194
    v_rcp_f32 v195, v195
    v_mul_f32 v180, v180, v188
    v_mul_f32 v181, v181, v189
    v_mul_f32 v182, v182, v190
    v_mul_f32 v183, v183, v191
    v_mul_f32 v184, v184, v192
    v_mul_f32 v185, v185, v193
    v_mul_f32 v186, v186, v194
    v_mul_f32 v187, v187, v195
    v_cvt_pk_bf16_f32 v196, v180, v181
    v_cvt_pk_bf16_f32 v197, v182, v183
    v_cvt_pk_bf16_f32 v198, v184, v185
    v_cvt_pk_bf16_f32 v199, v186, v187
    buffer_store_dwordx4 v[196:199], v30, s[8:11], s6 offen offset:1280 sc1
    v_accvgpr_read_b32 v160, a152
    v_accvgpr_read_b32 v161, a153
    v_accvgpr_read_b32 v162, a154
    v_accvgpr_read_b32 v163, a155
    v_accvgpr_read_b32 v164, a184
    v_accvgpr_read_b32 v165, a185
    v_accvgpr_read_b32 v166, a186
    v_accvgpr_read_b32 v167, a187
    v_mul_f32 v168, s4, v160
    v_mul_f32 v169, s4, v161
    v_mul_f32 v170, s4, v162
    v_mul_f32 v171, s4, v163
    v_mul_f32 v172, s4, v164
    v_mul_f32 v173, s4, v165
    v_mul_f32 v174, s4, v166
    v_mul_f32 v175, s4, v167
    v_exp_f32 v168, v168
    v_exp_f32 v169, v169
    v_exp_f32 v170, v170
    v_exp_f32 v171, v171
    v_exp_f32 v172, v172
    v_exp_f32 v173, v173
    v_exp_f32 v174, v174
    v_exp_f32 v175, v175
    v_add_f32 v168, 1.0, v168
    v_add_f32 v169, 1.0, v169
    v_add_f32 v170, 1.0, v170
    v_add_f32 v171, 1.0, v171
    v_add_f32 v172, 1.0, v172
    v_add_f32 v173, 1.0, v173
    v_add_f32 v174, 1.0, v174
    v_add_f32 v175, 1.0, v175
    v_rcp_f32 v168, v168
    v_rcp_f32 v169, v169
    v_rcp_f32 v170, v170
    v_rcp_f32 v171, v171
    v_rcp_f32 v172, v172
    v_rcp_f32 v173, v173
    v_rcp_f32 v174, v174
    v_rcp_f32 v175, v175
    v_mul_f32 v160, v160, v168
    v_mul_f32 v161, v161, v169
    v_mul_f32 v162, v162, v170
    v_mul_f32 v163, v163, v171
    v_mul_f32 v164, v164, v172
    v_mul_f32 v165, v165, v173
    v_mul_f32 v166, v166, v174
    v_mul_f32 v167, v167, v175
    v_cvt_pk_bf16_f32 v176, v160, v161
    v_cvt_pk_bf16_f32 v177, v162, v163
    v_cvt_pk_bf16_f32 v178, v164, v165
    v_cvt_pk_bf16_f32 v179, v166, v167
    buffer_store_dwordx4 v[176:179], v30, s[8:11], s6 offen offset:1536 sc1
    v_accvgpr_read_b32 v180, a156
    v_accvgpr_read_b32 v181, a157
    v_accvgpr_read_b32 v182, a158
    v_accvgpr_read_b32 v183, a159
    v_accvgpr_read_b32 v184, a188
    v_accvgpr_read_b32 v185, a189
    v_accvgpr_read_b32 v186, a190
    v_accvgpr_read_b32 v187, a191
    v_mul_f32 v188, s4, v180
    v_mul_f32 v189, s4, v181
    v_mul_f32 v190, s4, v182
    v_mul_f32 v191, s4, v183
    v_mul_f32 v192, s4, v184
    v_mul_f32 v193, s4, v185
    v_mul_f32 v194, s4, v186
    v_mul_f32 v195, s4, v187
    v_exp_f32 v188, v188
    v_exp_f32 v189, v189
    v_exp_f32 v190, v190
    v_exp_f32 v191, v191
    v_exp_f32 v192, v192
    v_exp_f32 v193, v193
    v_exp_f32 v194, v194
    v_exp_f32 v195, v195
    v_add_f32 v188, 1.0, v188
    v_add_f32 v189, 1.0, v189
    v_add_f32 v190, 1.0, v190
    v_add_f32 v191, 1.0, v191
    v_add_f32 v192, 1.0, v192
    v_add_f32 v193, 1.0, v193
    v_add_f32 v194, 1.0, v194
    v_add_f32 v195, 1.0, v195
    v_rcp_f32 v188, v188
    v_rcp_f32 v189, v189
    v_rcp_f32 v190, v190
    v_rcp_f32 v191, v191
    v_rcp_f32 v192, v192
    v_rcp_f32 v193, v193
    v_rcp_f32 v194, v194
    v_rcp_f32 v195, v195
    v_mul_f32 v180, v180, v188
    v_mul_f32 v181, v181, v189
    v_mul_f32 v182, v182, v190
    v_mul_f32 v183, v183, v191
    v_mul_f32 v184, v184, v192
    v_mul_f32 v185, v185, v193
    v_mul_f32 v186, v186, v194
    v_mul_f32 v187, v187, v195
    v_cvt_pk_bf16_f32 v196, v180, v181
    v_cvt_pk_bf16_f32 v197, v182, v183
    v_cvt_pk_bf16_f32 v198, v184, v185
    v_cvt_pk_bf16_f32 v199, v186, v187
    buffer_store_dwordx4 v[196:199], v30, s[8:11], s6 offen offset:1792 sc1
    s_add_u32 s6, s7, 81920
    v_accvgpr_read_b32 v160, a192
    v_accvgpr_read_b32 v161, a193
    v_accvgpr_read_b32 v162, a194
    v_accvgpr_read_b32 v163, a195
    v_accvgpr_read_b32 v164, a224
    v_accvgpr_read_b32 v165, a225
    v_accvgpr_read_b32 v166, a226
    v_accvgpr_read_b32 v167, a227
    v_mul_f32 v168, s4, v160
    v_mul_f32 v169, s4, v161
    v_mul_f32 v170, s4, v162
    v_mul_f32 v171, s4, v163
    v_mul_f32 v172, s4, v164
    v_mul_f32 v173, s4, v165
    v_mul_f32 v174, s4, v166
    v_mul_f32 v175, s4, v167
    v_exp_f32 v168, v168
    v_exp_f32 v169, v169
    v_exp_f32 v170, v170
    v_exp_f32 v171, v171
    v_exp_f32 v172, v172
    v_exp_f32 v173, v173
    v_exp_f32 v174, v174
    v_exp_f32 v175, v175
    v_add_f32 v168, 1.0, v168
    v_add_f32 v169, 1.0, v169
    v_add_f32 v170, 1.0, v170
    v_add_f32 v171, 1.0, v171
    v_add_f32 v172, 1.0, v172
    v_add_f32 v173, 1.0, v173
    v_add_f32 v174, 1.0, v174
    v_add_f32 v175, 1.0, v175
    v_rcp_f32 v168, v168
    v_rcp_f32 v169, v169
    v_rcp_f32 v170, v170
    v_rcp_f32 v171, v171
    v_rcp_f32 v172, v172
    v_rcp_f32 v173, v173
    v_rcp_f32 v174, v174
    v_rcp_f32 v175, v175
    v_mul_f32 v160, v160, v168
    v_mul_f32 v161, v161, v169
    v_mul_f32 v162, v162, v170
    v_mul_f32 v163, v163, v171
    v_mul_f32 v164, v164, v172
    v_mul_f32 v165, v165, v173
    v_mul_f32 v166, v166, v174
    v_mul_f32 v167, v167, v175
    v_cvt_pk_bf16_f32 v176, v160, v161
    v_cvt_pk_bf16_f32 v177, v162, v163
    v_cvt_pk_bf16_f32 v178, v164, v165
    v_cvt_pk_bf16_f32 v179, v166, v167
    buffer_store_dwordx4 v[176:179], v30, s[8:11], s6 offen offset:0 sc1
    v_accvgpr_read_b32 v180, a196
    v_accvgpr_read_b32 v181, a197
    v_accvgpr_read_b32 v182, a198
    v_accvgpr_read_b32 v183, a199
    v_accvgpr_read_b32 v184, a228
    v_accvgpr_read_b32 v185, a229
    v_accvgpr_read_b32 v186, a230
    v_accvgpr_read_b32 v187, a231
    v_mul_f32 v188, s4, v180
    v_mul_f32 v189, s4, v181
    v_mul_f32 v190, s4, v182
    v_mul_f32 v191, s4, v183
    v_mul_f32 v192, s4, v184
    v_mul_f32 v193, s4, v185
    v_mul_f32 v194, s4, v186
    v_mul_f32 v195, s4, v187
    v_exp_f32 v188, v188
    v_exp_f32 v189, v189
    v_exp_f32 v190, v190
    v_exp_f32 v191, v191
    v_exp_f32 v192, v192
    v_exp_f32 v193, v193
    v_exp_f32 v194, v194
    v_exp_f32 v195, v195
    v_add_f32 v188, 1.0, v188
    v_add_f32 v189, 1.0, v189
    v_add_f32 v190, 1.0, v190
    v_add_f32 v191, 1.0, v191
    v_add_f32 v192, 1.0, v192
    v_add_f32 v193, 1.0, v193
    v_add_f32 v194, 1.0, v194
    v_add_f32 v195, 1.0, v195
    v_rcp_f32 v188, v188
    v_rcp_f32 v189, v189
    v_rcp_f32 v190, v190
    v_rcp_f32 v191, v191
    v_rcp_f32 v192, v192
    v_rcp_f32 v193, v193
    v_rcp_f32 v194, v194
    v_rcp_f32 v195, v195
    v_mul_f32 v180, v180, v188
    v_mul_f32 v181, v181, v189
    v_mul_f32 v182, v182, v190
    v_mul_f32 v183, v183, v191
    v_mul_f32 v184, v184, v192
    v_mul_f32 v185, v185, v193
    v_mul_f32 v186, v186, v194
    v_mul_f32 v187, v187, v195
    v_cvt_pk_bf16_f32 v196, v180, v181
    v_cvt_pk_bf16_f32 v197, v182, v183
    v_cvt_pk_bf16_f32 v198, v184, v185
    v_cvt_pk_bf16_f32 v199, v186, v187
    buffer_store_dwordx4 v[196:199], v30, s[8:11], s6 offen offset:256 sc1
    v_accvgpr_read_b32 v160, a200
    v_accvgpr_read_b32 v161, a201
    v_accvgpr_read_b32 v162, a202
    v_accvgpr_read_b32 v163, a203
    v_accvgpr_read_b32 v164, a232
    v_accvgpr_read_b32 v165, a233
    v_accvgpr_read_b32 v166, a234
    v_accvgpr_read_b32 v167, a235
    v_mul_f32 v168, s4, v160
    v_mul_f32 v169, s4, v161
    v_mul_f32 v170, s4, v162
    v_mul_f32 v171, s4, v163
    v_mul_f32 v172, s4, v164
    v_mul_f32 v173, s4, v165
    v_mul_f32 v174, s4, v166
    v_mul_f32 v175, s4, v167
    v_exp_f32 v168, v168
    v_exp_f32 v169, v169
    v_exp_f32 v170, v170
    v_exp_f32 v171, v171
    v_exp_f32 v172, v172
    v_exp_f32 v173, v173
    v_exp_f32 v174, v174
    v_exp_f32 v175, v175
    v_add_f32 v168, 1.0, v168
    v_add_f32 v169, 1.0, v169
    v_add_f32 v170, 1.0, v170
    v_add_f32 v171, 1.0, v171
    v_add_f32 v172, 1.0, v172
    v_add_f32 v173, 1.0, v173
    v_add_f32 v174, 1.0, v174
    v_add_f32 v175, 1.0, v175
    v_rcp_f32 v168, v168
    v_rcp_f32 v169, v169
    v_rcp_f32 v170, v170
    v_rcp_f32 v171, v171
    v_rcp_f32 v172, v172
    v_rcp_f32 v173, v173
    v_rcp_f32 v174, v174
    v_rcp_f32 v175, v175
    v_mul_f32 v160, v160, v168
    v_mul_f32 v161, v161, v169
    v_mul_f32 v162, v162, v170
    v_mul_f32 v163, v163, v171
    v_mul_f32 v164, v164, v172
    v_mul_f32 v165, v165, v173
    v_mul_f32 v166, v166, v174
    v_mul_f32 v167, v167, v175
    v_cvt_pk_bf16_f32 v176, v160, v161
    v_cvt_pk_bf16_f32 v177, v162, v163
    v_cvt_pk_bf16_f32 v178, v164, v165
    v_cvt_pk_bf16_f32 v179, v166, v167
    buffer_store_dwordx4 v[176:179], v30, s[8:11], s6 offen offset:512 sc1
    v_accvgpr_read_b32 v180, a204
    v_accvgpr_read_b32 v181, a205
    v_accvgpr_read_b32 v182, a206
    v_accvgpr_read_b32 v183, a207
    v_accvgpr_read_b32 v184, a236
    v_accvgpr_read_b32 v185, a237
    v_accvgpr_read_b32 v186, a238
    v_accvgpr_read_b32 v187, a239
    v_mul_f32 v188, s4, v180
    v_mul_f32 v189, s4, v181
    v_mul_f32 v190, s4, v182
    v_mul_f32 v191, s4, v183
    v_mul_f32 v192, s4, v184
    v_mul_f32 v193, s4, v185
    v_mul_f32 v194, s4, v186
    v_mul_f32 v195, s4, v187
    v_exp_f32 v188, v188
    v_exp_f32 v189, v189
    v_exp_f32 v190, v190
    v_exp_f32 v191, v191
    v_exp_f32 v192, v192
    v_exp_f32 v193, v193
    v_exp_f32 v194, v194
    v_exp_f32 v195, v195
    v_add_f32 v188, 1.0, v188
    v_add_f32 v189, 1.0, v189
    v_add_f32 v190, 1.0, v190
    v_add_f32 v191, 1.0, v191
    v_add_f32 v192, 1.0, v192
    v_add_f32 v193, 1.0, v193
    v_add_f32 v194, 1.0, v194
    v_add_f32 v195, 1.0, v195
    v_rcp_f32 v188, v188
    v_rcp_f32 v189, v189
    v_rcp_f32 v190, v190
    v_rcp_f32 v191, v191
    v_rcp_f32 v192, v192
    v_rcp_f32 v193, v193
    v_rcp_f32 v194, v194
    v_rcp_f32 v195, v195
    v_mul_f32 v180, v180, v188
    v_mul_f32 v181, v181, v189
    v_mul_f32 v182, v182, v190
    v_mul_f32 v183, v183, v191
    v_mul_f32 v184, v184, v192
    v_mul_f32 v185, v185, v193
    v_mul_f32 v186, v186, v194
    v_mul_f32 v187, v187, v195
    v_cvt_pk_bf16_f32 v196, v180, v181
    v_cvt_pk_bf16_f32 v197, v182, v183
    v_cvt_pk_bf16_f32 v198, v184, v185
    v_cvt_pk_bf16_f32 v199, v186, v187
    buffer_store_dwordx4 v[196:199], v30, s[8:11], s6 offen offset:768 sc1
    v_accvgpr_read_b32 v160, a208
    v_accvgpr_read_b32 v161, a209
    v_accvgpr_read_b32 v162, a210
    v_accvgpr_read_b32 v163, a211
    v_accvgpr_read_b32 v164, a240
    v_accvgpr_read_b32 v165, a241
    v_accvgpr_read_b32 v166, a242
    v_accvgpr_read_b32 v167, a243
    v_mul_f32 v168, s4, v160
    v_mul_f32 v169, s4, v161
    v_mul_f32 v170, s4, v162
    v_mul_f32 v171, s4, v163
    v_mul_f32 v172, s4, v164
    v_mul_f32 v173, s4, v165
    v_mul_f32 v174, s4, v166
    v_mul_f32 v175, s4, v167
    v_exp_f32 v168, v168
    v_exp_f32 v169, v169
    v_exp_f32 v170, v170
    v_exp_f32 v171, v171
    v_exp_f32 v172, v172
    v_exp_f32 v173, v173
    v_exp_f32 v174, v174
    v_exp_f32 v175, v175
    v_add_f32 v168, 1.0, v168
    v_add_f32 v169, 1.0, v169
    v_add_f32 v170, 1.0, v170
    v_add_f32 v171, 1.0, v171
    v_add_f32 v172, 1.0, v172
    v_add_f32 v173, 1.0, v173
    v_add_f32 v174, 1.0, v174
    v_add_f32 v175, 1.0, v175
    v_rcp_f32 v168, v168
    v_rcp_f32 v169, v169
    v_rcp_f32 v170, v170
    v_rcp_f32 v171, v171
    v_rcp_f32 v172, v172
    v_rcp_f32 v173, v173
    v_rcp_f32 v174, v174
    v_rcp_f32 v175, v175
    v_mul_f32 v160, v160, v168
    v_mul_f32 v161, v161, v169
    v_mul_f32 v162, v162, v170
    v_mul_f32 v163, v163, v171
    v_mul_f32 v164, v164, v172
    v_mul_f32 v165, v165, v173
    v_mul_f32 v166, v166, v174
    v_mul_f32 v167, v167, v175
    v_cvt_pk_bf16_f32 v176, v160, v161
    v_cvt_pk_bf16_f32 v177, v162, v163
    v_cvt_pk_bf16_f32 v178, v164, v165
    v_cvt_pk_bf16_f32 v179, v166, v167
    buffer_store_dwordx4 v[176:179], v30, s[8:11], s6 offen offset:1024 sc1
    v_accvgpr_read_b32 v180, a212
    v_accvgpr_read_b32 v181, a213
    v_accvgpr_read_b32 v182, a214
    v_accvgpr_read_b32 v183, a215
    v_accvgpr_read_b32 v184, a244
    v_accvgpr_read_b32 v185, a245
    v_accvgpr_read_b32 v186, a246
    v_accvgpr_read_b32 v187, a247
    v_mul_f32 v188, s4, v180
    v_mul_f32 v189, s4, v181
    v_mul_f32 v190, s4, v182
    v_mul_f32 v191, s4, v183
    v_mul_f32 v192, s4, v184
    v_mul_f32 v193, s4, v185
    v_mul_f32 v194, s4, v186
    v_mul_f32 v195, s4, v187
    v_exp_f32 v188, v188
    v_exp_f32 v189, v189
    v_exp_f32 v190, v190
    v_exp_f32 v191, v191
    v_exp_f32 v192, v192
    v_exp_f32 v193, v193
    v_exp_f32 v194, v194
    v_exp_f32 v195, v195
    v_add_f32 v188, 1.0, v188
    v_add_f32 v189, 1.0, v189
    v_add_f32 v190, 1.0, v190
    v_add_f32 v191, 1.0, v191
    v_add_f32 v192, 1.0, v192
    v_add_f32 v193, 1.0, v193
    v_add_f32 v194, 1.0, v194
    v_add_f32 v195, 1.0, v195
    v_rcp_f32 v188, v188
    v_rcp_f32 v189, v189
    v_rcp_f32 v190, v190
    v_rcp_f32 v191, v191
    v_rcp_f32 v192, v192
    v_rcp_f32 v193, v193
    v_rcp_f32 v194, v194
    v_rcp_f32 v195, v195
    v_mul_f32 v180, v180, v188
    v_mul_f32 v181, v181, v189
    v_mul_f32 v182, v182, v190
    v_mul_f32 v183, v183, v191
    v_mul_f32 v184, v184, v192
    v_mul_f32 v185, v185, v193
    v_mul_f32 v186, v186, v194
    v_mul_f32 v187, v187, v195
    v_cvt_pk_bf16_f32 v196, v180, v181
    v_cvt_pk_bf16_f32 v197, v182, v183
    v_cvt_pk_bf16_f32 v198, v184, v185
    v_cvt_pk_bf16_f32 v199, v186, v187
    buffer_store_dwordx4 v[196:199], v30, s[8:11], s6 offen offset:1280 sc1
    v_accvgpr_read_b32 v160, a216
    v_accvgpr_read_b32 v161, a217
    v_accvgpr_read_b32 v162, a218
    v_accvgpr_read_b32 v163, a219
    v_accvgpr_read_b32 v164, a248
    v_accvgpr_read_b32 v165, a249
    v_accvgpr_read_b32 v166, a250
    v_accvgpr_read_b32 v167, a251
    v_mul_f32 v168, s4, v160
    v_mul_f32 v169, s4, v161
    v_mul_f32 v170, s4, v162
    v_mul_f32 v171, s4, v163
    v_mul_f32 v172, s4, v164
    v_mul_f32 v173, s4, v165
    v_mul_f32 v174, s4, v166
    v_mul_f32 v175, s4, v167
    v_exp_f32 v168, v168
    v_exp_f32 v169, v169
    v_exp_f32 v170, v170
    v_exp_f32 v171, v171
    v_exp_f32 v172, v172
    v_exp_f32 v173, v173
    v_exp_f32 v174, v174
    v_exp_f32 v175, v175
    v_add_f32 v168, 1.0, v168
    v_add_f32 v169, 1.0, v169
    v_add_f32 v170, 1.0, v170
    v_add_f32 v171, 1.0, v171
    v_add_f32 v172, 1.0, v172
    v_add_f32 v173, 1.0, v173
    v_add_f32 v174, 1.0, v174
    v_add_f32 v175, 1.0, v175
    v_rcp_f32 v168, v168
    v_rcp_f32 v169, v169
    v_rcp_f32 v170, v170
    v_rcp_f32 v171, v171
    v_rcp_f32 v172, v172
    v_rcp_f32 v173, v173
    v_rcp_f32 v174, v174
    v_rcp_f32 v175, v175
    v_mul_f32 v160, v160, v168
    v_mul_f32 v161, v161, v169
    v_mul_f32 v162, v162, v170
    v_mul_f32 v163, v163, v171
    v_mul_f32 v164, v164, v172
    v_mul_f32 v165, v165, v173
    v_mul_f32 v166, v166, v174
    v_mul_f32 v167, v167, v175
    v_cvt_pk_bf16_f32 v176, v160, v161
    v_cvt_pk_bf16_f32 v177, v162, v163
    v_cvt_pk_bf16_f32 v178, v164, v165
    v_cvt_pk_bf16_f32 v179, v166, v167
    buffer_store_dwordx4 v[176:179], v30, s[8:11], s6 offen offset:1536 sc1
    v_accvgpr_read_b32 v180, a220
    v_accvgpr_read_b32 v181, a221
    v_accvgpr_read_b32 v182, a222
    v_accvgpr_read_b32 v183, a223
    v_accvgpr_read_b32 v184, a252
    v_accvgpr_read_b32 v185, a253
    v_accvgpr_read_b32 v186, a254
    v_accvgpr_read_b32 v187, a255
    v_mul_f32 v188, s4, v180
    v_mul_f32 v189, s4, v181
    v_mul_f32 v190, s4, v182
    v_mul_f32 v191, s4, v183
    v_mul_f32 v192, s4, v184
    v_mul_f32 v193, s4, v185
    v_mul_f32 v194, s4, v186
    v_mul_f32 v195, s4, v187
    v_exp_f32 v188, v188
    v_exp_f32 v189, v189
    v_exp_f32 v190, v190
    v_exp_f32 v191, v191
    v_exp_f32 v192, v192
    v_exp_f32 v193, v193
    v_exp_f32 v194, v194
    v_exp_f32 v195, v195
    v_add_f32 v188, 1.0, v188
    v_add_f32 v189, 1.0, v189
    v_add_f32 v190, 1.0, v190
    v_add_f32 v191, 1.0, v191
    v_add_f32 v192, 1.0, v192
    v_add_f32 v193, 1.0, v193
    v_add_f32 v194, 1.0, v194
    v_add_f32 v195, 1.0, v195
    v_rcp_f32 v188, v188
    v_rcp_f32 v189, v189
    v_rcp_f32 v190, v190
    v_rcp_f32 v191, v191
    v_rcp_f32 v192, v192
    v_rcp_f32 v193, v193
    v_rcp_f32 v194, v194
    v_rcp_f32 v195, v195
    v_mul_f32 v180, v180, v188
    v_mul_f32 v181, v181, v189
    v_mul_f32 v182, v182, v190
    v_mul_f32 v183, v183, v191
    v_mul_f32 v184, v184, v192
    v_mul_f32 v185, v185, v193
    v_mul_f32 v186, v186, v194
    v_mul_f32 v187, v187, v195
    v_cvt_pk_bf16_f32 v196, v180, v181
    v_cvt_pk_bf16_f32 v197, v182, v183
    v_cvt_pk_bf16_f32 v198, v184, v185
    v_cvt_pk_bf16_f32 v199, v186, v187
    buffer_store_dwordx4 v[196:199], v30, s[8:11], s6 offen offset:1792 sc1
L_e1done:
    s_cmp_eq_u32 s61, 0
    s_cbranch_scc1 L_e1drain
    s_mov_b32 s62, s40
    s_mov_b32 s29, s42
    s_mov_b32 s40, s43
    s_mov_b32 s60, s61
    s_mov_b32 s21, s63
    s_cmp_eq_u32 s60, 2
    s_cbranch_scc1 L_f4S
    s_branch L_f4N
L_e1drain:
    s_waitcnt vmcnt(0) lgkmcnt(0)
    s_barrier
    buffer_atomic_add v24, v23, s[8:11], s40 offen sc1
    s_branch L_e1start
L_p2:
    v_lshrrev_b32 v4, 4, v0
    v_lshlrev_b32 v4, 9, v4
    v_and_b32 v5, 15, v0
    v_lshlrev_b32 v5, 4, v5
    v_add_u32 v205, v4, v5
    s_cmp_ge_u32 s25, 8
    s_cbranch_scc1 L_WO
    s_cmp_lg_u32 s3, 0
    s_cbranch_scc1 Lwwo_199
    v_mov_b32 v1, 160
Lww_198:
    buffer_load_dword v2, v1, s[64:67], 0 offen sc1
    s_waitcnt vmcnt(0)
    v_cmp_le_u32 vcc, 128, v2
    s_cbranch_vccnz Lwwo_199
    s_sleep 8
    s_sub_u32 s22, s22, 1
    s_cbranch_scc0 Lww_198
    s_branch L_abort
Lwwo_199:
    s_barrier
    s_lshr_b32 s60, s25, 1
    s_add_u32 s4, s60, 60
    s_lshl_b32 s4, s4, 18
    s_lshl_b32 s5, s23, 1
    s_and_b32 s6, s25, 1
    s_add_u32 s5, s5, s6
    s_lshl_b32 s5, s5, 2
    s_add_u32 s5, s5, s3
    s_lshl_b32 s5, s5, 13
    s_add_u32 s4, s4, s5
    s_add_u32 s4, s4, 71303168
    v_mov_b32 v32, -1
    v_mov_b32 v33, -1
    v_mov_b32 v34, -1
    v_mov_b32 v35, -1
    buffer_store_dwordx4 v[32:35], v205, s[8:11], s4 offen offset:0 sc1
    buffer_store_dwordx4 v[32:35], v205, s[8:11], s4 offen offset:256 sc1
    s_add_u32 s4, s4, 2048
    buffer_store_dwordx4 v[32:35], v205, s[8:11], s4 offen offset:0 sc1
    buffer_store_dwordx4 v[32:35], v205, s[8:11], s4 offen offset:256 sc1
    s_add_u32 s4, s4, 2048
    buffer_store_dwordx4 v[32:35], v205, s[8:11], s4 offen offset:0 sc1
    buffer_store_dwordx4 v[32:35], v205, s[8:11], s4 offen offset:256 sc1
    s_add_u32 s4, s4, 2048
    buffer_store_dwordx4 v[32:35], v205, s[8:11], s4 offen offset:0 sc1
    buffer_store_dwordx4 v[32:35], v205, s[8:11], s4 offen offset:256 sc1
L_AT:
    s_lshr_b32 s26, s60, 3
    s_lshl_b32 s5, s23, 1
    s_and_b32 s4, s25, 1
    s_add_u32 s4, s4, s5
    s_lshl_b32 s4, s4, 3
    s_and_b32 s6, s60, 7
    s_add_u32 s27, s4, s6
    s_lshl_b32 s5, s60, 8
    s_add_u32 s40, s5, 102776832
    s_lshl_b32 s4, s26, 8
    s_add_u32 s5, s4, 102760448
    v_mov_b32 v214, s5
    s_add_u32 s5, s4, 102762496
    v_writelane_b32 v214, s5, 1
    s_mov_b32 s5, 102772736
    v_writelane_b32 v214, s5, 2
    s_cmp_eq_u32 s26, 0
    s_cselect_b32 s5, 128, 32
    v_mov_b32 v215, s5
    s_mov_b32 s5, 16
    v_writelane_b32 v215, s5, 1
    s_cmp_ge_u32 s60, 48
    s_cselect_b32 s5, 1, 2
    s_add_u32 s5, s5, s60
    s_min_u32 s5, s5, 63
    v_writelane_b32 v215, s5, 2
    s_cmp_lg_u32 s3, 0
    s_cbranch_scc1 Lwmo_201
Lwm_200:
    buffer_load_dword v216, v214, s[8:11], 0 offen sc1
    s_waitcnt vmcnt(0)
    v_cmp_ge_u32 vcc, v216, v215
    s_cmp_eq_u64 vcc, -1
    s_cbranch_scc1 Lwmo_201
    s_sleep 8
    s_sub_u32 s22, s22, 1
    s_cbranch_scc0 Lwm_200
    s_branch L_abort
Lwmo_201:
    s_barrier
    s_and_b32 s30, s27, 7
    s_lshr_b32 s31, s27, 3
    s_lshl_b32 s31, s31, 2
    s_add_u32 s31, s31, s3
    s_lshl_b32 s4, s26, 21
    s_lshl_b32 s5, s31, 16
    s_add_u32 s4, s4, s5
    s_lshl_b32 s5, s30, 9
    s_add_u32 s4, s4, s5
    s_add_u32 s32, s4, 37748736
    s_add_u32 s33, s4, 4194304
    s_add_u32 s36, s4, 71303168
    s_lshl_b32 s4, s26, 3
    s_add_u32 s4, s4, s30
    s_lshl_b32 s5, s4, 18
    s_lshl_b32 s6, s31, 13
    s_add_u32 s5, s5, s6
    s_add_u32 s36, s5, 71303168
    s_lshl_b32 s5, s4, 18
    s_lshl_b32 s6, s31, 11
    s_add_u32 s5, s5, s6
    s_add_u32 s34, s5, 20971520
    s_lshl_b32 s5, s4, 17
    s_lshl_b32 s6, s31, 12
    s_add_u32 s5, s5, s6
    s_add_u32 s35, s5, 88080384
    buffer_load_dwordx4 v[64:67], v228, s[8:11], s33 offen offset:0 sc1
    buffer_load_dwordx4 v[32:35], v228, s[8:11], s32 offen offset:0 sc1
    buffer_load_dwordx4 v[80:83], v228, s[8:11], s33 offen offset:256 sc1
    buffer_load_dwordx4 v[48:51], v228, s[8:11], s32 offen offset:256 sc1
    s_add_u32 s33, s33, 16384
    s_add_u32 s32, s32, 16384
    buffer_load_dwordx4 v[68:71], v228, s[8:11], s33 offen offset:0 sc1
    buffer_load_dwordx4 v[36:39], v228, s[8:11], s32 offen offset:0 sc1
    buffer_load_dwordx4 v[84:87], v228, s[8:11], s33 offen offset:256 sc1
    buffer_load_dwordx4 v[52:55], v228, s[8:11], s32 offen offset:256 sc1
    s_add_u32 s33, s33, 16384
    s_add_u32 s32, s32, 16384
    buffer_load_dwordx4 v[72:75], v228, s[8:11], s33 offen offset:0 sc1
    buffer_load_dwordx4 v[40:43], v228, s[8:11], s32 offen offset:0 sc1
    buffer_load_dwordx4 v[88:91], v228, s[8:11], s33 offen offset:256 sc1
    buffer_load_dwordx4 v[56:59], v228, s[8:11], s32 offen offset:256 sc1
    s_add_u32 s33, s33, 16384
    s_add_u32 s32, s32, 16384
    buffer_load_dwordx4 v[76:79], v228, s[8:11], s33 offen offset:0 sc1
    buffer_load_dwordx4 v[44:47], v228, s[8:11], s32 offen offset:0 sc1
    buffer_load_dwordx4 v[92:95], v228, s[8:11], s33 offen offset:256 sc1
    buffer_load_dwordx4 v[60:63], v228, s[8:11], s32 offen offset:256 sc1
    buffer_load_dwordx4 v[112:115], v230, s[8:11], s34 offen offset:0 sc1
    buffer_load_dwordx4 v[116:119], v230, s[8:11], s34 offen offset:256 sc1
    buffer_load_dwordx4 v[120:123], v230, s[8:11], s34 offen offset:512 sc1
    buffer_load_dwordx4 v[124:127], v230, s[8:11], s34 offen offset:768 sc1
    buffer_load_dwordx4 v[128:131], v230, s[8:11], s34 offen offset:1024 sc1
    buffer_load_dwordx4 v[132:135], v230, s[8:11], s34 offen offset:1280 sc1
    buffer_load_dwordx4 v[136:139], v230, s[8:11], s34 offen offset:1536 sc1
    buffer_load_dwordx4 v[140:143], v230, s[8:11], s34 offen offset:1792 sc1
    buffer_load_dwordx4 v[96:99], v229, s[8:11], s35 offen offset:0 sc1
    buffer_load_dwordx4 v[100:103], v229, s[8:11], s35 offen offset:1024 sc1
    buffer_load_dwordx4 v[104:107], v229, s[8:11], s35 offen offset:2048 sc1
    buffer_load_dwordx4 v[108:111], v229, s[8:11], s35 offen offset:3072 sc1
    buffer_load_dword v144, v25, s[8:11], s35 offen offset:512 sc1
    buffer_load_dword v145, v25, s[8:11], s35 offen offset:768 sc1
    buffer_load_dword v146, v25, s[8:11], s35 offen offset:1536 sc1
    buffer_load_dword v147, v25, s[8:11], s35 offen offset:1792 sc1
    buffer_load_dword v148, v25, s[8:11], s35 offen offset:2560 sc1
    buffer_load_dword v149, v25, s[8:11], s35 offen offset:2816 sc1
    buffer_load_dword v150, v25, s[8:11], s35 offen offset:3584 sc1
    buffer_load_dword v151, v25, s[8:11], s35 offen offset:3840 sc1
    v_mov_b32 v152, 0
    v_mov_b32 v153, 0
    v_mov_b32 v156, 0x3f803f80
    v_mov_b32 v157, 0x3f803f80
    v_mov_b32 v158, 0x3f803f80
    v_mov_b32 v159, 0x3f803f80
    v_mov_b32 v188, 0
    v_mov_b32 v189, 0
    v_mov_b32 v190, 0
    v_mov_b32 v191, 0
    v_mov_b32 v192, 0
    v_mov_b32 v193, 0
    v_mov_b32 v194, 0
    v_mov_b32 v195, 0
    v_mov_b32 v196, 0
    v_mov_b32 v197, 0
    v_mov_b32 v198, 0
    v_mov_b32 v199, 0
    v_mov_b32 v200, 0
    v_mov_b32 v201, 0
    v_mov_b32 v202, 0
    v_mov_b32 v203, 0
Latp_202:
    s_waitcnt vmcnt(0)
    v_max3_u32 v1, v96, v97, v98
    v_max3_u32 v1, v1, v99, v100
    v_max3_u32 v1, v1, v101, v102
    v_max3_u32 v1, v1, v103, v104
    v_max3_u32 v1, v1, v105, v106
    v_max3_u32 v1, v1, v107, v108
    v_max3_u32 v1, v1, v109, v110
    v_max3_u32 v1, v1, v111, v144
    v_max3_u32 v1, v1, v145, v146
    v_max3_u32 v1, v1, v147, v148
    v_max3_u32 v1, v1, v149, v150
    v_max_u32 v1, v1, v151
    v_cmp_eq_u32 vcc, -1, v1
    s_cbranch_vccz Lato_203
    s_sleep 2
    s_sub_u32 s22, s22, 1
    s_cbranch_scc1 L_abort
    buffer_load_dwordx4 v[96:99], v229, s[8:11], s35 offen offset:0 sc1
    buffer_load_dwordx4 v[100:103], v229, s[8:11], s35 offen offset:1024 sc1
    buffer_load_dwordx4 v[104:107], v229, s[8:11], s35 offen offset:2048 sc1
    buffer_load_dwordx4 v[108:111], v229, s[8:11], s35 offen offset:3072 sc1
    buffer_load_dword v144, v25, s[8:11], s35 offen offset:512 sc1
    buffer_load_dword v145, v25, s[8:11], s35 offen offset:768 sc1
    buffer_load_dword v146, v25, s[8:11], s35 offen offset:1536 sc1
    buffer_load_dword v147, v25, s[8:11], s35 offen offset:1792 sc1
    buffer_load_dword v148, v25, s[8:11], s35 offen offset:2560 sc1
    buffer_load_dword v149, v25, s[8:11], s35 offen offset:2816 sc1
    buffer_load_dword v150, v25, s[8:11], s35 offen offset:3584 sc1
    buffer_load_dword v151, v25, s[8:11], s35 offen offset:3840 sc1
    s_branch Latp_202
Lato_203:
    v_mfma_f32_16x16x32_bf16 v[160:163], v[96:99], v[32:35], 0
    v_mfma_f32_16x16x32_bf16 v[164:167], v[64:67], v[32:35], 0
    v_mfma_f32_16x16x32_bf16 v[168:171], v[96:99], v[48:51], 0
    v_mfma_f32_16x16x32_bf16 v[172:175], v[64:67], v[48:51], 0
    v_mfma_f32_16x16x32_bf16 v[176:179], v[80:83], v[48:51], 0
    v_mfma_f32_16x16x32_bf16 v[160:163], v[100:103], v[36:39], v[160:163]
    v_mfma_f32_16x16x32_bf16 v[164:167], v[68:71], v[36:39], v[164:167]
    v_mfma_f32_16x16x32_bf16 v[168:171], v[100:103], v[52:55], v[168:171]
    v_mfma_f32_16x16x32_bf16 v[172:175], v[68:71], v[52:55], v[172:175]
    v_mfma_f32_16x16x32_bf16 v[176:179], v[84:87], v[52:55], v[176:179]
    v_mfma_f32_16x16x32_bf16 v[160:163], v[104:107], v[40:43], v[160:163]
    v_mfma_f32_16x16x32_bf16 v[164:167], v[72:75], v[40:43], v[164:167]
    v_mfma_f32_16x16x32_bf16 v[168:171], v[104:107], v[56:59], v[168:171]
    v_mfma_f32_16x16x32_bf16 v[172:175], v[72:75], v[56:59], v[172:175]
    v_mfma_f32_16x16x32_bf16 v[176:179], v[88:91], v[56:59], v[176:179]
    v_mfma_f32_16x16x32_bf16 v[160:163], v[108:111], v[44:47], v[160:163]
    v_mfma_f32_16x16x32_bf16 v[164:167], v[76:79], v[44:47], v[164:167]
    v_mfma_f32_16x16x32_bf16 v[168:171], v[108:111], v[60:63], v[168:171]
    v_mfma_f32_16x16x32_bf16 v[172:175], v[76:79], v[60:63], v[172:175]
    v_mfma_f32_16x16x32_bf16 v[176:179], v[92:95], v[60:63], v[176:179]
    s_nop 7
    s_mov_b32 s4, 0x3e0293ee
    v_cndmask_b32 v164, v231, v164, s[52:53]
    v_cndmask_b32 v165, v231, v165, s[54:55]
    v_cndmask_b32 v166, v231, v166, s[56:57]
    v_cndmask_b32 v167, v231, v167, s[58:59]
    v_max3_f32 v2, v160, v161, v164
    v_max3_f32 v2, v2, v165, v166
    v_max_f32 v2, v2, v167
    v_mov_b32 v3, v2
    s_nop 1
    v_permlane32_swap_b32 v3, v2
    v_max_f32 v2, v2, v3
    v_mov_b32 v3, v2
    s_nop 1
    v_permlane16_swap_b32 v3, v2
    v_max_f32 v2, v2, v3
    v_mul_f32 v2, s4, v2
    v_fma_f32 v160, v160, s4, -v2
    v_fma_f32 v161, v161, s4, -v2
    v_fma_f32 v164, v164, s4, -v2
    v_fma_f32 v165, v165, s4, -v2
    v_fma_f32 v166, v166, s4, -v2
    v_fma_f32 v167, v167, s4, -v2
    v_exp_f32 v160, v160
    v_exp_f32 v161, v161
    v_exp_f32 v164, v164
    v_exp_f32 v165, v165
    v_exp_f32 v166, v166
    v_exp_f32 v167, v167
    v_cvt_pk_bf16_f32 v188, v160, v161
    v_cvt_pk_bf16_f32 v180, v164, v165
    v_cvt_pk_bf16_f32 v181, v166, v167
    v_mov_b32 v182, 0
    v_mov_b32 v183, 0
    v_mov_b32 v197, v188
    v_cndmask_b32 v176, v231, v176, s[52:53]
    v_cndmask_b32 v177, v231, v177, s[54:55]
    v_cndmask_b32 v178, v231, v178, s[56:57]
    v_cndmask_b32 v179, v231, v179, s[58:59]
    v_max3_f32 v2, v168, v169, v172
    v_max3_f32 v2, v2, v173, v174
    v_max_f32 v2, v2, v175
    v_max3_f32 v2, v2, v176, v177
    v_max3_f32 v2, v2, v178, v179
    v_mov_b32 v3, v2
    s_nop 1
    v_permlane32_swap_b32 v3, v2
    v_max_f32 v2, v2, v3
    v_mov_b32 v3, v2
    s_nop 1
    v_permlane16_swap_b32 v3, v2
    v_max_f32 v2, v2, v3
    v_mul_f32 v2, s4, v2
    v_fma_f32 v168, v168, s4, -v2
    v_fma_f32 v169, v169, s4, -v2
    v_fma_f32 v172, v172, s4, -v2
    v_fma_f32 v173, v173, s4, -v2
    v_fma_f32 v174, v174, s4, -v2
    v_fma_f32 v175, v175, s4, -v2
    v_fma_f32 v176, v176, s4, -v2
    v_fma_f32 v177, v177, s4, -v2
    v_fma_f32 v178, v178, s4, -v2
    v_fma_f32 v179, v179, s4, -v2
    v_exp_f32 v168, v168
    v_exp_f32 v169, v169
    v_exp_f32 v172, v172
    v_exp_f32 v173, v173
    v_exp_f32 v174, v174
    v_exp_f32 v175, v175
    v_exp_f32 v176, v176
    v_exp_f32 v177, v177
    v_exp_f32 v178, v178
    v_exp_f32 v179, v179
    v_cvt_pk_bf16_f32 v192, v168, v169
    v_cvt_pk_bf16_f32 v184, v172, v173
    v_cvt_pk_bf16_f32 v185, v174, v175
    v_cvt_pk_bf16_f32 v186, v176, v177
    v_cvt_pk_bf16_f32 v187, v178, v179
    v_mov_b32 v201, v192
    s_nop 1
    v_mfma_f32_16x16x32_bf16 a[64:67], v[156:159], v[180:183], 0
    v_mfma_f32_16x16x32_bf16 a[0:3], v[112:115], v[180:183], 0
    v_mfma_f32_16x16x32_bf16 a[4:7], v[116:119], v[180:183], 0
    v_mfma_f32_16x16x32_bf16 a[8:11], v[120:123], v[180:183], 0
    v_mfma_f32_16x16x32_bf16 a[12:15], v[124:127], v[180:183], 0
    v_mfma_f32_16x16x32_bf16 a[16:19], v[128:131], v[180:183], 0
    v_mfma_f32_16x16x32_bf16 a[20:23], v[132:135], v[180:183], 0
    v_mfma_f32_16x16x32_bf16 a[24:27], v[136:139], v[180:183], 0
    v_mfma_f32_16x16x32_bf16 a[28:31], v[140:143], v[180:183], 0
    v_mfma_f32_16x16x32_bf16 a[68:71], v[156:159], v[184:187], 0
    v_mfma_f32_16x16x32_bf16 a[32:35], v[112:115], v[184:187], 0
    v_mfma_f32_16x16x32_bf16 a[36:39], v[116:119], v[184:187], 0
    v_mfma_f32_16x16x32_bf16 a[40:43], v[120:123], v[184:187], 0
    v_mfma_f32_16x16x32_bf16 a[44:47], v[124:127], v[184:187], 0
    v_mfma_f32_16x16x32_bf16 a[48:51], v[128:131], v[184:187], 0
    v_mfma_f32_16x16x32_bf16 a[52:55], v[132:135], v[184:187], 0
    v_mfma_f32_16x16x32_bf16 a[56:59], v[136:139], v[184:187], 0
    v_mfma_f32_16x16x32_bf16 a[60:63], v[140:143], v[184:187], 0
    v_mfma_f32_16x16x32_bf16 a[64:67], v[156:159], v[188:191], a[64:67]
    v_mfma_f32_16x16x32_bf16 a[0:3], v[144:147], v[188:191], a[0:3]
    v_mfma_f32_16x16x32_bf16 a[4:7], v[144:147], v[196:199], a[4:7]
    v_mfma_f32_16x16x32_bf16 a[8:11], v[146:149], v[188:191], a[8:11]
    v_mfma_f32_16x16x32_bf16 a[12:15], v[146:149], v[196:199], a[12:15]
    v_mfma_f32_16x16x32_bf16 a[16:19], v[148:151], v[188:191], a[16:19]
    v_mfma_f32_16x16x32_bf16 a[20:23], v[148:151], v[196:199], a[20:23]
    v_mfma_f32_16x16x32_bf16 a[24:27], v[150:153], v[188:191], a[24:27]
    v_mfma_f32_16x16x32_bf16 a[28:31], v[150:153], v[196:199], a[28:31]
    v_mfma_f32_16x16x32_bf16 a[68:71], v[156:159], v[192:195], a[68:71]
    v_mfma_f32_16x16x32_bf16 a[32:35], v[144:147], v[192:195], a[32:35]
    v_mfma_f32_16x16x32_bf16 a[36:39], v[144:147], v[200:203], a[36:39]
    v_mfma_f32_16x16x32_bf16 a[40:43], v[146:149], v[192:195], a[40:43]
    v_mfma_f32_16x16x32_bf16 a[44:47], v[146:149], v[200:203], a[44:47]
    v_mfma_f32_16x16x32_bf16 a[48:51], v[148:151], v[192:195], a[48:51]
    v_mfma_f32_16x16x32_bf16 a[52:55], v[148:151], v[200:203], a[52:55]
    v_mfma_f32_16x16x32_bf16 a[56:59], v[150:153], v[192:195], a[56:59]
    v_mfma_f32_16x16x32_bf16 a[60:63], v[150:153], v[200:203], a[60:63]
    s_nop 7
    v_accvgpr_read_b32 v2, a64
    s_nop 0
    v_rcp_f32 v2, v2
    v_accvgpr_read_b32 v3, a68
    s_nop 0
    v_rcp_f32 v3, v3
    v_accvgpr_read_b32 v32, a0
    v_accvgpr_read_b32 v33, a1
    v_accvgpr_read_b32 v34, a2
    v_accvgpr_read_b32 v35, a3
    v_accvgpr_read_b32 v36, a4
    v_accvgpr_read_b32 v37, a5
    v_accvgpr_read_b32 v38, a6
    v_accvgpr_read_b32 v39, a7
    v_mul_f32 v32, v32, v2
    v_mul_f32 v33, v33, v2
    v_mul_f32 v34, v34, v2
    v_mul_f32 v35, v35, v2
    v_mul_f32 v36, v36, v2
    v_mul_f32 v37, v37, v2
    v_mul_f32 v38, v38, v2
    v_mul_f32 v39, v39, v2
    v_cvt_pk_bf16_f32 v40, v32, v33
    v_cvt_pk_bf16_f32 v41, v34, v35
    v_cvt_pk_bf16_f32 v42, v36, v37
    v_cvt_pk_bf16_f32 v43, v38, v39
    s_add_u32 s5, s36, 0
    buffer_store_dwordx4 v[40:43], v205, s[8:11], s5 offen offset:0 sc1
    v_accvgpr_read_b32 v44, a8
    v_accvgpr_read_b32 v45, a9
    v_accvgpr_read_b32 v46, a10
    v_accvgpr_read_b32 v47, a11
    v_accvgpr_read_b32 v48, a12
    v_accvgpr_read_b32 v49, a13
    v_accvgpr_read_b32 v50, a14
    v_accvgpr_read_b32 v51, a15
    v_mul_f32 v44, v44, v2
    v_mul_f32 v45, v45, v2
    v_mul_f32 v46, v46, v2
    v_mul_f32 v47, v47, v2
    v_mul_f32 v48, v48, v2
    v_mul_f32 v49, v49, v2
    v_mul_f32 v50, v50, v2
    v_mul_f32 v51, v51, v2
    v_cvt_pk_bf16_f32 v52, v44, v45
    v_cvt_pk_bf16_f32 v53, v46, v47
    v_cvt_pk_bf16_f32 v54, v48, v49
    v_cvt_pk_bf16_f32 v55, v50, v51
    s_add_u32 s5, s36, 2048
    buffer_store_dwordx4 v[52:55], v205, s[8:11], s5 offen offset:0 sc1
    v_accvgpr_read_b32 v56, a16
    v_accvgpr_read_b32 v57, a17
    v_accvgpr_read_b32 v58, a18
    v_accvgpr_read_b32 v59, a19
    v_accvgpr_read_b32 v60, a20
    v_accvgpr_read_b32 v61, a21
    v_accvgpr_read_b32 v62, a22
    v_accvgpr_read_b32 v63, a23
    v_mul_f32 v56, v56, v2
    v_mul_f32 v57, v57, v2
    v_mul_f32 v58, v58, v2
    v_mul_f32 v59, v59, v2
    v_mul_f32 v60, v60, v2
    v_mul_f32 v61, v61, v2
    v_mul_f32 v62, v62, v2
    v_mul_f32 v63, v63, v2
    v_cvt_pk_bf16_f32 v64, v56, v57
    v_cvt_pk_bf16_f32 v65, v58, v59
    v_cvt_pk_bf16_f32 v66, v60, v61
    v_cvt_pk_bf16_f32 v67, v62, v63
    s_add_u32 s5, s36, 4096
    buffer_store_dwordx4 v[64:67], v205, s[8:11], s5 offen offset:0 sc1
    v_accvgpr_read_b32 v68, a24
    v_accvgpr_read_b32 v69, a25
    v_accvgpr_read_b32 v70, a26
    v_accvgpr_read_b32 v71, a27
    v_accvgpr_read_b32 v72, a28
    v_accvgpr_read_b32 v73, a29
    v_accvgpr_read_b32 v74, a30
    v_accvgpr_read_b32 v75, a31
    v_mul_f32 v68, v68, v2
    v_mul_f32 v69, v69, v2
    v_mul_f32 v70, v70, v2
    v_mul_f32 v71, v71, v2
    v_mul_f32 v72, v72, v2
    v_mul_f32 v73, v73, v2
    v_mul_f32 v74, v74, v2
    v_mul_f32 v75, v75, v2
    v_cvt_pk_bf16_f32 v76, v68, v69
    v_cvt_pk_bf16_f32 v77, v70, v71
    v_cvt_pk_bf16_f32 v78, v72, v73
    v_cvt_pk_bf16_f32 v79, v74, v75
    s_add_u32 s5, s36, 6144
    buffer_store_dwordx4 v[76:79], v205, s[8:11], s5 offen offset:0 sc1
    v_accvgpr_read_b32 v32, a32
    v_accvgpr_read_b32 v33, a33
    v_accvgpr_read_b32 v34, a34
    v_accvgpr_read_b32 v35, a35
    v_accvgpr_read_b32 v36, a36
    v_accvgpr_read_b32 v37, a37
    v_accvgpr_read_b32 v38, a38
    v_accvgpr_read_b32 v39, a39
    v_mul_f32 v32, v32, v3
    v_mul_f32 v33, v33, v3
    v_mul_f32 v34, v34, v3
    v_mul_f32 v35, v35, v3
    v_mul_f32 v36, v36, v3
    v_mul_f32 v37, v37, v3
    v_mul_f32 v38, v38, v3
    v_mul_f32 v39, v39, v3
    v_cvt_pk_bf16_f32 v40, v32, v33
    v_cvt_pk_bf16_f32 v41, v34, v35
    v_cvt_pk_bf16_f32 v42, v36, v37
    v_cvt_pk_bf16_f32 v43, v38, v39
    s_add_u32 s5, s36, 0
    buffer_store_dwordx4 v[40:43], v205, s[8:11], s5 offen offset:256 sc1
    v_accvgpr_read_b32 v44, a40
    v_accvgpr_read_b32 v45, a41
    v_accvgpr_read_b32 v46, a42
    v_accvgpr_read_b32 v47, a43
    v_accvgpr_read_b32 v48, a44
    v_accvgpr_read_b32 v49, a45
    v_accvgpr_read_b32 v50, a46
    v_accvgpr_read_b32 v51, a47
    v_mul_f32 v44, v44, v3
    v_mul_f32 v45, v45, v3
    v_mul_f32 v46, v46, v3
    v_mul_f32 v47, v47, v3
    v_mul_f32 v48, v48, v3
    v_mul_f32 v49, v49, v3
    v_mul_f32 v50, v50, v3
    v_mul_f32 v51, v51, v3
    v_cvt_pk_bf16_f32 v52, v44, v45
    v_cvt_pk_bf16_f32 v53, v46, v47
    v_cvt_pk_bf16_f32 v54, v48, v49
    v_cvt_pk_bf16_f32 v55, v50, v51
    s_add_u32 s5, s36, 2048
    buffer_store_dwordx4 v[52:55], v205, s[8:11], s5 offen offset:256 sc1
    v_accvgpr_read_b32 v56, a48
    v_accvgpr_read_b32 v57, a49
    v_accvgpr_read_b32 v58, a50
    v_accvgpr_read_b32 v59, a51
    v_accvgpr_read_b32 v60, a52
    v_accvgpr_read_b32 v61, a53
    v_accvgpr_read_b32 v62, a54
    v_accvgpr_read_b32 v63, a55
    v_mul_f32 v56, v56, v3
    v_mul_f32 v57, v57, v3
    v_mul_f32 v58, v58, v3
    v_mul_f32 v59, v59, v3
    v_mul_f32 v60, v60, v3
    v_mul_f32 v61, v61, v3
    v_mul_f32 v62, v62, v3
    v_mul_f32 v63, v63, v3
    v_cvt_pk_bf16_f32 v64, v56, v57
    v_cvt_pk_bf16_f32 v65, v58, v59
    v_cvt_pk_bf16_f32 v66, v60, v61
    v_cvt_pk_bf16_f32 v67, v62, v63
    s_add_u32 s5, s36, 4096
    buffer_store_dwordx4 v[64:67], v205, s[8:11], s5 offen offset:256 sc1
    v_accvgpr_read_b32 v68, a56
    v_accvgpr_read_b32 v69, a57
    v_accvgpr_read_b32 v70, a58
    v_accvgpr_read_b32 v71, a59
    v_accvgpr_read_b32 v72, a60
    v_accvgpr_read_b32 v73, a61
    v_accvgpr_read_b32 v74, a62
    v_accvgpr_read_b32 v75, a63
    v_mul_f32 v68, v68, v3
    v_mul_f32 v69, v69, v3
    v_mul_f32 v70, v70, v3
    v_mul_f32 v71, v71, v3
    v_mul_f32 v72, v72, v3
    v_mul_f32 v73, v73, v3
    v_mul_f32 v74, v74, v3
    v_mul_f32 v75, v75, v3
    v_cvt_pk_bf16_f32 v76, v68, v69
    v_cvt_pk_bf16_f32 v77, v70, v71
    v_cvt_pk_bf16_f32 v78, v72, v73
    v_cvt_pk_bf16_f32 v79, v74, v75
    s_add_u32 s5, s36, 6144
    buffer_store_dwordx4 v[76:79], v205, s[8:11], s5 offen offset:256 sc1
    s_waitcnt vmcnt(0) lgkmcnt(0)
    s_barrier
    buffer_atomic_add v24, v23, s[8:11], s40 offen sc1
    s_add_u32 s60, s60, 4
    s_cmp_lt_u32 s60, 64
    s_cbranch_scc1 L_AT
    s_branch L_p2end
L_WO:
    s_lshl_b32 s4, s23, 3
    s_and_b32 s5, s25, 7
    s_add_u32 s30, s4, s5
    s_mov_b32 s80, 0x93555555
    s_mov_b32 s81, 0x24924924
    s_cmp_ge_u32 s25, 16
    s_cselect_b32 s80, 0x2caaaaaa, s80
    s_cselect_b32 s81, 0x49249249, s81
    s_cmp_ge_u32 s25, 24
    s_cselect_b32 s80, 0x40000000, s80
    s_cselect_b32 s81, 0x92492492, s81
    s_cmp_eq_u64 s[80:81], 0
    s_cbranch_scc1 L_p2end
    s_load_dwordx2 s[12:13], s[0:1], 40
    s_mov_b32 s14, 8388608
    s_mov_b32 s15, 0x20000
    v_lshrrev_b32 v1, 2, v0
    v_lshlrev_b32 v1, 11, v1
    v_and_b32 v2, 3, v0
    v_lshlrev_b32 v2, 4, v2
    v_add_u32 v210, v1, v2
    v_lshrrev_b32 v1, 4, v0
    v_lshlrev_b32 v1, 2, v1
    v_bfe_u32 v2, v0, 2, 2
    v_add_u32 v1, v1, v2
    v_lshlrev_b32 v1, 6, v1
    v_and_b32 v2, 3, v0
    v_lshlrev_b32 v2, 3, v2
    v_add_u32 v1, v1, v2
    s_lshl_b32 s4, s3, 14
    v_add_u32 v208, s4, v1
    v_add_u32 v209, 0x10000, v208
    v_and_b32 v1, 15, v0
    v_lshlrev_b32 v1, 11, v1
    v_lshrrev_b32 v2, 4, v0
    v_lshlrev_b32 v2, 3, v2
    v_add_u32 v211, v1, v2
    v_lshlrev_b32 v1, 4, v0
    s_lshl_b32 s4, s3, 13
    v_add_u32 v212, s4, v1
    s_lshl_b32 s4, s3, 10
    v_add_u32 v213, s4, v1
    v_mov_b32 v204, v213
    s_and_b32 s5, s30, 1
    s_lshl_b32 s5, s5, 2
    s_add_u32 s5, s5, s3
    s_lshl_b32 s38, s5, 20
    s_lshl_b32 s41, s3, 14
    v_mov_b32 v160, -1
    v_mov_b32 v161, -1
    v_mov_b32 v162, -1
    v_mov_b32 v163, -1
    s_mov_b64 s[6:7], s[80:81]
L_e3arm:
    s_ff1_i32_b64 s4, s[6:7]
    s_bitset0_b64 s[6:7], s4
    s_lshl_b32 s4, s4, 17
    s_lshl_b32 s5, s30, 12
    s_add_u32 s4, s4, s5
    s_add_u32 s4, s4, 117440512
    buffer_store_dwordx4 v[160:163], v204, s[8:11], s4 offen
    s_cmp_lg_u64 s[6:7], 0
    s_cbranch_scc1 L_e3arm
    s_waitcnt lgkmcnt(0)
    s_xor_b32 s4, s30, 0
    s_lshl_b32 s4, s4, 6
    s_add_u32 s17, s38, s4
    s_add_u32 s17, s17, 0
    s_add_u32 m0, s41, 0
    s_nop 0
    buffer_load_dwordx4 v210, s[12:15], s17 offen lds
    s_add_u32 s17, s17, 32768
    s_add_u32 m0, s41, 1024
    s_nop 0
    buffer_load_dwordx4 v210, s[12:15], s17 offen lds
    s_add_u32 s17, s17, 32768
    s_add_u32 m0, s41, 2048
    s_nop 0
    buffer_load_dwordx4 v210, s[12:15], s17 offen lds
    s_add_u32 s17, s17, 32768
    s_add_u32 m0, s41, 3072
    s_nop 0
    buffer_load_dwordx4 v210, s[12:15], s17 offen lds
    s_add_u32 s17, s17, 32768
    s_add_u32 m0, s41, 4096
    s_nop 0
    buffer_load_dwordx4 v210, s[12:15], s17 offen lds
    s_add_u32 s17, s17, 32768
    s_add_u32 m0, s41, 5120
    s_nop 0
    buffer_load_dwordx4 v210, s[12:15], s17 offen lds
    s_add_u32 s17, s17, 32768
    s_add_u32 m0, s41, 6144
    s_nop 0
    buffer_load_dwordx4 v210, s[12:15], s17 offen lds
    s_add_u32 s17, s17, 32768
    s_add_u32 m0, s41, 7168
    s_nop 0
    buffer_load_dwordx4 v210, s[12:15], s17 offen lds
    s_add_u32 s17, s17, 32768
    s_add_u32 m0, s41, 8192
    s_nop 0
    buffer_load_dwordx4 v210, s[12:15], s17 offen lds
    s_add_u32 s17, s17, 32768
    s_add_u32 m0, s41, 9216
    s_nop 0
    buffer_load_dwordx4 v210, s[12:15], s17 offen lds
    s_add_u32 s17, s17, 32768
    s_add_u32 m0, s41, 10240
    s_nop 0
    buffer_load_dwordx4 v210, s[12:15], s17 offen lds
    s_add_u32 s17, s17, 32768
    s_add_u32 m0, s41, 11264
    s_nop 0
    buffer_load_dwordx4 v210, s[12:15], s17 offen lds
    s_add_u32 s17, s17, 32768
    s_add_u32 m0, s41, 12288
    s_nop 0
    buffer_load_dwordx4 v210, s[12:15], s17 offen lds
    s_add_u32 s17, s17, 32768
    s_add_u32 m0, s41, 13312
    s_nop 0
    buffer_load_dwordx4 v210, s[12:15], s17 offen lds
    s_add_u32 s17, s17, 32768
    s_add_u32 m0, s41, 14336
    s_nop 0
    buffer_load_dwordx4 v210, s[12:15], s17 offen lds
    s_add_u32 s17, s17, 32768
    s_add_u32 m0, s41, 15360
    s_nop 0
    buffer_load_dwordx4 v210, s[12:15], s17 offen lds
    s_add_u32 s17, s17, 32768
    s_xor_b32 s4, s30, 0
    s_lshl_b32 s4, s4, 6
    s_add_u32 s17, s38, s4
    s_add_u32 s17, s17, 524288
    s_add_u32 m0, s41, 65536
    s_nop 0
    buffer_load_dwordx4 v210, s[12:15], s17 offen lds
    s_add_u32 s17, s17, 32768
    s_add_u32 m0, s41, 66560
    s_nop 0
    buffer_load_dwordx4 v210, s[12:15], s17 offen lds
    s_add_u32 s17, s17, 32768
    s_add_u32 m0, s41, 67584
    s_nop 0
    buffer_load_dwordx4 v210, s[12:15], s17 offen lds
    s_add_u32 s17, s17, 32768
    s_add_u32 m0, s41, 68608
    s_nop 0
    buffer_load_dwordx4 v210, s[12:15], s17 offen lds
    s_add_u32 s17, s17, 32768
    s_add_u32 m0, s41, 69632
    s_nop 0
    buffer_load_dwordx4 v210, s[12:15], s17 offen lds
    s_add_u32 s17, s17, 32768
    s_add_u32 m0, s41, 70656
    s_nop 0
    buffer_load_dwordx4 v210, s[12:15], s17 offen lds
    s_add_u32 s17, s17, 32768
    s_add_u32 m0, s41, 71680
    s_nop 0
    buffer_load_dwordx4 v210, s[12:15], s17 offen lds
    s_add_u32 s17, s17, 32768
    s_add_u32 m0, s41, 72704
    s_nop 0
    buffer_load_dwordx4 v210, s[12:15], s17 offen lds
    s_add_u32 s17, s17, 32768
    s_add_u32 m0, s41, 73728
    s_nop 0
    buffer_load_dwordx4 v210, s[12:15], s17 offen lds
    s_add_u32 s17, s17, 32768
    s_add_u32 m0, s41, 74752
    s_nop 0
    buffer_load_dwordx4 v210, s[12:15], s17 offen lds
    s_add_u32 s17, s17, 32768
    s_add_u32 m0, s41, 75776
    s_nop 0
    buffer_load_dwordx4 v210, s[12:15], s17 offen lds
    s_add_u32 s17, s17, 32768
    s_add_u32 m0, s41, 76800
    s_nop 0
    buffer_load_dwordx4 v210, s[12:15], s17 offen lds
    s_add_u32 s17, s17, 32768
    s_add_u32 m0, s41, 77824
    s_nop 0
    buffer_load_dwordx4 v210, s[12:15], s17 offen lds
    s_add_u32 s17, s17, 32768
    s_add_u32 m0, s41, 78848
    s_nop 0
    buffer_load_dwordx4 v210, s[12:15], s17 offen lds
    s_add_u32 s17, s17, 32768
    s_add_u32 m0, s41, 79872
    s_nop 0
    buffer_load_dwordx4 v210, s[12:15], s17 offen lds
    s_add_u32 s17, s17, 32768
    s_add_u32 m0, s41, 80896
    s_nop 0
    buffer_load_dwordx4 v210, s[12:15], s17 offen lds
    s_add_u32 s17, s17, 32768
    s_waitcnt vmcnt(16)
    ds_read_b64_tr_b16 a[0:1], v208 offset:0
    ds_read_b64_tr_b16 a[2:3], v208 offset:1024
    ds_read_b64_tr_b16 a[4:5], v208 offset:32
    ds_read_b64_tr_b16 a[6:7], v208 offset:1056
    ds_read_b64_tr_b16 a[16:17], v208 offset:2048
    ds_read_b64_tr_b16 a[18:19], v208 offset:3072
    ds_read_b64_tr_b16 a[20:21], v208 offset:2080
    ds_read_b64_tr_b16 a[22:23], v208 offset:3104
    s_waitcnt lgkmcnt(4)
    ds_read_b64_tr_b16 a[32:33], v208 offset:4096
    ds_read_b64_tr_b16 a[34:35], v208 offset:5120
    ds_read_b64_tr_b16 a[36:37], v208 offset:4128
    ds_read_b64_tr_b16 a[38:39], v208 offset:5152
    ds_read_b64_tr_b16 a[48:49], v208 offset:6144
    ds_read_b64_tr_b16 a[50:51], v208 offset:7168
    ds_read_b64_tr_b16 a[52:53], v208 offset:6176
    ds_read_b64_tr_b16 a[54:55], v208 offset:7200
    s_waitcnt lgkmcnt(4)
    ds_read_b64_tr_b16 a[64:65], v208 offset:8192
    ds_read_b64_tr_b16 a[66:67], v208 offset:9216
    ds_read_b64_tr_b16 a[68:69], v208 offset:8224
    ds_read_b64_tr_b16 a[70:71], v208 offset:9248
    ds_read_b64_tr_b16 a[80:81], v208 offset:10240
    ds_read_b64_tr_b16 a[82:83], v208 offset:11264
    ds_read_b64_tr_b16 a[84:85], v208 offset:10272
    ds_read_b64_tr_b16 a[86:87], v208 offset:11296
    s_waitcnt lgkmcnt(4)
    ds_read_b64_tr_b16 a[96:97], v208 offset:12288
    ds_read_b64_tr_b16 a[98:99], v208 offset:13312
    ds_read_b64_tr_b16 a[100:101], v208 offset:12320
    ds_read_b64_tr_b16 a[102:103], v208 offset:13344
    ds_read_b64_tr_b16 a[112:113], v208 offset:14336
    ds_read_b64_tr_b16 a[114:115], v208 offset:15360
    ds_read_b64_tr_b16 a[116:117], v208 offset:14368
    ds_read_b64_tr_b16 a[118:119], v208 offset:15392
    s_waitcnt lgkmcnt(4)
    s_waitcnt lgkmcnt(0)
    s_xor_b32 s4, s30, 1
    s_lshl_b32 s4, s4, 6
    s_add_u32 s17, s38, s4
    s_add_u32 s17, s17, 0
    s_add_u32 m0, s41, 0
    s_nop 0
    buffer_load_dwordx4 v210, s[12:15], s17 offen lds
    s_add_u32 s17, s17, 32768
    s_add_u32 m0, s41, 1024
    s_nop 0
    buffer_load_dwordx4 v210, s[12:15], s17 offen lds
    s_add_u32 s17, s17, 32768
    s_add_u32 m0, s41, 2048
    s_nop 0
    buffer_load_dwordx4 v210, s[12:15], s17 offen lds
    s_add_u32 s17, s17, 32768
    s_add_u32 m0, s41, 3072
    s_nop 0
    buffer_load_dwordx4 v210, s[12:15], s17 offen lds
    s_add_u32 s17, s17, 32768
    s_add_u32 m0, s41, 4096
    s_nop 0
    buffer_load_dwordx4 v210, s[12:15], s17 offen lds
    s_add_u32 s17, s17, 32768
    s_add_u32 m0, s41, 5120
    s_nop 0
    buffer_load_dwordx4 v210, s[12:15], s17 offen lds
    s_add_u32 s17, s17, 32768
    s_add_u32 m0, s41, 6144
    s_nop 0
    buffer_load_dwordx4 v210, s[12:15], s17 offen lds
    s_add_u32 s17, s17, 32768
    s_add_u32 m0, s41, 7168
    s_nop 0
    buffer_load_dwordx4 v210, s[12:15], s17 offen lds
    s_add_u32 s17, s17, 32768
    s_add_u32 m0, s41, 8192
    s_nop 0
    buffer_load_dwordx4 v210, s[12:15], s17 offen lds
    s_add_u32 s17, s17, 32768
    s_add_u32 m0, s41, 9216
    s_nop 0
    buffer_load_dwordx4 v210, s[12:15], s17 offen lds
    s_add_u32 s17, s17, 32768
    s_add_u32 m0, s41, 10240
    s_nop 0
    buffer_load_dwordx4 v210, s[12:15], s17 offen lds
    s_add_u32 s17, s17, 32768
    s_add_u32 m0, s41, 11264
    s_nop 0
    buffer_load_dwordx4 v210, s[12:15], s17 offen lds
    s_add_u32 s17, s17, 32768
    s_add_u32 m0, s41, 12288
    s_nop 0
    buffer_load_dwordx4 v210, s[12:15], s17 offen lds
    s_add_u32 s17, s17, 32768
    s_add_u32 m0, s41, 13312
    s_nop 0
    buffer_load_dwordx4 v210, s[12:15], s17 offen lds
    s_add_u32 s17, s17, 32768
    s_add_u32 m0, s41, 14336
    s_nop 0
    buffer_load_dwordx4 v210, s[12:15], s17 offen lds
    s_add_u32 s17, s17, 32768
    s_add_u32 m0, s41, 15360
    s_nop 0
    buffer_load_dwordx4 v210, s[12:15], s17 offen lds
    s_add_u32 s17, s17, 32768
    s_waitcnt vmcnt(16)
    ds_read_b64_tr_b16 a[128:129], v209 offset:0
    ds_read_b64_tr_b16 a[130:131], v209 offset:1024
    ds_read_b64_tr_b16 a[132:133], v209 offset:32
    ds_read_b64_tr_b16 a[134:135], v209 offset:1056
    ds_read_b64_tr_b16 a[144:145], v209 offset:2048
    ds_read_b64_tr_b16 a[146:147], v209 offset:3072
    ds_read_b64_tr_b16 a[148:149], v209 offset:2080
    ds_read_b64_tr_b16 a[150:151], v209 offset:3104
    s_waitcnt lgkmcnt(4)
    ds_read_b64_tr_b16 a[160:161], v209 offset:4096
    ds_read_b64_tr_b16 a[162:163], v209 offset:5120
    ds_read_b64_tr_b16 a[164:165], v209 offset:4128
    ds_read_b64_tr_b16 a[166:167], v209 offset:5152
    ds_read_b64_tr_b16 a[176:177], v209 offset:6144
    ds_read_b64_tr_b16 a[178:179], v209 offset:7168
    ds_read_b64_tr_b16 a[180:181], v209 offset:6176
    ds_read_b64_tr_b16 a[182:183], v209 offset:7200
    s_waitcnt lgkmcnt(4)
    ds_read_b64_tr_b16 a[192:193], v209 offset:8192
    ds_read_b64_tr_b16 a[194:195], v209 offset:9216
    ds_read_b64_tr_b16 a[196:197], v209 offset:8224
    ds_read_b64_tr_b16 a[198:199], v209 offset:9248
    ds_read_b64_tr_b16 a[208:209], v209 offset:10240
    ds_read_b64_tr_b16 a[210:211], v209 offset:11264
    ds_read_b64_tr_b16 a[212:213], v209 offset:10272
    ds_read_b64_tr_b16 a[214:215], v209 offset:11296
    s_waitcnt lgkmcnt(4)
    ds_read_b64_tr_b16 a[224:225], v209 offset:12288
    ds_read_b64_tr_b16 a[226:227], v209 offset:13312
    ds_read_b64_tr_b16 a[228:229], v209 offset:12320
    ds_read_b64_tr_b16 a[230:231], v209 offset:13344
    ds_read_b64_tr_b16 a[240:241], v209 offset:14336
    ds_read_b64_tr_b16 a[242:243], v209 offset:15360
    ds_read_b64_tr_b16 a[244:245], v209 offset:14368
    ds_read_b64_tr_b16 a[246:247], v209 offset:15392
    s_waitcnt lgkmcnt(4)
    s_waitcnt lgkmcnt(0)
    s_xor_b32 s4, s30, 1
    s_lshl_b32 s4, s4, 6
    s_add_u32 s17, s38, s4
    s_add_u32 s17, s17, 524288
    s_add_u32 m0, s41, 65536
    s_nop 0
    buffer_load_dwordx4 v210, s[12:15], s17 offen lds
    s_add_u32 s17, s17, 32768
    s_add_u32 m0, s41, 66560
    s_nop 0
    buffer_load_dwordx4 v210, s[12:15], s17 offen lds
    s_add_u32 s17, s17, 32768
    s_add_u32 m0, s41, 67584
    s_nop 0
    buffer_load_dwordx4 v210, s[12:15], s17 offen lds
    s_add_u32 s17, s17, 32768
    s_add_u32 m0, s41, 68608
    s_nop 0
    buffer_load_dwordx4 v210, s[12:15], s17 offen lds
    s_add_u32 s17, s17, 32768
    s_add_u32 m0, s41, 69632
    s_nop 0
    buffer_load_dwordx4 v210, s[12:15], s17 offen lds
    s_add_u32 s17, s17, 32768
    s_add_u32 m0, s41, 70656
    s_nop 0
    buffer_load_dwordx4 v210, s[12:15], s17 offen lds
    s_add_u32 s17, s17, 32768
    s_add_u32 m0, s41, 71680
    s_nop 0
    buffer_load_dwordx4 v210, s[12:15], s17 offen lds
    s_add_u32 s17, s17, 32768
    s_add_u32 m0, s41, 72704
    s_nop 0
    buffer_load_dwordx4 v210, s[12:15], s17 offen lds
    s_add_u32 s17, s17, 32768
    s_add_u32 m0, s41, 73728
    s_nop 0
    buffer_load_dwordx4 v210, s[12:15], s17 offen lds
    s_add_u32 s17, s17, 32768
    s_add_u32 m0, s41, 74752
    s_nop 0
    buffer_load_dwordx4 v210, s[12:15], s17 offen lds
    s_add_u32 s17, s17, 32768
    s_add_u32 m0, s41, 75776
    s_nop 0
    buffer_load_dwordx4 v210, s[12:15], s17 offen lds
    s_add_u32 s17, s17, 32768
    s_add_u32 m0, s41, 76800
    s_nop 0
    buffer_load_dwordx4 v210, s[12:15], s17 offen lds
    s_add_u32 s17, s17, 32768
    s_add_u32 m0, s41, 77824
    s_nop 0
    buffer_load_dwordx4 v210, s[12:15], s17 offen lds
    s_add_u32 s17, s17, 32768
    s_add_u32 m0, s41, 78848
    s_nop 0
    buffer_load_dwordx4 v210, s[12:15], s17 offen lds
    s_add_u32 s17, s17, 32768
    s_add_u32 m0, s41, 79872
    s_nop 0
    buffer_load_dwordx4 v210, s[12:15], s17 offen lds
    s_add_u32 s17, s17, 32768
    s_add_u32 m0, s41, 80896
    s_nop 0
    buffer_load_dwordx4 v210, s[12:15], s17 offen lds
    s_add_u32 s17, s17, 32768
    s_waitcnt vmcnt(16)
    ds_read_b64_tr_b16 a[8:9], v208 offset:0
    ds_read_b64_tr_b16 a[10:11], v208 offset:1024
    ds_read_b64_tr_b16 a[12:13], v208 offset:32
    ds_read_b64_tr_b16 a[14:15], v208 offset:1056
    ds_read_b64_tr_b16 a[24:25], v208 offset:2048
    ds_read_b64_tr_b16 a[26:27], v208 offset:3072
    ds_read_b64_tr_b16 a[28:29], v208 offset:2080
    ds_read_b64_tr_b16 a[30:31], v208 offset:3104
    s_waitcnt lgkmcnt(4)
    ds_read_b64_tr_b16 a[40:41], v208 offset:4096
    ds_read_b64_tr_b16 a[42:43], v208 offset:5120
    ds_read_b64_tr_b16 a[44:45], v208 offset:4128
    ds_read_b64_tr_b16 a[46:47], v208 offset:5152
    ds_read_b64_tr_b16 a[56:57], v208 offset:6144
    ds_read_b64_tr_b16 a[58:59], v208 offset:7168
    ds_read_b64_tr_b16 a[60:61], v208 offset:6176
    ds_read_b64_tr_b16 a[62:63], v208 offset:7200
    s_waitcnt lgkmcnt(4)
    ds_read_b64_tr_b16 a[72:73], v208 offset:8192
    ds_read_b64_tr_b16 a[74:75], v208 offset:9216
    ds_read_b64_tr_b16 a[76:77], v208 offset:8224
    ds_read_b64_tr_b16 a[78:79], v208 offset:9248
    ds_read_b64_tr_b16 a[88:89], v208 offset:10240
    ds_read_b64_tr_b16 a[90:91], v208 offset:11264
    ds_read_b64_tr_b16 a[92:93], v208 offset:10272
    ds_read_b64_tr_b16 a[94:95], v208 offset:11296
    s_waitcnt lgkmcnt(4)
    ds_read_b64_tr_b16 a[104:105], v208 offset:12288
    ds_read_b64_tr_b16 a[106:107], v208 offset:13312
    ds_read_b64_tr_b16 a[108:109], v208 offset:12320
    ds_read_b64_tr_b16 a[110:111], v208 offset:13344
    ds_read_b64_tr_b16 a[120:121], v208 offset:14336
    ds_read_b64_tr_b16 a[122:123], v208 offset:15360
    ds_read_b64_tr_b16 a[124:125], v208 offset:14368
    ds_read_b64_tr_b16 a[126:127], v208 offset:15392
    s_waitcnt lgkmcnt(4)
    s_waitcnt lgkmcnt(0)
    s_waitcnt vmcnt(0)
    ds_read_b64_tr_b16 a[136:137], v209 offset:0
    ds_read_b64_tr_b16 a[138:139], v209 offset:1024
    ds_read_b64_tr_b16 a[140:141], v209 offset:32
    ds_read_b64_tr_b16 a[142:143], v209 offset:1056
    ds_read_b64_tr_b16 a[152:153], v209 offset:2048
    ds_read_b64_tr_b16 a[154:155], v209 offset:3072
    ds_read_b64_tr_b16 a[156:157], v209 offset:2080
    ds_read_b64_tr_b16 a[158:159], v209 offset:3104
    s_waitcnt lgkmcnt(4)
    ds_read_b64_tr_b16 a[168:169], v209 offset:4096
    ds_read_b64_tr_b16 a[170:171], v209 offset:5120
    ds_read_b64_tr_b16 a[172:173], v209 offset:4128
    ds_read_b64_tr_b16 a[174:175], v209 offset:5152
    ds_read_b64_tr_b16 a[184:185], v209 offset:6144
    ds_read_b64_tr_b16 a[186:187], v209 offset:7168
    ds_read_b64_tr_b16 a[188:189], v209 offset:6176
    ds_read_b64_tr_b16 a[190:191], v209 offset:7200
    s_waitcnt lgkmcnt(4)
    ds_read_b64_tr_b16 a[200:201], v209 offset:8192
    ds_read_b64_tr_b16 a[202:203], v209 offset:9216
    ds_read_b64_tr_b16 a[204:205], v209 offset:8224
    ds_read_b64_tr_b16 a[206:207], v209 offset:9248
    ds_read_b64_tr_b16 a[216:217], v209 offset:10240
    ds_read_b64_tr_b16 a[218:219], v209 offset:11264
    ds_read_b64_tr_b16 a[220:221], v209 offset:10272
    ds_read_b64_tr_b16 a[222:223], v209 offset:11296
    s_waitcnt lgkmcnt(4)
    ds_read_b64_tr_b16 a[232:233], v209 offset:12288
    ds_read_b64_tr_b16 a[234:235], v209 offset:13312
    ds_read_b64_tr_b16 a[236:237], v209 offset:12320
    ds_read_b64_tr_b16 a[238:239], v209 offset:13344
    ds_read_b64_tr_b16 a[248:249], v209 offset:14336
    ds_read_b64_tr_b16 a[250:251], v209 offset:15360
    ds_read_b64_tr_b16 a[252:253], v209 offset:14368
    ds_read_b64_tr_b16 a[254:255], v209 offset:15392
    s_waitcnt lgkmcnt(4)
    s_waitcnt lgkmcnt(0)
    s_barrier
    s_lshr_b32 s4, s25, 1
    s_lshl_b32 s5, s23, 4
    s_add_u32 s4, s4, s5
    s_lshl_b32 s4, s4, 8
    s_add_u32 s40, s4, 102793216
    buffer_atomic_add v24, v23, s[8:11], s40 offen sc1
    s_load_dwordx2 s[12:13], s[0:1], 0
    s_mov_b32 s14, 4194304
    s_mov_b32 s15, 0x20000
    s_load_dwordx2 s[44:45], s[0:1], 88
    s_mov_b32 s46, 4194304
    s_mov_b32 s47, 0x20000
    s_mov_b32 s48, s8
    s_mov_b32 s49, s9
    s_mov_b32 s51, 0x20000
    s_waitcnt lgkmcnt(0)
    s_cmp_lg_u32 s3, 0
    s_cbranch_scc1 Lwwo_205
    v_mov_b32 v1, s40
Lww_204:
    buffer_load_dword v2, v1, s[8:11], 0 offen sc1
    s_waitcnt vmcnt(0)
    v_cmp_le_u32 vcc, 2, v2
    s_cbranch_vccnz Lwwo_205
    s_sleep 2
    s_sub_u32 s22, s22, 1
    s_cbranch_scc0 Lww_204
    s_branch L_abort
Lwwo_205:
    s_barrier
    v_mov_b32 v215, 8
    s_mov_b32 s4, 4
    v_writelane_b32 v215, s4, 1
    s_ff1_i32_b64 s31, s[80:81]
    s_bitset0_b64 s[80:81], s31
    s_mov_b32 s37, -1
L_e3cold:
    s_cmp_ge_u32 s31, 61
    s_cbranch_scc1 L_e3data
    s_lshl_b32 s4, s31, 8
    s_add_u32 s4, s4, 102776832
    v_mov_b32 v214, s4
    s_lshr_b32 s5, s31, 3
    s_lshl_b32 s5, s5, 8
    s_add_u32 s5, s5, 102766592
    v_writelane_b32 v214, s5, 1
Le3p_206:
    buffer_load_dword v216, v214, s[8:11], 0 offen sc1
    s_waitcnt vmcnt(0)
    v_cmp_ge_u32 vcc, v216, v215
    s_cmp_eq_u64 vcc, -1
    s_cbranch_scc1 Le3o_207
    s_sleep 4
    s_sub_u32 s22, s22, 1
    s_cbranch_scc0 Le3p_206
    s_branch L_abort
Le3o_207:
    s_lshl_b32 s4, s31, 18
    s_and_b32 s5, s30, 1
    s_lshl_b32 s5, s5, 2
    s_add_u32 s5, s5, s3
    s_lshl_b32 s5, s5, 15
    s_add_u32 s4, s4, s5
    s_add_u32 s16, s4, 71303168
    buffer_load_dwordx4 v[32:35], v205, s[8:11], s16 offen offset:0 sc1
    buffer_load_dwordx4 v[36:39], v205, s[8:11], s16 offen offset:256 sc1
    s_add_u32 s16, s16, 2048
    buffer_load_dwordx4 v[40:43], v205, s[8:11], s16 offen offset:0 sc1
    buffer_load_dwordx4 v[44:47], v205, s[8:11], s16 offen offset:256 sc1
    s_add_u32 s16, s16, 2048
    buffer_load_dwordx4 v[48:51], v205, s[8:11], s16 offen offset:0 sc1
    buffer_load_dwordx4 v[52:55], v205, s[8:11], s16 offen offset:256 sc1
    s_add_u32 s16, s16, 2048
    buffer_load_dwordx4 v[56:59], v205, s[8:11], s16 offen offset:0 sc1
    buffer_load_dwordx4 v[60:63], v205, s[8:11], s16 offen offset:256 sc1
    s_add_u32 s16, s16, 2048
    buffer_load_dwordx4 v[64:67], v205, s[8:11], s16 offen offset:0 sc1
    buffer_load_dwordx4 v[68:71], v205, s[8:11], s16 offen offset:256 sc1
    s_add_u32 s16, s16, 2048
    buffer_load_dwordx4 v[72:75], v205, s[8:11], s16 offen offset:0 sc1
    buffer_load_dwordx4 v[76:79], v205, s[8:11], s16 offen offset:256 sc1
    s_add_u32 s16, s16, 2048
    buffer_load_dwordx4 v[80:83], v205, s[8:11], s16 offen offset:0 sc1
    buffer_load_dwordx4 v[84:87], v205, s[8:11], s16 offen offset:256 sc1
    s_add_u32 s16, s16, 2048
    buffer_load_dwordx4 v[88:91], v205, s[8:11], s16 offen offset:0 sc1
    buffer_load_dwordx4 v[92:95], v205, s[8:11], s16 offen offset:256 sc1
    s_add_u32 s16, s16, 2048
    buffer_store_dword v24, v26, s[8:11], 0 offen
    buffer_store_dword v24, v26, s[8:11], 0 offen
L_e3top:
    s_cmp_lt_i32 s37, 0
    s_cselect_b32 s38, s31, s37
    s_lshl_b32 s4, s38, 16
    s_lshr_b32 s5, s3, 1
    s_lshl_b32 s6, s5, 15
    s_add_u32 s4, s4, s6
    s_lshl_b32 s6, s30, 6
    s_add_u32 s4, s4, s6
    s_and_b32 s7, s3, 1
    s_lshl_b32 s6, s7, 5
    s_add_u32 s33, s4, s6
    s_lshr_b32 s4, s38, 3
    s_lshl_b32 s4, s4, 19
    s_lshl_b32 s6, s30, 14
    s_add_u32 s4, s4, s6
    s_and_b32 s6, s38, 7
    s_lshl_b32 s6, s6, 9
    s_add_u32 s4, s4, s6
    s_lshl_b32 s6, s5, 8
    s_add_u32 s4, s4, s6
    s_lshl_b32 s6, s7, 3
    s_add_u32 s4, s4, s6
    s_add_u32 s34, s4, 104857600
    s_lshl_b32 s4, s38, 17
    s_xor_b32 s5, s30, 1
    s_lshl_b32 s5, s5, 12
    s_add_u32 s4, s4, s5
    s_add_u32 s39, s4, 117440512
    s_lshl_b32 s4, s31, 17
    s_lshl_b32 s5, s30, 12
    s_add_u32 s4, s4, s5
    s_add_u32 s29, s4, 117440512
    s_ff1_i32_b64 s32, s[80:81]
    s_max_i32 s7, s32, 0
    s_mov_b32 s38, s7
    s_lshl_b32 s4, s38, 8
    s_add_u32 s4, s4, 102776832
    v_mov_b32 v214, s4
    s_lshr_b32 s5, s38, 3
    s_lshl_b32 s5, s5, 8
    s_add_u32 s5, s5, 102766592
    v_writelane_b32 v214, s5, 1
    buffer_load_dwordx2 v[192:193], v211, s[12:15], s33 offen
    buffer_load_dwordx2 v[194:195], v228, s[8:11], s34 offen sc1
    buffer_load_dword v216, v214, s[8:11], 0 offen sc1
    s_lshl_b32 s4, s38, 18
    s_and_b32 s5, s30, 1
    s_lshl_b32 s5, s5, 2
    s_add_u32 s5, s5, s3
    s_lshl_b32 s5, s5, 15
    s_add_u32 s4, s4, s5
    s_add_u32 s35, s4, 71303168
    s_waitcnt vmcnt(19)
    v_mfma_f32_16x16x32_bf16 v[160:163], a[0:3], v[32:35], 0
    v_mfma_f32_16x16x32_bf16 v[168:171], a[0:3], v[36:39], 0
    v_mfma_f32_16x16x32_bf16 v[164:167], a[4:7], v[32:35], 0
    v_mfma_f32_16x16x32_bf16 v[172:175], a[4:7], v[36:39], 0
    v_mfma_f32_16x16x32_bf16 v[176:179], a[8:11], v[32:35], 0
    v_mfma_f32_16x16x32_bf16 v[184:187], a[8:11], v[36:39], 0
    v_mfma_f32_16x16x32_bf16 v[180:183], a[12:15], v[32:35], 0
    v_mfma_f32_16x16x32_bf16 v[188:191], a[12:15], v[36:39], 0
    buffer_load_dwordx4 v[96:99], v205, s[8:11], s16 offen offset:0 sc1
    buffer_load_dwordx4 v[100:103], v205, s[8:11], s16 offen offset:256 sc1
    s_add_u32 s16, s16, 2048
    s_waitcnt vmcnt(19)
    v_mfma_f32_16x16x32_bf16 v[160:163], a[16:19], v[40:43], v[160:163]
    v_mfma_f32_16x16x32_bf16 v[168:171], a[16:19], v[44:47], v[168:171]
    v_mfma_f32_16x16x32_bf16 v[164:167], a[20:23], v[40:43], v[164:167]
    v_mfma_f32_16x16x32_bf16 v[172:175], a[20:23], v[44:47], v[172:175]
    v_mfma_f32_16x16x32_bf16 v[176:179], a[24:27], v[40:43], v[176:179]
    v_mfma_f32_16x16x32_bf16 v[184:187], a[24:27], v[44:47], v[184:187]
    v_mfma_f32_16x16x32_bf16 v[180:183], a[28:31], v[40:43], v[180:183]
    v_mfma_f32_16x16x32_bf16 v[188:191], a[28:31], v[44:47], v[188:191]
    buffer_load_dwordx4 v[104:107], v205, s[8:11], s16 offen offset:0 sc1
    buffer_load_dwordx4 v[108:111], v205, s[8:11], s16 offen offset:256 sc1
    s_add_u32 s16, s16, 2048
    s_waitcnt vmcnt(19)
    v_mfma_f32_16x16x32_bf16 v[160:163], a[32:35], v[48:51], v[160:163]
    v_mfma_f32_16x16x32_bf16 v[168:171], a[32:35], v[52:55], v[168:171]
    v_mfma_f32_16x16x32_bf16 v[164:167], a[36:39], v[48:51], v[164:167]
    v_mfma_f32_16x16x32_bf16 v[172:175], a[36:39], v[52:55], v[172:175]
    v_mfma_f32_16x16x32_bf16 v[176:179], a[40:43], v[48:51], v[176:179]
    v_mfma_f32_16x16x32_bf16 v[184:187], a[40:43], v[52:55], v[184:187]
    v_mfma_f32_16x16x32_bf16 v[180:183], a[44:47], v[48:51], v[180:183]
    v_mfma_f32_16x16x32_bf16 v[188:191], a[44:47], v[52:55], v[188:191]
    buffer_load_dwordx4 v[112:115], v205, s[8:11], s16 offen offset:0 sc1
    buffer_load_dwordx4 v[116:119], v205, s[8:11], s16 offen offset:256 sc1
    s_add_u32 s16, s16, 2048
    s_waitcnt vmcnt(19)
    v_mfma_f32_16x16x32_bf16 v[160:163], a[48:51], v[56:59], v[160:163]
    v_mfma_f32_16x16x32_bf16 v[168:171], a[48:51], v[60:63], v[168:171]
    v_mfma_f32_16x16x32_bf16 v[164:167], a[52:55], v[56:59], v[164:167]
    v_mfma_f32_16x16x32_bf16 v[172:175], a[52:55], v[60:63], v[172:175]
    v_mfma_f32_16x16x32_bf16 v[176:179], a[56:59], v[56:59], v[176:179]
    v_mfma_f32_16x16x32_bf16 v[184:187], a[56:59], v[60:63], v[184:187]
    v_mfma_f32_16x16x32_bf16 v[180:183], a[60:63], v[56:59], v[180:183]
    v_mfma_f32_16x16x32_bf16 v[188:191], a[60:63], v[60:63], v[188:191]
    buffer_load_dwordx4 v[120:123], v205, s[8:11], s16 offen offset:0 sc1
    buffer_load_dwordx4 v[124:127], v205, s[8:11], s16 offen offset:256 sc1
    s_add_u32 s16, s16, 2048
    s_waitcnt vmcnt(19)
    v_mfma_f32_16x16x32_bf16 v[160:163], a[64:67], v[64:67], v[160:163]
    v_mfma_f32_16x16x32_bf16 v[168:171], a[64:67], v[68:71], v[168:171]
    v_mfma_f32_16x16x32_bf16 v[164:167], a[68:71], v[64:67], v[164:167]
    v_mfma_f32_16x16x32_bf16 v[172:175], a[68:71], v[68:71], v[172:175]
    v_mfma_f32_16x16x32_bf16 v[176:179], a[72:75], v[64:67], v[176:179]
    v_mfma_f32_16x16x32_bf16 v[184:187], a[72:75], v[68:71], v[184:187]
    v_mfma_f32_16x16x32_bf16 v[180:183], a[76:79], v[64:67], v[180:183]
    v_mfma_f32_16x16x32_bf16 v[188:191], a[76:79], v[68:71], v[188:191]
    buffer_load_dwordx4 v[128:131], v205, s[8:11], s16 offen offset:0 sc1
    buffer_load_dwordx4 v[132:135], v205, s[8:11], s16 offen offset:256 sc1
    s_add_u32 s16, s16, 2048
    s_waitcnt vmcnt(19)
    v_mfma_f32_16x16x32_bf16 v[160:163], a[80:83], v[72:75], v[160:163]
    v_mfma_f32_16x16x32_bf16 v[168:171], a[80:83], v[76:79], v[168:171]
    v_mfma_f32_16x16x32_bf16 v[164:167], a[84:87], v[72:75], v[164:167]
    v_mfma_f32_16x16x32_bf16 v[172:175], a[84:87], v[76:79], v[172:175]
    v_mfma_f32_16x16x32_bf16 v[176:179], a[88:91], v[72:75], v[176:179]
    v_mfma_f32_16x16x32_bf16 v[184:187], a[88:91], v[76:79], v[184:187]
    v_mfma_f32_16x16x32_bf16 v[180:183], a[92:95], v[72:75], v[180:183]
    v_mfma_f32_16x16x32_bf16 v[188:191], a[92:95], v[76:79], v[188:191]
    buffer_load_dwordx4 v[136:139], v205, s[8:11], s16 offen offset:0 sc1
    buffer_load_dwordx4 v[140:143], v205, s[8:11], s16 offen offset:256 sc1
    s_add_u32 s16, s16, 2048
    s_waitcnt vmcnt(19)
    v_mfma_f32_16x16x32_bf16 v[160:163], a[96:99], v[80:83], v[160:163]
    v_mfma_f32_16x16x32_bf16 v[168:171], a[96:99], v[84:87], v[168:171]
    v_mfma_f32_16x16x32_bf16 v[164:167], a[100:103], v[80:83], v[164:167]
    v_mfma_f32_16x16x32_bf16 v[172:175], a[100:103], v[84:87], v[172:175]
    v_mfma_f32_16x16x32_bf16 v[176:179], a[104:107], v[80:83], v[176:179]
    v_mfma_f32_16x16x32_bf16 v[184:187], a[104:107], v[84:87], v[184:187]
    v_mfma_f32_16x16x32_bf16 v[180:183], a[108:111], v[80:83], v[180:183]
    v_mfma_f32_16x16x32_bf16 v[188:191], a[108:111], v[84:87], v[188:191]
    buffer_load_dwordx4 v[144:147], v205, s[8:11], s16 offen offset:0 sc1
    buffer_load_dwordx4 v[148:151], v205, s[8:11], s16 offen offset:256 sc1
    s_add_u32 s16, s16, 2048
    s_waitcnt vmcnt(19)
    v_mfma_f32_16x16x32_bf16 v[160:163], a[112:115], v[88:91], v[160:163]
    v_mfma_f32_16x16x32_bf16 v[168:171], a[112:115], v[92:95], v[168:171]
    v_mfma_f32_16x16x32_bf16 v[164:167], a[116:119], v[88:91], v[164:167]
    v_mfma_f32_16x16x32_bf16 v[172:175], a[116:119], v[92:95], v[172:175]
    v_mfma_f32_16x16x32_bf16 v[176:179], a[120:123], v[88:91], v[176:179]
    v_mfma_f32_16x16x32_bf16 v[184:187], a[120:123], v[92:95], v[184:187]
    v_mfma_f32_16x16x32_bf16 v[180:183], a[124:127], v[88:91], v[180:183]
    v_mfma_f32_16x16x32_bf16 v[188:191], a[124:127], v[92:95], v[188:191]
    buffer_load_dwordx4 v[152:155], v205, s[8:11], s16 offen offset:0 sc1
    buffer_load_dwordx4 v[156:159], v205, s[8:11], s16 offen offset:256 sc1
    s_add_u32 s16, s16, 2048
    s_waitcnt vmcnt(14)
    v_cmp_ge_u32 vcc, v216, v215
    s_cmp_eq_u64 vcc, -1
    s_cselect_b32 s36, 1, 0
    s_cmp_lt_i32 s32, 0
    s_cselect_b32 s36, 0, s36
    s_cmp_eq_u32 s36, 1
    s_cselect_b32 s50, 268435456, 0
    buffer_load_dwordx4 v[200:203], v204, s[8:11], s39 offen sc1
    v_mfma_f32_16x16x32_bf16 v[160:163], a[128:131], v[96:99], v[160:163]
    v_mfma_f32_16x16x32_bf16 v[168:171], a[128:131], v[100:103], v[168:171]
    v_mfma_f32_16x16x32_bf16 v[164:167], a[132:135], v[96:99], v[164:167]
    v_mfma_f32_16x16x32_bf16 v[172:175], a[132:135], v[100:103], v[172:175]
    v_mfma_f32_16x16x32_bf16 v[176:179], a[136:139], v[96:99], v[176:179]
    v_mfma_f32_16x16x32_bf16 v[184:187], a[136:139], v[100:103], v[184:187]
    v_mfma_f32_16x16x32_bf16 v[180:183], a[140:143], v[96:99], v[180:183]
    v_mfma_f32_16x16x32_bf16 v[188:191], a[140:143], v[100:103], v[188:191]
    buffer_load_dwordx4 v[32:35], v205, s[48:51], s35 offen offset:0 sc1
    buffer_load_dwordx4 v[36:39], v205, s[48:51], s35 offen offset:256 sc1
    s_add_u32 s35, s35, 2048
    s_waitcnt vmcnt(15)
    v_mfma_f32_16x16x32_bf16 v[160:163], a[144:147], v[104:107], v[160:163]
    v_mfma_f32_16x16x32_bf16 v[168:171], a[144:147], v[108:111], v[168:171]
    v_mfma_f32_16x16x32_bf16 v[164:167], a[148:151], v[104:107], v[164:167]
    v_mfma_f32_16x16x32_bf16 v[172:175], a[148:151], v[108:111], v[172:175]
    v_mfma_f32_16x16x32_bf16 v[176:179], a[152:155], v[104:107], v[176:179]
    v_mfma_f32_16x16x32_bf16 v[184:187], a[152:155], v[108:111], v[184:187]
    v_mfma_f32_16x16x32_bf16 v[180:183], a[156:159], v[104:107], v[180:183]
    v_mfma_f32_16x16x32_bf16 v[188:191], a[156:159], v[108:111], v[188:191]
    buffer_load_dwordx4 v[40:43], v205, s[48:51], s35 offen offset:0 sc1
    buffer_load_dwordx4 v[44:47], v205, s[48:51], s35 offen offset:256 sc1
    s_add_u32 s35, s35, 2048
    s_waitcnt vmcnt(15)
    v_mfma_f32_16x16x32_bf16 v[160:163], a[160:163], v[112:115], v[160:163]
    v_mfma_f32_16x16x32_bf16 v[168:171], a[160:163], v[116:119], v[168:171]
    v_mfma_f32_16x16x32_bf16 v[164:167], a[164:167], v[112:115], v[164:167]
    v_mfma_f32_16x16x32_bf16 v[172:175], a[164:167], v[116:119], v[172:175]
    v_mfma_f32_16x16x32_bf16 v[176:179], a[168:171], v[112:115], v[176:179]
    v_mfma_f32_16x16x32_bf16 v[184:187], a[168:171], v[116:119], v[184:187]
    v_mfma_f32_16x16x32_bf16 v[180:183], a[172:175], v[112:115], v[180:183]
    v_mfma_f32_16x16x32_bf16 v[188:191], a[172:175], v[116:119], v[188:191]
    buffer_load_dwordx4 v[48:51], v205, s[48:51], s35 offen offset:0 sc1
    buffer_load_dwordx4 v[52:55], v205, s[48:51], s35 offen offset:256 sc1
    s_add_u32 s35, s35, 2048
    s_waitcnt vmcnt(15)
    v_mfma_f32_16x16x32_bf16 v[160:163], a[176:179], v[120:123], v[160:163]
    v_mfma_f32_16x16x32_bf16 v[168:171], a[176:179], v[124:127], v[168:171]
    v_mfma_f32_16x16x32_bf16 v[164:167], a[180:183], v[120:123], v[164:167]
    v_mfma_f32_16x16x32_bf16 v[172:175], a[180:183], v[124:127], v[172:175]
    v_mfma_f32_16x16x32_bf16 v[176:179], a[184:187], v[120:123], v[176:179]
    v_mfma_f32_16x16x32_bf16 v[184:187], a[184:187], v[124:127], v[184:187]
    v_mfma_f32_16x16x32_bf16 v[180:183], a[188:191], v[120:123], v[180:183]
    v_mfma_f32_16x16x32_bf16 v[188:191], a[188:191], v[124:127], v[188:191]
    buffer_load_dwordx4 v[56:59], v205, s[48:51], s35 offen offset:0 sc1
    buffer_load_dwordx4 v[60:63], v205, s[48:51], s35 offen offset:256 sc1
    s_add_u32 s35, s35, 2048
    s_waitcnt vmcnt(15)
    v_mfma_f32_16x16x32_bf16 v[160:163], a[192:195], v[128:131], v[160:163]
    v_mfma_f32_16x16x32_bf16 v[168:171], a[192:195], v[132:135], v[168:171]
    v_mfma_f32_16x16x32_bf16 v[164:167], a[196:199], v[128:131], v[164:167]
    v_mfma_f32_16x16x32_bf16 v[172:175], a[196:199], v[132:135], v[172:175]
    v_mfma_f32_16x16x32_bf16 v[176:179], a[200:203], v[128:131], v[176:179]
    v_mfma_f32_16x16x32_bf16 v[184:187], a[200:203], v[132:135], v[184:187]
    v_mfma_f32_16x16x32_bf16 v[180:183], a[204:207], v[128:131], v[180:183]
    v_mfma_f32_16x16x32_bf16 v[188:191], a[204:207], v[132:135], v[188:191]
    buffer_load_dwordx4 v[64:67], v205, s[48:51], s35 offen offset:0 sc1
    buffer_load_dwordx4 v[68:71], v205, s[48:51], s35 offen offset:256 sc1
    s_add_u32 s35, s35, 2048
    s_waitcnt vmcnt(15)
    v_mfma_f32_16x16x32_bf16 v[160:163], a[208:211], v[136:139], v[160:163]
    v_mfma_f32_16x16x32_bf16 v[168:171], a[208:211], v[140:143], v[168:171]
    v_mfma_f32_16x16x32_bf16 v[164:167], a[212:215], v[136:139], v[164:167]
    v_mfma_f32_16x16x32_bf16 v[172:175], a[212:215], v[140:143], v[172:175]
    v_mfma_f32_16x16x32_bf16 v[176:179], a[216:219], v[136:139], v[176:179]
    v_mfma_f32_16x16x32_bf16 v[184:187], a[216:219], v[140:143], v[184:187]
    v_mfma_f32_16x16x32_bf16 v[180:183], a[220:223], v[136:139], v[180:183]
    v_mfma_f32_16x16x32_bf16 v[188:191], a[220:223], v[140:143], v[188:191]
    buffer_load_dwordx4 v[72:75], v205, s[48:51], s35 offen offset:0 sc1
    buffer_load_dwordx4 v[76:79], v205, s[48:51], s35 offen offset:256 sc1
    s_add_u32 s35, s35, 2048
    s_waitcnt vmcnt(15)
    v_mfma_f32_16x16x32_bf16 v[160:163], a[224:227], v[144:147], v[160:163]
    v_mfma_f32_16x16x32_bf16 v[168:171], a[224:227], v[148:151], v[168:171]
    v_mfma_f32_16x16x32_bf16 v[164:167], a[228:231], v[144:147], v[164:167]
    v_mfma_f32_16x16x32_bf16 v[172:175], a[228:231], v[148:151], v[172:175]
    v_mfma_f32_16x16x32_bf16 v[176:179], a[232:235], v[144:147], v[176:179]
    v_mfma_f32_16x16x32_bf16 v[184:187], a[232:235], v[148:151], v[184:187]
    v_mfma_f32_16x16x32_bf16 v[180:183], a[236:239], v[144:147], v[180:183]
    v_mfma_f32_16x16x32_bf16 v[188:191], a[236:239], v[148:151], v[188:191]
    buffer_load_dwordx4 v[80:83], v205, s[48:51], s35 offen offset:0 sc1
    buffer_load_dwordx4 v[84:87], v205, s[48:51], s35 offen offset:256 sc1
    s_add_u32 s35, s35, 2048
    s_waitcnt vmcnt(15)
    v_mfma_f32_16x16x32_bf16 v[160:163], a[240:243], v[152:155], v[160:163]
    v_mfma_f32_16x16x32_bf16 v[168:171], a[240:243], v[156:159], v[168:171]
    v_mfma_f32_16x16x32_bf16 v[164:167], a[244:247], v[152:155], v[164:167]
    v_mfma_f32_16x16x32_bf16 v[172:175], a[244:247], v[156:159], v[172:175]
    v_mfma_f32_16x16x32_bf16 v[176:179], a[248:251], v[152:155], v[176:179]
    v_mfma_f32_16x16x32_bf16 v[184:187], a[248:251], v[156:159], v[184:187]
    v_mfma_f32_16x16x32_bf16 v[180:183], a[252:255], v[152:155], v[180:183]
    v_mfma_f32_16x16x32_bf16 v[188:191], a[252:255], v[156:159], v[188:191]
    buffer_load_dwordx4 v[88:91], v205, s[48:51], s35 offen offset:0 sc1
    buffer_load_dwordx4 v[92:95], v205, s[48:51], s35 offen offset:256 sc1
    s_add_u32 s35, s35, 2048
L_e3red:
    s_nop 7
    ds_write_b128 v212, v[160:163] offset:0
    ds_write_b128 v212, v[164:167] offset:1024
    ds_write_b128 v212, v[168:171] offset:2048
    ds_write_b128 v212, v[172:175] offset:3072
    ds_write_b128 v212, v[176:179] offset:4096
    ds_write_b128 v212, v[180:183] offset:5120
    ds_write_b128 v212, v[184:187] offset:6144
    ds_write_b128 v212, v[188:191] offset:7168
    s_waitcnt lgkmcnt(0)
    s_barrier
    ds_read_b128 v[176:179], v213 offset:4096
    ds_read_b128 v[180:183], v213 offset:12288
    ds_read_b128 v[184:187], v213 offset:20480
    ds_read_b128 v[188:191], v213 offset:28672
    ds_read_b128 v[160:163], v213 offset:0
    ds_read_b128 v[164:167], v213 offset:8192
    ds_read_b128 v[168:171], v213 offset:16384
    ds_read_b128 v[172:175], v213 offset:24576
    v_xor_b32 v212, 32768, v212
    v_xor_b32 v213, 32768, v213
    s_waitcnt lgkmcnt(4)
    v_pk_add_f32 v[176:177], v[176:177], v[180:181]
    v_pk_add_f32 v[178:179], v[178:179], v[182:183]
    v_pk_add_f32 v[184:185], v[184:185], v[188:189]
    v_pk_add_f32 v[186:187], v[186:187], v[190:191]
    v_pk_add_f32 v[176:177], v[176:177], v[184:185]
    v_pk_add_f32 v[178:179], v[178:179], v[186:187]
    buffer_store_dwordx4 v[176:179], v204, s[8:11], s29 offen
    s_cmp_lt_i32 s37, 0
    s_cbranch_scc1 Le3n_208
    s_waitcnt vmcnt(17)
Le3f_210:
    v_max3_u32 v218, v200, v201, v202
    v_max_u32 v218, v218, v203
    v_cmp_eq_u32 vcc, -1, v218
    s_cbranch_vccnz Le3r_211
    v_pk_add_f32 v[200:201], v[200:201], v[196:197]
    v_pk_add_f32 v[202:203], v[202:203], v[198:199]
    v_lshlrev_b32 v218, 16, v192
    v_and_b32 v219, 0xffff0000, v192
    v_lshlrev_b32 v220, 16, v193
    v_and_b32 v221, 0xffff0000, v193
    v_lshlrev_b32 v222, 16, v194
    v_and_b32 v223, 0xffff0000, v194
    v_lshlrev_b32 v224, 16, v195
    v_and_b32 v225, 0xffff0000, v195
    v_fma_f32 v218, v200, v222, v218
    v_fma_f32 v219, v201, v223, v219
    v_fma_f32 v220, v202, v224, v220
    v_fma_f32 v221, v203, v225, v221
    v_cvt_pk_bf16_f32 v226, v218, v219
    v_cvt_pk_bf16_f32 v227, v220, v221
    buffer_store_dwordx2 v[226:227], v211, s[44:47], s33 offen
Le3d_209:
    s_waitcnt lgkmcnt(0)
    v_pk_add_f32 v[160:161], v[160:161], v[164:165]
    v_pk_add_f32 v[162:163], v[162:163], v[166:167]
    v_pk_add_f32 v[168:169], v[168:169], v[172:173]
    v_pk_add_f32 v[170:171], v[170:171], v[174:175]
    v_pk_add_f32 v[196:197], v[160:161], v[168:169]
    v_pk_add_f32 v[198:199], v[162:163], v[170:171]
    s_mov_b32 s37, s31
    s_cmp_lt_i32 s32, 0
    s_cbranch_scc1 L_e3tail
    s_mov_b32 s31, s32
    s_bitset0_b64 s[80:81], s31
    s_cmp_eq_u32 s36, 0
    s_cbranch_scc1 L_e3cold
    s_mov_b32 s16, s35
    s_branch L_e3top
L_e3tail:
    s_lshl_b32 s4, s37, 16
    s_lshr_b32 s5, s3, 1
    s_lshl_b32 s6, s5, 15
    s_add_u32 s4, s4, s6
    s_lshl_b32 s6, s30, 6
    s_add_u32 s4, s4, s6
    s_and_b32 s7, s3, 1
    s_lshl_b32 s6, s7, 5
    s_add_u32 s33, s4, s6
    s_lshr_b32 s4, s37, 3
    s_lshl_b32 s4, s4, 19
    s_lshl_b32 s6, s30, 14
    s_add_u32 s4, s4, s6
    s_and_b32 s6, s37, 7
    s_lshl_b32 s6, s6, 9
    s_add_u32 s4, s4, s6
    s_lshl_b32 s6, s5, 8
    s_add_u32 s4, s4, s6
    s_lshl_b32 s6, s7, 3
    s_add_u32 s4, s4, s6
    s_add_u32 s34, s4, 104857600
    s_lshl_b32 s4, s37, 17
    s_xor_b32 s5, s30, 1
    s_lshl_b32 s5, s5, 12
    s_add_u32 s4, s4, s5
    s_add_u32 s39, s4, 117440512
    buffer_load_dwordx2 v[192:193], v211, s[12:15], s33 offen
    buffer_load_dwordx2 v[194:195], v228, s[8:11], s34 offen sc1
    buffer_load_dwordx4 v[200:203], v204, s[8:11], s39 offen sc1
    s_waitcnt vmcnt(0)
Le3f_212:
    v_max3_u32 v218, v200, v201, v202
    v_max_u32 v218, v218, v203
    v_cmp_eq_u32 vcc, -1, v218
    s_cbranch_vccnz Le3r_213
    v_pk_add_f32 v[200:201], v[200:201], v[196:197]
    v_pk_add_f32 v[202:203], v[202:203], v[198:199]
    v_lshlrev_b32 v218, 16, v192
    v_and_b32 v219, 0xffff0000, v192
    v_lshlrev_b32 v220, 16, v193
    v_and_b32 v221, 0xffff0000, v193
    v_lshlrev_b32 v222, 16, v194
    v_and_b32 v223, 0xffff0000, v194
    v_lshlrev_b32 v224, 16, v195
    v_and_b32 v225, 0xffff0000, v195
    v_fma_f32 v218, v200, v222, v218
    v_fma_f32 v219, v201, v223, v219
    v_fma_f32 v220, v202, v224, v220
    v_fma_f32 v221, v203, v225, v221
    v_cvt_pk_bf16_f32 v226, v218, v219
    v_cvt_pk_bf16_f32 v227, v220, v221
    buffer_store_dwordx2 v[226:227], v211, s[44:47], s33 offen
    s_waitcnt vmcnt(0)
    s_branch L_e3end
L_e3data:
    s_cmp_lt_i32 s37, 0
    s_cbranch_scc1 Le3dn_214
    s_lshl_b32 s4, s37, 16
    s_lshr_b32 s5, s3, 1
    s_lshl_b32 s6, s5, 15
    s_add_u32 s4, s4, s6
    s_lshl_b32 s6, s30, 6
    s_add_u32 s4, s4, s6
    s_and_b32 s7, s3, 1
    s_lshl_b32 s6, s7, 5
    s_add_u32 s33, s4, s6
    s_lshr_b32 s4, s37, 3
    s_lshl_b32 s4, s4, 19
    s_lshl_b32 s6, s30, 14
    s_add_u32 s4, s4, s6
    s_and_b32 s6, s37, 7
    s_lshl_b32 s6, s6, 9
    s_add_u32 s4, s4, s6
    s_lshl_b32 s6, s5, 8
    s_add_u32 s4, s4, s6
    s_lshl_b32 s6, s7, 3
    s_add_u32 s4, s4, s6
    s_add_u32 s34, s4, 104857600
    s_lshl_b32 s4, s37, 17
    s_xor_b32 s5, s30, 1
    s_lshl_b32 s5, s5, 12
    s_add_u32 s4, s4, s5
    s_add_u32 s39, s4, 117440512
    buffer_load_dwordx2 v[192:193], v211, s[12:15], s33 offen
    buffer_load_dwordx2 v[194:195], v228, s[8:11], s34 offen sc1
    buffer_load_dwordx4 v[200:203], v204, s[8:11], s39 offen sc1
    s_waitcnt vmcnt(0)
Le3f_220:
    v_max3_u32 v218, v200, v201, v202
    v_max_u32 v218, v218, v203
    v_cmp_eq_u32 vcc, -1, v218
    s_cbranch_vccnz Le3r_221
    v_pk_add_f32 v[200:201], v[200:201], v[196:197]
    v_pk_add_f32 v[202:203], v[202:203], v[198:199]
    v_lshlrev_b32 v218, 16, v192
    v_and_b32 v219, 0xffff0000, v192
    v_lshlrev_b32 v220, 16, v193
    v_and_b32 v221, 0xffff0000, v193
    v_lshlrev_b32 v222, 16, v194
    v_and_b32 v223, 0xffff0000, v194
    v_lshlrev_b32 v224, 16, v195
    v_and_b32 v225, 0xffff0000, v195
    v_fma_f32 v218, v200, v222, v218
    v_fma_f32 v219, v201, v223, v219
    v_fma_f32 v220, v202, v224, v220
    v_fma_f32 v221, v203, v225, v221
    v_cvt_pk_bf16_f32 v226, v218, v219
    v_cvt_pk_bf16_f32 v227, v220, v221
    buffer_store_dwordx2 v[226:227], v211, s[44:47], s33 offen
    s_mov_b32 s37, -1
Le3dn_214:
    s_sub_u32 s4, s31, 4
    s_lshl_b32 s4, s4, 8
    s_add_u32 s4, s4, 102776832
    v_mov_b32 v214, s4
    s_lshr_b32 s5, s31, 3
    s_lshl_b32 s5, s5, 8
    s_add_u32 s5, s5, 102766592
    v_writelane_b32 v214, s5, 1
Le3dp_215:
    buffer_load_dword v216, v214, s[8:11], 0 offen sc1
    s_waitcnt vmcnt(0)
    v_cmp_ge_u32 vcc, v216, v215
    s_cmp_eq_u64 vcc, -1
    s_cbranch_scc1 Le3do_216
    s_sleep 4
    s_sub_u32 s22, s22, 1
    s_cbranch_scc0 Le3dp_215
    s_branch L_abort
Le3do_216:
    s_lshl_b32 s4, s31, 18
    s_and_b32 s5, s30, 1
    s_lshl_b32 s5, s5, 2
    s_add_u32 s5, s5, s3
    s_lshl_b32 s5, s5, 15
    s_add_u32 s4, s4, s5
    s_add_u32 s16, s4, 71303168
    s_lshl_b32 s4, s31, 17
    s_lshl_b32 s5, s30, 12
    s_add_u32 s4, s4, s5
    s_add_u32 s29, s4, 117440512
    s_ff1_i32_b64 s32, s[80:81]
    s_mov_b32 s36, 0
    v_lshrrev_b32 v218, 4, v0
    v_lshlrev_b32 v218, 13, v218
    v_and_b32 v219, 15, v0
    v_lshlrev_b32 v219, 4, v219
    v_add_u32 v218, v218, v219
    v_add_u32 v218, 7936, v218
Le3ds_217:
    buffer_load_dword v219, v218, s[8:11], s16 offen sc1
    s_waitcnt vmcnt(0)
    v_cmp_eq_u32 vcc, -1, v219
    s_cbranch_vccz Le3df_219
    s_sleep 2
    s_sub_u32 s22, s22, 1
    s_cbranch_scc0 Le3ds_217
    s_branch L_abort
Le3df_219:
    s_mov_b32 s35, s16
    buffer_load_dwordx4 v[32:35], v205, s[8:11], s35 offen offset:0 sc1
    buffer_load_dwordx4 v[36:39], v205, s[8:11], s35 offen offset:256 sc1
    s_add_u32 s35, s35, 2048
    buffer_load_dwordx4 v[40:43], v205, s[8:11], s35 offen offset:0 sc1
    buffer_load_dwordx4 v[44:47], v205, s[8:11], s35 offen offset:256 sc1
    s_add_u32 s35, s35, 2048
    buffer_load_dwordx4 v[48:51], v205, s[8:11], s35 offen offset:0 sc1
    buffer_load_dwordx4 v[52:55], v205, s[8:11], s35 offen offset:256 sc1
    s_add_u32 s35, s35, 2048
    buffer_load_dwordx4 v[56:59], v205, s[8:11], s35 offen offset:0 sc1
    buffer_load_dwordx4 v[60:63], v205, s[8:11], s35 offen offset:256 sc1
    s_add_u32 s35, s35, 2048
    buffer_load_dwordx4 v[64:67], v205, s[8:11], s35 offen offset:0 sc1
    buffer_load_dwordx4 v[68:71], v205, s[8:11], s35 offen offset:256 sc1
    s_add_u32 s35, s35, 2048
    buffer_load_dwordx4 v[72:75], v205, s[8:11], s35 offen offset:0 sc1
    buffer_load_dwordx4 v[76:79], v205, s[8:11], s35 offen offset:256 sc1
    s_add_u32 s35, s35, 2048
    buffer_load_dwordx4 v[80:83], v205, s[8:11], s35 offen offset:0 sc1
    buffer_load_dwordx4 v[84:87], v205, s[8:11], s35 offen offset:256 sc1
    s_add_u32 s35, s35, 2048
    buffer_load_dwordx4 v[88:91], v205, s[8:11], s35 offen offset:0 sc1
    buffer_load_dwordx4 v[92:95], v205, s[8:11], s35 offen offset:256 sc1
    s_add_u32 s35, s35, 2048
    buffer_load_dwordx4 v[96:99], v205, s[8:11], s35 offen offset:0 sc1
    buffer_load_dwordx4 v[100:103], v205, s[8:11], s35 offen offset:256 sc1
    s_add_u32 s35, s35, 2048
    buffer_load_dwordx4 v[104:107], v205, s[8:11], s35 offen offset:0 sc1
    buffer_load_dwordx4 v[108:111], v205, s[8:11], s35 offen offset:256 sc1
    s_add_u32 s35, s35, 2048
    buffer_load_dwordx4 v[112:115], v205, s[8:11], s35 offen offset:0 sc1
    buffer_load_dwordx4 v[116:119], v205, s[8:11], s35 offen offset:256 sc1
    s_add_u32 s35, s35, 2048
    buffer_load_dwordx4 v[120:123], v205, s[8:11], s35 offen offset:0 sc1
    buffer_load_dwordx4 v[124:127], v205, s[8:11], s35 offen offset:256 sc1
    s_add_u32 s35, s35, 2048
    buffer_load_dwordx4 v[128:131], v205, s[8:11], s35 offen offset:0 sc1
    buffer_load_dwordx4 v[132:135], v205, s[8:11], s35 offen offset:256 sc1
    s_add_u32 s35, s35, 2048
    buffer_load_dwordx4 v[136:139], v205, s[8:11], s35 offen offset:0 sc1
    buffer_load_dwordx4 v[140:143], v205, s[8:11], s35 offen offset:256 sc1
    s_add_u32 s35, s35, 2048
    buffer_load_dwordx4 v[144:147], v205, s[8:11], s35 offen offset:0 sc1
    buffer_load_dwordx4 v[148:151], v205, s[8:11], s35 offen offset:256 sc1
    s_add_u32 s35, s35, 2048
    buffer_load_dwordx4 v[152:155], v205, s[8:11], s35 offen offset:0 sc1
    buffer_load_dwordx4 v[156:159], v205, s[8:11], s35 offen offset:256 sc1
    v_mov_b32 v219, 0
    s_waitcnt vmcnt(30)
    v_mfma_f32_16x16x32_bf16 v[160:163], a[0:3], v[32:35], 0
    v_max3_u32 v219, v219, v32, v33
    v_mfma_f32_16x16x32_bf16 v[168:171], a[0:3], v[36:39], 0
    v_max3_u32 v219, v219, v34, v35
    v_mfma_f32_16x16x32_bf16 v[164:167], a[4:7], v[32:35], 0
    v_max3_u32 v219, v219, v36, v37
    v_mfma_f32_16x16x32_bf16 v[172:175], a[4:7], v[36:39], 0
    v_max3_u32 v219, v219, v38, v39
    v_mfma_f32_16x16x32_bf16 v[176:179], a[8:11], v[32:35], 0
    v_mfma_f32_16x16x32_bf16 v[184:187], a[8:11], v[36:39], 0
    v_mfma_f32_16x16x32_bf16 v[180:183], a[12:15], v[32:35], 0
    v_mfma_f32_16x16x32_bf16 v[188:191], a[12:15], v[36:39], 0
    s_waitcnt vmcnt(28)
    v_mfma_f32_16x16x32_bf16 v[160:163], a[16:19], v[40:43], v[160:163]
    v_max3_u32 v219, v219, v40, v41
    v_mfma_f32_16x16x32_bf16 v[168:171], a[16:19], v[44:47], v[168:171]
    v_max3_u32 v219, v219, v42, v43
    v_mfma_f32_16x16x32_bf16 v[164:167], a[20:23], v[40:43], v[164:167]
    v_max3_u32 v219, v219, v44, v45
    v_mfma_f32_16x16x32_bf16 v[172:175], a[20:23], v[44:47], v[172:175]
    v_max3_u32 v219, v219, v46, v47
    v_mfma_f32_16x16x32_bf16 v[176:179], a[24:27], v[40:43], v[176:179]
    v_mfma_f32_16x16x32_bf16 v[184:187], a[24:27], v[44:47], v[184:187]
    v_mfma_f32_16x16x32_bf16 v[180:183], a[28:31], v[40:43], v[180:183]
    v_mfma_f32_16x16x32_bf16 v[188:191], a[28:31], v[44:47], v[188:191]
    s_waitcnt vmcnt(26)
    v_mfma_f32_16x16x32_bf16 v[160:163], a[32:35], v[48:51], v[160:163]
    v_max3_u32 v219, v219, v48, v49
    v_mfma_f32_16x16x32_bf16 v[168:171], a[32:35], v[52:55], v[168:171]
    v_max3_u32 v219, v219, v50, v51
    v_mfma_f32_16x16x32_bf16 v[164:167], a[36:39], v[48:51], v[164:167]
    v_max3_u32 v219, v219, v52, v53
    v_mfma_f32_16x16x32_bf16 v[172:175], a[36:39], v[52:55], v[172:175]
    v_max3_u32 v219, v219, v54, v55
    v_mfma_f32_16x16x32_bf16 v[176:179], a[40:43], v[48:51], v[176:179]
    v_mfma_f32_16x16x32_bf16 v[184:187], a[40:43], v[52:55], v[184:187]
    v_mfma_f32_16x16x32_bf16 v[180:183], a[44:47], v[48:51], v[180:183]
    v_mfma_f32_16x16x32_bf16 v[188:191], a[44:47], v[52:55], v[188:191]
    s_waitcnt vmcnt(24)
    v_mfma_f32_16x16x32_bf16 v[160:163], a[48:51], v[56:59], v[160:163]
    v_max3_u32 v219, v219, v56, v57
    v_mfma_f32_16x16x32_bf16 v[168:171], a[48:51], v[60:63], v[168:171]
    v_max3_u32 v219, v219, v58, v59
    v_mfma_f32_16x16x32_bf16 v[164:167], a[52:55], v[56:59], v[164:167]
    v_max3_u32 v219, v219, v60, v61
    v_mfma_f32_16x16x32_bf16 v[172:175], a[52:55], v[60:63], v[172:175]
    v_max3_u32 v219, v219, v62, v63
    v_mfma_f32_16x16x32_bf16 v[176:179], a[56:59], v[56:59], v[176:179]
    v_mfma_f32_16x16x32_bf16 v[184:187], a[56:59], v[60:63], v[184:187]
    v_mfma_f32_16x16x32_bf16 v[180:183], a[60:63], v[56:59], v[180:183]
    v_mfma_f32_16x16x32_bf16 v[188:191], a[60:63], v[60:63], v[188:191]
    s_waitcnt vmcnt(22)
    v_mfma_f32_16x16x32_bf16 v[160:163], a[64:67], v[64:67], v[160:163]
    v_max3_u32 v219, v219, v64, v65
    v_mfma_f32_16x16x32_bf16 v[168:171], a[64:67], v[68:71], v[168:171]
    v_max3_u32 v219, v219, v66, v67
    v_mfma_f32_16x16x32_bf16 v[164:167], a[68:71], v[64:67], v[164:167]
    v_max3_u32 v219, v219, v68, v69
    v_mfma_f32_16x16x32_bf16 v[172:175], a[68:71], v[68:71], v[172:175]
    v_max3_u32 v219, v219, v70, v71
    v_mfma_f32_16x16x32_bf16 v[176:179], a[72:75], v[64:67], v[176:179]
    v_mfma_f32_16x16x32_bf16 v[184:187], a[72:75], v[68:71], v[184:187]
    v_mfma_f32_16x16x32_bf16 v[180:183], a[76:79], v[64:67], v[180:183]
    v_mfma_f32_16x16x32_bf16 v[188:191], a[76:79], v[68:71], v[188:191]
    s_waitcnt vmcnt(20)
    v_mfma_f32_16x16x32_bf16 v[160:163], a[80:83], v[72:75], v[160:163]
    v_max3_u32 v219, v219, v72, v73
    v_mfma_f32_16x16x32_bf16 v[168:171], a[80:83], v[76:79], v[168:171]
    v_max3_u32 v219, v219, v74, v75
    v_mfma_f32_16x16x32_bf16 v[164:167], a[84:87], v[72:75], v[164:167]
    v_max3_u32 v219, v219, v76, v77
    v_mfma_f32_16x16x32_bf16 v[172:175], a[84:87], v[76:79], v[172:175]
    v_max3_u32 v219, v219, v78, v79
    v_mfma_f32_16x16x32_bf16 v[176:179], a[88:91], v[72:75], v[176:179]
    v_mfma_f32_16x16x32_bf16 v[184:187], a[88:91], v[76:79], v[184:187]
    v_mfma_f32_16x16x32_bf16 v[180:183], a[92:95], v[72:75], v[180:183]
    v_mfma_f32_16x16x32_bf16 v[188:191], a[92:95], v[76:79], v[188:191]
    s_waitcnt vmcnt(18)
    v_mfma_f32_16x16x32_bf16 v[160:163], a[96:99], v[80:83], v[160:163]
    v_max3_u32 v219, v219, v80, v81
    v_mfma_f32_16x16x32_bf16 v[168:171], a[96:99], v[84:87], v[168:171]
    v_max3_u32 v219, v219, v82, v83
    v_mfma_f32_16x16x32_bf16 v[164:167], a[100:103], v[80:83], v[164:167]
    v_max3_u32 v219, v219, v84, v85
    v_mfma_f32_16x16x32_bf16 v[172:175], a[100:103], v[84:87], v[172:175]
    v_max3_u32 v219, v219, v86, v87
    v_mfma_f32_16x16x32_bf16 v[176:179], a[104:107], v[80:83], v[176:179]
    v_mfma_f32_16x16x32_bf16 v[184:187], a[104:107], v[84:87], v[184:187]
    v_mfma_f32_16x16x32_bf16 v[180:183], a[108:111], v[80:83], v[180:183]
    v_mfma_f32_16x16x32_bf16 v[188:191], a[108:111], v[84:87], v[188:191]
    s_waitcnt vmcnt(16)
    v_mfma_f32_16x16x32_bf16 v[160:163], a[112:115], v[88:91], v[160:163]
    v_max3_u32 v219, v219, v88, v89
    v_mfma_f32_16x16x32_bf16 v[168:171], a[112:115], v[92:95], v[168:171]
    v_max3_u32 v219, v219, v90, v91
    v_mfma_f32_16x16x32_bf16 v[164:167], a[116:119], v[88:91], v[164:167]
    v_max3_u32 v219, v219, v92, v93
    v_mfma_f32_16x16x32_bf16 v[172:175], a[116:119], v[92:95], v[172:175]
    v_max3_u32 v219, v219, v94, v95
    v_mfma_f32_16x16x32_bf16 v[176:179], a[120:123], v[88:91], v[176:179]
    v_mfma_f32_16x16x32_bf16 v[184:187], a[120:123], v[92:95], v[184:187]
    v_mfma_f32_16x16x32_bf16 v[180:183], a[124:127], v[88:91], v[180:183]
    v_mfma_f32_16x16x32_bf16 v[188:191], a[124:127], v[92:95], v[188:191]
    s_waitcnt vmcnt(14)
    v_mfma_f32_16x16x32_bf16 v[160:163], a[128:131], v[96:99], v[160:163]
    v_max3_u32 v219, v219, v96, v97
    v_mfma_f32_16x16x32_bf16 v[168:171], a[128:131], v[100:103], v[168:171]
    v_max3_u32 v219, v219, v98, v99
    v_mfma_f32_16x16x32_bf16 v[164:167], a[132:135], v[96:99], v[164:167]
    v_max3_u32 v219, v219, v100, v101
    v_mfma_f32_16x16x32_bf16 v[172:175], a[132:135], v[100:103], v[172:175]
    v_max3_u32 v219, v219, v102, v103
    v_mfma_f32_16x16x32_bf16 v[176:179], a[136:139], v[96:99], v[176:179]
    v_mfma_f32_16x16x32_bf16 v[184:187], a[136:139], v[100:103], v[184:187]
    v_mfma_f32_16x16x32_bf16 v[180:183], a[140:143], v[96:99], v[180:183]
    v_mfma_f32_16x16x32_bf16 v[188:191], a[140:143], v[100:103], v[188:191]
    s_waitcnt vmcnt(12)
    v_mfma_f32_16x16x32_bf16 v[160:163], a[144:147], v[104:107], v[160:163]
    v_max3_u32 v219, v219, v104, v105
    v_mfma_f32_16x16x32_bf16 v[168:171], a[144:147], v[108:111], v[168:171]
    v_max3_u32 v219, v219, v106, v107
    v_mfma_f32_16x16x32_bf16 v[164:167], a[148:151], v[104:107], v[164:167]
    v_max3_u32 v219, v219, v108, v109
    v_mfma_f32_16x16x32_bf16 v[172:175], a[148:151], v[108:111], v[172:175]
    v_max3_u32 v219, v219, v110, v111
    v_mfma_f32_16x16x32_bf16 v[176:179], a[152:155], v[104:107], v[176:179]
    v_mfma_f32_16x16x32_bf16 v[184:187], a[152:155], v[108:111], v[184:187]
    v_mfma_f32_16x16x32_bf16 v[180:183], a[156:159], v[104:107], v[180:183]
    v_mfma_f32_16x16x32_bf16 v[188:191], a[156:159], v[108:111], v[188:191]
    s_waitcnt vmcnt(10)
    v_mfma_f32_16x16x32_bf16 v[160:163], a[160:163], v[112:115], v[160:163]
    v_max3_u32 v219, v219, v112, v113
    v_mfma_f32_16x16x32_bf16 v[168:171], a[160:163], v[116:119], v[168:171]
    v_max3_u32 v219, v219, v114, v115
    v_mfma_f32_16x16x32_bf16 v[164:167], a[164:167], v[112:115], v[164:167]
    v_max3_u32 v219, v219, v116, v117
    v_mfma_f32_16x16x32_bf16 v[172:175], a[164:167], v[116:119], v[172:175]
    v_max3_u32 v219, v219, v118, v119
    v_mfma_f32_16x16x32_bf16 v[176:179], a[168:171], v[112:115], v[176:179]
    v_mfma_f32_16x16x32_bf16 v[184:187], a[168:171], v[116:119], v[184:187]
    v_mfma_f32_16x16x32_bf16 v[180:183], a[172:175], v[112:115], v[180:183]
    v_mfma_f32_16x16x32_bf16 v[188:191], a[172:175], v[116:119], v[188:191]
    s_waitcnt vmcnt(8)
    v_mfma_f32_16x16x32_bf16 v[160:163], a[176:179], v[120:123], v[160:163]
    v_max3_u32 v219, v219, v120, v121
    v_mfma_f32_16x16x32_bf16 v[168:171], a[176:179], v[124:127], v[168:171]
    v_max3_u32 v219, v219, v122, v123
    v_mfma_f32_16x16x32_bf16 v[164:167], a[180:183], v[120:123], v[164:167]
    v_max3_u32 v219, v219, v124, v125
    v_mfma_f32_16x16x32_bf16 v[172:175], a[180:183], v[124:127], v[172:175]
    v_max3_u32 v219, v219, v126, v127
    v_mfma_f32_16x16x32_bf16 v[176:179], a[184:187], v[120:123], v[176:179]
    v_mfma_f32_16x16x32_bf16 v[184:187], a[184:187], v[124:127], v[184:187]
    v_mfma_f32_16x16x32_bf16 v[180:183], a[188:191], v[120:123], v[180:183]
    v_mfma_f32_16x16x32_bf16 v[188:191], a[188:191], v[124:127], v[188:191]
    s_waitcnt vmcnt(6)
    v_mfma_f32_16x16x32_bf16 v[160:163], a[192:195], v[128:131], v[160:163]
    v_max3_u32 v219, v219, v128, v129
    v_mfma_f32_16x16x32_bf16 v[168:171], a[192:195], v[132:135], v[168:171]
    v_max3_u32 v219, v219, v130, v131
    v_mfma_f32_16x16x32_bf16 v[164:167], a[196:199], v[128:131], v[164:167]
    v_max3_u32 v219, v219, v132, v133
    v_mfma_f32_16x16x32_bf16 v[172:175], a[196:199], v[132:135], v[172:175]
    v_max3_u32 v219, v219, v134, v135
    v_mfma_f32_16x16x32_bf16 v[176:179], a[200:203], v[128:131], v[176:179]
    v_mfma_f32_16x16x32_bf16 v[184:187], a[200:203], v[132:135], v[184:187]
    v_mfma_f32_16x16x32_bf16 v[180:183], a[204:207], v[128:131], v[180:183]
    v_mfma_f32_16x16x32_bf16 v[188:191], a[204:207], v[132:135], v[188:191]
    s_waitcnt vmcnt(4)
    v_mfma_f32_16x16x32_bf16 v[160:163], a[208:211], v[136:139], v[160:163]
    v_max3_u32 v219, v219, v136, v137
    v_mfma_f32_16x16x32_bf16 v[168:171], a[208:211], v[140:143], v[168:171]
    v_max3_u32 v219, v219, v138, v139
    v_mfma_f32_16x16x32_bf16 v[164:167], a[212:215], v[136:139], v[164:167]
    v_max3_u32 v219, v219, v140, v141
    v_mfma_f32_16x16x32_bf16 v[172:175], a[212:215], v[140:143], v[172:175]
    v_max3_u32 v219, v219, v142, v143
    v_mfma_f32_16x16x32_bf16 v[176:179], a[216:219], v[136:139], v[176:179]
    v_mfma_f32_16x16x32_bf16 v[184:187], a[216:219], v[140:143], v[184:187]
    v_mfma_f32_16x16x32_bf16 v[180:183], a[220:223], v[136:139], v[180:183]
    v_mfma_f32_16x16x32_bf16 v[188:191], a[220:223], v[140:143], v[188:191]
    s_waitcnt vmcnt(2)
    v_mfma_f32_16x16x32_bf16 v[160:163], a[224:227], v[144:147], v[160:163]
    v_max3_u32 v219, v219, v144, v145
    v_mfma_f32_16x16x32_bf16 v[168:171], a[224:227], v[148:151], v[168:171]
    v_max3_u32 v219, v219, v146, v147
    v_mfma_f32_16x16x32_bf16 v[164:167], a[228:231], v[144:147], v[164:167]
    v_max3_u32 v219, v219, v148, v149
    v_mfma_f32_16x16x32_bf16 v[172:175], a[228:231], v[148:151], v[172:175]
    v_max3_u32 v219, v219, v150, v151
    v_mfma_f32_16x16x32_bf16 v[176:179], a[232:235], v[144:147], v[176:179]
    v_mfma_f32_16x16x32_bf16 v[184:187], a[232:235], v[148:151], v[184:187]
    v_mfma_f32_16x16x32_bf16 v[180:183], a[236:239], v[144:147], v[180:183]
    v_mfma_f32_16x16x32_bf16 v[188:191], a[236:239], v[148:151], v[188:191]
    s_waitcnt vmcnt(0)
    v_mfma_f32_16x16x32_bf16 v[160:163], a[240:243], v[152:155], v[160:163]
    v_max3_u32 v219, v219, v152, v153
    v_mfma_f32_16x16x32_bf16 v[168:171], a[240:243], v[156:159], v[168:171]
    v_max3_u32 v219, v219, v154, v155
    v_mfma_f32_16x16x32_bf16 v[164:167], a[244:247], v[152:155], v[164:167]
    v_max3_u32 v219, v219, v156, v157
    v_mfma_f32_16x16x32_bf16 v[172:175], a[244:247], v[156:159], v[172:175]
    v_max3_u32 v219, v219, v158, v159
    v_mfma_f32_16x16x32_bf16 v[176:179], a[248:251], v[152:155], v[176:179]
    v_mfma_f32_16x16x32_bf16 v[184:187], a[248:251], v[156:159], v[184:187]
    v_mfma_f32_16x16x32_bf16 v[180:183], a[252:255], v[152:155], v[180:183]
    v_mfma_f32_16x16x32_bf16 v[188:191], a[252:255], v[156:159], v[188:191]
    v_cmp_eq_u32 vcc, -1, v219
    s_cbranch_vccz L_e3red
    s_sub_u32 s22, s22, 1
    s_cbranch_scc0 Le3df_219
    s_branch L_abort
Le3r_211:
    s_sub_u32 s22, s22, 1
    s_cbranch_scc1 L_abort
    buffer_load_dwordx4 v[200:203], v204, s[8:11], s39 offen sc1
    s_waitcnt vmcnt(0)
    s_branch Le3f_210
Le3n_208:
    buffer_store_dword v24, v26, s[8:11], 0 offen
    s_branch Le3d_209
Le3r_213:
    s_sub_u32 s22, s22, 1
    s_cbranch_scc1 L_abort
    buffer_load_dwordx4 v[200:203], v204, s[8:11], s39 offen sc1
    s_waitcnt vmcnt(0)
    s_branch Le3f_212
Le3r_221:
    s_sub_u32 s22, s22, 1
    s_cbranch_scc1 L_abort
    buffer_load_dwordx4 v[200:203], v204, s[8:11], s39 offen sc1
    s_waitcnt vmcnt(0)
    s_branch Le3f_220
L_e3end:
L_p2end:
    s_branch L_exit
L_abort:
L_exit:
    s_endpgm

.section .rodata,"a"
.p2align 6
.amdhsa_kernel recurrent_scan__memory_aug_recurrent_mem_tr__glu_gated_reglu__prompt_kernel
  .amdhsa_next_free_vgpr 512
  .amdhsa_next_free_sgpr 102
  .amdhsa_accum_offset 256
  .amdhsa_group_segment_fixed_size 0
  .amdhsa_kernarg_size 112
  .amdhsa_user_sgpr_count 2
  .amdhsa_user_sgpr_kernarg_segment_ptr 1
  .amdhsa_system_sgpr_workgroup_id_x 1
.end_amdhsa_kernel
```
